```python
import torch

def _softmax(x, axis=-1):
    return torch.softmax(x, dim=axis)

def _gelu(x):
    return torch.nn.functional.gelu(x, approximate='tanh')

def _silu(x):
    return torch.nn.functional.silu(x)

def _sigmoid(x):
    return torch.sigmoid(x)

def _layernorm(x, axis=-1, eps=1e-05):
    m = x.mean(dim=axis, keepdim=True)
    v = x.var(dim=axis, keepdim=True, unbiased=False)
    return (x - m) / torch.sqrt(v + eps)

def _scatter_add(tgt, idx, src, axis=0):
    return tgt.clone().index_add_(axis, idx, src)

def _segment_sum(src, seg, n):
    out = torch.zeros((n,) + src.shape[1:], dtype=src.dtype)
    return out.index_add_(0, seg, src)

def _pad(x, pw):
    flat = tuple((v for pair in reversed(pw) for v in pair))
    return torch.nn.functional.pad(x, flat)
kernel_name = 'interleave_layers__memory_aug_recurrent_mem_tr__swiglu_ffn__prompt'

def setup_inputs():

    _w = lambda a: (lambda t: t.to(torch.bfloat16) if t.is_floating_point() else t)(torch.as_tensor(a))

    def _A_setup():
        B, S, Dm = (1, 2048, 512)
        H, Dh = (32, 128)
        M, seg = (8, 32)
        seg = min(seg, S)
        S = S // seg * seg
        return {'x': _w((lambda *s: torch.randn(*s, dtype=torch.bfloat16) * 0.05)(B, S, Dm)), 'mem0': _w((lambda *s: torch.randn(*s, dtype=torch.bfloat16) * 0.8)(B, M, Dm)), 'Wq': _w((lambda *s: torch.randn(*s, dtype=torch.bfloat16) * 0.8)(Dm, H, Dh) * Dm ** (-0.5)), 'Wk': _w((lambda *s: torch.randn(*s, dtype=torch.bfloat16) * 0.8)(Dm, H, Dh) * Dm ** (-0.5)), 'Wv': _w((lambda *s: torch.randn(*s, dtype=torch.bfloat16) * 0.8)(Dm, H, Dh) * Dm ** (-0.5)), 'Wo': _w((lambda *s: torch.randn(*s, dtype=torch.bfloat16) * 0.8)(H, Dh, Dm) * (H * Dh) ** (-0.5)), 'seg_len': seg}
    _A_in = _A_setup()

    def _B_setup():
        B, S, D, F = (1, 2048, 512, 1376)
        return {'x': _w((lambda *s: torch.randn(*s, dtype=torch.bfloat16) * 0.05)(B, S, D)), 'w_gate': _w((lambda *s: torch.randn(*s, dtype=torch.bfloat16) * 0.05)(D, F)), 'w_up': _w((lambda *s: torch.randn(*s, dtype=torch.bfloat16) * 0.05)(D, F)), 'w_down': _w((lambda *s: torch.randn(*s, dtype=torch.bfloat16) * 0.05)(F, D))}
    _B_in = _B_setup()
    return {'A_x': _A_in['x'], 'A_mem0': _A_in['mem0'], 'A_Wq': _A_in['Wq'], 'A_Wk': _A_in['Wk'], 'A_Wv': _A_in['Wv'], 'A_Wo': _A_in['Wo'], 'A_seg_len': _A_in['seg_len'], 'B_x': _B_in['x'], 'B_w_gate': _B_in['w_gate'], 'B_w_up': _B_in['w_up'], 'B_w_down': _B_in['w_down']}

def reference(A_x, A_mem0, A_Wq, A_Wk, A_Wv, A_Wo, A_seg_len, B_x, B_w_gate, B_w_up, B_w_down):

    def _A_ref(x, mem0, Wq, Wk, Wv, Wo, seg_len):
        B, S, Dm = x.shape
        H, Dh = (Wq.shape[1], Wq.shape[2])
        M = mem0.shape[1]
        scale = Dh ** (-0.5)
        n_seg = S // seg_len
        L = M + seg_len
        idx = torch.arange(L)
        mask = (idx[:, None] < M) | (idx[:, None] >= idx[None, :])
        mem = mem0
        outs = []
        for s in range(n_seg):
            xs = x[:, s * seg_len:(s + 1) * seg_len, :].clone()
            h = torch.concatenate([mem, xs], axis=1)
            q = torch.einsum('btd,dhe->bhte', h, Wq)
            k = torch.einsum('btd,dhe->bhte', h, Wk)
            v = torch.einsum('btd,dhe->bhte', h, Wv)
            scores = torch.einsum('bhqe,bhke->bhqk', q, k) * scale
            scores = torch.where(mask[None, None], scores, -1000000000.0)
            p = _softmax(scores, axis=-1)
            o = torch.einsum('bhqk,bhke->bhqe', p, v)
            o = torch.einsum('bhte,hed->btd', o, Wo)
            mem = o[:, :M, :].clone()
            outs.append(o[:, M:, :])
        return torch.concatenate(outs, axis=1)

    def _B_ref(x, w_gate, w_up, w_down):
        g = _silu(x @ w_gate)
        u = x @ w_up
        return g * u @ w_down
    x = A_x
    x = x + _A_ref(_layernorm(x, axis=-1), A_mem0, A_Wq, A_Wk, A_Wv, A_Wo, A_seg_len)
    x = x + _B_ref(_layernorm(x, axis=-1), B_w_gate, B_w_up, B_w_down)
    x = x + _A_ref(_layernorm(x, axis=-1), A_mem0, A_Wq, A_Wk, A_Wv, A_Wo, A_seg_len)
    x = x + _B_ref(_layernorm(x, axis=-1), B_w_gate, B_w_up, B_w_down)
    return x
```

```asm
; @launch grid=(256,1,1) block=(256,1,1) lds=163840
.amdgcn_target "amdgcn-amd-amdhsa--gfx950"
.text
.globl interleave_layers__memory_aug_recurrent_mem_tr__swiglu_ffn__prompt_kernel
.p2align 8
.type interleave_layers__memory_aug_recurrent_mem_tr__swiglu_ffn__prompt_kernel,@function
interleave_layers__memory_aug_recurrent_mem_tr__swiglu_ffn__prompt_kernel:
    s_cmp_ge_u32 s2, 256
    s_cbranch_scc1 L_exit
    s_load_dwordx16 s[4:19], s[0:1], 0
    s_load_dwordx8 s[20:27], s[0:1], 64
    s_load_dwordx4 s[28:31], s[0:1], 96
    v_and_b32 v1, 63, v0
    v_lshrrev_b32 v2, 6, v0
    s_nop 0
    v_readfirstlane_b32 s56, v2
    s_getreg_b32 s57, hwreg(HW_REG_XCC_ID)
    s_and_b32 s57, s57, 7
    s_mov_b32 s99, 0
    s_mov_b32 s58, 0
    s_waitcnt lgkmcnt(0)
    s_mov_b32 s32, s30
    s_and_b32 s33, s31, 0xffff
    s_mov_b32 s34, 0x10000000
    s_mov_b32 s35, 0x20000
    s_mov_b32 s36, s28
    s_and_b32 s37, s29, 0xffff
    s_mov_b32 s38, 0x100
    s_mov_b32 s39, 0x20000
    s_mov_b32 s52, s4
    s_and_b32 s53, s5, 0xffff
    s_mov_b32 s54, 0x200000
    s_mov_b32 s55, 0x20000
    s_lshl_b32 s3, s57, 2
    v_mov_b32 v4, s3
    v_mov_b32 v3, 1
    s_cmp_lg_u32 s56, 0
    s_cbranch_scc1 Lc_1
    s_mov_b64 exec, 1
    buffer_atomic_add v3, v4, s[36:39], 0 offen sc0
    s_mov_b64 exec, -1
Lc_1:
    s_lshl_b32 s3, s2, 3
    s_lshl_b32 s61, s56, 1
    s_add_u32 s3, s3, s61
    s_lshl_b32 s3, s3, 10
    v_lshlrev_b32 v5, 4, v1
    v_add_u32 v6, s3, v5
    buffer_load_dwordx4 v[8:11], v6, s[52:55], 0 offen
    buffer_load_dwordx4 v[12:15], v6, s[52:55], 0 offen offset:1024
    v_mov_b32 v16, 0
    v_mov_b32 v17, 0
    v_mov_b32 v18, 0
    v_mov_b32 v19, 0
    v_mov_b32 v20, -1
    v_mov_b32 v21, -1
    v_mov_b32 v22, -1
    v_mov_b32 v23, -1
    v_lshlrev_b32 v7, 4, v0
    s_lshl_b32 s61, s2, 13
    s_add_u32 s61, s61, 0x8c00000
    buffer_store_dwordx4 v[20:23], v7, s[32:35], s61 offen sc1
    s_add_u32 s61, s61, 4096
    buffer_store_dwordx4 v[20:23], v7, s[32:35], s61 offen sc1
    s_cmp_lg_u32 s56, 1
    s_cbranch_scc1 Lc_2
    s_lshl_b32 s61, s2, 10
    s_add_u32 s61, s61, 0x9000000
    buffer_store_dwordx4 v[16:19], v5, s[32:35], s61 offen sc1
    s_lshl_b32 s61, s2, 7
    s_add_u32 s61, s61, 0x8e00000
    s_mov_b64 exec, 0xff
    buffer_store_dwordx4 v[20:23], v5, s[32:35], s61 offen sc1
    s_mov_b64 exec, -1
Lc_2:
    s_waitcnt vmcnt(0)
    s_cmp_lg_u32 s56, 0
    s_cbranch_scc1 Lc_3
    v_mov_b32 v4, 0
    s_mov_b64 exec, 1
    ds_write_b32 v4, v3
    s_mov_b64 exec, -1
Lc_3:
    v_lshlrev_b32 v24, 16, v8
    v_and_b32 v25, 0xffff0000, v8
    v_lshlrev_b32 v26, 16, v9
    v_and_b32 v27, 0xffff0000, v9
    v_lshlrev_b32 v28, 16, v10
    v_and_b32 v29, 0xffff0000, v10
    v_lshlrev_b32 v30, 16, v11
    v_and_b32 v31, 0xffff0000, v11
    v_lshlrev_b32 v32, 16, v12
    v_and_b32 v33, 0xffff0000, v12
    v_lshlrev_b32 v34, 16, v13
    v_and_b32 v35, 0xffff0000, v13
    v_lshlrev_b32 v36, 16, v14
    v_and_b32 v37, 0xffff0000, v14
    v_lshlrev_b32 v38, 16, v15
    v_and_b32 v39, 0xffff0000, v15
    v_add_f32 v40, v24, v25
    v_add_f32 v40, v40, v26
    v_add_f32 v40, v40, v27
    v_add_f32 v40, v40, v28
    v_add_f32 v40, v40, v29
    v_add_f32 v40, v40, v30
    v_add_f32 v40, v40, v31
    v_add_f32 v41, v32, v33
    v_add_f32 v41, v41, v34
    v_add_f32 v41, v41, v35
    v_add_f32 v41, v41, v36
    v_add_f32 v41, v41, v37
    v_add_f32 v41, v41, v38
    v_add_f32 v41, v41, v39
    v_add_f32 v40, v40, v40 row_ror:8 row_mask:0xf bank_mask:0xf
    s_nop 1
    v_add_f32 v40, v40, v40 row_ror:4 row_mask:0xf bank_mask:0xf
    s_nop 1
    v_add_f32 v40, v40, v40 row_ror:2 row_mask:0xf bank_mask:0xf
    s_nop 1
    v_add_f32 v40, v40, v40 row_ror:1 row_mask:0xf bank_mask:0xf
    v_add_f32 v41, v41, v41 row_ror:8 row_mask:0xf bank_mask:0xf
    s_nop 1
    v_add_f32 v41, v41, v41 row_ror:4 row_mask:0xf bank_mask:0xf
    s_nop 1
    v_add_f32 v41, v41, v41 row_ror:2 row_mask:0xf bank_mask:0xf
    s_nop 1
    v_add_f32 v41, v41, v41 row_ror:1 row_mask:0xf bank_mask:0xf
    v_mov_b32 v42, v40
    s_nop 1
    v_permlane16_swap_b32 v40, v42
    v_add_f32 v40, v40, v42
    v_mov_b32 v42, v40
    s_nop 1
    v_permlane32_swap_b32 v40, v42
    v_add_f32 v40, v40, v42
    v_mov_b32 v43, v41
    s_nop 1
    v_permlane16_swap_b32 v41, v43
    v_add_f32 v41, v41, v43
    v_mov_b32 v43, v41
    s_nop 1
    v_permlane32_swap_b32 v41, v43
    v_add_f32 v41, v41, v43
    v_mul_f32 v40, 0x3b000000, v40
    v_sub_f32 v24, v24, v40
    v_sub_f32 v25, v25, v40
    v_sub_f32 v26, v26, v40
    v_sub_f32 v27, v27, v40
    v_sub_f32 v28, v28, v40
    v_sub_f32 v29, v29, v40
    v_sub_f32 v30, v30, v40
    v_sub_f32 v31, v31, v40
    v_mul_f32 v44, v24, v24
    v_fmac_f32 v44, v25, v25
    v_fmac_f32 v44, v26, v26
    v_fmac_f32 v44, v27, v27
    v_fmac_f32 v44, v28, v28
    v_fmac_f32 v44, v29, v29
    v_fmac_f32 v44, v30, v30
    v_fmac_f32 v44, v31, v31
    v_mul_f32 v41, 0x3b000000, v41
    v_sub_f32 v32, v32, v41
    v_sub_f32 v33, v33, v41
    v_sub_f32 v34, v34, v41
    v_sub_f32 v35, v35, v41
    v_sub_f32 v36, v36, v41
    v_sub_f32 v37, v37, v41
    v_sub_f32 v38, v38, v41
    v_sub_f32 v39, v39, v41
    v_mul_f32 v45, v32, v32
    v_fmac_f32 v45, v33, v33
    v_fmac_f32 v45, v34, v34
    v_fmac_f32 v45, v35, v35
    v_fmac_f32 v45, v36, v36
    v_fmac_f32 v45, v37, v37
    v_fmac_f32 v45, v38, v38
    v_fmac_f32 v45, v39, v39
    v_add_f32 v44, v44, v44 row_ror:8 row_mask:0xf bank_mask:0xf
    s_nop 1
    v_add_f32 v44, v44, v44 row_ror:4 row_mask:0xf bank_mask:0xf
    s_nop 1
    v_add_f32 v44, v44, v44 row_ror:2 row_mask:0xf bank_mask:0xf
    s_nop 1
    v_add_f32 v44, v44, v44 row_ror:1 row_mask:0xf bank_mask:0xf
    v_add_f32 v45, v45, v45 row_ror:8 row_mask:0xf bank_mask:0xf
    s_nop 1
    v_add_f32 v45, v45, v45 row_ror:4 row_mask:0xf bank_mask:0xf
    s_nop 1
    v_add_f32 v45, v45, v45 row_ror:2 row_mask:0xf bank_mask:0xf
    s_nop 1
    v_add_f32 v45, v45, v45 row_ror:1 row_mask:0xf bank_mask:0xf
    v_mov_b32 v42, v44
    s_nop 1
    v_permlane16_swap_b32 v44, v42
    v_add_f32 v44, v44, v42
    v_mov_b32 v42, v44
    s_nop 1
    v_permlane32_swap_b32 v44, v42
    v_add_f32 v44, v44, v42
    v_mov_b32 v43, v45
    s_nop 1
    v_permlane16_swap_b32 v45, v43
    v_add_f32 v45, v45, v43
    v_mov_b32 v43, v45
    s_nop 1
    v_permlane32_swap_b32 v45, v43
    v_add_f32 v45, v45, v43
    v_mov_b32 v46, 0x3727c5ac
    v_mov_b32 v42, v46
    v_fmac_f32 v42, 0x3b000000, v44
    v_rsq_f32 v42, v42
    s_nop 0
    v_mul_f32 v24, v24, v42
    v_mul_f32 v25, v25, v42
    v_mul_f32 v26, v26, v42
    v_mul_f32 v27, v27, v42
    v_mul_f32 v28, v28, v42
    v_mul_f32 v29, v29, v42
    v_mul_f32 v30, v30, v42
    v_mul_f32 v31, v31, v42
    v_cvt_pk_bf16_f32 v8, v24, v25
    v_cvt_pk_bf16_f32 v9, v26, v27
    v_cvt_pk_bf16_f32 v10, v28, v29
    v_cvt_pk_bf16_f32 v11, v30, v31
    v_mov_b32 v43, v46
    v_fmac_f32 v43, 0x3b000000, v45
    v_rsq_f32 v43, v43
    s_nop 0
    v_mul_f32 v32, v32, v43
    v_mul_f32 v33, v33, v43
    v_mul_f32 v34, v34, v43
    v_mul_f32 v35, v35, v43
    v_mul_f32 v36, v36, v43
    v_mul_f32 v37, v37, v43
    v_mul_f32 v38, v38, v43
    v_mul_f32 v39, v39, v43
    v_cvt_pk_bf16_f32 v12, v32, v33
    v_cvt_pk_bf16_f32 v13, v34, v35
    v_cvt_pk_bf16_f32 v14, v36, v37
    v_cvt_pk_bf16_f32 v15, v38, v39
    buffer_store_dwordx4 v[8:11], v6, s[32:35], 0 offen sc1
    buffer_store_dwordx4 v[12:15], v6, s[32:35], 0 offen offset:1024 sc1
    s_waitcnt vmcnt(0) lgkmcnt(0)
    s_barrier
    v_mov_b32 v4, 0
    ds_read_b32 v3, v4
    s_cmp_lg_u32 s56, 0
    s_cbranch_scc1 Lc_4
    v_mov_b32 v4, 32
    v_mov_b32 v2, 1
    s_mov_b64 exec, 1
    buffer_atomic_add v2, v4, s[36:39], 0 offen
    s_mov_b64 exec, -1
Lc_4:
    s_waitcnt lgkmcnt(0)
    v_readfirstlane_b32 s58, v3
    s_barrier
    s_cmp_lt_u32 s58, 32
    s_cbranch_scc1 L_dispatch
    v_lshlrev_b32 v120, 2, v1
    s_cmp_lg_u32 s56, 0
    s_cbranch_scc1 Lcw_6
Lcw_5:
    buffer_load_dword v121, v120, s[36:39], 0 offen sc1
    s_add_u32 s99, s99, 1
    s_cmp_gt_u32 s99, 0x2dc6c0
    s_cbranch_scc0 Lto_7
    s_mov_b32 s3, 2
    s_branch L_abort
Lto_7:
    s_waitcnt vmcnt(0)
    v_readlane_b32 s3, v121, 8
    s_cmp_ge_u32 s3, 256
    s_cbranch_scc1 Lcw_8
    s_sleep 8
    s_branch Lcw_5
Lcw_8:
    v_readlane_b32 s3, v121, s57
    v_mov_b32 v120, 163836
    s_nop 0
    v_mov_b32 v121, s3
    ds_write_b32 v120, v121
    s_waitcnt lgkmcnt(0)
Lcw_6:
    s_barrier
    v_mov_b32 v120, 163836
    ds_read_b32 v121, v120
    s_waitcnt lgkmcnt(0)
    v_readfirstlane_b32 s3, v121
    s_cmp_lt_u32 s3, 32
    s_cselect_b32 s59, 1, 0
    s_barrier
    v_mov_b32 v4, 36
    v_mov_b32 v3, 1
    s_cmp_lg_u32 s56, 0
    s_cbranch_scc1 Lc_9
    s_mov_b64 exec, 1
    buffer_atomic_add v3, v4, s[36:39], 0 offen sc0
    s_waitcnt vmcnt(0)
    v_mov_b32 v4, 0
    ds_write_b32 v4, v3
    s_waitcnt lgkmcnt(0)
    s_mov_b64 exec, -1
Lc_9:
    s_barrier
    v_mov_b32 v4, 0
    ds_read_b32 v3, v4
    v_lshlrev_b32 v4, 2, v1
    buffer_load_dword v2, v4, s[36:39], 0 offen sc1
    s_waitcnt vmcnt(0) lgkmcnt(0)
    v_readfirstlane_b32 s61, v3
    s_barrier
    v_readlane_b32 s62, v2, 0
    s_min_u32 s62, s62, 32
    s_sub_u32 s63, 32, s62
    s_mov_b32 s57, 0
    s_add_u32 s58, s62, s61
    s_cmp_lt_u32 s61, s63
    s_cbranch_scc1 L_dispatch
    s_sub_u32 s61, s61, s63
    v_readlane_b32 s62, v2, 1
    s_min_u32 s62, s62, 32
    s_sub_u32 s63, 32, s62
    s_mov_b32 s57, 1
    s_add_u32 s58, s62, s61
    s_cmp_lt_u32 s61, s63
    s_cbranch_scc1 L_dispatch
    s_sub_u32 s61, s61, s63
    v_readlane_b32 s62, v2, 2
    s_min_u32 s62, s62, 32
    s_sub_u32 s63, 32, s62
    s_mov_b32 s57, 2
    s_add_u32 s58, s62, s61
    s_cmp_lt_u32 s61, s63
    s_cbranch_scc1 L_dispatch
    s_sub_u32 s61, s61, s63
    v_readlane_b32 s62, v2, 3
    s_min_u32 s62, s62, 32
    s_sub_u32 s63, 32, s62
    s_mov_b32 s57, 3
    s_add_u32 s58, s62, s61
    s_cmp_lt_u32 s61, s63
    s_cbranch_scc1 L_dispatch
    s_sub_u32 s61, s61, s63
    v_readlane_b32 s62, v2, 4
    s_min_u32 s62, s62, 32
    s_sub_u32 s63, 32, s62
    s_mov_b32 s57, 4
    s_add_u32 s58, s62, s61
    s_cmp_lt_u32 s61, s63
    s_cbranch_scc1 L_dispatch
    s_sub_u32 s61, s61, s63
    v_readlane_b32 s62, v2, 5
    s_min_u32 s62, s62, 32
    s_sub_u32 s63, 32, s62
    s_mov_b32 s57, 5
    s_add_u32 s58, s62, s61
    s_cmp_lt_u32 s61, s63
    s_cbranch_scc1 L_dispatch
    s_sub_u32 s61, s61, s63
    v_readlane_b32 s62, v2, 6
    s_min_u32 s62, s62, 32
    s_sub_u32 s63, 32, s62
    s_mov_b32 s57, 6
    s_add_u32 s58, s62, s61
    s_cmp_lt_u32 s61, s63
    s_cbranch_scc1 L_dispatch
    s_sub_u32 s61, s61, s63
    v_readlane_b32 s62, v2, 7
    s_min_u32 s62, s62, 32
    s_sub_u32 s63, 32, s62
    s_mov_b32 s57, 7
    s_add_u32 s58, s62, s61
    s_cmp_lt_u32 s61, s63
    s_cbranch_scc1 L_dispatch
    s_sub_u32 s61, s61, s63
    s_mov_b32 s3, 1
    s_branch L_abort
L_dispatch:
    s_nop 1
    s_cmp_eq_u32 s57, 0
    s_cbranch_scc1 L_role_ch
    s_mov_b32 s85, 0
    s_cmp_lg_u32 s57, 1
    s_cbranch_scc1 Ld_10
    s_cmp_lg_u32 s56, 0
    s_cbranch_scc1 Ldw_12
    v_mov_b32 v120, 252
    s_mov_b64 exec, 1
Ldw_11:
    buffer_load_dword v121, v120, s[36:39], 0 offen sc1
    s_add_u32 s99, s99, 1
    s_cmp_gt_u32 s99, 0x2dc6c0
    s_cbranch_scc0 Lto_13
    s_mov_b32 s3, 6
    s_branch L_abort
Lto_13:
    s_waitcnt vmcnt(0)
    v_cmp_gt_u32 vcc, 8, v121
    s_cbranch_vccz Ldw_14
    s_sleep 32
    s_branch Ldw_11
Ldw_14:
    s_mov_b64 exec, -1
Ldw_12:
    s_barrier
    v_mov_b32 v8, -1
    v_mov_b32 v9, -1
    v_mov_b32 v10, -1
    v_mov_b32 v11, -1
    v_lshlrev_b32 v4, 4, v0
    s_lshl_b32 s63, s58, 16
    s_add_u32 s62, s63, 0x400000
    buffer_store_dwordx4 v[8:11], v4, s[32:35], s62 offen sc1
    s_add_u32 s62, s63, 0x401000
    buffer_store_dwordx4 v[8:11], v4, s[32:35], s62 offen sc1
    s_add_u32 s62, s63, 0x402000
    buffer_store_dwordx4 v[8:11], v4, s[32:35], s62 offen sc1
    s_add_u32 s62, s63, 0x403000
    buffer_store_dwordx4 v[8:11], v4, s[32:35], s62 offen sc1
    s_add_u32 s62, s63, 0x404000
    buffer_store_dwordx4 v[8:11], v4, s[32:35], s62 offen sc1
    s_add_u32 s62, s63, 0x405000
    buffer_store_dwordx4 v[8:11], v4, s[32:35], s62 offen sc1
    s_add_u32 s62, s63, 0x406000
    buffer_store_dwordx4 v[8:11], v4, s[32:35], s62 offen sc1
    s_add_u32 s62, s63, 0x407000
    buffer_store_dwordx4 v[8:11], v4, s[32:35], s62 offen sc1
    s_add_u32 s62, s63, 0x408000
    buffer_store_dwordx4 v[8:11], v4, s[32:35], s62 offen sc1
    s_add_u32 s62, s63, 0x409000
    buffer_store_dwordx4 v[8:11], v4, s[32:35], s62 offen sc1
    s_add_u32 s62, s63, 0x40a000
    buffer_store_dwordx4 v[8:11], v4, s[32:35], s62 offen sc1
    s_add_u32 s62, s63, 0x40b000
    buffer_store_dwordx4 v[8:11], v4, s[32:35], s62 offen sc1
    s_add_u32 s62, s63, 0x40c000
    buffer_store_dwordx4 v[8:11], v4, s[32:35], s62 offen sc1
    s_add_u32 s62, s63, 0x40d000
    buffer_store_dwordx4 v[8:11], v4, s[32:35], s62 offen sc1
    s_add_u32 s62, s63, 0x40e000
    buffer_store_dwordx4 v[8:11], v4, s[32:35], s62 offen sc1
    s_add_u32 s62, s63, 0x40f000
    buffer_store_dwordx4 v[8:11], v4, s[32:35], s62 offen sc1
    s_add_u32 s62, s63, 0x800000
    buffer_store_dwordx4 v[8:11], v4, s[32:35], s62 offen sc1
    s_add_u32 s62, s63, 0x801000
    buffer_store_dwordx4 v[8:11], v4, s[32:35], s62 offen sc1
    s_add_u32 s62, s63, 0x802000
    buffer_store_dwordx4 v[8:11], v4, s[32:35], s62 offen sc1
    s_add_u32 s62, s63, 0x803000
    buffer_store_dwordx4 v[8:11], v4, s[32:35], s62 offen sc1
    s_add_u32 s62, s63, 0x804000
    buffer_store_dwordx4 v[8:11], v4, s[32:35], s62 offen sc1
    s_add_u32 s62, s63, 0x805000
    buffer_store_dwordx4 v[8:11], v4, s[32:35], s62 offen sc1
    s_add_u32 s62, s63, 0x806000
    buffer_store_dwordx4 v[8:11], v4, s[32:35], s62 offen sc1
    s_add_u32 s62, s63, 0x807000
    buffer_store_dwordx4 v[8:11], v4, s[32:35], s62 offen sc1
    s_add_u32 s62, s63, 0x808000
    buffer_store_dwordx4 v[8:11], v4, s[32:35], s62 offen sc1
    s_add_u32 s62, s63, 0x809000
    buffer_store_dwordx4 v[8:11], v4, s[32:35], s62 offen sc1
    s_add_u32 s62, s63, 0x80a000
    buffer_store_dwordx4 v[8:11], v4, s[32:35], s62 offen sc1
    s_add_u32 s62, s63, 0x80b000
    buffer_store_dwordx4 v[8:11], v4, s[32:35], s62 offen sc1
    s_add_u32 s62, s63, 0x80c000
    buffer_store_dwordx4 v[8:11], v4, s[32:35], s62 offen sc1
    s_add_u32 s62, s63, 0x80d000
    buffer_store_dwordx4 v[8:11], v4, s[32:35], s62 offen sc1
    s_add_u32 s62, s63, 0x80e000
    buffer_store_dwordx4 v[8:11], v4, s[32:35], s62 offen sc1
    s_add_u32 s62, s63, 0x80f000
    buffer_store_dwordx4 v[8:11], v4, s[32:35], s62 offen sc1
    s_waitcnt vmcnt(0)
    s_barrier
    s_cmp_lg_u32 s56, 0
    s_cbranch_scc1 Lda_15
    v_mov_b32 v120, 56
    v_mov_b32 v121, 1
    s_mov_b64 exec, 1
    buffer_atomic_add v121, v120, s[36:39], 0 offen
    s_mov_b64 exec, -1
Lda_15:
    s_add_u32 s62, s63, 0x200000
    buffer_store_dwordx4 v[8:11], v4, s[32:35], s62 offen sc1
    s_add_u32 s62, s63, 0x201000
    buffer_store_dwordx4 v[8:11], v4, s[32:35], s62 offen sc1
    s_add_u32 s62, s63, 0x202000
    buffer_store_dwordx4 v[8:11], v4, s[32:35], s62 offen sc1
    s_add_u32 s62, s63, 0x203000
    buffer_store_dwordx4 v[8:11], v4, s[32:35], s62 offen sc1
    s_add_u32 s62, s63, 0x204000
    buffer_store_dwordx4 v[8:11], v4, s[32:35], s62 offen sc1
    s_add_u32 s62, s63, 0x205000
    buffer_store_dwordx4 v[8:11], v4, s[32:35], s62 offen sc1
    s_add_u32 s62, s63, 0x206000
    buffer_store_dwordx4 v[8:11], v4, s[32:35], s62 offen sc1
    s_add_u32 s62, s63, 0x207000
    buffer_store_dwordx4 v[8:11], v4, s[32:35], s62 offen sc1
    s_add_u32 s62, s63, 0x208000
    buffer_store_dwordx4 v[8:11], v4, s[32:35], s62 offen sc1
    s_add_u32 s62, s63, 0x209000
    buffer_store_dwordx4 v[8:11], v4, s[32:35], s62 offen sc1
    s_add_u32 s62, s63, 0x20a000
    buffer_store_dwordx4 v[8:11], v4, s[32:35], s62 offen sc1
    s_add_u32 s62, s63, 0x20b000
    buffer_store_dwordx4 v[8:11], v4, s[32:35], s62 offen sc1
    s_add_u32 s62, s63, 0x20c000
    buffer_store_dwordx4 v[8:11], v4, s[32:35], s62 offen sc1
    s_add_u32 s62, s63, 0x20d000
    buffer_store_dwordx4 v[8:11], v4, s[32:35], s62 offen sc1
    s_add_u32 s62, s63, 0x20e000
    buffer_store_dwordx4 v[8:11], v4, s[32:35], s62 offen sc1
    s_add_u32 s62, s63, 0x20f000
    buffer_store_dwordx4 v[8:11], v4, s[32:35], s62 offen sc1
    s_add_u32 s62, s63, 0xc00000
    buffer_store_dwordx4 v[8:11], v4, s[32:35], s62 offen sc1
    s_add_u32 s62, s63, 0xc01000
    buffer_store_dwordx4 v[8:11], v4, s[32:35], s62 offen sc1
    s_add_u32 s62, s63, 0xc02000
    buffer_store_dwordx4 v[8:11], v4, s[32:35], s62 offen sc1
    s_add_u32 s62, s63, 0xc03000
    buffer_store_dwordx4 v[8:11], v4, s[32:35], s62 offen sc1
    s_add_u32 s62, s63, 0xc04000
    buffer_store_dwordx4 v[8:11], v4, s[32:35], s62 offen sc1
    s_add_u32 s62, s63, 0xc05000
    buffer_store_dwordx4 v[8:11], v4, s[32:35], s62 offen sc1
    s_add_u32 s62, s63, 0xc06000
    buffer_store_dwordx4 v[8:11], v4, s[32:35], s62 offen sc1
    s_add_u32 s62, s63, 0xc07000
    buffer_store_dwordx4 v[8:11], v4, s[32:35], s62 offen sc1
    s_add_u32 s62, s63, 0xc08000
    buffer_store_dwordx4 v[8:11], v4, s[32:35], s62 offen sc1
    s_add_u32 s62, s63, 0xc09000
    buffer_store_dwordx4 v[8:11], v4, s[32:35], s62 offen sc1
    s_add_u32 s62, s63, 0xc0a000
    buffer_store_dwordx4 v[8:11], v4, s[32:35], s62 offen sc1
    s_add_u32 s62, s63, 0xc0b000
    buffer_store_dwordx4 v[8:11], v4, s[32:35], s62 offen sc1
    s_add_u32 s62, s63, 0xc0c000
    buffer_store_dwordx4 v[8:11], v4, s[32:35], s62 offen sc1
    s_add_u32 s62, s63, 0xc0d000
    buffer_store_dwordx4 v[8:11], v4, s[32:35], s62 offen sc1
    s_add_u32 s62, s63, 0xc0e000
    buffer_store_dwordx4 v[8:11], v4, s[32:35], s62 offen sc1
    s_add_u32 s62, s63, 0xc0f000
    buffer_store_dwordx4 v[8:11], v4, s[32:35], s62 offen sc1
    s_waitcnt vmcnt(0)
    s_barrier
    s_cmp_lg_u32 s56, 0
    s_cbranch_scc1 Lda_16
    v_mov_b32 v120, 72
    v_mov_b32 v121, 1
    s_mov_b64 exec, 1
    buffer_atomic_add v121, v120, s[36:39], 0 offen
    s_mov_b64 exec, -1
Lda_16:
    s_add_u32 s62, s63, 0x600000
    buffer_store_dwordx4 v[8:11], v4, s[32:35], s62 offen sc1
    s_add_u32 s62, s63, 0x601000
    buffer_store_dwordx4 v[8:11], v4, s[32:35], s62 offen sc1
    s_add_u32 s62, s63, 0x602000
    buffer_store_dwordx4 v[8:11], v4, s[32:35], s62 offen sc1
    s_add_u32 s62, s63, 0x603000
    buffer_store_dwordx4 v[8:11], v4, s[32:35], s62 offen sc1
    s_add_u32 s62, s63, 0x604000
    buffer_store_dwordx4 v[8:11], v4, s[32:35], s62 offen sc1
    s_add_u32 s62, s63, 0x605000
    buffer_store_dwordx4 v[8:11], v4, s[32:35], s62 offen sc1
    s_add_u32 s62, s63, 0x606000
    buffer_store_dwordx4 v[8:11], v4, s[32:35], s62 offen sc1
    s_add_u32 s62, s63, 0x607000
    buffer_store_dwordx4 v[8:11], v4, s[32:35], s62 offen sc1
    s_add_u32 s62, s63, 0x608000
    buffer_store_dwordx4 v[8:11], v4, s[32:35], s62 offen sc1
    s_add_u32 s62, s63, 0x609000
    buffer_store_dwordx4 v[8:11], v4, s[32:35], s62 offen sc1
    s_add_u32 s62, s63, 0x60a000
    buffer_store_dwordx4 v[8:11], v4, s[32:35], s62 offen sc1
    s_add_u32 s62, s63, 0x60b000
    buffer_store_dwordx4 v[8:11], v4, s[32:35], s62 offen sc1
    s_add_u32 s62, s63, 0x60c000
    buffer_store_dwordx4 v[8:11], v4, s[32:35], s62 offen sc1
    s_add_u32 s62, s63, 0x60d000
    buffer_store_dwordx4 v[8:11], v4, s[32:35], s62 offen sc1
    s_add_u32 s62, s63, 0x60e000
    buffer_store_dwordx4 v[8:11], v4, s[32:35], s62 offen sc1
    s_add_u32 s62, s63, 0x60f000
    buffer_store_dwordx4 v[8:11], v4, s[32:35], s62 offen sc1
    s_add_u32 s62, s63, 0xa00000
    buffer_store_dwordx4 v[8:11], v4, s[32:35], s62 offen sc1
    s_add_u32 s62, s63, 0xa01000
    buffer_store_dwordx4 v[8:11], v4, s[32:35], s62 offen sc1
    s_add_u32 s62, s63, 0xa02000
    buffer_store_dwordx4 v[8:11], v4, s[32:35], s62 offen sc1
    s_add_u32 s62, s63, 0xa03000
    buffer_store_dwordx4 v[8:11], v4, s[32:35], s62 offen sc1
    s_add_u32 s62, s63, 0xa04000
    buffer_store_dwordx4 v[8:11], v4, s[32:35], s62 offen sc1
    s_add_u32 s62, s63, 0xa05000
    buffer_store_dwordx4 v[8:11], v4, s[32:35], s62 offen sc1
    s_add_u32 s62, s63, 0xa06000
    buffer_store_dwordx4 v[8:11], v4, s[32:35], s62 offen sc1
    s_add_u32 s62, s63, 0xa07000
    buffer_store_dwordx4 v[8:11], v4, s[32:35], s62 offen sc1
    s_add_u32 s62, s63, 0xa08000
    buffer_store_dwordx4 v[8:11], v4, s[32:35], s62 offen sc1
    s_add_u32 s62, s63, 0xa09000
    buffer_store_dwordx4 v[8:11], v4, s[32:35], s62 offen sc1
    s_add_u32 s62, s63, 0xa0a000
    buffer_store_dwordx4 v[8:11], v4, s[32:35], s62 offen sc1
    s_add_u32 s62, s63, 0xa0b000
    buffer_store_dwordx4 v[8:11], v4, s[32:35], s62 offen sc1
    s_add_u32 s62, s63, 0xa0c000
    buffer_store_dwordx4 v[8:11], v4, s[32:35], s62 offen sc1
    s_add_u32 s62, s63, 0xa0d000
    buffer_store_dwordx4 v[8:11], v4, s[32:35], s62 offen sc1
    s_add_u32 s62, s63, 0xa0e000
    buffer_store_dwordx4 v[8:11], v4, s[32:35], s62 offen sc1
    s_add_u32 s62, s63, 0xa0f000
    buffer_store_dwordx4 v[8:11], v4, s[32:35], s62 offen sc1
    s_waitcnt vmcnt(0)
    s_barrier
    s_cmp_lg_u32 s56, 0
    s_cbranch_scc1 Lda_17
    v_mov_b32 v120, 60
    v_mov_b32 v121, 1
    s_mov_b64 exec, 1
    buffer_atomic_add v121, v120, s[36:39], 0 offen
    s_mov_b64 exec, -1
Lda_17:
Ld_10:
    s_cmp_lg_u32 s57, 1
    s_cbranch_scc1 Ld_18
    s_cmp_lg_u32 s56, 0
    s_cbranch_scc1 Ldw_20
    v_mov_b32 v120, 44
    s_mov_b64 exec, 1
Ldw_19:
    buffer_load_dword v121, v120, s[36:39], 0 offen sc1
    s_add_u32 s99, s99, 1
    s_cmp_gt_u32 s99, 0x2dc6c0
    s_cbranch_scc0 Lto_21
    s_mov_b32 s3, 6
    s_branch L_abort
Lto_21:
    s_waitcnt vmcnt(0)
    v_cmp_gt_u32 vcc, 32, v121
    s_cbranch_vccz Ldw_22
    s_sleep 64
    s_branch Ldw_19
Ldw_22:
    s_mov_b64 exec, -1
Ldw_20:
    s_barrier
    s_branch L_role_ch
Ld_18:
    s_cmp_lt_u32 s57, 4
    s_cbranch_scc1 Ld_23
    s_bitcmp1_b32 s57, 0
    s_cbranch_scc1 Ld_24
    s_lshr_b32 s60, s57, 1
    s_sub_u32 s60, s60, 2
    v_mov_b32 v40, -1
    v_mov_b32 v41, -1
    v_mov_b32 v42, -1
    v_mov_b32 v43, -1
    v_and_b32 v44, 127, v0
    v_lshlrev_b32 v44, 4, v44
    v_lshrrev_b32 v45, 7, v0
    v_lshlrev_b32 v45, 23, v45
    v_add_u32 v44, v44, v45
    s_lshl_b32 s61, s60, 22
    s_lshl_b32 s62, s58, 11
    s_add_u32 s61, s61, s62
    s_add_u32 s61, s61, 0x1000000
    buffer_store_dwordx4 v[40:43], v44, s[32:35], s61 offen sc1
    s_add_u32 s61, s61, 0x10000
    buffer_store_dwordx4 v[40:43], v44, s[32:35], s61 offen sc1
    s_add_u32 s61, s61, 0x10000
    buffer_store_dwordx4 v[40:43], v44, s[32:35], s61 offen sc1
    s_add_u32 s61, s61, 0x10000
    buffer_store_dwordx4 v[40:43], v44, s[32:35], s61 offen sc1
    s_add_u32 s61, s61, 0x10000
    buffer_store_dwordx4 v[40:43], v44, s[32:35], s61 offen sc1
    s_add_u32 s61, s61, 0x10000
    buffer_store_dwordx4 v[40:43], v44, s[32:35], s61 offen sc1
    s_add_u32 s61, s61, 0x10000
    buffer_store_dwordx4 v[40:43], v44, s[32:35], s61 offen sc1
    s_add_u32 s61, s61, 0x10000
    buffer_store_dwordx4 v[40:43], v44, s[32:35], s61 offen sc1
    s_add_u32 s61, s61, 0x10000
    buffer_store_dwordx4 v[40:43], v44, s[32:35], s61 offen sc1
    s_add_u32 s61, s61, 0x10000
    buffer_store_dwordx4 v[40:43], v44, s[32:35], s61 offen sc1
    s_add_u32 s61, s61, 0x10000
    buffer_store_dwordx4 v[40:43], v44, s[32:35], s61 offen sc1
    s_add_u32 s61, s61, 0x10000
    buffer_store_dwordx4 v[40:43], v44, s[32:35], s61 offen sc1
    v_lshlrev_b32 v44, 4, v0
    s_lshl_b32 s61, s60, 21
    s_lshl_b32 s62, s58, 16
    s_add_u32 s61, s61, s62
    s_add_u32 s61, s61, 0x8000000
    buffer_store_dwordx4 v[40:43], v44, s[32:35], s61 offen sc1
    s_add_u32 s61, s61, 4096
    buffer_store_dwordx4 v[40:43], v44, s[32:35], s61 offen sc1
    s_add_u32 s61, s61, 4096
    buffer_store_dwordx4 v[40:43], v44, s[32:35], s61 offen sc1
    s_add_u32 s61, s61, 4096
    buffer_store_dwordx4 v[40:43], v44, s[32:35], s61 offen sc1
    s_add_u32 s61, s61, 4096
    buffer_store_dwordx4 v[40:43], v44, s[32:35], s61 offen sc1
    s_add_u32 s61, s61, 4096
    buffer_store_dwordx4 v[40:43], v44, s[32:35], s61 offen sc1
    s_add_u32 s61, s61, 4096
    buffer_store_dwordx4 v[40:43], v44, s[32:35], s61 offen sc1
    s_add_u32 s61, s61, 4096
    buffer_store_dwordx4 v[40:43], v44, s[32:35], s61 offen sc1
    s_add_u32 s61, s61, 4096
    buffer_store_dwordx4 v[40:43], v44, s[32:35], s61 offen sc1
    s_add_u32 s61, s61, 4096
    buffer_store_dwordx4 v[40:43], v44, s[32:35], s61 offen sc1
    s_add_u32 s61, s61, 4096
    buffer_store_dwordx4 v[40:43], v44, s[32:35], s61 offen sc1
    s_add_u32 s61, s61, 4096
    buffer_store_dwordx4 v[40:43], v44, s[32:35], s61 offen sc1
    s_add_u32 s61, s61, 4096
    buffer_store_dwordx4 v[40:43], v44, s[32:35], s61 offen sc1
    s_add_u32 s61, s61, 4096
    buffer_store_dwordx4 v[40:43], v44, s[32:35], s61 offen sc1
    s_add_u32 s61, s61, 4096
    buffer_store_dwordx4 v[40:43], v44, s[32:35], s61 offen sc1
    s_add_u32 s61, s61, 4096
    buffer_store_dwordx4 v[40:43], v44, s[32:35], s61 offen sc1
    s_waitcnt vmcnt(0)
    s_barrier
    s_lshl_b32 s61, s60, 2
    s_add_u32 s61, s61, 48
    s_cmp_lg_u32 s56, 0
    s_cbranch_scc1 Lda_25
    v_mov_b32 v120, s61
    v_mov_b32 v121, 1
    s_mov_b64 exec, 1
    buffer_atomic_add v121, v120, s[36:39], 0 offen
    s_mov_b64 exec, -1
Lda_25:
    s_branch Ld_23
Ld_24:
    s_lshr_b32 s60, s57, 1
    s_sub_u32 s60, s60, 2
    v_mov_b32 v8, -1
    v_mov_b32 v9, -1
    v_mov_b32 v10, -1
    v_mov_b32 v11, -1
    v_lshlrev_b32 v4, 4, v0
    s_cmp_ge_u32 s58, 22
    s_cbranch_scc1 Lfp_26
    s_lshl_b32 s61, s60, 22
    s_lshl_b32 s62, s58, 15
    s_add_u32 s61, s61, s62
    s_add_u32 s61, s61, 0x8400000
    s_add_u32 s62, s61, 0x0
    buffer_store_dwordx4 v[8:11], v4, s[32:35], s62 offen sc1
    s_add_u32 s62, s61, 0x1000
    buffer_store_dwordx4 v[8:11], v4, s[32:35], s62 offen sc1
    s_add_u32 s62, s61, 0x2000
    buffer_store_dwordx4 v[8:11], v4, s[32:35], s62 offen sc1
    s_add_u32 s62, s61, 0x3000
    buffer_store_dwordx4 v[8:11], v4, s[32:35], s62 offen sc1
    s_add_u32 s62, s61, 0x4000
    buffer_store_dwordx4 v[8:11], v4, s[32:35], s62 offen sc1
    s_add_u32 s62, s61, 0x5000
    buffer_store_dwordx4 v[8:11], v4, s[32:35], s62 offen sc1
    s_add_u32 s62, s61, 0x6000
    buffer_store_dwordx4 v[8:11], v4, s[32:35], s62 offen sc1
    s_add_u32 s62, s61, 0x7000
    buffer_store_dwordx4 v[8:11], v4, s[32:35], s62 offen sc1
    s_add_u32 s62, s61, 0x100000
    buffer_store_dwordx4 v[8:11], v4, s[32:35], s62 offen sc1
    s_add_u32 s62, s61, 0x101000
    buffer_store_dwordx4 v[8:11], v4, s[32:35], s62 offen sc1
    s_add_u32 s62, s61, 0x102000
    buffer_store_dwordx4 v[8:11], v4, s[32:35], s62 offen sc1
    s_add_u32 s62, s61, 0x103000
    buffer_store_dwordx4 v[8:11], v4, s[32:35], s62 offen sc1
    s_add_u32 s62, s61, 0x104000
    buffer_store_dwordx4 v[8:11], v4, s[32:35], s62 offen sc1
    s_add_u32 s62, s61, 0x105000
    buffer_store_dwordx4 v[8:11], v4, s[32:35], s62 offen sc1
    s_add_u32 s62, s61, 0x106000
    buffer_store_dwordx4 v[8:11], v4, s[32:35], s62 offen sc1
    s_add_u32 s62, s61, 0x107000
    buffer_store_dwordx4 v[8:11], v4, s[32:35], s62 offen sc1
    s_add_u32 s62, s61, 0x200000
    buffer_store_dwordx4 v[8:11], v4, s[32:35], s62 offen sc1
    s_add_u32 s62, s61, 0x201000
    buffer_store_dwordx4 v[8:11], v4, s[32:35], s62 offen sc1
    s_add_u32 s62, s61, 0x202000
    buffer_store_dwordx4 v[8:11], v4, s[32:35], s62 offen sc1
    s_add_u32 s62, s61, 0x203000
    buffer_store_dwordx4 v[8:11], v4, s[32:35], s62 offen sc1
    s_add_u32 s62, s61, 0x204000
    buffer_store_dwordx4 v[8:11], v4, s[32:35], s62 offen sc1
    s_add_u32 s62, s61, 0x205000
    buffer_store_dwordx4 v[8:11], v4, s[32:35], s62 offen sc1
    s_add_u32 s62, s61, 0x206000
    buffer_store_dwordx4 v[8:11], v4, s[32:35], s62 offen sc1
    s_add_u32 s62, s61, 0x207000
    buffer_store_dwordx4 v[8:11], v4, s[32:35], s62 offen sc1
    s_add_u32 s62, s61, 0x300000
    buffer_store_dwordx4 v[8:11], v4, s[32:35], s62 offen sc1
    s_add_u32 s62, s61, 0x301000
    buffer_store_dwordx4 v[8:11], v4, s[32:35], s62 offen sc1
    s_add_u32 s62, s61, 0x302000
    buffer_store_dwordx4 v[8:11], v4, s[32:35], s62 offen sc1
    s_add_u32 s62, s61, 0x303000
    buffer_store_dwordx4 v[8:11], v4, s[32:35], s62 offen sc1
    s_add_u32 s62, s61, 0x304000
    buffer_store_dwordx4 v[8:11], v4, s[32:35], s62 offen sc1
    s_add_u32 s62, s61, 0x305000
    buffer_store_dwordx4 v[8:11], v4, s[32:35], s62 offen sc1
    s_add_u32 s62, s61, 0x306000
    buffer_store_dwordx4 v[8:11], v4, s[32:35], s62 offen sc1
    s_add_u32 s62, s61, 0x307000
    buffer_store_dwordx4 v[8:11], v4, s[32:35], s62 offen sc1
Lfp_26:
    s_waitcnt vmcnt(0)
    s_barrier
    s_lshl_b32 s61, s60, 2
    s_add_u32 s61, s61, 64
    s_cmp_lg_u32 s56, 0
    s_cbranch_scc1 Lda_27
    v_mov_b32 v120, s61
    v_mov_b32 v121, 1
    s_mov_b64 exec, 1
    buffer_atomic_add v121, v120, s[36:39], 0 offen
    s_mov_b64 exec, -1
Lda_27:
Ld_23:
L_qkv_again:
    s_mov_b32 s64, 0
    s_mov_b32 s65, 33
    s_mov_b32 s66, 0
    s_lshr_b32 s3, s57, 1
    s_cmp_eq_u32 s3, 1
    s_cbranch_scc1 Lq_28
    s_mov_b32 s64, 33
    s_mov_b32 s65, 33
    s_mov_b32 s66, 64
    s_cmp_eq_u32 s3, 2
    s_cbranch_scc1 Lq_28
    s_mov_b32 s64, 33
    s_mov_b32 s65, 33
    s_cmp_eq_u32 s3, 0
    s_cbranch_scc1 Lq_28
    s_mov_b32 s64, 33
    s_mov_b32 s65, 64
Lq_28:
    s_cmp_lt_u32 s66, 64
    s_cbranch_scc1 Lq_29
    s_cmp_ge_u32 s64, s65
    s_cbranch_scc1 L_after_qkv
Lq_29:
    s_and_b32 s68, s57, 1
    s_xor_b32 s68, s68, s85
    s_mov_b32 s40, s8
    s_and_b32 s41, s9, 0xffff
    s_mov_b32 s42, 0x400000
    s_mov_b32 s43, 0x20000
    s_mov_b32 s44, s10
    s_and_b32 s45, s11, 0xffff
    s_mov_b32 s46, 0x400000
    s_mov_b32 s47, 0x20000
    s_mov_b32 s48, s12
    s_and_b32 s49, s13, 0xffff
    s_mov_b32 s50, 0x400000
    s_mov_b32 s51, 0x20000
    v_and_b32 v2, 15, v1
    v_lshrrev_b32 v3, 4, v1
    s_lshl_b32 s61, s68, 6
    s_lshl_b32 s62, s56, 4
    s_add_u32 s61, s61, s62
    v_lshlrev_b32 v4, 16, v3
    v_add_u32 v5, s61, v2
    v_lshlrev_b32 v5, 1, v5
    v_add_u32 v4, v4, v5
    s_lshl_b32 s62, s58, 8
    v_add_u32 v4, s62, v4
    s_lshl_b32 s63, s68, 2
    s_add_u32 s63, s63, s56
    s_lshr_b32 s3, s63, 1
    s_lshl_b32 s3, s3, 5
    s_and_b32 s63, s63, 1
    s_add_u32 s3, s3, s63
    s_lshl_b32 s3, s3, 1
    s_add_u32 s3, s3, s62
    v_lshlrev_b32 v27, 16, v3
    v_lshlrev_b32 v5, 2, v2
    v_add_u32 v27, v27, v5
    v_add_u32 v27, s3, v27
    v_lshrrev_b32 v28, 3, v1
    v_lshlrev_b32 v28, 13, v28
    v_and_b32 v29, 7, v1
    v_lshlrev_b32 v29, 4, v29
    v_add_u32 v28, v28, v29
    s_lshl_b32 s61, s58, 8
    s_lshl_b32 s62, s68, 7
    s_add_u32 s61, s61, s62
    v_add_u32 v28, s61, v28
    s_mul_i32 s61, s56, 1048576
    s_add_u32 s61, s61, 0
    s_mul_i32 s62, s56, 16384
    s_add_u32 s62, s62, 65536
    s_mov_b32 m0, s62
    s_nop 0
    buffer_load_dwordx4 v28, s[44:47], s61 offen lds
    s_add_u32 s61, s61, 65536
    s_add_u32 s62, s62, 1024
    s_mov_b32 m0, s62
    s_nop 0
    buffer_load_dwordx4 v28, s[44:47], s61 offen lds
    s_add_u32 s61, s61, 65536
    s_add_u32 s62, s62, 1024
    s_mov_b32 m0, s62
    s_nop 0
    buffer_load_dwordx4 v28, s[44:47], s61 offen lds
    s_add_u32 s61, s61, 65536
    s_add_u32 s62, s62, 1024
    s_mov_b32 m0, s62
    s_nop 0
    buffer_load_dwordx4 v28, s[44:47], s61 offen lds
    s_add_u32 s61, s61, 65536
    s_add_u32 s62, s62, 1024
    s_mov_b32 m0, s62
    s_nop 0
    buffer_load_dwordx4 v28, s[44:47], s61 offen lds
    s_add_u32 s61, s61, 65536
    s_add_u32 s62, s62, 1024
    s_mov_b32 m0, s62
    s_nop 0
    buffer_load_dwordx4 v28, s[44:47], s61 offen lds
    s_add_u32 s61, s61, 65536
    s_add_u32 s62, s62, 1024
    s_mov_b32 m0, s62
    s_nop 0
    buffer_load_dwordx4 v28, s[44:47], s61 offen lds
    s_add_u32 s61, s61, 65536
    s_add_u32 s62, s62, 1024
    s_mov_b32 m0, s62
    s_nop 0
    buffer_load_dwordx4 v28, s[44:47], s61 offen lds
    s_add_u32 s61, s61, 65536
    s_add_u32 s62, s62, 1024
    s_mov_b32 m0, s62
    s_nop 0
    buffer_load_dwordx4 v28, s[44:47], s61 offen lds
    s_add_u32 s61, s61, 65536
    s_add_u32 s62, s62, 1024
    s_mov_b32 m0, s62
    s_nop 0
    buffer_load_dwordx4 v28, s[44:47], s61 offen lds
    s_add_u32 s61, s61, 65536
    s_add_u32 s62, s62, 1024
    s_mov_b32 m0, s62
    s_nop 0
    buffer_load_dwordx4 v28, s[44:47], s61 offen lds
    s_add_u32 s61, s61, 65536
    s_add_u32 s62, s62, 1024
    s_mov_b32 m0, s62
    s_nop 0
    buffer_load_dwordx4 v28, s[44:47], s61 offen lds
    s_add_u32 s61, s61, 65536
    s_add_u32 s62, s62, 1024
    s_mov_b32 m0, s62
    s_nop 0
    buffer_load_dwordx4 v28, s[44:47], s61 offen lds
    s_add_u32 s61, s61, 65536
    s_add_u32 s62, s62, 1024
    s_mov_b32 m0, s62
    s_nop 0
    buffer_load_dwordx4 v28, s[44:47], s61 offen lds
    s_add_u32 s61, s61, 65536
    s_add_u32 s62, s62, 1024
    s_mov_b32 m0, s62
    s_nop 0
    buffer_load_dwordx4 v28, s[44:47], s61 offen lds
    s_add_u32 s61, s61, 65536
    s_add_u32 s62, s62, 1024
    s_mov_b32 m0, s62
    s_nop 0
    buffer_load_dwordx4 v28, s[44:47], s61 offen lds
    s_mul_i32 s61, s56, 1048576
    s_add_u32 s61, s61, 0
    s_mul_i32 s62, s56, 16384
    s_add_u32 s62, s62, 0
    s_mov_b32 m0, s62
    s_nop 0
    buffer_load_dwordx4 v28, s[40:43], s61 offen lds
    s_add_u32 s61, s61, 65536
    s_add_u32 s62, s62, 1024
    s_mov_b32 m0, s62
    s_nop 0
    buffer_load_dwordx4 v28, s[40:43], s61 offen lds
    s_add_u32 s61, s61, 65536
    s_add_u32 s62, s62, 1024
    s_mov_b32 m0, s62
    s_nop 0
    buffer_load_dwordx4 v28, s[40:43], s61 offen lds
    s_add_u32 s61, s61, 65536
    s_add_u32 s62, s62, 1024
    s_mov_b32 m0, s62
    s_nop 0
    buffer_load_dwordx4 v28, s[40:43], s61 offen lds
    s_add_u32 s61, s61, 65536
    s_add_u32 s62, s62, 1024
    s_mov_b32 m0, s62
    s_nop 0
    buffer_load_dwordx4 v28, s[40:43], s61 offen lds
    s_add_u32 s61, s61, 65536
    s_add_u32 s62, s62, 1024
    s_mov_b32 m0, s62
    s_nop 0
    buffer_load_dwordx4 v28, s[40:43], s61 offen lds
    s_add_u32 s61, s61, 65536
    s_add_u32 s62, s62, 1024
    s_mov_b32 m0, s62
    s_nop 0
    buffer_load_dwordx4 v28, s[40:43], s61 offen lds
    s_add_u32 s61, s61, 65536
    s_add_u32 s62, s62, 1024
    s_mov_b32 m0, s62
    s_nop 0
    buffer_load_dwordx4 v28, s[40:43], s61 offen lds
    s_add_u32 s61, s61, 65536
    s_add_u32 s62, s62, 1024
    s_mov_b32 m0, s62
    s_nop 0
    buffer_load_dwordx4 v28, s[40:43], s61 offen lds
    s_add_u32 s61, s61, 65536
    s_add_u32 s62, s62, 1024
    s_mov_b32 m0, s62
    s_nop 0
    buffer_load_dwordx4 v28, s[40:43], s61 offen lds
    s_add_u32 s61, s61, 65536
    s_add_u32 s62, s62, 1024
    s_mov_b32 m0, s62
    s_nop 0
    buffer_load_dwordx4 v28, s[40:43], s61 offen lds
    s_add_u32 s61, s61, 65536
    s_add_u32 s62, s62, 1024
    s_mov_b32 m0, s62
    s_nop 0
    buffer_load_dwordx4 v28, s[40:43], s61 offen lds
    s_add_u32 s61, s61, 65536
    s_add_u32 s62, s62, 1024
    s_mov_b32 m0, s62
    s_nop 0
    buffer_load_dwordx4 v28, s[40:43], s61 offen lds
    s_add_u32 s61, s61, 65536
    s_add_u32 s62, s62, 1024
    s_mov_b32 m0, s62
    s_nop 0
    buffer_load_dwordx4 v28, s[40:43], s61 offen lds
    s_add_u32 s61, s61, 65536
    s_add_u32 s62, s62, 1024
    s_mov_b32 m0, s62
    s_nop 0
    buffer_load_dwordx4 v28, s[40:43], s61 offen lds
    s_add_u32 s61, s61, 65536
    s_add_u32 s62, s62, 1024
    s_mov_b32 m0, s62
    s_nop 0
    buffer_load_dwordx4 v28, s[40:43], s61 offen lds
    buffer_load_ushort v64, v27, s[48:51], 0 offen
    s_mov_b32 s3, 0x2000
    buffer_load_ushort v65, v27, s[48:51], s3 offen
    s_mov_b32 s3, 0x4000
    buffer_load_ushort v66, v27, s[48:51], s3 offen
    s_mov_b32 s3, 0x6000
    buffer_load_ushort v67, v27, s[48:51], s3 offen
    s_mov_b32 s3, 0x8000
    buffer_load_ushort v68, v27, s[48:51], s3 offen
    s_mov_b32 s3, 0xa000
    buffer_load_ushort v69, v27, s[48:51], s3 offen
    s_mov_b32 s3, 0xc000
    buffer_load_ushort v70, v27, s[48:51], s3 offen
    s_mov_b32 s3, 0xe000
    buffer_load_ushort v71, v27, s[48:51], s3 offen
    s_mov_b32 s3, 0x40000
    buffer_load_ushort v72, v27, s[48:51], s3 offen
    s_mov_b32 s3, 0x42000
    buffer_load_ushort v73, v27, s[48:51], s3 offen
    s_mov_b32 s3, 0x44000
    buffer_load_ushort v74, v27, s[48:51], s3 offen
    s_mov_b32 s3, 0x46000
    buffer_load_ushort v75, v27, s[48:51], s3 offen
    s_mov_b32 s3, 0x48000
    buffer_load_ushort v76, v27, s[48:51], s3 offen
    s_mov_b32 s3, 0x4a000
    buffer_load_ushort v77, v27, s[48:51], s3 offen
    s_mov_b32 s3, 0x4c000
    buffer_load_ushort v78, v27, s[48:51], s3 offen
    s_mov_b32 s3, 0x4e000
    buffer_load_ushort v79, v27, s[48:51], s3 offen
    s_mov_b32 s3, 0x80000
    buffer_load_ushort v80, v27, s[48:51], s3 offen
    s_mov_b32 s3, 0x82000
    buffer_load_ushort v81, v27, s[48:51], s3 offen
    s_mov_b32 s3, 0x84000
    buffer_load_ushort v82, v27, s[48:51], s3 offen
    s_mov_b32 s3, 0x86000
    buffer_load_ushort v83, v27, s[48:51], s3 offen
    s_mov_b32 s3, 0x88000
    buffer_load_ushort v84, v27, s[48:51], s3 offen
    s_mov_b32 s3, 0x8a000
    buffer_load_ushort v85, v27, s[48:51], s3 offen
    s_mov_b32 s3, 0x8c000
    buffer_load_ushort v86, v27, s[48:51], s3 offen
    s_mov_b32 s3, 0x8e000
    buffer_load_ushort v87, v27, s[48:51], s3 offen
    s_mov_b32 s3, 0xc0000
    buffer_load_ushort v88, v27, s[48:51], s3 offen
    s_mov_b32 s3, 0xc2000
    buffer_load_ushort v89, v27, s[48:51], s3 offen
    s_mov_b32 s3, 0xc4000
    buffer_load_ushort v90, v27, s[48:51], s3 offen
    s_mov_b32 s3, 0xc6000
    buffer_load_ushort v91, v27, s[48:51], s3 offen
    s_waitcnt vmcnt(20)
    v_lshl_or_b32 v64, v65, 16, v64
    v_accvgpr_write_b32 a128, v64
    v_lshl_or_b32 v66, v67, 16, v66
    v_accvgpr_write_b32 a129, v66
    v_lshl_or_b32 v68, v69, 16, v68
    v_accvgpr_write_b32 a130, v68
    v_lshl_or_b32 v70, v71, 16, v70
    v_accvgpr_write_b32 a131, v70
    s_mov_b32 s3, 0xc8000
    buffer_load_ushort v64, v27, s[48:51], s3 offen
    s_mov_b32 s3, 0xca000
    buffer_load_ushort v65, v27, s[48:51], s3 offen
    s_mov_b32 s3, 0xcc000
    buffer_load_ushort v66, v27, s[48:51], s3 offen
    s_mov_b32 s3, 0xce000
    buffer_load_ushort v67, v27, s[48:51], s3 offen
    s_mov_b32 s3, 0x100000
    buffer_load_ushort v68, v27, s[48:51], s3 offen
    s_mov_b32 s3, 0x102000
    buffer_load_ushort v69, v27, s[48:51], s3 offen
    s_mov_b32 s3, 0x104000
    buffer_load_ushort v70, v27, s[48:51], s3 offen
    s_mov_b32 s3, 0x106000
    buffer_load_ushort v71, v27, s[48:51], s3 offen
    s_waitcnt vmcnt(20)
    v_lshl_or_b32 v72, v73, 16, v72
    v_accvgpr_write_b32 a132, v72
    v_lshl_or_b32 v74, v75, 16, v74
    v_accvgpr_write_b32 a133, v74
    v_lshl_or_b32 v76, v77, 16, v76
    v_accvgpr_write_b32 a134, v76
    v_lshl_or_b32 v78, v79, 16, v78
    v_accvgpr_write_b32 a135, v78
    s_mov_b32 s3, 0x108000
    buffer_load_ushort v72, v27, s[48:51], s3 offen
    s_mov_b32 s3, 0x10a000
    buffer_load_ushort v73, v27, s[48:51], s3 offen
    s_mov_b32 s3, 0x10c000
    buffer_load_ushort v74, v27, s[48:51], s3 offen
    s_mov_b32 s3, 0x10e000
    buffer_load_ushort v75, v27, s[48:51], s3 offen
    s_mov_b32 s3, 0x140000
    buffer_load_ushort v76, v27, s[48:51], s3 offen
    s_mov_b32 s3, 0x142000
    buffer_load_ushort v77, v27, s[48:51], s3 offen
    s_mov_b32 s3, 0x144000
    buffer_load_ushort v78, v27, s[48:51], s3 offen
    s_mov_b32 s3, 0x146000
    buffer_load_ushort v79, v27, s[48:51], s3 offen
    s_waitcnt vmcnt(20)
    v_lshl_or_b32 v80, v81, 16, v80
    v_accvgpr_write_b32 a136, v80
    v_lshl_or_b32 v82, v83, 16, v82
    v_accvgpr_write_b32 a137, v82
    v_lshl_or_b32 v84, v85, 16, v84
    v_accvgpr_write_b32 a138, v84
    v_lshl_or_b32 v86, v87, 16, v86
    v_accvgpr_write_b32 a139, v86
    s_mov_b32 s3, 0x148000
    buffer_load_ushort v80, v27, s[48:51], s3 offen
    s_mov_b32 s3, 0x14a000
    buffer_load_ushort v81, v27, s[48:51], s3 offen
    s_mov_b32 s3, 0x14c000
    buffer_load_ushort v82, v27, s[48:51], s3 offen
    s_mov_b32 s3, 0x14e000
    buffer_load_ushort v83, v27, s[48:51], s3 offen
    s_mov_b32 s3, 0x180000
    buffer_load_ushort v84, v27, s[48:51], s3 offen
    s_mov_b32 s3, 0x182000
    buffer_load_ushort v85, v27, s[48:51], s3 offen
    s_mov_b32 s3, 0x184000
    buffer_load_ushort v86, v27, s[48:51], s3 offen
    s_mov_b32 s3, 0x186000
    buffer_load_ushort v87, v27, s[48:51], s3 offen
    s_waitcnt vmcnt(20)
    v_lshl_or_b32 v88, v89, 16, v88
    v_accvgpr_write_b32 a140, v88
    v_lshl_or_b32 v90, v91, 16, v90
    v_accvgpr_write_b32 a141, v90
    v_lshl_or_b32 v64, v65, 16, v64
    v_accvgpr_write_b32 a142, v64
    v_lshl_or_b32 v66, v67, 16, v66
    v_accvgpr_write_b32 a143, v66
    s_mov_b32 s3, 0x188000
    buffer_load_ushort v88, v27, s[48:51], s3 offen
    s_mov_b32 s3, 0x18a000
    buffer_load_ushort v89, v27, s[48:51], s3 offen
    s_mov_b32 s3, 0x18c000
    buffer_load_ushort v90, v27, s[48:51], s3 offen
    s_mov_b32 s3, 0x18e000
    buffer_load_ushort v91, v27, s[48:51], s3 offen
    s_mov_b32 s3, 0x1c0000
    buffer_load_ushort v64, v27, s[48:51], s3 offen
    s_mov_b32 s3, 0x1c2000
    buffer_load_ushort v65, v27, s[48:51], s3 offen
    s_mov_b32 s3, 0x1c4000
    buffer_load_ushort v66, v27, s[48:51], s3 offen
    s_mov_b32 s3, 0x1c6000
    buffer_load_ushort v67, v27, s[48:51], s3 offen
    s_waitcnt vmcnt(20)
    v_lshl_or_b32 v68, v69, 16, v68
    v_accvgpr_write_b32 a144, v68
    v_lshl_or_b32 v70, v71, 16, v70
    v_accvgpr_write_b32 a145, v70
    v_lshl_or_b32 v72, v73, 16, v72
    v_accvgpr_write_b32 a146, v72
    v_lshl_or_b32 v74, v75, 16, v74
    v_accvgpr_write_b32 a147, v74
    s_mov_b32 s3, 0x1c8000
    buffer_load_ushort v68, v27, s[48:51], s3 offen
    s_mov_b32 s3, 0x1ca000
    buffer_load_ushort v69, v27, s[48:51], s3 offen
    s_mov_b32 s3, 0x1cc000
    buffer_load_ushort v70, v27, s[48:51], s3 offen
    s_mov_b32 s3, 0x1ce000
    buffer_load_ushort v71, v27, s[48:51], s3 offen
    s_mov_b32 s3, 0x200000
    buffer_load_ushort v72, v27, s[48:51], s3 offen
    s_mov_b32 s3, 0x202000
    buffer_load_ushort v73, v27, s[48:51], s3 offen
    s_mov_b32 s3, 0x204000
    buffer_load_ushort v74, v27, s[48:51], s3 offen
    s_mov_b32 s3, 0x206000
    buffer_load_ushort v75, v27, s[48:51], s3 offen
    s_waitcnt vmcnt(20)
    v_lshl_or_b32 v76, v77, 16, v76
    v_accvgpr_write_b32 a148, v76
    v_lshl_or_b32 v78, v79, 16, v78
    v_accvgpr_write_b32 a149, v78
    v_lshl_or_b32 v80, v81, 16, v80
    v_accvgpr_write_b32 a150, v80
    v_lshl_or_b32 v82, v83, 16, v82
    v_accvgpr_write_b32 a151, v82
    s_mov_b32 s3, 0x208000
    buffer_load_ushort v76, v27, s[48:51], s3 offen
    s_mov_b32 s3, 0x20a000
    buffer_load_ushort v77, v27, s[48:51], s3 offen
    s_mov_b32 s3, 0x20c000
    buffer_load_ushort v78, v27, s[48:51], s3 offen
    s_mov_b32 s3, 0x20e000
    buffer_load_ushort v79, v27, s[48:51], s3 offen
    s_mov_b32 s3, 0x240000
    buffer_load_ushort v80, v27, s[48:51], s3 offen
    s_mov_b32 s3, 0x242000
    buffer_load_ushort v81, v27, s[48:51], s3 offen
    s_mov_b32 s3, 0x244000
    buffer_load_ushort v82, v27, s[48:51], s3 offen
    s_mov_b32 s3, 0x246000
    buffer_load_ushort v83, v27, s[48:51], s3 offen
    s_waitcnt vmcnt(20)
    v_lshl_or_b32 v84, v85, 16, v84
    v_accvgpr_write_b32 a152, v84
    v_lshl_or_b32 v86, v87, 16, v86
    v_accvgpr_write_b32 a153, v86
    v_lshl_or_b32 v88, v89, 16, v88
    v_accvgpr_write_b32 a154, v88
    v_lshl_or_b32 v90, v91, 16, v90
    v_accvgpr_write_b32 a155, v90
    s_mov_b32 s3, 0x248000
    buffer_load_ushort v84, v27, s[48:51], s3 offen
    s_mov_b32 s3, 0x24a000
    buffer_load_ushort v85, v27, s[48:51], s3 offen
    s_mov_b32 s3, 0x24c000
    buffer_load_ushort v86, v27, s[48:51], s3 offen
    s_mov_b32 s3, 0x24e000
    buffer_load_ushort v87, v27, s[48:51], s3 offen
    s_mov_b32 s3, 0x280000
    buffer_load_ushort v88, v27, s[48:51], s3 offen
    s_mov_b32 s3, 0x282000
    buffer_load_ushort v89, v27, s[48:51], s3 offen
    s_mov_b32 s3, 0x284000
    buffer_load_ushort v90, v27, s[48:51], s3 offen
    s_mov_b32 s3, 0x286000
    buffer_load_ushort v91, v27, s[48:51], s3 offen
    s_waitcnt vmcnt(20)
    v_lshl_or_b32 v64, v65, 16, v64
    v_accvgpr_write_b32 a156, v64
    v_lshl_or_b32 v66, v67, 16, v66
    v_accvgpr_write_b32 a157, v66
    v_lshl_or_b32 v68, v69, 16, v68
    v_accvgpr_write_b32 a158, v68
    v_lshl_or_b32 v70, v71, 16, v70
    v_accvgpr_write_b32 a159, v70
    s_mov_b32 s3, 0x288000
    buffer_load_ushort v64, v27, s[48:51], s3 offen
    s_mov_b32 s3, 0x28a000
    buffer_load_ushort v65, v27, s[48:51], s3 offen
    s_mov_b32 s3, 0x28c000
    buffer_load_ushort v66, v27, s[48:51], s3 offen
    s_mov_b32 s3, 0x28e000
    buffer_load_ushort v67, v27, s[48:51], s3 offen
    s_mov_b32 s3, 0x2c0000
    buffer_load_ushort v68, v27, s[48:51], s3 offen
    s_mov_b32 s3, 0x2c2000
    buffer_load_ushort v69, v27, s[48:51], s3 offen
    s_mov_b32 s3, 0x2c4000
    buffer_load_ushort v70, v27, s[48:51], s3 offen
    s_mov_b32 s3, 0x2c6000
    buffer_load_ushort v71, v27, s[48:51], s3 offen
    s_waitcnt vmcnt(20)
    v_lshl_or_b32 v72, v73, 16, v72
    v_accvgpr_write_b32 a160, v72
    v_lshl_or_b32 v74, v75, 16, v74
    v_accvgpr_write_b32 a161, v74
    v_lshl_or_b32 v76, v77, 16, v76
    v_accvgpr_write_b32 a162, v76
    v_lshl_or_b32 v78, v79, 16, v78
    v_accvgpr_write_b32 a163, v78
    s_mov_b32 s3, 0x2c8000
    buffer_load_ushort v72, v27, s[48:51], s3 offen
    s_mov_b32 s3, 0x2ca000
    buffer_load_ushort v73, v27, s[48:51], s3 offen
    s_mov_b32 s3, 0x2cc000
    buffer_load_ushort v74, v27, s[48:51], s3 offen
    s_mov_b32 s3, 0x2ce000
    buffer_load_ushort v75, v27, s[48:51], s3 offen
    s_mov_b32 s3, 0x300000
    buffer_load_ushort v76, v27, s[48:51], s3 offen
    s_mov_b32 s3, 0x302000
    buffer_load_ushort v77, v27, s[48:51], s3 offen
    s_mov_b32 s3, 0x304000
    buffer_load_ushort v78, v27, s[48:51], s3 offen
    s_mov_b32 s3, 0x306000
    buffer_load_ushort v79, v27, s[48:51], s3 offen
    s_waitcnt vmcnt(20)
    v_lshl_or_b32 v80, v81, 16, v80
    v_accvgpr_write_b32 a164, v80
    v_lshl_or_b32 v82, v83, 16, v82
    v_accvgpr_write_b32 a165, v82
    v_lshl_or_b32 v84, v85, 16, v84
    v_accvgpr_write_b32 a166, v84
    v_lshl_or_b32 v86, v87, 16, v86
    v_accvgpr_write_b32 a167, v86
    s_mov_b32 s3, 0x308000
    buffer_load_ushort v80, v27, s[48:51], s3 offen
    s_mov_b32 s3, 0x30a000
    buffer_load_ushort v81, v27, s[48:51], s3 offen
    s_mov_b32 s3, 0x30c000
    buffer_load_ushort v82, v27, s[48:51], s3 offen
    s_mov_b32 s3, 0x30e000
    buffer_load_ushort v83, v27, s[48:51], s3 offen
    s_mov_b32 s3, 0x340000
    buffer_load_ushort v84, v27, s[48:51], s3 offen
    s_mov_b32 s3, 0x342000
    buffer_load_ushort v85, v27, s[48:51], s3 offen
    s_mov_b32 s3, 0x344000
    buffer_load_ushort v86, v27, s[48:51], s3 offen
    s_mov_b32 s3, 0x346000
    buffer_load_ushort v87, v27, s[48:51], s3 offen
    s_waitcnt vmcnt(20)
    v_lshl_or_b32 v88, v89, 16, v88
    v_accvgpr_write_b32 a168, v88
    v_lshl_or_b32 v90, v91, 16, v90
    v_accvgpr_write_b32 a169, v90
    v_lshl_or_b32 v64, v65, 16, v64
    v_accvgpr_write_b32 a170, v64
    v_lshl_or_b32 v66, v67, 16, v66
    v_accvgpr_write_b32 a171, v66
    s_mov_b32 s3, 0x348000
    buffer_load_ushort v88, v27, s[48:51], s3 offen
    s_mov_b32 s3, 0x34a000
    buffer_load_ushort v89, v27, s[48:51], s3 offen
    s_mov_b32 s3, 0x34c000
    buffer_load_ushort v90, v27, s[48:51], s3 offen
    s_mov_b32 s3, 0x34e000
    buffer_load_ushort v91, v27, s[48:51], s3 offen
    s_mov_b32 s3, 0x380000
    buffer_load_ushort v64, v27, s[48:51], s3 offen
    s_mov_b32 s3, 0x382000
    buffer_load_ushort v65, v27, s[48:51], s3 offen
    s_mov_b32 s3, 0x384000
    buffer_load_ushort v66, v27, s[48:51], s3 offen
    s_mov_b32 s3, 0x386000
    buffer_load_ushort v67, v27, s[48:51], s3 offen
    s_waitcnt vmcnt(20)
    v_lshl_or_b32 v68, v69, 16, v68
    v_accvgpr_write_b32 a172, v68
    v_lshl_or_b32 v70, v71, 16, v70
    v_accvgpr_write_b32 a173, v70
    v_lshl_or_b32 v72, v73, 16, v72
    v_accvgpr_write_b32 a174, v72
    v_lshl_or_b32 v74, v75, 16, v74
    v_accvgpr_write_b32 a175, v74
    s_mov_b32 s3, 0x388000
    buffer_load_ushort v68, v27, s[48:51], s3 offen
    s_mov_b32 s3, 0x38a000
    buffer_load_ushort v69, v27, s[48:51], s3 offen
    s_mov_b32 s3, 0x38c000
    buffer_load_ushort v70, v27, s[48:51], s3 offen
    s_mov_b32 s3, 0x38e000
    buffer_load_ushort v71, v27, s[48:51], s3 offen
    s_mov_b32 s3, 0x3c0000
    buffer_load_ushort v72, v27, s[48:51], s3 offen
    s_mov_b32 s3, 0x3c2000
    buffer_load_ushort v73, v27, s[48:51], s3 offen
    s_mov_b32 s3, 0x3c4000
    buffer_load_ushort v74, v27, s[48:51], s3 offen
    s_mov_b32 s3, 0x3c6000
    buffer_load_ushort v75, v27, s[48:51], s3 offen
    s_waitcnt vmcnt(20)
    v_lshl_or_b32 v76, v77, 16, v76
    v_accvgpr_write_b32 a176, v76
    v_lshl_or_b32 v78, v79, 16, v78
    v_accvgpr_write_b32 a177, v78
    v_lshl_or_b32 v80, v81, 16, v80
    v_accvgpr_write_b32 a178, v80
    v_lshl_or_b32 v82, v83, 16, v82
    v_accvgpr_write_b32 a179, v82
    s_mov_b32 s3, 0x3c8000
    buffer_load_ushort v76, v27, s[48:51], s3 offen
    s_mov_b32 s3, 0x3ca000
    buffer_load_ushort v77, v27, s[48:51], s3 offen
    s_mov_b32 s3, 0x3cc000
    buffer_load_ushort v78, v27, s[48:51], s3 offen
    s_mov_b32 s3, 0x3ce000
    buffer_load_ushort v79, v27, s[48:51], s3 offen
    s_waitcnt vmcnt(16)
    v_lshl_or_b32 v84, v85, 16, v84
    v_accvgpr_write_b32 a180, v84
    v_lshl_or_b32 v86, v87, 16, v86
    v_accvgpr_write_b32 a181, v86
    v_lshl_or_b32 v88, v89, 16, v88
    v_accvgpr_write_b32 a182, v88
    v_lshl_or_b32 v90, v91, 16, v90
    v_accvgpr_write_b32 a183, v90
    s_waitcnt vmcnt(8)
    v_lshl_or_b32 v64, v65, 16, v64
    v_accvgpr_write_b32 a184, v64
    v_lshl_or_b32 v66, v67, 16, v66
    v_accvgpr_write_b32 a185, v66
    v_lshl_or_b32 v68, v69, 16, v68
    v_accvgpr_write_b32 a186, v68
    v_lshl_or_b32 v70, v71, 16, v70
    v_accvgpr_write_b32 a187, v70
    s_waitcnt vmcnt(0)
    v_lshl_or_b32 v72, v73, 16, v72
    v_accvgpr_write_b32 a188, v72
    v_lshl_or_b32 v74, v75, 16, v74
    v_accvgpr_write_b32 a189, v74
    v_lshl_or_b32 v76, v77, 16, v76
    v_accvgpr_write_b32 a190, v76
    v_lshl_or_b32 v78, v79, 16, v78
    v_accvgpr_write_b32 a191, v78
    s_waitcnt vmcnt(0)
    s_barrier
    v_lshlrev_b32 v28, 3, v3
    v_lshrrev_b32 v29, 2, v2
    v_add_u32 v28, v28, v29
    v_lshlrev_b32 v28, 7, v28
    v_and_b32 v29, 3, v2
    v_lshlrev_b32 v29, 3, v29
    v_add_u32 v28, v28, v29
    s_lshl_b32 s61, s56, 5
    v_add_u32 v28, s61, v28
    v_add_u32 v29, 0x10000, v28
    ds_read_b64_tr_b16 v[64:65], v29 offset:0
    ds_read_b64_tr_b16 v[66:67], v29 offset:512
    ds_read_b64_tr_b16 v[68:69], v29 offset:4096
    ds_read_b64_tr_b16 v[70:71], v29 offset:4608
    ds_read_b64_tr_b16 v[72:73], v29 offset:8192
    ds_read_b64_tr_b16 v[74:75], v29 offset:8704
    ds_read_b64_tr_b16 v[76:77], v29 offset:12288
    ds_read_b64_tr_b16 v[78:79], v29 offset:12800
    s_waitcnt lgkmcnt(7)
    v_accvgpr_write_b32 a64, v64
    v_accvgpr_write_b32 a65, v65
    ds_read_b64_tr_b16 v[64:65], v29 offset:16384
    s_waitcnt lgkmcnt(7)
    v_accvgpr_write_b32 a66, v66
    v_accvgpr_write_b32 a67, v67
    ds_read_b64_tr_b16 v[66:67], v29 offset:16896
    s_waitcnt lgkmcnt(7)
    v_accvgpr_write_b32 a68, v68
    v_accvgpr_write_b32 a69, v69
    ds_read_b64_tr_b16 v[68:69], v29 offset:20480
    s_waitcnt lgkmcnt(7)
    v_accvgpr_write_b32 a70, v70
    v_accvgpr_write_b32 a71, v71
    ds_read_b64_tr_b16 v[70:71], v29 offset:20992
    s_waitcnt lgkmcnt(7)
    v_accvgpr_write_b32 a72, v72
    v_accvgpr_write_b32 a73, v73
    ds_read_b64_tr_b16 v[72:73], v29 offset:24576
    s_waitcnt lgkmcnt(7)
    v_accvgpr_write_b32 a74, v74
    v_accvgpr_write_b32 a75, v75
    ds_read_b64_tr_b16 v[74:75], v29 offset:25088
    s_waitcnt lgkmcnt(7)
    v_accvgpr_write_b32 a76, v76
    v_accvgpr_write_b32 a77, v77
    ds_read_b64_tr_b16 v[76:77], v29 offset:28672
    s_waitcnt lgkmcnt(7)
    v_accvgpr_write_b32 a78, v78
    v_accvgpr_write_b32 a79, v79
    ds_read_b64_tr_b16 v[78:79], v29 offset:29184
    s_waitcnt lgkmcnt(7)
    v_accvgpr_write_b32 a80, v64
    v_accvgpr_write_b32 a81, v65
    ds_read_b64_tr_b16 v[64:65], v29 offset:32768
    s_waitcnt lgkmcnt(7)
    v_accvgpr_write_b32 a82, v66
    v_accvgpr_write_b32 a83, v67
    ds_read_b64_tr_b16 v[66:67], v29 offset:33280
    s_waitcnt lgkmcnt(7)
    v_accvgpr_write_b32 a84, v68
    v_accvgpr_write_b32 a85, v69
    ds_read_b64_tr_b16 v[68:69], v29 offset:36864
    s_waitcnt lgkmcnt(7)
    v_accvgpr_write_b32 a86, v70
    v_accvgpr_write_b32 a87, v71
    ds_read_b64_tr_b16 v[70:71], v29 offset:37376
    s_waitcnt lgkmcnt(7)
    v_accvgpr_write_b32 a88, v72
    v_accvgpr_write_b32 a89, v73
    ds_read_b64_tr_b16 v[72:73], v29 offset:40960
    s_waitcnt lgkmcnt(7)
    v_accvgpr_write_b32 a90, v74
    v_accvgpr_write_b32 a91, v75
    ds_read_b64_tr_b16 v[74:75], v29 offset:41472
    s_waitcnt lgkmcnt(7)
    v_accvgpr_write_b32 a92, v76
    v_accvgpr_write_b32 a93, v77
    ds_read_b64_tr_b16 v[76:77], v29 offset:45056
    s_waitcnt lgkmcnt(7)
    v_accvgpr_write_b32 a94, v78
    v_accvgpr_write_b32 a95, v79
    ds_read_b64_tr_b16 v[78:79], v29 offset:45568
    s_waitcnt lgkmcnt(7)
    v_accvgpr_write_b32 a96, v64
    v_accvgpr_write_b32 a97, v65
    ds_read_b64_tr_b16 v[64:65], v29 offset:49152
    s_waitcnt lgkmcnt(7)
    v_accvgpr_write_b32 a98, v66
    v_accvgpr_write_b32 a99, v67
    ds_read_b64_tr_b16 v[66:67], v29 offset:49664
    s_waitcnt lgkmcnt(7)
    v_accvgpr_write_b32 a100, v68
    v_accvgpr_write_b32 a101, v69
    ds_read_b64_tr_b16 v[68:69], v29 offset:53248
    s_waitcnt lgkmcnt(7)
    v_accvgpr_write_b32 a102, v70
    v_accvgpr_write_b32 a103, v71
    ds_read_b64_tr_b16 v[70:71], v29 offset:53760
    s_waitcnt lgkmcnt(7)
    v_accvgpr_write_b32 a104, v72
    v_accvgpr_write_b32 a105, v73
    ds_read_b64_tr_b16 v[72:73], v29 offset:57344
    s_waitcnt lgkmcnt(7)
    v_accvgpr_write_b32 a106, v74
    v_accvgpr_write_b32 a107, v75
    ds_read_b64_tr_b16 v[74:75], v29 offset:57856
    s_waitcnt lgkmcnt(7)
    v_accvgpr_write_b32 a108, v76
    v_accvgpr_write_b32 a109, v77
    ds_read_b64_tr_b16 v[76:77], v29 offset:61440
    s_waitcnt lgkmcnt(7)
    v_accvgpr_write_b32 a110, v78
    v_accvgpr_write_b32 a111, v79
    ds_read_b64_tr_b16 v[78:79], v29 offset:61952
    s_waitcnt lgkmcnt(7)
    v_accvgpr_write_b32 a112, v64
    v_accvgpr_write_b32 a113, v65
    s_waitcnt lgkmcnt(6)
    v_accvgpr_write_b32 a114, v66
    v_accvgpr_write_b32 a115, v67
    s_waitcnt lgkmcnt(5)
    v_accvgpr_write_b32 a116, v68
    v_accvgpr_write_b32 a117, v69
    s_waitcnt lgkmcnt(4)
    v_accvgpr_write_b32 a118, v70
    v_accvgpr_write_b32 a119, v71
    s_waitcnt lgkmcnt(3)
    v_accvgpr_write_b32 a120, v72
    v_accvgpr_write_b32 a121, v73
    s_waitcnt lgkmcnt(2)
    v_accvgpr_write_b32 a122, v74
    v_accvgpr_write_b32 a123, v75
    s_waitcnt lgkmcnt(1)
    v_accvgpr_write_b32 a124, v76
    v_accvgpr_write_b32 a125, v77
    s_waitcnt lgkmcnt(0)
    v_accvgpr_write_b32 a126, v78
    v_accvgpr_write_b32 a127, v79
    ds_read_b64_tr_b16 v[64:65], v28 offset:0
    ds_read_b64_tr_b16 v[66:67], v28 offset:512
    ds_read_b64_tr_b16 v[68:69], v28 offset:4096
    ds_read_b64_tr_b16 v[70:71], v28 offset:4608
    ds_read_b64_tr_b16 v[72:73], v28 offset:8192
    ds_read_b64_tr_b16 v[74:75], v28 offset:8704
    ds_read_b64_tr_b16 v[76:77], v28 offset:12288
    ds_read_b64_tr_b16 v[78:79], v28 offset:12800
    s_waitcnt lgkmcnt(7)
    v_accvgpr_write_b32 a0, v64
    v_accvgpr_write_b32 a1, v65
    ds_read_b64_tr_b16 v[64:65], v28 offset:16384
    s_waitcnt lgkmcnt(7)
    v_accvgpr_write_b32 a2, v66
    v_accvgpr_write_b32 a3, v67
    ds_read_b64_tr_b16 v[66:67], v28 offset:16896
    s_waitcnt lgkmcnt(7)
    v_accvgpr_write_b32 a4, v68
    v_accvgpr_write_b32 a5, v69
    ds_read_b64_tr_b16 v[68:69], v28 offset:20480
    s_waitcnt lgkmcnt(7)
    v_accvgpr_write_b32 a6, v70
    v_accvgpr_write_b32 a7, v71
    ds_read_b64_tr_b16 v[70:71], v28 offset:20992
    s_waitcnt lgkmcnt(7)
    v_accvgpr_write_b32 a8, v72
    v_accvgpr_write_b32 a9, v73
    ds_read_b64_tr_b16 v[72:73], v28 offset:24576
    s_waitcnt lgkmcnt(7)
    v_accvgpr_write_b32 a10, v74
    v_accvgpr_write_b32 a11, v75
    ds_read_b64_tr_b16 v[74:75], v28 offset:25088
    s_waitcnt lgkmcnt(7)
    v_accvgpr_write_b32 a12, v76
    v_accvgpr_write_b32 a13, v77
    ds_read_b64_tr_b16 v[76:77], v28 offset:28672
    s_waitcnt lgkmcnt(7)
    v_accvgpr_write_b32 a14, v78
    v_accvgpr_write_b32 a15, v79
    ds_read_b64_tr_b16 v[78:79], v28 offset:29184
    s_waitcnt lgkmcnt(7)
    v_accvgpr_write_b32 a16, v64
    v_accvgpr_write_b32 a17, v65
    ds_read_b64_tr_b16 v[64:65], v28 offset:32768
    s_waitcnt lgkmcnt(7)
    v_accvgpr_write_b32 a18, v66
    v_accvgpr_write_b32 a19, v67
    ds_read_b64_tr_b16 v[66:67], v28 offset:33280
    s_waitcnt lgkmcnt(7)
    v_accvgpr_write_b32 a20, v68
    v_accvgpr_write_b32 a21, v69
    ds_read_b64_tr_b16 v[68:69], v28 offset:36864
    s_waitcnt lgkmcnt(7)
    v_accvgpr_write_b32 a22, v70
    v_accvgpr_write_b32 a23, v71
    ds_read_b64_tr_b16 v[70:71], v28 offset:37376
    s_waitcnt lgkmcnt(7)
    v_accvgpr_write_b32 a24, v72
    v_accvgpr_write_b32 a25, v73
    ds_read_b64_tr_b16 v[72:73], v28 offset:40960
    s_waitcnt lgkmcnt(7)
    v_accvgpr_write_b32 a26, v74
    v_accvgpr_write_b32 a27, v75
    ds_read_b64_tr_b16 v[74:75], v28 offset:41472
    s_waitcnt lgkmcnt(7)
    v_accvgpr_write_b32 a28, v76
    v_accvgpr_write_b32 a29, v77
    ds_read_b64_tr_b16 v[76:77], v28 offset:45056
    s_waitcnt lgkmcnt(7)
    v_accvgpr_write_b32 a30, v78
    v_accvgpr_write_b32 a31, v79
    ds_read_b64_tr_b16 v[78:79], v28 offset:45568
    s_waitcnt lgkmcnt(7)
    v_accvgpr_write_b32 a32, v64
    v_accvgpr_write_b32 a33, v65
    ds_read_b64_tr_b16 v[64:65], v28 offset:49152
    s_waitcnt lgkmcnt(7)
    v_accvgpr_write_b32 a34, v66
    v_accvgpr_write_b32 a35, v67
    ds_read_b64_tr_b16 v[66:67], v28 offset:49664
    s_waitcnt lgkmcnt(7)
    v_accvgpr_write_b32 a36, v68
    v_accvgpr_write_b32 a37, v69
    ds_read_b64_tr_b16 v[68:69], v28 offset:53248
    s_waitcnt lgkmcnt(7)
    v_accvgpr_write_b32 a38, v70
    v_accvgpr_write_b32 a39, v71
    ds_read_b64_tr_b16 v[70:71], v28 offset:53760
    s_waitcnt lgkmcnt(7)
    v_accvgpr_write_b32 a40, v72
    v_accvgpr_write_b32 a41, v73
    ds_read_b64_tr_b16 v[72:73], v28 offset:57344
    s_waitcnt lgkmcnt(7)
    v_accvgpr_write_b32 a42, v74
    v_accvgpr_write_b32 a43, v75
    ds_read_b64_tr_b16 v[74:75], v28 offset:57856
    s_waitcnt lgkmcnt(7)
    v_accvgpr_write_b32 a44, v76
    v_accvgpr_write_b32 a45, v77
    ds_read_b64_tr_b16 v[76:77], v28 offset:61440
    s_waitcnt lgkmcnt(7)
    v_accvgpr_write_b32 a46, v78
    v_accvgpr_write_b32 a47, v79
    ds_read_b64_tr_b16 v[78:79], v28 offset:61952
    s_waitcnt lgkmcnt(7)
    v_accvgpr_write_b32 a48, v64
    v_accvgpr_write_b32 a49, v65
    s_waitcnt lgkmcnt(6)
    v_accvgpr_write_b32 a50, v66
    v_accvgpr_write_b32 a51, v67
    s_waitcnt lgkmcnt(5)
    v_accvgpr_write_b32 a52, v68
    v_accvgpr_write_b32 a53, v69
    s_waitcnt lgkmcnt(4)
    v_accvgpr_write_b32 a54, v70
    v_accvgpr_write_b32 a55, v71
    s_waitcnt lgkmcnt(3)
    v_accvgpr_write_b32 a56, v72
    v_accvgpr_write_b32 a57, v73
    s_waitcnt lgkmcnt(2)
    v_accvgpr_write_b32 a58, v74
    v_accvgpr_write_b32 a59, v75
    s_waitcnt lgkmcnt(1)
    v_accvgpr_write_b32 a60, v76
    v_accvgpr_write_b32 a61, v77
    s_waitcnt lgkmcnt(0)
    v_accvgpr_write_b32 a62, v78
    v_accvgpr_write_b32 a63, v79
    s_barrier
    v_lshlrev_b32 v6, 4, v1
    s_mul_i32 s62, s56, 8448
    v_add_u32 v7, s62, v6
    s_lshl_b32 s62, s56, 13
    v_add_u32 v6, s62, v6
    v_mul_u32_u24 v8, 1056, v2
    v_lshlrev_b32 v9, 4, v3
    v_add_u32 v8, v8, v9
    s_lshl_b32 s62, s58, 13
    s_lshl_b32 s63, s68, 2
    s_add_u32 s63, s63, s56
    s_lshl_b32 s63, s63, 10
    s_add_u32 s63, s63, s62
    v_lshlrev_b32 v10, 4, v1
    v_add_u32 v10, s63, v10
    s_lshl_b32 s62, s58, 1
    s_add_u32 s62, s62, s68
    s_lshl_b32 s62, s62, 2
    s_add_u32 s62, s62, s56
    s_lshl_b32 s62, s62, 2
    v_mov_b32 v11, s62
    v_lshlrev_b32 v12, 2, v1
    v_mov_b32 v13, 1
    v_lshlrev_b32 v120, 2, v1
    s_cmp_lg_u32 s56, 0
    s_cbranch_scc1 Lcw_31
Lcw_30:
    buffer_load_dword v121, v120, s[36:39], 0 offen sc1
    s_add_u32 s99, s99, 1
    s_cmp_gt_u32 s99, 0x2dc6c0
    s_cbranch_scc0 Lto_32
    s_mov_b32 s3, 2
    s_branch L_abort
Lto_32:
    s_waitcnt vmcnt(0)
    v_readlane_b32 s3, v121, 8
    s_cmp_ge_u32 s3, 256
    s_cbranch_scc1 Lcw_33
    s_sleep 8
    s_branch Lcw_30
Lcw_33:
    v_readlane_b32 s3, v121, s57
    v_mov_b32 v120, 163836
    s_nop 0
    v_mov_b32 v121, s3
    ds_write_b32 v120, v121
    s_waitcnt lgkmcnt(0)
Lcw_31:
    s_barrier
    v_mov_b32 v120, 163836
    ds_read_b32 v121, v120
    s_waitcnt lgkmcnt(0)
    v_readfirstlane_b32 s3, v121
    s_cmp_lt_u32 s3, 32
    s_cselect_b32 s59, 1, 0
    s_barrier
    s_mov_b32 s82, 0
    s_mov_b32 s84, 0
    v_mul_u32_u24 v17, 144, v2
    v_lshlrev_b32 v18, 3, v3
    v_add_u32 v17, v17, v18
    s_lshl_b32 s62, s56, 5
    s_add_u32 s62, s62, 67648
    v_add_u32 v17, s62, v17
    v_mul_u32_u24 v18, 144, v2
    v_lshlrev_b32 v19, 4, v3
    v_add_u32 v18, v18, v19
    s_lshr_b32 s62, s56, 1
    s_mul_i32 s63, s62, 2304
    s_and_b32 s3, s56, 1
    s_lshl_b32 s61, s3, 6
    s_add_u32 s63, s63, s61
    s_add_u32 s63, s63, 67648
    v_add_u32 v18, s63, v18
    s_lshl_b32 s62, s62, 2
    s_add_u32 s62, s62, s3
    s_lshl_b32 s63, s68, 1
    s_add_u32 s62, s62, s63
    s_lshl_b32 s62, s62, 10
    s_lshl_b32 s63, s58, 13
    s_add_u32 s62, s62, s63
    v_lshlrev_b32 v9, 4, v1
    v_add_u32 v9, s62, v9
    s_mov_b32 s83, s66
    v_mov_b32 v14, 0x10800
    v_mov_b32 v16, 0
    s_mov_b32 s73, 0x9200000
    s_mov_b32 s74, 0x9300000
    s_mov_b32 s75, 0x9400000
    s_mov_b32 s76, 0x9500000
    s_mov_b32 s71, 0
    s_mov_b32 s77, 0x9500000
    s_lshl_b32 s62, s58, 10
    s_lshl_b32 s63, s56, 8
    s_add_u32 s62, s62, s63
    v_add_u32 v24, s62, v12
    s_mov_b32 s78, s64
    v_lshlrev_b32 v26, 9, v1
    v_add_u32 v26, 0x2001f0, v26
    s_mov_b32 s81, 999
    s_min_u32 s3, s78, 63
    s_lshl_b32 s3, s3, 15
    buffer_load_dword v25, v24, s[32:35], s3 offen
    s_add_u32 s78, s78, 1
    s_min_u32 s3, s78, 63
    s_lshl_b32 s3, s3, 15
    buffer_load_dword v25, v24, s[32:35], s3 offen
    s_add_u32 s78, s78, 1
    s_min_u32 s3, s78, 63
    s_lshl_b32 s3, s3, 15
    buffer_load_dword v25, v24, s[32:35], s3 offen
    s_add_u32 s78, s78, 1
    s_min_u32 s3, s78, 63
    s_lshl_b32 s3, s3, 15
    buffer_load_dword v25, v24, s[32:35], s3 offen
    s_add_u32 s78, s78, 1
    s_branch Lqacq_34
Lqacq_34:
    s_cmp_eq_u32 s71, 0
    s_cbranch_scc1 Lqf_38
    s_mov_b32 s86, 0
    s_cmp_lt_u32 s64, s65
    s_cbranch_scc1 Lqj_41
    s_cmp_ge_u32 s83, 64
    s_cbranch_scc1 Lqj_41
    s_cmp_lg_u32 s84, 0
    s_cbranch_scc1 Lqz_42
    s_cmp_lg_u32 s56, 0
    s_cbranch_scc1 Ldw_44
    v_mov_b32 v120, 72
    s_mov_b64 exec, 1
Ldw_43:
    buffer_load_dword v121, v120, s[36:39], 0 offen sc1
    s_add_u32 s99, s99, 1
    s_cmp_gt_u32 s99, 0x2dc6c0
    s_cbranch_scc0 Lto_45
    s_mov_b32 s3, 8
    s_branch L_abort
Lto_45:
    s_waitcnt vmcnt(0)
    v_cmp_gt_u32 vcc, 32, v121
    s_cbranch_vccz Ldw_46
    s_sleep 8
    s_branch Ldw_43
Ldw_46:
    s_mov_b64 exec, -1
Ldw_44:
    s_barrier
    s_mov_b32 s84, 1
Lqz_42:
    s_or_b32 s70, s83, 0x100
    s_mov_b32 s86, 1
    s_lshr_b32 s61, s70, 8
    s_lshl_b32 s61, s61, 21
    s_and_b32 s62, s70, 0xff
    s_lshl_b32 s62, s62, 15
    s_add_u32 s61, s61, s62
    buffer_load_dwordx4 v[128:131], v6, s[32:35], s61 offen offset:0 sc1
    buffer_load_dwordx4 v[132:135], v6, s[32:35], s61 offen offset:1024 sc1
    buffer_load_dwordx4 v[136:139], v6, s[32:35], s61 offen offset:2048 sc1
    buffer_load_dwordx4 v[140:143], v6, s[32:35], s61 offen offset:3072 sc1
    s_add_u32 s61, s61, 4096
    buffer_load_dwordx4 v[144:147], v6, s[32:35], s61 offen offset:0 sc1
    buffer_load_dwordx4 v[148:151], v6, s[32:35], s61 offen offset:1024 sc1
    buffer_load_dwordx4 v[152:155], v6, s[32:35], s61 offen offset:2048 sc1
    buffer_load_dwordx4 v[156:159], v6, s[32:35], s61 offen offset:3072 sc1
    s_mov_b32 s87, s61
Lqj_41:
    v_cvt_pk_bf16_f32 v36, v96, v97
    v_cvt_pk_bf16_f32 v37, v98, v99
    ds_write_b64 v17, v[36:37] offset:4608
    v_cvt_pk_bf16_f32 v38, v100, v101
    v_cvt_pk_bf16_f32 v39, v102, v103
    ds_write_b64 v17, v[38:39] offset:6912
    v_cvt_pk_bf16_f32 v40, v104, v105
    v_cvt_pk_bf16_f32 v41, v106, v107
    v_cvt_pk_bf16_f32 v42, v108, v109
    v_cvt_pk_bf16_f32 v43, v110, v111
    buffer_store_dwordx4 v[40:43], v10, s[32:35], s75 offen sc1
    v_cvt_pk_bf16_f32 v32, v88, v89
    v_cvt_pk_bf16_f32 v33, v90, v91
    ds_write_b64 v17, v[32:33] offset:0
    v_cvt_pk_bf16_f32 v34, v92, v93
    v_cvt_pk_bf16_f32 v35, v94, v95
    ds_write_b64 v17, v[34:35] offset:2304
    s_waitcnt lgkmcnt(0)
    s_barrier
    ds_read_b128 v[48:51], v18
    ds_read_b128 v[52:55], v18 offset:4608
    s_waitcnt lgkmcnt(0)
    buffer_store_dwordx4 v[52:55], v9, s[32:35], s74 offen sc1
    buffer_store_dwordx4 v[48:51], v9, s[32:35], s73 offen sc1
    s_cmp_eq_u32 s86, 0
    s_cbranch_scc1 Lqj_39
    s_waitcnt vmcnt(3)
    s_mov_b64 exec, 1
    buffer_store_dword v13, v11, s[32:35], s77 offen sc1
    s_mov_b64 exec, -1
    s_mov_b32 s77, s76
    s_mov_b32 s61, s87
    s_mov_b32 s73, 0x9200000
    s_mov_b32 s74, 0x9300000
    s_mov_b32 s75, 0x9400000
    s_mov_b32 s76, 0x9500000
    s_mov_b32 s71, 0
    v_max3_u32 v28, v128, v132, v136
    v_max3_u32 v29, v140, v144, v148
    v_max3_u32 v28, v28, v152, v156
    v_max_u32 v28, v28, v29
    v_cmp_eq_u32 vcc, -1, v28
    s_cbranch_vccz Lqj_47
    s_waitcnt vmcnt(0)
    s_mov_b64 exec, 1
    buffer_store_dword v13, v11, s[32:35], s77 offen sc1
    s_mov_b64 exec, -1
    s_mov_b32 s77, 0x9500000
Lqj_48:
    s_add_u32 s3, s61, 3072
    buffer_load_dwordx4 v[156:159], v6, s[32:35], s3 offen sc1
    s_sleep 2
    s_add_u32 s99, s99, 1
    s_cmp_gt_u32 s99, 0x2dc6c0
    s_cbranch_scc0 Lto_49
    s_mov_b32 s3, 7
    s_branch L_abort
Lto_49:
    s_waitcnt vmcnt(0)
    v_cmp_eq_u32 vcc, -1, v156
    s_cbranch_vccnz Lqj_48
    s_lshr_b32 s61, s70, 8
    s_lshl_b32 s61, s61, 21
    s_and_b32 s62, s70, 0xff
    s_lshl_b32 s62, s62, 15
    s_add_u32 s61, s61, s62
    buffer_load_dwordx4 v[128:131], v6, s[32:35], s61 offen offset:0 sc1
    buffer_load_dwordx4 v[132:135], v6, s[32:35], s61 offen offset:1024 sc1
    buffer_load_dwordx4 v[136:139], v6, s[32:35], s61 offen offset:2048 sc1
    buffer_load_dwordx4 v[140:143], v6, s[32:35], s61 offen offset:3072 sc1
    s_add_u32 s61, s61, 4096
    buffer_load_dwordx4 v[144:147], v6, s[32:35], s61 offen offset:0 sc1
    buffer_load_dwordx4 v[148:151], v6, s[32:35], s61 offen offset:1024 sc1
    buffer_load_dwordx4 v[152:155], v6, s[32:35], s61 offen offset:2048 sc1
    buffer_load_dwordx4 v[156:159], v6, s[32:35], s61 offen offset:3072 sc1
    s_waitcnt vmcnt(0)
    v_max3_u32 v28, v128, v132, v136
    v_max3_u32 v29, v140, v144, v148
    v_max3_u32 v28, v28, v152, v156
    v_max_u32 v28, v28, v29
    v_cmp_eq_u32 vcc, -1, v28
    s_cbranch_vccnz Lqj_48
Lqj_47:
    s_add_u32 s83, s83, 1
    s_mov_b32 s66, s83
    s_branch Lqj_40
Lqj_39:
    s_waitcnt vmcnt(3)
    s_mov_b64 exec, 1
    buffer_store_dword v13, v11, s[32:35], s77 offen sc1
    s_mov_b64 exec, -1
    s_waitcnt vmcnt(1)
    s_mov_b64 exec, 1
    buffer_store_dword v13, v11, s[32:35], s76 offen sc1
    s_mov_b64 exec, -1
    s_mov_b32 s73, 0x9200000
    s_mov_b32 s74, 0x9300000
    s_mov_b32 s75, 0x9400000
    s_mov_b32 s76, 0x9500000
    s_mov_b32 s71, 0
    s_mov_b32 s77, 0x9500000
Lqf_38:
    s_cmp_lg_u32 s56, 0
    s_cbranch_scc1 Lqd_50
Lqp_51:
    s_cmp_ge_u32 s66, 64
    s_cbranch_scc1 Lq1_52
    s_cmp_ge_u32 s64, s65
    s_cbranch_scc1 Lqe_55
    s_add_u32 s3, s66, 14
    s_cmp_lt_u32 s64, s3
    s_cbranch_scc1 Lq1_52
Lqe_55:
    s_cmp_lg_u32 s82, 0
    s_cbranch_scc1 Lqz_56
    v_mov_b32 v28, 72
    buffer_load_dword v29, v28, s[36:39], 0 offen sc1
    s_waitcnt vmcnt(0)
    v_readfirstlane_b32 s3, v29
    s_cmp_ge_u32 s3, 32
    s_cselect_b32 s82, 1, 0
    s_mov_b32 s81, 999
    s_cmp_eq_u32 s82, 0
    s_cbranch_scc1 Lq1_52
Lqz_56:
    s_lshl_b32 s3, s66, 15
    s_mov_b32 s81, s66
    buffer_load_dword v16, v26, s[32:35], s3 offen sc1
    s_waitcnt vmcnt(0)
    s_cmp_lg_u32 s81, s66
    s_cbranch_scc1 Lq1_52
    v_cmp_eq_u32 vcc, -1, v16
    s_cbranch_vccnz Lq1_52
    s_or_b32 s3, s66, 0x100
    s_add_u32 s66, s66, 1
    s_branch Lqw_53
Lq1_52:
    s_cmp_ge_u32 s64, s65
    s_cbranch_scc1 Lqdn_54
    s_mov_b32 s3, s64
    s_add_u32 s64, s64, 1
    s_branch Lqw_53
Lqdn_54:
    s_mov_b32 s3, 0xffff
    s_cmp_ge_u32 s66, 64
    s_cbranch_scc1 Lqw_53
    s_sleep 2
    s_add_u32 s99, s99, 1
    s_cmp_gt_u32 s99, 0x2dc6c0
    s_cbranch_scc0 Lto_57
    s_mov_b32 s3, 3
    s_branch L_abort
Lto_57:
    s_branch Lqp_51
Lqw_53:
    v_mov_b32 v21, s3
    ds_write_b32 v14, v21 offset:8
Lqd_50:
    s_waitcnt lgkmcnt(0)
    s_barrier
    ds_read_b32 v21, v14 offset:8
    s_waitcnt lgkmcnt(0)
    v_readfirstlane_b32 s70, v21
    s_cmp_eq_u32 s70, 0xffff
    s_cbranch_scc1 L_after_qkv
    s_cmp_ge_u32 s70, 0xfffe
    s_cbranch_scc1 Lqt_59
    s_cmp_lt_u32 s70, 0x100
    s_cbranch_scc1 Lqt_58
    s_and_b32 s83, s70, 0xff
    s_add_u32 s83, s83, 1
    s_branch Lqt_59
Lqt_58:
    s_add_u32 s3, s70, 1
    s_max_u32 s64, s64, s3
Lqt_59:
Lqre_60:
    s_lshr_b32 s61, s70, 8
    s_lshl_b32 s61, s61, 21
    s_and_b32 s62, s70, 0xff
    s_lshl_b32 s62, s62, 15
    s_add_u32 s61, s61, s62
    buffer_load_dwordx4 v[128:131], v6, s[32:35], s61 offen offset:0 sc1
    buffer_load_dwordx4 v[132:135], v6, s[32:35], s61 offen offset:1024 sc1
    buffer_load_dwordx4 v[136:139], v6, s[32:35], s61 offen offset:2048 sc1
    buffer_load_dwordx4 v[140:143], v6, s[32:35], s61 offen offset:3072 sc1
    s_add_u32 s61, s61, 4096
    buffer_load_dwordx4 v[144:147], v6, s[32:35], s61 offen offset:0 sc1
    buffer_load_dwordx4 v[148:151], v6, s[32:35], s61 offen offset:1024 sc1
    buffer_load_dwordx4 v[152:155], v6, s[32:35], s61 offen offset:2048 sc1
    buffer_load_dwordx4 v[156:159], v6, s[32:35], s61 offen offset:3072 sc1
    s_sleep 2
    s_add_u32 s99, s99, 1
    s_cmp_gt_u32 s99, 0x2dc6c0
    s_cbranch_scc0 Lto_61
    s_mov_b32 s3, 4
    s_branch L_abort
Lto_61:
    s_waitcnt vmcnt(0)
    v_max3_u32 v28, v128, v132, v136
    v_max3_u32 v29, v140, v144, v148
    v_max3_u32 v28, v28, v152, v156
    v_max_u32 v28, v28, v29
    v_cmp_eq_u32 vcc, -1, v28
    s_cbranch_vccnz Lqre_60
Lqj_40:
    ds_write_b128 v7, v[128:131] offset:0
    ds_write_b128 v7, v[132:135] offset:1056
    ds_write_b128 v7, v[136:139] offset:2112
    ds_write_b128 v7, v[140:143] offset:3168
    ds_write_b128 v7, v[144:147] offset:4224
    ds_write_b128 v7, v[148:151] offset:5280
    ds_write_b128 v7, v[152:155] offset:6336
    ds_write_b128 v7, v[156:159] offset:7392
    s_cmp_lg_u32 s56, 0
    s_cbranch_scc1 Lqd_62
Lqp_63:
    s_cmp_ge_u32 s66, 64
    s_cbranch_scc1 Lq1_64
    s_cmp_ge_u32 s64, s65
    s_cbranch_scc1 Lqe_67
    s_add_u32 s3, s66, 14
    s_cmp_lt_u32 s64, s3
    s_cbranch_scc1 Lq1_64
Lqe_67:
    s_cmp_lg_u32 s82, 0
    s_cbranch_scc1 Lqz_68
    v_mov_b32 v28, 72
    buffer_load_dword v29, v28, s[36:39], 0 offen sc1
    s_waitcnt vmcnt(0)
    v_readfirstlane_b32 s3, v29
    s_cmp_ge_u32 s3, 32
    s_cselect_b32 s82, 1, 0
    s_mov_b32 s81, 999
    s_cmp_eq_u32 s82, 0
    s_cbranch_scc1 Lq1_64
Lqz_68:
    s_cmp_lg_u32 s81, s66
    s_cbranch_scc1 Lq1_64
    v_cmp_eq_u32 vcc, -1, v16
    s_cbranch_vccnz Lq1_64
    s_or_b32 s3, s66, 0x100
    s_add_u32 s66, s66, 1
    s_branch Lqw_65
Lq1_64:
    s_cmp_ge_u32 s64, s65
    s_cbranch_scc1 Lqdn_66
    s_mov_b32 s3, s64
    s_add_u32 s64, s64, 1
    s_branch Lqw_65
Lqdn_66:
    s_mov_b32 s3, 0xffff
    s_cmp_ge_u32 s66, 64
    s_cbranch_scc1 Lqw_65
    s_mov_b32 s3, 0xfffe
Lqw_65:
    v_mov_b32 v21, s3
    ds_write_b32 v14, v21 offset:0
Lqd_62:
    s_mov_b32 s69, s70
Lqloop_36:
    s_waitcnt lgkmcnt(0)
    s_barrier
    ds_read_b128 v[160:163], v8 offset:0
    ds_read_b128 v[164:167], v8 offset:16896
    ds_read_b128 v[168:171], v8 offset:64
    ds_read_b128 v[172:175], v8 offset:16960
    ds_read_b128 v[176:179], v8 offset:128
    ds_read_b32 v21, v14 offset:0
    ds_read_b128 v[180:183], v8 offset:17024
    s_waitcnt lgkmcnt(5)
    v_mfma_f32_16x16x32_bf16 v[72:75], a[64:67], v[160:163], 0
    v_mfma_f32_16x16x32_bf16 v[80:83], v[160:163], a[128:131], 0
    v_mfma_f32_16x16x32_bf16 v[64:67], a[0:3], v[160:163], 0
    v_cvt_pk_bf16_f32 v36, v96, v97
    v_cvt_pk_bf16_f32 v37, v98, v99
    ds_write_b64 v17, v[36:37] offset:4608
    s_cmp_lg_u32 s56, 0
    s_cbranch_scc1 Lqw0_69
    s_cmp_ge_u32 s66, 64
    s_cbranch_scc1 Lqw0_69
    s_lshl_b32 s3, s66, 15
    s_mov_b32 s81, s66
    buffer_load_dword v16, v26, s[32:35], s3 offen sc1
    s_branch Lqw1_70
Lqw0_69:
    buffer_load_dword v25, v24, s[32:35], 0 offen
Lqw1_70:
    ds_read_b128 v[160:163], v8 offset:192
    v_mfma_f32_16x16x32_bf16 v[76:79], a[64:67], v[164:167], 0
    v_mfma_f32_16x16x32_bf16 v[84:87], v[164:167], a[128:131], 0
    v_mfma_f32_16x16x32_bf16 v[68:71], a[0:3], v[164:167], 0
    v_cvt_pk_bf16_f32 v38, v100, v101
    v_cvt_pk_bf16_f32 v39, v102, v103
    ds_write_b64 v17, v[38:39] offset:6912
    s_waitcnt lgkmcnt(4)
    v_readfirstlane_b32 s70, v21
    s_cmp_ge_u32 s70, 0xfffe
    s_cbranch_scc1 Lqt_72
    s_cmp_lt_u32 s70, 0x100
    s_cbranch_scc1 Lqt_71
    s_and_b32 s83, s70, 0xff
    s_add_u32 s83, s83, 1
    s_branch Lqt_72
Lqt_71:
    s_add_u32 s3, s70, 1
    s_max_u32 s64, s64, s3
Lqt_72:
    s_cmp_ge_u32 s70, 0xfffe
    s_cselect_b32 s79, s69, s70
    s_lshr_b32 s61, s79, 8
    s_lshl_b32 s61, s61, 21
    s_and_b32 s62, s79, 0xff
    s_lshl_b32 s62, s62, 15
    s_add_u32 s79, s61, s62
    ds_read_b128 v[164:167], v8 offset:17088
    v_mfma_f32_16x16x32_bf16 v[72:75], a[68:71], v[168:171], v[72:75]
    v_mfma_f32_16x16x32_bf16 v[80:83], v[168:171], a[132:135], v[80:83]
    v_mfma_f32_16x16x32_bf16 v[64:67], a[4:7], v[168:171], v[64:67]
    v_cvt_pk_bf16_f32 v32, v88, v89
    v_cvt_pk_bf16_f32 v33, v90, v91
    ds_write_b64 v17, v[32:33] offset:0
    s_cmp_lg_u32 s56, 0
    s_cbranch_scc1 Lqdw_73
    s_mul_i32 s62, s56, 8448
    s_add_u32 s62, s62, 33792
    s_mov_b32 s61, s79
    s_mov_b32 m0, s62
    s_nop 0
    buffer_load_dwordx4 v6, s[32:35], s61 offen lds
    s_add_u32 s61, s61, 1024
    s_add_u32 s62, s62, 1056
    s_mov_b32 m0, s62
    s_nop 0
    buffer_load_dwordx4 v6, s[32:35], s61 offen lds
    s_add_u32 s61, s61, 1024
    s_add_u32 s62, s62, 1056
    s_mov_b32 m0, s62
    s_nop 0
    buffer_load_dwordx4 v6, s[32:35], s61 offen lds
    s_add_u32 s61, s61, 1024
    s_add_u32 s62, s62, 1056
    s_mov_b32 m0, s62
    s_nop 0
    buffer_load_dwordx4 v6, s[32:35], s61 offen lds
    s_add_u32 s61, s61, 1024
    s_add_u32 s62, s62, 1056
    s_mov_b32 m0, s62
    s_nop 0
    buffer_load_dwordx4 v6, s[32:35], s61 offen lds
    s_add_u32 s61, s61, 1024
    s_add_u32 s62, s62, 1056
    s_mov_b32 m0, s62
    s_nop 0
    buffer_load_dwordx4 v6, s[32:35], s61 offen lds
    s_add_u32 s61, s61, 1024
    s_add_u32 s62, s62, 1056
    s_mov_b32 m0, s62
    s_nop 0
    buffer_load_dwordx4 v6, s[32:35], s61 offen lds
    s_add_u32 s61, s61, 1024
    s_add_u32 s62, s62, 1056
    s_mov_b32 m0, s62
    s_nop 0
    buffer_load_dwordx4 v6, s[32:35], s61 offen lds
Lqdw_73:
    ds_read_b128 v[168:171], v8 offset:256
    v_mfma_f32_16x16x32_bf16 v[76:79], a[68:71], v[172:175], v[76:79]
    v_mfma_f32_16x16x32_bf16 v[84:87], v[172:175], a[132:135], v[84:87]
    v_mfma_f32_16x16x32_bf16 v[68:71], a[4:7], v[172:175], v[68:71]
    v_cvt_pk_bf16_f32 v34, v92, v93
    v_cvt_pk_bf16_f32 v35, v94, v95
    ds_write_b64 v17, v[34:35] offset:2304
    ds_read_b128 v[172:175], v8 offset:17152
    s_waitcnt lgkmcnt(8)
    v_mfma_f32_16x16x32_bf16 v[72:75], a[72:75], v[176:179], v[72:75]
    v_mfma_f32_16x16x32_bf16 v[80:83], v[176:179], a[136:139], v[80:83]
    v_mfma_f32_16x16x32_bf16 v[64:67], a[8:11], v[176:179], v[64:67]
    s_cmp_lg_u32 s56, 1
    s_cbranch_scc1 Lqdw_74
    s_mul_i32 s62, s56, 8448
    s_add_u32 s62, s62, 33792
    s_mov_b32 s61, s79
    s_mov_b32 m0, s62
    s_nop 0
    buffer_load_dwordx4 v6, s[32:35], s61 offen lds
    s_add_u32 s61, s61, 1024
    s_add_u32 s62, s62, 1056
    s_mov_b32 m0, s62
    s_nop 0
    buffer_load_dwordx4 v6, s[32:35], s61 offen lds
    s_add_u32 s61, s61, 1024
    s_add_u32 s62, s62, 1056
    s_mov_b32 m0, s62
    s_nop 0
    buffer_load_dwordx4 v6, s[32:35], s61 offen lds
    s_add_u32 s61, s61, 1024
    s_add_u32 s62, s62, 1056
    s_mov_b32 m0, s62
    s_nop 0
    buffer_load_dwordx4 v6, s[32:35], s61 offen lds
    s_add_u32 s61, s61, 1024
    s_add_u32 s62, s62, 1056
    s_mov_b32 m0, s62
    s_nop 0
    buffer_load_dwordx4 v6, s[32:35], s61 offen lds
    s_add_u32 s61, s61, 1024
    s_add_u32 s62, s62, 1056
    s_mov_b32 m0, s62
    s_nop 0
    buffer_load_dwordx4 v6, s[32:35], s61 offen lds
    s_add_u32 s61, s61, 1024
    s_add_u32 s62, s62, 1056
    s_mov_b32 m0, s62
    s_nop 0
    buffer_load_dwordx4 v6, s[32:35], s61 offen lds
    s_add_u32 s61, s61, 1024
    s_add_u32 s62, s62, 1056
    s_mov_b32 m0, s62
    s_nop 0
    buffer_load_dwordx4 v6, s[32:35], s61 offen lds
Lqdw_74:
    ds_read_b128 v[176:179], v8 offset:320
    v_mfma_f32_16x16x32_bf16 v[76:79], a[72:75], v[180:183], v[76:79]
    v_mfma_f32_16x16x32_bf16 v[84:87], v[180:183], a[136:139], v[84:87]
    v_mfma_f32_16x16x32_bf16 v[68:71], a[8:11], v[180:183], v[68:71]
    ds_read_b128 v[180:183], v8 offset:17216
    s_waitcnt lgkmcnt(6)
    v_mfma_f32_16x16x32_bf16 v[72:75], a[76:79], v[160:163], v[72:75]
    v_mfma_f32_16x16x32_bf16 v[80:83], v[160:163], a[140:143], v[80:83]
    v_mfma_f32_16x16x32_bf16 v[64:67], a[12:15], v[160:163], v[64:67]
    s_cmp_lg_u32 s56, 2
    s_cbranch_scc1 Lqdw_75
    s_mul_i32 s62, s56, 8448
    s_add_u32 s62, s62, 33792
    s_mov_b32 s61, s79
    s_mov_b32 m0, s62
    s_nop 0
    buffer_load_dwordx4 v6, s[32:35], s61 offen lds
    s_add_u32 s61, s61, 1024
    s_add_u32 s62, s62, 1056
    s_mov_b32 m0, s62
    s_nop 0
    buffer_load_dwordx4 v6, s[32:35], s61 offen lds
    s_add_u32 s61, s61, 1024
    s_add_u32 s62, s62, 1056
    s_mov_b32 m0, s62
    s_nop 0
    buffer_load_dwordx4 v6, s[32:35], s61 offen lds
    s_add_u32 s61, s61, 1024
    s_add_u32 s62, s62, 1056
    s_mov_b32 m0, s62
    s_nop 0
    buffer_load_dwordx4 v6, s[32:35], s61 offen lds
    s_add_u32 s61, s61, 1024
    s_add_u32 s62, s62, 1056
    s_mov_b32 m0, s62
    s_nop 0
    buffer_load_dwordx4 v6, s[32:35], s61 offen lds
    s_add_u32 s61, s61, 1024
    s_add_u32 s62, s62, 1056
    s_mov_b32 m0, s62
    s_nop 0
    buffer_load_dwordx4 v6, s[32:35], s61 offen lds
    s_add_u32 s61, s61, 1024
    s_add_u32 s62, s62, 1056
    s_mov_b32 m0, s62
    s_nop 0
    buffer_load_dwordx4 v6, s[32:35], s61 offen lds
    s_add_u32 s61, s61, 1024
    s_add_u32 s62, s62, 1056
    s_mov_b32 m0, s62
    s_nop 0
    buffer_load_dwordx4 v6, s[32:35], s61 offen lds
Lqdw_75:
    ds_read_b128 v[160:163], v8 offset:384
    v_mfma_f32_16x16x32_bf16 v[76:79], a[76:79], v[164:167], v[76:79]
    v_mfma_f32_16x16x32_bf16 v[84:87], v[164:167], a[140:143], v[84:87]
    v_mfma_f32_16x16x32_bf16 v[68:71], a[12:15], v[164:167], v[68:71]
    ds_read_b128 v[164:167], v8 offset:17280
    s_waitcnt lgkmcnt(4)
    v_mfma_f32_16x16x32_bf16 v[72:75], a[80:83], v[168:171], v[72:75]
    v_mfma_f32_16x16x32_bf16 v[80:83], v[168:171], a[144:147], v[80:83]
    v_mfma_f32_16x16x32_bf16 v[64:67], a[16:19], v[168:171], v[64:67]
    s_cmp_lg_u32 s56, 3
    s_cbranch_scc1 Lqdw_76
    s_mul_i32 s62, s56, 8448
    s_add_u32 s62, s62, 33792
    s_mov_b32 s61, s79
    s_mov_b32 m0, s62
    s_nop 0
    buffer_load_dwordx4 v6, s[32:35], s61 offen lds
    s_add_u32 s61, s61, 1024
    s_add_u32 s62, s62, 1056
    s_mov_b32 m0, s62
    s_nop 0
    buffer_load_dwordx4 v6, s[32:35], s61 offen lds
    s_add_u32 s61, s61, 1024
    s_add_u32 s62, s62, 1056
    s_mov_b32 m0, s62
    s_nop 0
    buffer_load_dwordx4 v6, s[32:35], s61 offen lds
    s_add_u32 s61, s61, 1024
    s_add_u32 s62, s62, 1056
    s_mov_b32 m0, s62
    s_nop 0
    buffer_load_dwordx4 v6, s[32:35], s61 offen lds
    s_add_u32 s61, s61, 1024
    s_add_u32 s62, s62, 1056
    s_mov_b32 m0, s62
    s_nop 0
    buffer_load_dwordx4 v6, s[32:35], s61 offen lds
    s_add_u32 s61, s61, 1024
    s_add_u32 s62, s62, 1056
    s_mov_b32 m0, s62
    s_nop 0
    buffer_load_dwordx4 v6, s[32:35], s61 offen lds
    s_add_u32 s61, s61, 1024
    s_add_u32 s62, s62, 1056
    s_mov_b32 m0, s62
    s_nop 0
    buffer_load_dwordx4 v6, s[32:35], s61 offen lds
    s_add_u32 s61, s61, 1024
    s_add_u32 s62, s62, 1056
    s_mov_b32 m0, s62
    s_nop 0
    buffer_load_dwordx4 v6, s[32:35], s61 offen lds
Lqdw_76:
    ds_read_b128 v[168:171], v8 offset:448
    v_mfma_f32_16x16x32_bf16 v[76:79], a[80:83], v[172:175], v[76:79]
    v_mfma_f32_16x16x32_bf16 v[84:87], v[172:175], a[144:147], v[84:87]
    v_mfma_f32_16x16x32_bf16 v[68:71], a[16:19], v[172:175], v[68:71]
    s_barrier
    ds_read_b128 v[52:55], v18 offset:4608
    ds_read_b128 v[48:51], v18
    ds_read_b128 v[172:175], v8 offset:17344
    s_waitcnt lgkmcnt(6)
    v_mfma_f32_16x16x32_bf16 v[72:75], a[84:87], v[176:179], v[72:75]
    v_mfma_f32_16x16x32_bf16 v[80:83], v[176:179], a[148:151], v[80:83]
    v_mfma_f32_16x16x32_bf16 v[64:67], a[20:23], v[176:179], v[64:67]
    s_min_u32 s3, s78, 63
    s_lshl_b32 s3, s3, 15
    buffer_load_dword v25, v24, s[32:35], s3 offen
    s_add_u32 s78, s78, 1
    ds_read_b128 v[176:179], v8 offset:512
    v_mfma_f32_16x16x32_bf16 v[76:79], a[84:87], v[180:183], v[76:79]
    v_mfma_f32_16x16x32_bf16 v[84:87], v[180:183], a[148:151], v[84:87]
    v_mfma_f32_16x16x32_bf16 v[68:71], a[20:23], v[180:183], v[68:71]
    ds_read_b128 v[180:183], v8 offset:17408
    s_waitcnt lgkmcnt(6)
    v_mfma_f32_16x16x32_bf16 v[72:75], a[88:91], v[160:163], v[72:75]
    v_mfma_f32_16x16x32_bf16 v[80:83], v[160:163], a[152:155], v[80:83]
    v_mfma_f32_16x16x32_bf16 v[64:67], a[24:27], v[160:163], v[64:67]
    v_cvt_pk_bf16_f32 v40, v104, v105
    v_cvt_pk_bf16_f32 v41, v106, v107
    v_cvt_pk_bf16_f32 v42, v108, v109
    v_cvt_pk_bf16_f32 v43, v110, v111
    ds_read_b128 v[160:163], v8 offset:576
    v_mfma_f32_16x16x32_bf16 v[76:79], a[88:91], v[164:167], v[76:79]
    v_mfma_f32_16x16x32_bf16 v[84:87], v[164:167], a[152:155], v[84:87]
    v_mfma_f32_16x16x32_bf16 v[68:71], a[24:27], v[164:167], v[68:71]
    buffer_store_dwordx4 v[40:43], v10, s[32:35], s75 offen sc1
    ds_read_b128 v[164:167], v8 offset:17472
    s_waitcnt lgkmcnt(4)
    v_mfma_f32_16x16x32_bf16 v[72:75], a[92:95], v[168:171], v[72:75]
    v_mfma_f32_16x16x32_bf16 v[80:83], v[168:171], a[156:159], v[80:83]
    v_mfma_f32_16x16x32_bf16 v[64:67], a[28:31], v[168:171], v[64:67]
    ds_read_b128 v[168:171], v8 offset:640
    v_mfma_f32_16x16x32_bf16 v[76:79], a[92:95], v[172:175], v[76:79]
    v_mfma_f32_16x16x32_bf16 v[84:87], v[172:175], a[156:159], v[84:87]
    v_mfma_f32_16x16x32_bf16 v[68:71], a[28:31], v[172:175], v[68:71]
    ds_read_b128 v[172:175], v8 offset:17536
    s_waitcnt lgkmcnt(4)
    v_mfma_f32_16x16x32_bf16 v[72:75], a[96:99], v[176:179], v[72:75]
    v_mfma_f32_16x16x32_bf16 v[80:83], v[176:179], a[160:163], v[80:83]
    v_mfma_f32_16x16x32_bf16 v[64:67], a[32:35], v[176:179], v[64:67]
    buffer_store_dwordx4 v[52:55], v9, s[32:35], s74 offen sc1
    ds_read_b128 v[176:179], v8 offset:704
    v_mfma_f32_16x16x32_bf16 v[76:79], a[96:99], v[180:183], v[76:79]
    v_mfma_f32_16x16x32_bf16 v[84:87], v[180:183], a[160:163], v[84:87]
    v_mfma_f32_16x16x32_bf16 v[68:71], a[32:35], v[180:183], v[68:71]
    ds_read_b128 v[180:183], v8 offset:17600
    s_waitcnt lgkmcnt(4)
    v_mfma_f32_16x16x32_bf16 v[72:75], a[100:103], v[160:163], v[72:75]
    v_mfma_f32_16x16x32_bf16 v[80:83], v[160:163], a[164:167], v[80:83]
    v_mfma_f32_16x16x32_bf16 v[64:67], a[36:39], v[160:163], v[64:67]
    ds_read_b128 v[160:163], v8 offset:768
    v_mfma_f32_16x16x32_bf16 v[76:79], a[100:103], v[164:167], v[76:79]
    v_mfma_f32_16x16x32_bf16 v[84:87], v[164:167], a[164:167], v[84:87]
    v_mfma_f32_16x16x32_bf16 v[68:71], a[36:39], v[164:167], v[68:71]
    buffer_store_dwordx4 v[48:51], v9, s[32:35], s73 offen sc1
    ds_read_b128 v[164:167], v8 offset:17664
    s_waitcnt lgkmcnt(4)
    v_mfma_f32_16x16x32_bf16 v[72:75], a[104:107], v[168:171], v[72:75]
    v_mfma_f32_16x16x32_bf16 v[80:83], v[168:171], a[168:171], v[80:83]
    v_mfma_f32_16x16x32_bf16 v[64:67], a[40:43], v[168:171], v[64:67]
    ds_read_b128 v[168:171], v8 offset:832
    v_mfma_f32_16x16x32_bf16 v[76:79], a[104:107], v[172:175], v[76:79]
    v_mfma_f32_16x16x32_bf16 v[84:87], v[172:175], a[168:171], v[84:87]
    v_mfma_f32_16x16x32_bf16 v[68:71], a[40:43], v[172:175], v[68:71]
    ds_read_b128 v[172:175], v8 offset:17728
    s_waitcnt lgkmcnt(4)
    v_mfma_f32_16x16x32_bf16 v[72:75], a[108:111], v[176:179], v[72:75]
    v_mfma_f32_16x16x32_bf16 v[80:83], v[176:179], a[172:175], v[80:83]
    v_mfma_f32_16x16x32_bf16 v[64:67], a[44:47], v[176:179], v[64:67]
    ds_read_b128 v[176:179], v8 offset:896
    v_mfma_f32_16x16x32_bf16 v[76:79], a[108:111], v[180:183], v[76:79]
    v_mfma_f32_16x16x32_bf16 v[84:87], v[180:183], a[172:175], v[84:87]
    v_mfma_f32_16x16x32_bf16 v[68:71], a[44:47], v[180:183], v[68:71]
    ds_read_b128 v[180:183], v8 offset:17792
    s_waitcnt lgkmcnt(4)
    v_mfma_f32_16x16x32_bf16 v[72:75], a[112:115], v[160:163], v[72:75]
    v_mfma_f32_16x16x32_bf16 v[80:83], v[160:163], a[176:179], v[80:83]
    v_mfma_f32_16x16x32_bf16 v[64:67], a[48:51], v[160:163], v[64:67]
    s_waitcnt vmcnt(4)
    s_mov_b64 exec, 1
    buffer_store_dword v13, v11, s[32:35], s77 offen sc1
    s_mov_b64 exec, -1
    s_mov_b32 s77, s76
    ds_read_b128 v[160:163], v8 offset:960
    v_mfma_f32_16x16x32_bf16 v[76:79], a[112:115], v[164:167], v[76:79]
    v_mfma_f32_16x16x32_bf16 v[84:87], v[164:167], a[176:179], v[84:87]
    v_mfma_f32_16x16x32_bf16 v[68:71], a[48:51], v[164:167], v[68:71]
    s_cmp_lt_u32 s79, 0x200000
    s_cbranch_scc1 Lqg_77
Lqg_78:
    ds_read_b32 v128, v7 offset:33792
    ds_read_b32 v129, v7 offset:34848
    ds_read_b32 v130, v7 offset:35904
    ds_read_b32 v131, v7 offset:36960
    ds_read_b32 v132, v7 offset:38016
    ds_read_b32 v133, v7 offset:39072
    ds_read_b32 v134, v7 offset:40128
    ds_read_b32 v135, v7 offset:41184
    s_waitcnt lgkmcnt(0)
    v_max3_u32 v28, v128, v129, v130
    v_max3_u32 v29, v131, v132, v133
    v_max3_u32 v28, v28, v134, v135
    v_max_u32 v28, v28, v29
    v_cmp_eq_u32 vcc, -1, v28
    s_cbranch_vccz Lqg_77
    s_mul_i32 s62, s56, 8448
    s_add_u32 s62, s62, 33792
    s_mov_b32 s61, s79
    s_mov_b32 m0, s62
    s_nop 0
    buffer_load_dwordx4 v6, s[32:35], s61 offen sc1 lds
    s_add_u32 s61, s61, 1024
    s_add_u32 s62, s62, 1056
    s_mov_b32 m0, s62
    s_nop 0
    buffer_load_dwordx4 v6, s[32:35], s61 offen sc1 lds
    s_add_u32 s61, s61, 1024
    s_add_u32 s62, s62, 1056
    s_mov_b32 m0, s62
    s_nop 0
    buffer_load_dwordx4 v6, s[32:35], s61 offen sc1 lds
    s_add_u32 s61, s61, 1024
    s_add_u32 s62, s62, 1056
    s_mov_b32 m0, s62
    s_nop 0
    buffer_load_dwordx4 v6, s[32:35], s61 offen sc1 lds
    s_add_u32 s61, s61, 1024
    s_add_u32 s62, s62, 1056
    s_mov_b32 m0, s62
    s_nop 0
    buffer_load_dwordx4 v6, s[32:35], s61 offen sc1 lds
    s_add_u32 s61, s61, 1024
    s_add_u32 s62, s62, 1056
    s_mov_b32 m0, s62
    s_nop 0
    buffer_load_dwordx4 v6, s[32:35], s61 offen sc1 lds
    s_add_u32 s61, s61, 1024
    s_add_u32 s62, s62, 1056
    s_mov_b32 m0, s62
    s_nop 0
    buffer_load_dwordx4 v6, s[32:35], s61 offen sc1 lds
    s_add_u32 s61, s61, 1024
    s_add_u32 s62, s62, 1056
    s_mov_b32 m0, s62
    s_nop 0
    buffer_load_dwordx4 v6, s[32:35], s61 offen sc1 lds
    s_sleep 2
    s_add_u32 s99, s99, 1
    s_cmp_gt_u32 s99, 0x2dc6c0
    s_cbranch_scc0 Lto_79
    s_mov_b32 s3, 5
    s_branch L_abort
Lto_79:
    s_waitcnt vmcnt(0)
    s_branch Lqg_78
Lqg_77:
    ds_read_b128 v[164:167], v8 offset:17856
    s_waitcnt lgkmcnt(4)
    v_mfma_f32_16x16x32_bf16 v[72:75], a[116:119], v[168:171], v[72:75]
    v_mfma_f32_16x16x32_bf16 v[80:83], v[168:171], a[180:183], v[80:83]
    v_mfma_f32_16x16x32_bf16 v[64:67], a[52:55], v[168:171], v[64:67]
    v_mfma_f32_16x16x32_bf16 v[76:79], a[116:119], v[172:175], v[76:79]
    v_mfma_f32_16x16x32_bf16 v[84:87], v[172:175], a[180:183], v[84:87]
    v_mfma_f32_16x16x32_bf16 v[68:71], a[52:55], v[172:175], v[68:71]
    s_waitcnt lgkmcnt(2)
    v_mfma_f32_16x16x32_bf16 v[72:75], a[120:123], v[176:179], v[72:75]
    v_mfma_f32_16x16x32_bf16 v[80:83], v[176:179], a[184:187], v[80:83]
    v_mfma_f32_16x16x32_bf16 v[64:67], a[56:59], v[176:179], v[64:67]
    s_cmp_lg_u32 s56, 0
    s_cbranch_scc1 Lqd_80
    s_cmp_ge_u32 s70, 0xfffe
    s_cbranch_scc1 Lqd_80
Lqp_81:
    s_cmp_ge_u32 s66, 64
    s_cbranch_scc1 Lq1_82
    s_cmp_ge_u32 s64, s65
    s_cbranch_scc1 Lqe_85
    s_add_u32 s3, s66, 14
    s_cmp_lt_u32 s64, s3
    s_cbranch_scc1 Lq1_82
Lqe_85:
    s_cmp_lg_u32 s82, 0
    s_cbranch_scc1 Lqz_86
    v_mov_b32 v28, 72
    buffer_load_dword v29, v28, s[36:39], 0 offen sc1
    s_waitcnt vmcnt(0)
    v_readfirstlane_b32 s3, v29
    s_cmp_ge_u32 s3, 32
    s_cselect_b32 s82, 1, 0
    s_mov_b32 s81, 999
    s_cmp_eq_u32 s82, 0
    s_cbranch_scc1 Lq1_82
Lqz_86:
    s_cmp_lg_u32 s81, s66
    s_cbranch_scc1 Lq1_82
    v_cmp_eq_u32 vcc, -1, v16
    s_cbranch_vccnz Lq1_82
    s_or_b32 s3, s66, 0x100
    s_add_u32 s66, s66, 1
    s_branch Lqw_83
Lq1_82:
    s_cmp_ge_u32 s64, s65
    s_cbranch_scc1 Lqdn_84
    s_mov_b32 s3, s64
    s_add_u32 s64, s64, 1
    s_branch Lqw_83
Lqdn_84:
    s_mov_b32 s3, 0xffff
    s_cmp_ge_u32 s66, 64
    s_cbranch_scc1 Lqw_83
    s_mov_b32 s3, 0xfffe
Lqw_83:
    v_mov_b32 v21, s3
Lqd_80:
    s_cmp_lg_u32 s56, 0
    s_cselect_b32 s3, 16, 4
    v_add_u32 v23, s3, v14
    ds_write_b32 v23, v21
    v_mfma_f32_16x16x32_bf16 v[76:79], a[120:123], v[180:183], v[76:79]
    v_mfma_f32_16x16x32_bf16 v[84:87], v[180:183], a[184:187], v[84:87]
    v_mfma_f32_16x16x32_bf16 v[68:71], a[56:59], v[180:183], v[68:71]
    s_waitcnt lgkmcnt(1)
    v_mfma_f32_16x16x32_bf16 v[72:75], a[124:127], v[160:163], v[72:75]
    v_mfma_f32_16x16x32_bf16 v[80:83], v[160:163], a[188:191], v[80:83]
    v_mfma_f32_16x16x32_bf16 v[64:67], a[60:63], v[160:163], v[64:67]
    v_mfma_f32_16x16x32_bf16 v[76:79], a[124:127], v[164:167], v[76:79]
    v_mfma_f32_16x16x32_bf16 v[84:87], v[164:167], a[188:191], v[84:87]
    v_mfma_f32_16x16x32_bf16 v[68:71], a[60:63], v[164:167], v[68:71]
    s_lshr_b32 s60, s69, 8
    s_and_b32 s67, s69, 0xff
    s_lshl_b32 s61, s60, 24
    s_lshl_b32 s62, s67, 18
    s_add_u32 s61, s61, s62
    s_add_u32 s73, s61, 0x2000000
    s_add_u32 s74, s61, 0x4000000
    s_add_u32 s75, s61, 0x6000000
    s_lshl_b32 s61, s60, 16
    s_lshl_b32 s62, s67, 10
    s_add_u32 s61, s61, s62
    s_add_u32 s76, s61, 0x9000000
    s_mov_b32 s71, 1
    s_mov_b32 s69, s70
    s_cmp_ge_u32 s70, 0xfffe
    s_cbranch_scc1 Lqacq_35
    s_branch Lqloop_37
Lqacq_35:
    s_cmp_eq_u32 s71, 0
    s_cbranch_scc1 Lqf_87
    s_mov_b32 s86, 0
    s_cmp_lt_u32 s64, s65
    s_cbranch_scc1 Lqj_90
    s_cmp_ge_u32 s83, 64
    s_cbranch_scc1 Lqj_90
    s_cmp_lg_u32 s84, 0
    s_cbranch_scc1 Lqz_91
    s_cmp_lg_u32 s56, 0
    s_cbranch_scc1 Ldw_93
    v_mov_b32 v120, 72
    s_mov_b64 exec, 1
Ldw_92:
    buffer_load_dword v121, v120, s[36:39], 0 offen sc1
    s_add_u32 s99, s99, 1
    s_cmp_gt_u32 s99, 0x2dc6c0
    s_cbranch_scc0 Lto_94
    s_mov_b32 s3, 8
    s_branch L_abort
Lto_94:
    s_waitcnt vmcnt(0)
    v_cmp_gt_u32 vcc, 32, v121
    s_cbranch_vccz Ldw_95
    s_sleep 8
    s_branch Ldw_92
Ldw_95:
    s_mov_b64 exec, -1
Ldw_93:
    s_barrier
    s_mov_b32 s84, 1
Lqz_91:
    s_or_b32 s70, s83, 0x100
    s_mov_b32 s86, 1
    s_lshr_b32 s61, s70, 8
    s_lshl_b32 s61, s61, 21
    s_and_b32 s62, s70, 0xff
    s_lshl_b32 s62, s62, 15
    s_add_u32 s61, s61, s62
    buffer_load_dwordx4 v[128:131], v6, s[32:35], s61 offen offset:0 sc1
    buffer_load_dwordx4 v[132:135], v6, s[32:35], s61 offen offset:1024 sc1
    buffer_load_dwordx4 v[136:139], v6, s[32:35], s61 offen offset:2048 sc1
    buffer_load_dwordx4 v[140:143], v6, s[32:35], s61 offen offset:3072 sc1
    s_add_u32 s61, s61, 4096
    buffer_load_dwordx4 v[144:147], v6, s[32:35], s61 offen offset:0 sc1
    buffer_load_dwordx4 v[148:151], v6, s[32:35], s61 offen offset:1024 sc1
    buffer_load_dwordx4 v[152:155], v6, s[32:35], s61 offen offset:2048 sc1
    buffer_load_dwordx4 v[156:159], v6, s[32:35], s61 offen offset:3072 sc1
    s_mov_b32 s87, s61
Lqj_90:
    v_cvt_pk_bf16_f32 v36, v72, v73
    v_cvt_pk_bf16_f32 v37, v74, v75
    ds_write_b64 v17, v[36:37] offset:4608
    v_cvt_pk_bf16_f32 v38, v76, v77
    v_cvt_pk_bf16_f32 v39, v78, v79
    ds_write_b64 v17, v[38:39] offset:6912
    v_cvt_pk_bf16_f32 v40, v80, v81
    v_cvt_pk_bf16_f32 v41, v82, v83
    v_cvt_pk_bf16_f32 v42, v84, v85
    v_cvt_pk_bf16_f32 v43, v86, v87
    buffer_store_dwordx4 v[40:43], v10, s[32:35], s75 offen sc1
    v_cvt_pk_bf16_f32 v32, v64, v65
    v_cvt_pk_bf16_f32 v33, v66, v67
    ds_write_b64 v17, v[32:33] offset:0
    v_cvt_pk_bf16_f32 v34, v68, v69
    v_cvt_pk_bf16_f32 v35, v70, v71
    ds_write_b64 v17, v[34:35] offset:2304
    s_waitcnt lgkmcnt(0)
    s_barrier
    ds_read_b128 v[48:51], v18
    ds_read_b128 v[52:55], v18 offset:4608
    s_waitcnt lgkmcnt(0)
    buffer_store_dwordx4 v[52:55], v9, s[32:35], s74 offen sc1
    buffer_store_dwordx4 v[48:51], v9, s[32:35], s73 offen sc1
    s_cmp_eq_u32 s86, 0
    s_cbranch_scc1 Lqj_88
    s_waitcnt vmcnt(3)
    s_mov_b64 exec, 1
    buffer_store_dword v13, v11, s[32:35], s77 offen sc1
    s_mov_b64 exec, -1
    s_mov_b32 s77, s76
    s_mov_b32 s61, s87
    s_mov_b32 s73, 0x9200000
    s_mov_b32 s74, 0x9300000
    s_mov_b32 s75, 0x9400000
    s_mov_b32 s76, 0x9500000
    s_mov_b32 s71, 0
    v_max3_u32 v28, v128, v132, v136
    v_max3_u32 v29, v140, v144, v148
    v_max3_u32 v28, v28, v152, v156
    v_max_u32 v28, v28, v29
    v_cmp_eq_u32 vcc, -1, v28
    s_cbranch_vccz Lqj_96
    s_waitcnt vmcnt(0)
    s_mov_b64 exec, 1
    buffer_store_dword v13, v11, s[32:35], s77 offen sc1
    s_mov_b64 exec, -1
    s_mov_b32 s77, 0x9500000
Lqj_97:
    s_add_u32 s3, s61, 3072
    buffer_load_dwordx4 v[156:159], v6, s[32:35], s3 offen sc1
    s_sleep 2
    s_add_u32 s99, s99, 1
    s_cmp_gt_u32 s99, 0x2dc6c0
    s_cbranch_scc0 Lto_98
    s_mov_b32 s3, 7
    s_branch L_abort
Lto_98:
    s_waitcnt vmcnt(0)
    v_cmp_eq_u32 vcc, -1, v156
    s_cbranch_vccnz Lqj_97
    s_lshr_b32 s61, s70, 8
    s_lshl_b32 s61, s61, 21
    s_and_b32 s62, s70, 0xff
    s_lshl_b32 s62, s62, 15
    s_add_u32 s61, s61, s62
    buffer_load_dwordx4 v[128:131], v6, s[32:35], s61 offen offset:0 sc1
    buffer_load_dwordx4 v[132:135], v6, s[32:35], s61 offen offset:1024 sc1
    buffer_load_dwordx4 v[136:139], v6, s[32:35], s61 offen offset:2048 sc1
    buffer_load_dwordx4 v[140:143], v6, s[32:35], s61 offen offset:3072 sc1
    s_add_u32 s61, s61, 4096
    buffer_load_dwordx4 v[144:147], v6, s[32:35], s61 offen offset:0 sc1
    buffer_load_dwordx4 v[148:151], v6, s[32:35], s61 offen offset:1024 sc1
    buffer_load_dwordx4 v[152:155], v6, s[32:35], s61 offen offset:2048 sc1
    buffer_load_dwordx4 v[156:159], v6, s[32:35], s61 offen offset:3072 sc1
    s_waitcnt vmcnt(0)
    v_max3_u32 v28, v128, v132, v136
    v_max3_u32 v29, v140, v144, v148
    v_max3_u32 v28, v28, v152, v156
    v_max_u32 v28, v28, v29
    v_cmp_eq_u32 vcc, -1, v28
    s_cbranch_vccnz Lqj_97
Lqj_96:
    s_add_u32 s83, s83, 1
    s_mov_b32 s66, s83
    s_branch Lqj_89
Lqj_88:
    s_waitcnt vmcnt(3)
    s_mov_b64 exec, 1
    buffer_store_dword v13, v11, s[32:35], s77 offen sc1
    s_mov_b64 exec, -1
    s_waitcnt vmcnt(1)
    s_mov_b64 exec, 1
    buffer_store_dword v13, v11, s[32:35], s76 offen sc1
    s_mov_b64 exec, -1
    s_mov_b32 s73, 0x9200000
    s_mov_b32 s74, 0x9300000
    s_mov_b32 s75, 0x9400000
    s_mov_b32 s76, 0x9500000
    s_mov_b32 s71, 0
    s_mov_b32 s77, 0x9500000
Lqf_87:
    s_cmp_lg_u32 s56, 0
    s_cbranch_scc1 Lqd_99
Lqp_100:
    s_cmp_ge_u32 s66, 64
    s_cbranch_scc1 Lq1_101
    s_cmp_ge_u32 s64, s65
    s_cbranch_scc1 Lqe_104
    s_add_u32 s3, s66, 14
    s_cmp_lt_u32 s64, s3
    s_cbranch_scc1 Lq1_101
Lqe_104:
    s_cmp_lg_u32 s82, 0
    s_cbranch_scc1 Lqz_105
    v_mov_b32 v28, 72
    buffer_load_dword v29, v28, s[36:39], 0 offen sc1
    s_waitcnt vmcnt(0)
    v_readfirstlane_b32 s3, v29
    s_cmp_ge_u32 s3, 32
    s_cselect_b32 s82, 1, 0
    s_mov_b32 s81, 999
    s_cmp_eq_u32 s82, 0
    s_cbranch_scc1 Lq1_101
Lqz_105:
    s_lshl_b32 s3, s66, 15
    s_mov_b32 s81, s66
    buffer_load_dword v16, v26, s[32:35], s3 offen sc1
    s_waitcnt vmcnt(0)
    s_cmp_lg_u32 s81, s66
    s_cbranch_scc1 Lq1_101
    v_cmp_eq_u32 vcc, -1, v16
    s_cbranch_vccnz Lq1_101
    s_or_b32 s3, s66, 0x100
    s_add_u32 s66, s66, 1
    s_branch Lqw_102
Lq1_101:
    s_cmp_ge_u32 s64, s65
    s_cbranch_scc1 Lqdn_103
    s_mov_b32 s3, s64
    s_add_u32 s64, s64, 1
    s_branch Lqw_102
Lqdn_103:
    s_mov_b32 s3, 0xffff
    s_cmp_ge_u32 s66, 64
    s_cbranch_scc1 Lqw_102
    s_sleep 2
    s_add_u32 s99, s99, 1
    s_cmp_gt_u32 s99, 0x2dc6c0
    s_cbranch_scc0 Lto_106
    s_mov_b32 s3, 3
    s_branch L_abort
Lto_106:
    s_branch Lqp_100
Lqw_102:
    v_mov_b32 v21, s3
    ds_write_b32 v14, v21 offset:8
Lqd_99:
    s_waitcnt lgkmcnt(0)
    s_barrier
    ds_read_b32 v21, v14 offset:8
    s_waitcnt lgkmcnt(0)
    v_readfirstlane_b32 s70, v21
    s_cmp_eq_u32 s70, 0xffff
    s_cbranch_scc1 L_after_qkv
    s_cmp_ge_u32 s70, 0xfffe
    s_cbranch_scc1 Lqt_108
    s_cmp_lt_u32 s70, 0x100
    s_cbranch_scc1 Lqt_107
    s_and_b32 s83, s70, 0xff
    s_add_u32 s83, s83, 1
    s_branch Lqt_108
Lqt_107:
    s_add_u32 s3, s70, 1
    s_max_u32 s64, s64, s3
Lqt_108:
Lqre_109:
    s_lshr_b32 s61, s70, 8
    s_lshl_b32 s61, s61, 21
    s_and_b32 s62, s70, 0xff
    s_lshl_b32 s62, s62, 15
    s_add_u32 s61, s61, s62
    buffer_load_dwordx4 v[128:131], v6, s[32:35], s61 offen offset:0 sc1
    buffer_load_dwordx4 v[132:135], v6, s[32:35], s61 offen offset:1024 sc1
    buffer_load_dwordx4 v[136:139], v6, s[32:35], s61 offen offset:2048 sc1
    buffer_load_dwordx4 v[140:143], v6, s[32:35], s61 offen offset:3072 sc1
    s_add_u32 s61, s61, 4096
    buffer_load_dwordx4 v[144:147], v6, s[32:35], s61 offen offset:0 sc1
    buffer_load_dwordx4 v[148:151], v6, s[32:35], s61 offen offset:1024 sc1
    buffer_load_dwordx4 v[152:155], v6, s[32:35], s61 offen offset:2048 sc1
    buffer_load_dwordx4 v[156:159], v6, s[32:35], s61 offen offset:3072 sc1
    s_sleep 2
    s_add_u32 s99, s99, 1
    s_cmp_gt_u32 s99, 0x2dc6c0
    s_cbranch_scc0 Lto_110
    s_mov_b32 s3, 4
    s_branch L_abort
Lto_110:
    s_waitcnt vmcnt(0)
    v_max3_u32 v28, v128, v132, v136
    v_max3_u32 v29, v140, v144, v148
    v_max3_u32 v28, v28, v152, v156
    v_max_u32 v28, v28, v29
    v_cmp_eq_u32 vcc, -1, v28
    s_cbranch_vccnz Lqre_109
Lqj_89:
    ds_write_b128 v7, v[128:131] offset:33792
    ds_write_b128 v7, v[132:135] offset:34848
    ds_write_b128 v7, v[136:139] offset:35904
    ds_write_b128 v7, v[140:143] offset:36960
    ds_write_b128 v7, v[144:147] offset:38016
    ds_write_b128 v7, v[148:151] offset:39072
    ds_write_b128 v7, v[152:155] offset:40128
    ds_write_b128 v7, v[156:159] offset:41184
    s_cmp_lg_u32 s56, 0
    s_cbranch_scc1 Lqd_111
Lqp_112:
    s_cmp_ge_u32 s66, 64
    s_cbranch_scc1 Lq1_113
    s_cmp_ge_u32 s64, s65
    s_cbranch_scc1 Lqe_116
    s_add_u32 s3, s66, 14
    s_cmp_lt_u32 s64, s3
    s_cbranch_scc1 Lq1_113
Lqe_116:
    s_cmp_lg_u32 s82, 0
    s_cbranch_scc1 Lqz_117
    v_mov_b32 v28, 72
    buffer_load_dword v29, v28, s[36:39], 0 offen sc1
    s_waitcnt vmcnt(0)
    v_readfirstlane_b32 s3, v29
    s_cmp_ge_u32 s3, 32
    s_cselect_b32 s82, 1, 0
    s_mov_b32 s81, 999
    s_cmp_eq_u32 s82, 0
    s_cbranch_scc1 Lq1_113
Lqz_117:
    s_cmp_lg_u32 s81, s66
    s_cbranch_scc1 Lq1_113
    v_cmp_eq_u32 vcc, -1, v16
    s_cbranch_vccnz Lq1_113
    s_or_b32 s3, s66, 0x100
    s_add_u32 s66, s66, 1
    s_branch Lqw_114
Lq1_113:
    s_cmp_ge_u32 s64, s65
    s_cbranch_scc1 Lqdn_115
    s_mov_b32 s3, s64
    s_add_u32 s64, s64, 1
    s_branch Lqw_114
Lqdn_115:
    s_mov_b32 s3, 0xffff
    s_cmp_ge_u32 s66, 64
    s_cbranch_scc1 Lqw_114
    s_mov_b32 s3, 0xfffe
Lqw_114:
    v_mov_b32 v21, s3
    ds_write_b32 v14, v21 offset:4
Lqd_111:
    s_mov_b32 s69, s70
Lqloop_37:
    s_waitcnt lgkmcnt(0)
    s_barrier
    ds_read_b128 v[160:163], v8 offset:33792
    ds_read_b128 v[164:167], v8 offset:50688
    ds_read_b128 v[168:171], v8 offset:33856
    ds_read_b128 v[172:175], v8 offset:50752
    ds_read_b128 v[176:179], v8 offset:33920
    ds_read_b32 v21, v14 offset:4
    ds_read_b128 v[180:183], v8 offset:50816
    s_waitcnt lgkmcnt(5)
    v_mfma_f32_16x16x32_bf16 v[96:99], a[64:67], v[160:163], 0
    v_mfma_f32_16x16x32_bf16 v[104:107], v[160:163], a[128:131], 0
    v_mfma_f32_16x16x32_bf16 v[88:91], a[0:3], v[160:163], 0
    v_cvt_pk_bf16_f32 v36, v72, v73
    v_cvt_pk_bf16_f32 v37, v74, v75
    ds_write_b64 v17, v[36:37] offset:4608
    s_cmp_lg_u32 s56, 0
    s_cbranch_scc1 Lqw0_118
    s_cmp_ge_u32 s66, 64
    s_cbranch_scc1 Lqw0_118
    s_lshl_b32 s3, s66, 15
    s_mov_b32 s81, s66
    buffer_load_dword v16, v26, s[32:35], s3 offen sc1
    s_branch Lqw1_119
Lqw0_118:
    buffer_load_dword v25, v24, s[32:35], 0 offen
Lqw1_119:
    ds_read_b128 v[160:163], v8 offset:33984
    v_mfma_f32_16x16x32_bf16 v[100:103], a[64:67], v[164:167], 0
    v_mfma_f32_16x16x32_bf16 v[108:111], v[164:167], a[128:131], 0
    v_mfma_f32_16x16x32_bf16 v[92:95], a[0:3], v[164:167], 0
    v_cvt_pk_bf16_f32 v38, v76, v77
    v_cvt_pk_bf16_f32 v39, v78, v79
    ds_write_b64 v17, v[38:39] offset:6912
    s_waitcnt lgkmcnt(4)
    v_readfirstlane_b32 s70, v21
    s_cmp_ge_u32 s70, 0xfffe
    s_cbranch_scc1 Lqt_121
    s_cmp_lt_u32 s70, 0x100
    s_cbranch_scc1 Lqt_120
    s_and_b32 s83, s70, 0xff
    s_add_u32 s83, s83, 1
    s_branch Lqt_121
Lqt_120:
    s_add_u32 s3, s70, 1
    s_max_u32 s64, s64, s3
Lqt_121:
    s_cmp_ge_u32 s70, 0xfffe
    s_cselect_b32 s79, s69, s70
    s_lshr_b32 s61, s79, 8
    s_lshl_b32 s61, s61, 21
    s_and_b32 s62, s79, 0xff
    s_lshl_b32 s62, s62, 15
    s_add_u32 s79, s61, s62
    ds_read_b128 v[164:167], v8 offset:50880
    v_mfma_f32_16x16x32_bf16 v[96:99], a[68:71], v[168:171], v[96:99]
    v_mfma_f32_16x16x32_bf16 v[104:107], v[168:171], a[132:135], v[104:107]
    v_mfma_f32_16x16x32_bf16 v[88:91], a[4:7], v[168:171], v[88:91]
    v_cvt_pk_bf16_f32 v32, v64, v65
    v_cvt_pk_bf16_f32 v33, v66, v67
    ds_write_b64 v17, v[32:33] offset:0
    s_cmp_lg_u32 s56, 0
    s_cbranch_scc1 Lqdw_122
    s_mul_i32 s62, s56, 8448
    s_add_u32 s62, s62, 0
    s_mov_b32 s61, s79
    s_mov_b32 m0, s62
    s_nop 0
    buffer_load_dwordx4 v6, s[32:35], s61 offen lds
    s_add_u32 s61, s61, 1024
    s_add_u32 s62, s62, 1056
    s_mov_b32 m0, s62
    s_nop 0
    buffer_load_dwordx4 v6, s[32:35], s61 offen lds
    s_add_u32 s61, s61, 1024
    s_add_u32 s62, s62, 1056
    s_mov_b32 m0, s62
    s_nop 0
    buffer_load_dwordx4 v6, s[32:35], s61 offen lds
    s_add_u32 s61, s61, 1024
    s_add_u32 s62, s62, 1056
    s_mov_b32 m0, s62
    s_nop 0
    buffer_load_dwordx4 v6, s[32:35], s61 offen lds
    s_add_u32 s61, s61, 1024
    s_add_u32 s62, s62, 1056
    s_mov_b32 m0, s62
    s_nop 0
    buffer_load_dwordx4 v6, s[32:35], s61 offen lds
    s_add_u32 s61, s61, 1024
    s_add_u32 s62, s62, 1056
    s_mov_b32 m0, s62
    s_nop 0
    buffer_load_dwordx4 v6, s[32:35], s61 offen lds
    s_add_u32 s61, s61, 1024
    s_add_u32 s62, s62, 1056
    s_mov_b32 m0, s62
    s_nop 0
    buffer_load_dwordx4 v6, s[32:35], s61 offen lds
    s_add_u32 s61, s61, 1024
    s_add_u32 s62, s62, 1056
    s_mov_b32 m0, s62
    s_nop 0
    buffer_load_dwordx4 v6, s[32:35], s61 offen lds
Lqdw_122:
    ds_read_b128 v[168:171], v8 offset:34048
    v_mfma_f32_16x16x32_bf16 v[100:103], a[68:71], v[172:175], v[100:103]
    v_mfma_f32_16x16x32_bf16 v[108:111], v[172:175], a[132:135], v[108:111]
    v_mfma_f32_16x16x32_bf16 v[92:95], a[4:7], v[172:175], v[92:95]
    v_cvt_pk_bf16_f32 v34, v68, v69
    v_cvt_pk_bf16_f32 v35, v70, v71
    ds_write_b64 v17, v[34:35] offset:2304
    ds_read_b128 v[172:175], v8 offset:50944
    s_waitcnt lgkmcnt(8)
    v_mfma_f32_16x16x32_bf16 v[96:99], a[72:75], v[176:179], v[96:99]
    v_mfma_f32_16x16x32_bf16 v[104:107], v[176:179], a[136:139], v[104:107]
    v_mfma_f32_16x16x32_bf16 v[88:91], a[8:11], v[176:179], v[88:91]
    s_cmp_lg_u32 s56, 1
    s_cbranch_scc1 Lqdw_123
    s_mul_i32 s62, s56, 8448
    s_add_u32 s62, s62, 0
    s_mov_b32 s61, s79
    s_mov_b32 m0, s62
    s_nop 0
    buffer_load_dwordx4 v6, s[32:35], s61 offen lds
    s_add_u32 s61, s61, 1024
    s_add_u32 s62, s62, 1056
    s_mov_b32 m0, s62
    s_nop 0
    buffer_load_dwordx4 v6, s[32:35], s61 offen lds
    s_add_u32 s61, s61, 1024
    s_add_u32 s62, s62, 1056
    s_mov_b32 m0, s62
    s_nop 0
    buffer_load_dwordx4 v6, s[32:35], s61 offen lds
    s_add_u32 s61, s61, 1024
    s_add_u32 s62, s62, 1056
    s_mov_b32 m0, s62
    s_nop 0
    buffer_load_dwordx4 v6, s[32:35], s61 offen lds
    s_add_u32 s61, s61, 1024
    s_add_u32 s62, s62, 1056
    s_mov_b32 m0, s62
    s_nop 0
    buffer_load_dwordx4 v6, s[32:35], s61 offen lds
    s_add_u32 s61, s61, 1024
    s_add_u32 s62, s62, 1056
    s_mov_b32 m0, s62
    s_nop 0
    buffer_load_dwordx4 v6, s[32:35], s61 offen lds
    s_add_u32 s61, s61, 1024
    s_add_u32 s62, s62, 1056
    s_mov_b32 m0, s62
    s_nop 0
    buffer_load_dwordx4 v6, s[32:35], s61 offen lds
    s_add_u32 s61, s61, 1024
    s_add_u32 s62, s62, 1056
    s_mov_b32 m0, s62
    s_nop 0
    buffer_load_dwordx4 v6, s[32:35], s61 offen lds
Lqdw_123:
    ds_read_b128 v[176:179], v8 offset:34112
    v_mfma_f32_16x16x32_bf16 v[100:103], a[72:75], v[180:183], v[100:103]
    v_mfma_f32_16x16x32_bf16 v[108:111], v[180:183], a[136:139], v[108:111]
    v_mfma_f32_16x16x32_bf16 v[92:95], a[8:11], v[180:183], v[92:95]
    ds_read_b128 v[180:183], v8 offset:51008
    s_waitcnt lgkmcnt(6)
    v_mfma_f32_16x16x32_bf16 v[96:99], a[76:79], v[160:163], v[96:99]
    v_mfma_f32_16x16x32_bf16 v[104:107], v[160:163], a[140:143], v[104:107]
    v_mfma_f32_16x16x32_bf16 v[88:91], a[12:15], v[160:163], v[88:91]
    s_cmp_lg_u32 s56, 2
    s_cbranch_scc1 Lqdw_124
    s_mul_i32 s62, s56, 8448
    s_add_u32 s62, s62, 0
    s_mov_b32 s61, s79
    s_mov_b32 m0, s62
    s_nop 0
    buffer_load_dwordx4 v6, s[32:35], s61 offen lds
    s_add_u32 s61, s61, 1024
    s_add_u32 s62, s62, 1056
    s_mov_b32 m0, s62
    s_nop 0
    buffer_load_dwordx4 v6, s[32:35], s61 offen lds
    s_add_u32 s61, s61, 1024
    s_add_u32 s62, s62, 1056
    s_mov_b32 m0, s62
    s_nop 0
    buffer_load_dwordx4 v6, s[32:35], s61 offen lds
    s_add_u32 s61, s61, 1024
    s_add_u32 s62, s62, 1056
    s_mov_b32 m0, s62
    s_nop 0
    buffer_load_dwordx4 v6, s[32:35], s61 offen lds
    s_add_u32 s61, s61, 1024
    s_add_u32 s62, s62, 1056
    s_mov_b32 m0, s62
    s_nop 0
    buffer_load_dwordx4 v6, s[32:35], s61 offen lds
    s_add_u32 s61, s61, 1024
    s_add_u32 s62, s62, 1056
    s_mov_b32 m0, s62
    s_nop 0
    buffer_load_dwordx4 v6, s[32:35], s61 offen lds
    s_add_u32 s61, s61, 1024
    s_add_u32 s62, s62, 1056
    s_mov_b32 m0, s62
    s_nop 0
    buffer_load_dwordx4 v6, s[32:35], s61 offen lds
    s_add_u32 s61, s61, 1024
    s_add_u32 s62, s62, 1056
    s_mov_b32 m0, s62
    s_nop 0
    buffer_load_dwordx4 v6, s[32:35], s61 offen lds
Lqdw_124:
    ds_read_b128 v[160:163], v8 offset:34176
    v_mfma_f32_16x16x32_bf16 v[100:103], a[76:79], v[164:167], v[100:103]
    v_mfma_f32_16x16x32_bf16 v[108:111], v[164:167], a[140:143], v[108:111]
    v_mfma_f32_16x16x32_bf16 v[92:95], a[12:15], v[164:167], v[92:95]
    ds_read_b128 v[164:167], v8 offset:51072
    s_waitcnt lgkmcnt(4)
    v_mfma_f32_16x16x32_bf16 v[96:99], a[80:83], v[168:171], v[96:99]
    v_mfma_f32_16x16x32_bf16 v[104:107], v[168:171], a[144:147], v[104:107]
    v_mfma_f32_16x16x32_bf16 v[88:91], a[16:19], v[168:171], v[88:91]
    s_cmp_lg_u32 s56, 3
    s_cbranch_scc1 Lqdw_125
    s_mul_i32 s62, s56, 8448
    s_add_u32 s62, s62, 0
    s_mov_b32 s61, s79
    s_mov_b32 m0, s62
    s_nop 0
    buffer_load_dwordx4 v6, s[32:35], s61 offen lds
    s_add_u32 s61, s61, 1024
    s_add_u32 s62, s62, 1056
    s_mov_b32 m0, s62
    s_nop 0
    buffer_load_dwordx4 v6, s[32:35], s61 offen lds
    s_add_u32 s61, s61, 1024
    s_add_u32 s62, s62, 1056
    s_mov_b32 m0, s62
    s_nop 0
    buffer_load_dwordx4 v6, s[32:35], s61 offen lds
    s_add_u32 s61, s61, 1024
    s_add_u32 s62, s62, 1056
    s_mov_b32 m0, s62
    s_nop 0
    buffer_load_dwordx4 v6, s[32:35], s61 offen lds
    s_add_u32 s61, s61, 1024
    s_add_u32 s62, s62, 1056
    s_mov_b32 m0, s62
    s_nop 0
    buffer_load_dwordx4 v6, s[32:35], s61 offen lds
    s_add_u32 s61, s61, 1024
    s_add_u32 s62, s62, 1056
    s_mov_b32 m0, s62
    s_nop 0
    buffer_load_dwordx4 v6, s[32:35], s61 offen lds
    s_add_u32 s61, s61, 1024
    s_add_u32 s62, s62, 1056
    s_mov_b32 m0, s62
    s_nop 0
    buffer_load_dwordx4 v6, s[32:35], s61 offen lds
    s_add_u32 s61, s61, 1024
    s_add_u32 s62, s62, 1056
    s_mov_b32 m0, s62
    s_nop 0
    buffer_load_dwordx4 v6, s[32:35], s61 offen lds
Lqdw_125:
    ds_read_b128 v[168:171], v8 offset:34240
    v_mfma_f32_16x16x32_bf16 v[100:103], a[80:83], v[172:175], v[100:103]
    v_mfma_f32_16x16x32_bf16 v[108:111], v[172:175], a[144:147], v[108:111]
    v_mfma_f32_16x16x32_bf16 v[92:95], a[16:19], v[172:175], v[92:95]
    s_barrier
    ds_read_b128 v[52:55], v18 offset:4608
    ds_read_b128 v[48:51], v18
    ds_read_b128 v[172:175], v8 offset:51136
    s_waitcnt lgkmcnt(6)
    v_mfma_f32_16x16x32_bf16 v[96:99], a[84:87], v[176:179], v[96:99]
    v_mfma_f32_16x16x32_bf16 v[104:107], v[176:179], a[148:151], v[104:107]
    v_mfma_f32_16x16x32_bf16 v[88:91], a[20:23], v[176:179], v[88:91]
    s_min_u32 s3, s78, 63
    s_lshl_b32 s3, s3, 15
    buffer_load_dword v25, v24, s[32:35], s3 offen
    s_add_u32 s78, s78, 1
    ds_read_b128 v[176:179], v8 offset:34304
    v_mfma_f32_16x16x32_bf16 v[100:103], a[84:87], v[180:183], v[100:103]
    v_mfma_f32_16x16x32_bf16 v[108:111], v[180:183], a[148:151], v[108:111]
    v_mfma_f32_16x16x32_bf16 v[92:95], a[20:23], v[180:183], v[92:95]
    ds_read_b128 v[180:183], v8 offset:51200
    s_waitcnt lgkmcnt(6)
    v_mfma_f32_16x16x32_bf16 v[96:99], a[88:91], v[160:163], v[96:99]
    v_mfma_f32_16x16x32_bf16 v[104:107], v[160:163], a[152:155], v[104:107]
    v_mfma_f32_16x16x32_bf16 v[88:91], a[24:27], v[160:163], v[88:91]
    v_cvt_pk_bf16_f32 v40, v80, v81
    v_cvt_pk_bf16_f32 v41, v82, v83
    v_cvt_pk_bf16_f32 v42, v84, v85
    v_cvt_pk_bf16_f32 v43, v86, v87
    ds_read_b128 v[160:163], v8 offset:34368
    v_mfma_f32_16x16x32_bf16 v[100:103], a[88:91], v[164:167], v[100:103]
    v_mfma_f32_16x16x32_bf16 v[108:111], v[164:167], a[152:155], v[108:111]
    v_mfma_f32_16x16x32_bf16 v[92:95], a[24:27], v[164:167], v[92:95]
    buffer_store_dwordx4 v[40:43], v10, s[32:35], s75 offen sc1
    ds_read_b128 v[164:167], v8 offset:51264
    s_waitcnt lgkmcnt(4)
    v_mfma_f32_16x16x32_bf16 v[96:99], a[92:95], v[168:171], v[96:99]
    v_mfma_f32_16x16x32_bf16 v[104:107], v[168:171], a[156:159], v[104:107]
    v_mfma_f32_16x16x32_bf16 v[88:91], a[28:31], v[168:171], v[88:91]
    ds_read_b128 v[168:171], v8 offset:34432
    v_mfma_f32_16x16x32_bf16 v[100:103], a[92:95], v[172:175], v[100:103]
    v_mfma_f32_16x16x32_bf16 v[108:111], v[172:175], a[156:159], v[108:111]
    v_mfma_f32_16x16x32_bf16 v[92:95], a[28:31], v[172:175], v[92:95]
    ds_read_b128 v[172:175], v8 offset:51328
    s_waitcnt lgkmcnt(4)
    v_mfma_f32_16x16x32_bf16 v[96:99], a[96:99], v[176:179], v[96:99]
    v_mfma_f32_16x16x32_bf16 v[104:107], v[176:179], a[160:163], v[104:107]
    v_mfma_f32_16x16x32_bf16 v[88:91], a[32:35], v[176:179], v[88:91]
    buffer_store_dwordx4 v[52:55], v9, s[32:35], s74 offen sc1
    ds_read_b128 v[176:179], v8 offset:34496
    v_mfma_f32_16x16x32_bf16 v[100:103], a[96:99], v[180:183], v[100:103]
    v_mfma_f32_16x16x32_bf16 v[108:111], v[180:183], a[160:163], v[108:111]
    v_mfma_f32_16x16x32_bf16 v[92:95], a[32:35], v[180:183], v[92:95]
    ds_read_b128 v[180:183], v8 offset:51392
    s_waitcnt lgkmcnt(4)
    v_mfma_f32_16x16x32_bf16 v[96:99], a[100:103], v[160:163], v[96:99]
    v_mfma_f32_16x16x32_bf16 v[104:107], v[160:163], a[164:167], v[104:107]
    v_mfma_f32_16x16x32_bf16 v[88:91], a[36:39], v[160:163], v[88:91]
    ds_read_b128 v[160:163], v8 offset:34560
    v_mfma_f32_16x16x32_bf16 v[100:103], a[100:103], v[164:167], v[100:103]
    v_mfma_f32_16x16x32_bf16 v[108:111], v[164:167], a[164:167], v[108:111]
    v_mfma_f32_16x16x32_bf16 v[92:95], a[36:39], v[164:167], v[92:95]
    buffer_store_dwordx4 v[48:51], v9, s[32:35], s73 offen sc1
    ds_read_b128 v[164:167], v8 offset:51456
    s_waitcnt lgkmcnt(4)
    v_mfma_f32_16x16x32_bf16 v[96:99], a[104:107], v[168:171], v[96:99]
    v_mfma_f32_16x16x32_bf16 v[104:107], v[168:171], a[168:171], v[104:107]
    v_mfma_f32_16x16x32_bf16 v[88:91], a[40:43], v[168:171], v[88:91]
    ds_read_b128 v[168:171], v8 offset:34624
    v_mfma_f32_16x16x32_bf16 v[100:103], a[104:107], v[172:175], v[100:103]
    v_mfma_f32_16x16x32_bf16 v[108:111], v[172:175], a[168:171], v[108:111]
    v_mfma_f32_16x16x32_bf16 v[92:95], a[40:43], v[172:175], v[92:95]
    ds_read_b128 v[172:175], v8 offset:51520
    s_waitcnt lgkmcnt(4)
    v_mfma_f32_16x16x32_bf16 v[96:99], a[108:111], v[176:179], v[96:99]
    v_mfma_f32_16x16x32_bf16 v[104:107], v[176:179], a[172:175], v[104:107]
    v_mfma_f32_16x16x32_bf16 v[88:91], a[44:47], v[176:179], v[88:91]
    ds_read_b128 v[176:179], v8 offset:34688
    v_mfma_f32_16x16x32_bf16 v[100:103], a[108:111], v[180:183], v[100:103]
    v_mfma_f32_16x16x32_bf16 v[108:111], v[180:183], a[172:175], v[108:111]
    v_mfma_f32_16x16x32_bf16 v[92:95], a[44:47], v[180:183], v[92:95]
    ds_read_b128 v[180:183], v8 offset:51584
    s_waitcnt lgkmcnt(4)
    v_mfma_f32_16x16x32_bf16 v[96:99], a[112:115], v[160:163], v[96:99]
    v_mfma_f32_16x16x32_bf16 v[104:107], v[160:163], a[176:179], v[104:107]
    v_mfma_f32_16x16x32_bf16 v[88:91], a[48:51], v[160:163], v[88:91]
    s_waitcnt vmcnt(4)
    s_mov_b64 exec, 1
    buffer_store_dword v13, v11, s[32:35], s77 offen sc1
    s_mov_b64 exec, -1
    s_mov_b32 s77, s76
    ds_read_b128 v[160:163], v8 offset:34752
    v_mfma_f32_16x16x32_bf16 v[100:103], a[112:115], v[164:167], v[100:103]
    v_mfma_f32_16x16x32_bf16 v[108:111], v[164:167], a[176:179], v[108:111]
    v_mfma_f32_16x16x32_bf16 v[92:95], a[48:51], v[164:167], v[92:95]
    s_cmp_lt_u32 s79, 0x200000
    s_cbranch_scc1 Lqg_126
Lqg_127:
    ds_read_b32 v128, v7 offset:0
    ds_read_b32 v129, v7 offset:1056
    ds_read_b32 v130, v7 offset:2112
    ds_read_b32 v131, v7 offset:3168
    ds_read_b32 v132, v7 offset:4224
    ds_read_b32 v133, v7 offset:5280
    ds_read_b32 v134, v7 offset:6336
    ds_read_b32 v135, v7 offset:7392
    s_waitcnt lgkmcnt(0)
    v_max3_u32 v28, v128, v129, v130
    v_max3_u32 v29, v131, v132, v133
    v_max3_u32 v28, v28, v134, v135
    v_max_u32 v28, v28, v29
    v_cmp_eq_u32 vcc, -1, v28
    s_cbranch_vccz Lqg_126
    s_mul_i32 s62, s56, 8448
    s_add_u32 s62, s62, 0
    s_mov_b32 s61, s79
    s_mov_b32 m0, s62
    s_nop 0
    buffer_load_dwordx4 v6, s[32:35], s61 offen sc1 lds
    s_add_u32 s61, s61, 1024
    s_add_u32 s62, s62, 1056
    s_mov_b32 m0, s62
    s_nop 0
    buffer_load_dwordx4 v6, s[32:35], s61 offen sc1 lds
    s_add_u32 s61, s61, 1024
    s_add_u32 s62, s62, 1056
    s_mov_b32 m0, s62
    s_nop 0
    buffer_load_dwordx4 v6, s[32:35], s61 offen sc1 lds
    s_add_u32 s61, s61, 1024
    s_add_u32 s62, s62, 1056
    s_mov_b32 m0, s62
    s_nop 0
    buffer_load_dwordx4 v6, s[32:35], s61 offen sc1 lds
    s_add_u32 s61, s61, 1024
    s_add_u32 s62, s62, 1056
    s_mov_b32 m0, s62
    s_nop 0
    buffer_load_dwordx4 v6, s[32:35], s61 offen sc1 lds
    s_add_u32 s61, s61, 1024
    s_add_u32 s62, s62, 1056
    s_mov_b32 m0, s62
    s_nop 0
    buffer_load_dwordx4 v6, s[32:35], s61 offen sc1 lds
    s_add_u32 s61, s61, 1024
    s_add_u32 s62, s62, 1056
    s_mov_b32 m0, s62
    s_nop 0
    buffer_load_dwordx4 v6, s[32:35], s61 offen sc1 lds
    s_add_u32 s61, s61, 1024
    s_add_u32 s62, s62, 1056
    s_mov_b32 m0, s62
    s_nop 0
    buffer_load_dwordx4 v6, s[32:35], s61 offen sc1 lds
    s_sleep 2
    s_add_u32 s99, s99, 1
    s_cmp_gt_u32 s99, 0x2dc6c0
    s_cbranch_scc0 Lto_128
    s_mov_b32 s3, 5
    s_branch L_abort
Lto_128:
    s_waitcnt vmcnt(0)
    s_branch Lqg_127
Lqg_126:
    ds_read_b128 v[164:167], v8 offset:51648
    s_waitcnt lgkmcnt(4)
    v_mfma_f32_16x16x32_bf16 v[96:99], a[116:119], v[168:171], v[96:99]
    v_mfma_f32_16x16x32_bf16 v[104:107], v[168:171], a[180:183], v[104:107]
    v_mfma_f32_16x16x32_bf16 v[88:91], a[52:55], v[168:171], v[88:91]
    v_mfma_f32_16x16x32_bf16 v[100:103], a[116:119], v[172:175], v[100:103]
    v_mfma_f32_16x16x32_bf16 v[108:111], v[172:175], a[180:183], v[108:111]
    v_mfma_f32_16x16x32_bf16 v[92:95], a[52:55], v[172:175], v[92:95]
    s_waitcnt lgkmcnt(2)
    v_mfma_f32_16x16x32_bf16 v[96:99], a[120:123], v[176:179], v[96:99]
    v_mfma_f32_16x16x32_bf16 v[104:107], v[176:179], a[184:187], v[104:107]
    v_mfma_f32_16x16x32_bf16 v[88:91], a[56:59], v[176:179], v[88:91]
    s_cmp_lg_u32 s56, 0
    s_cbranch_scc1 Lqd_129
    s_cmp_ge_u32 s70, 0xfffe
    s_cbranch_scc1 Lqd_129
Lqp_130:
    s_cmp_ge_u32 s66, 64
    s_cbranch_scc1 Lq1_131
    s_cmp_ge_u32 s64, s65
    s_cbranch_scc1 Lqe_134
    s_add_u32 s3, s66, 14
    s_cmp_lt_u32 s64, s3
    s_cbranch_scc1 Lq1_131
Lqe_134:
    s_cmp_lg_u32 s82, 0
    s_cbranch_scc1 Lqz_135
    v_mov_b32 v28, 72
    buffer_load_dword v29, v28, s[36:39], 0 offen sc1
    s_waitcnt vmcnt(0)
    v_readfirstlane_b32 s3, v29
    s_cmp_ge_u32 s3, 32
    s_cselect_b32 s82, 1, 0
    s_mov_b32 s81, 999
    s_cmp_eq_u32 s82, 0
    s_cbranch_scc1 Lq1_131
Lqz_135:
    s_cmp_lg_u32 s81, s66
    s_cbranch_scc1 Lq1_131
    v_cmp_eq_u32 vcc, -1, v16
    s_cbranch_vccnz Lq1_131
    s_or_b32 s3, s66, 0x100
    s_add_u32 s66, s66, 1
    s_branch Lqw_132
Lq1_131:
    s_cmp_ge_u32 s64, s65
    s_cbranch_scc1 Lqdn_133
    s_mov_b32 s3, s64
    s_add_u32 s64, s64, 1
    s_branch Lqw_132
Lqdn_133:
    s_mov_b32 s3, 0xffff
    s_cmp_ge_u32 s66, 64
    s_cbranch_scc1 Lqw_132
    s_mov_b32 s3, 0xfffe
Lqw_132:
    v_mov_b32 v21, s3
Lqd_129:
    s_cmp_lg_u32 s56, 0
    s_cselect_b32 s3, 16, 0
    v_add_u32 v23, s3, v14
    ds_write_b32 v23, v21
    v_mfma_f32_16x16x32_bf16 v[100:103], a[120:123], v[180:183], v[100:103]
    v_mfma_f32_16x16x32_bf16 v[108:111], v[180:183], a[184:187], v[108:111]
    v_mfma_f32_16x16x32_bf16 v[92:95], a[56:59], v[180:183], v[92:95]
    s_waitcnt lgkmcnt(1)
    v_mfma_f32_16x16x32_bf16 v[96:99], a[124:127], v[160:163], v[96:99]
    v_mfma_f32_16x16x32_bf16 v[104:107], v[160:163], a[188:191], v[104:107]
    v_mfma_f32_16x16x32_bf16 v[88:91], a[60:63], v[160:163], v[88:91]
    v_mfma_f32_16x16x32_bf16 v[100:103], a[124:127], v[164:167], v[100:103]
    v_mfma_f32_16x16x32_bf16 v[108:111], v[164:167], a[188:191], v[108:111]
    v_mfma_f32_16x16x32_bf16 v[92:95], a[60:63], v[164:167], v[92:95]
    s_lshr_b32 s60, s69, 8
    s_and_b32 s67, s69, 0xff
    s_lshl_b32 s61, s60, 24
    s_lshl_b32 s62, s67, 18
    s_add_u32 s61, s61, s62
    s_add_u32 s73, s61, 0x2000000
    s_add_u32 s74, s61, 0x4000000
    s_add_u32 s75, s61, 0x6000000
    s_lshl_b32 s61, s60, 16
    s_lshl_b32 s62, s67, 10
    s_add_u32 s61, s61, s62
    s_add_u32 s76, s61, 0x9000000
    s_mov_b32 s71, 1
    s_mov_b32 s69, s70
    s_cmp_ge_u32 s70, 0xfffe
    s_cbranch_scc1 Lqacq_34
    s_branch Lqloop_36
L_after_qkv:
    s_nop 2
    s_cmp_lg_u32 s57, 1
    s_cbranch_scc1 Ld_136
    s_waitcnt vmcnt(0) lgkmcnt(0)
    s_barrier
    s_add_u32 s85, s85, 1
    s_cmp_eq_u32 s85, 1
    s_cbranch_scc1 L_qkv_again
    s_branch L_role_ch
Ld_136:
    s_cmp_lt_u32 s57, 4
    s_cbranch_scc1 L_exit
    s_waitcnt vmcnt(0) lgkmcnt(0)
    s_barrier
    s_and_b32 s3, s57, 1
    s_cmp_eq_u32 s3, 0
    s_cbranch_scc1 L_role_ao
L_role_ff:
    s_lshr_b32 s60, s57, 1
    s_sub_u32 s60, s60, 2
    v_and_b32 v2, 15, v1
    v_lshrrev_b32 v3, 4, v1
    v_lshlrev_b32 v14, 2, v1
    v_lshlrev_b32 v15, 3, v1
    s_mov_b32 s92, -1
    s_mov_b32 s93, 0
    s_cmp_ge_u32 s58, 30
    s_cbranch_scc1 L_exit
    s_cmp_ge_u32 s58, 22
    s_cbranch_scc1 L_ff_red
    s_mov_b32 s40, s20
    s_and_b32 s41, s21, 0xffff
    s_mov_b32 s42, 0x158000
    s_mov_b32 s43, 0x20000
    s_mov_b32 s44, s22
    s_and_b32 s45, s23, 0xffff
    s_mov_b32 s46, 0x158000
    s_mov_b32 s47, 0x20000
    s_mov_b32 s48, s24
    s_and_b32 s49, s25, 0xffff
    s_mov_b32 s50, 0x158000
    s_mov_b32 s51, 0x20000
    v_and_b32 v5, 7, v1
    v_lshlrev_b32 v6, 3, v5
    s_lshl_b32 s61, s58, 6
    v_add_u32 v6, s61, v6
    v_cmp_gt_u32 vcc, 1376, v6
    v_lshrrev_b32 v4, 3, v1
    v_mul_u32_u24 v4, 2752, v4
    v_lshlrev_b32 v6, 1, v6
    v_add_u32 v4, v4, v6
    v_mov_b32 v5, 0x40000000
    v_cndmask_b32 v4, v5, v4, vcc
    s_mul_i32 s61, s56, 352256
    s_add_u32 s61, s61, 0
    s_mul_i32 s62, s56, 16384
    s_add_u32 s62, s62, 0
    s_mov_b32 m0, s62
    s_nop 0
    buffer_load_dwordx4 v4, s[40:43], s61 offen lds
    s_add_u32 s61, s61, 22016
    s_add_u32 s62, s62, 1024
    s_mov_b32 m0, s62
    s_nop 0
    buffer_load_dwordx4 v4, s[40:43], s61 offen lds
    s_add_u32 s61, s61, 22016
    s_add_u32 s62, s62, 1024
    s_mov_b32 m0, s62
    s_nop 0
    buffer_load_dwordx4 v4, s[40:43], s61 offen lds
    s_add_u32 s61, s61, 22016
    s_add_u32 s62, s62, 1024
    s_mov_b32 m0, s62
    s_nop 0
    buffer_load_dwordx4 v4, s[40:43], s61 offen lds
    s_add_u32 s61, s61, 22016
    s_add_u32 s62, s62, 1024
    s_mov_b32 m0, s62
    s_nop 0
    buffer_load_dwordx4 v4, s[40:43], s61 offen lds
    s_add_u32 s61, s61, 22016
    s_add_u32 s62, s62, 1024
    s_mov_b32 m0, s62
    s_nop 0
    buffer_load_dwordx4 v4, s[40:43], s61 offen lds
    s_add_u32 s61, s61, 22016
    s_add_u32 s62, s62, 1024
    s_mov_b32 m0, s62
    s_nop 0
    buffer_load_dwordx4 v4, s[40:43], s61 offen lds
    s_add_u32 s61, s61, 22016
    s_add_u32 s62, s62, 1024
    s_mov_b32 m0, s62
    s_nop 0
    buffer_load_dwordx4 v4, s[40:43], s61 offen lds
    s_add_u32 s61, s61, 22016
    s_add_u32 s62, s62, 1024
    s_mov_b32 m0, s62
    s_nop 0
    buffer_load_dwordx4 v4, s[40:43], s61 offen lds
    s_add_u32 s61, s61, 22016
    s_add_u32 s62, s62, 1024
    s_mov_b32 m0, s62
    s_nop 0
    buffer_load_dwordx4 v4, s[40:43], s61 offen lds
    s_add_u32 s61, s61, 22016
    s_add_u32 s62, s62, 1024
    s_mov_b32 m0, s62
    s_nop 0
    buffer_load_dwordx4 v4, s[40:43], s61 offen lds
    s_add_u32 s61, s61, 22016
    s_add_u32 s62, s62, 1024
    s_mov_b32 m0, s62
    s_nop 0
    buffer_load_dwordx4 v4, s[40:43], s61 offen lds
    s_add_u32 s61, s61, 22016
    s_add_u32 s62, s62, 1024
    s_mov_b32 m0, s62
    s_nop 0
    buffer_load_dwordx4 v4, s[40:43], s61 offen lds
    s_add_u32 s61, s61, 22016
    s_add_u32 s62, s62, 1024
    s_mov_b32 m0, s62
    s_nop 0
    buffer_load_dwordx4 v4, s[40:43], s61 offen lds
    s_add_u32 s61, s61, 22016
    s_add_u32 s62, s62, 1024
    s_mov_b32 m0, s62
    s_nop 0
    buffer_load_dwordx4 v4, s[40:43], s61 offen lds
    s_add_u32 s61, s61, 22016
    s_add_u32 s62, s62, 1024
    s_mov_b32 m0, s62
    s_nop 0
    buffer_load_dwordx4 v4, s[40:43], s61 offen lds
    s_mul_i32 s61, s56, 352256
    s_add_u32 s61, s61, 0
    s_mul_i32 s62, s56, 16384
    s_add_u32 s62, s62, 65536
    s_mov_b32 m0, s62
    s_nop 0
    buffer_load_dwordx4 v4, s[44:47], s61 offen lds
    s_add_u32 s61, s61, 22016
    s_add_u32 s62, s62, 1024
    s_mov_b32 m0, s62
    s_nop 0
    buffer_load_dwordx4 v4, s[44:47], s61 offen lds
    s_add_u32 s61, s61, 22016
    s_add_u32 s62, s62, 1024
    s_mov_b32 m0, s62
    s_nop 0
    buffer_load_dwordx4 v4, s[44:47], s61 offen lds
    s_add_u32 s61, s61, 22016
    s_add_u32 s62, s62, 1024
    s_mov_b32 m0, s62
    s_nop 0
    buffer_load_dwordx4 v4, s[44:47], s61 offen lds
    s_add_u32 s61, s61, 22016
    s_add_u32 s62, s62, 1024
    s_mov_b32 m0, s62
    s_nop 0
    buffer_load_dwordx4 v4, s[44:47], s61 offen lds
    s_add_u32 s61, s61, 22016
    s_add_u32 s62, s62, 1024
    s_mov_b32 m0, s62
    s_nop 0
    buffer_load_dwordx4 v4, s[44:47], s61 offen lds
    s_add_u32 s61, s61, 22016
    s_add_u32 s62, s62, 1024
    s_mov_b32 m0, s62
    s_nop 0
    buffer_load_dwordx4 v4, s[44:47], s61 offen lds
    s_add_u32 s61, s61, 22016
    s_add_u32 s62, s62, 1024
    s_mov_b32 m0, s62
    s_nop 0
    buffer_load_dwordx4 v4, s[44:47], s61 offen lds
    s_add_u32 s61, s61, 22016
    s_add_u32 s62, s62, 1024
    s_mov_b32 m0, s62
    s_nop 0
    buffer_load_dwordx4 v4, s[44:47], s61 offen lds
    s_add_u32 s61, s61, 22016
    s_add_u32 s62, s62, 1024
    s_mov_b32 m0, s62
    s_nop 0
    buffer_load_dwordx4 v4, s[44:47], s61 offen lds
    s_add_u32 s61, s61, 22016
    s_add_u32 s62, s62, 1024
    s_mov_b32 m0, s62
    s_nop 0
    buffer_load_dwordx4 v4, s[44:47], s61 offen lds
    s_add_u32 s61, s61, 22016
    s_add_u32 s62, s62, 1024
    s_mov_b32 m0, s62
    s_nop 0
    buffer_load_dwordx4 v4, s[44:47], s61 offen lds
    s_add_u32 s61, s61, 22016
    s_add_u32 s62, s62, 1024
    s_mov_b32 m0, s62
    s_nop 0
    buffer_load_dwordx4 v4, s[44:47], s61 offen lds
    s_add_u32 s61, s61, 22016
    s_add_u32 s62, s62, 1024
    s_mov_b32 m0, s62
    s_nop 0
    buffer_load_dwordx4 v4, s[44:47], s61 offen lds
    s_add_u32 s61, s61, 22016
    s_add_u32 s62, s62, 1024
    s_mov_b32 m0, s62
    s_nop 0
    buffer_load_dwordx4 v4, s[44:47], s61 offen lds
    s_add_u32 s61, s61, 22016
    s_add_u32 s62, s62, 1024
    s_mov_b32 m0, s62
    s_nop 0
    buffer_load_dwordx4 v4, s[44:47], s61 offen lds
    v_lshlrev_b32 v28, 3, v3
    v_lshrrev_b32 v29, 2, v2
    v_add_u32 v28, v28, v29
    v_lshlrev_b32 v28, 7, v28
    v_and_b32 v29, 3, v2
    v_lshlrev_b32 v29, 3, v29
    v_add_u32 v28, v28, v29
    s_lshl_b32 s61, s56, 5
    v_add_u32 v28, s61, v28
    v_add_u32 v29, 0x10000, v28
    s_waitcnt vmcnt(0)
    s_barrier
    ds_read_b64_tr_b16 v[64:65], v28 offset:0
    ds_read_b64_tr_b16 v[66:67], v28 offset:512
    ds_read_b64_tr_b16 v[68:69], v28 offset:4096
    ds_read_b64_tr_b16 v[70:71], v28 offset:4608
    ds_read_b64_tr_b16 v[72:73], v28 offset:8192
    ds_read_b64_tr_b16 v[74:75], v28 offset:8704
    ds_read_b64_tr_b16 v[76:77], v28 offset:12288
    ds_read_b64_tr_b16 v[78:79], v28 offset:12800
    s_waitcnt lgkmcnt(7)
    v_accvgpr_write_b32 a0, v64
    v_accvgpr_write_b32 a1, v65
    ds_read_b64_tr_b16 v[64:65], v28 offset:16384
    s_waitcnt lgkmcnt(7)
    v_accvgpr_write_b32 a2, v66
    v_accvgpr_write_b32 a3, v67
    ds_read_b64_tr_b16 v[66:67], v28 offset:16896
    s_waitcnt lgkmcnt(7)
    v_accvgpr_write_b32 a4, v68
    v_accvgpr_write_b32 a5, v69
    ds_read_b64_tr_b16 v[68:69], v28 offset:20480
    s_waitcnt lgkmcnt(7)
    v_accvgpr_write_b32 a6, v70
    v_accvgpr_write_b32 a7, v71
    ds_read_b64_tr_b16 v[70:71], v28 offset:20992
    s_waitcnt lgkmcnt(7)
    v_accvgpr_write_b32 a8, v72
    v_accvgpr_write_b32 a9, v73
    ds_read_b64_tr_b16 v[72:73], v28 offset:24576
    s_waitcnt lgkmcnt(7)
    v_accvgpr_write_b32 a10, v74
    v_accvgpr_write_b32 a11, v75
    ds_read_b64_tr_b16 v[74:75], v28 offset:25088
    s_waitcnt lgkmcnt(7)
    v_accvgpr_write_b32 a12, v76
    v_accvgpr_write_b32 a13, v77
    ds_read_b64_tr_b16 v[76:77], v28 offset:28672
    s_waitcnt lgkmcnt(7)
    v_accvgpr_write_b32 a14, v78
    v_accvgpr_write_b32 a15, v79
    ds_read_b64_tr_b16 v[78:79], v28 offset:29184
    s_waitcnt lgkmcnt(7)
    v_accvgpr_write_b32 a16, v64
    v_accvgpr_write_b32 a17, v65
    ds_read_b64_tr_b16 v[64:65], v28 offset:32768
    s_waitcnt lgkmcnt(7)
    v_accvgpr_write_b32 a18, v66
    v_accvgpr_write_b32 a19, v67
    ds_read_b64_tr_b16 v[66:67], v28 offset:33280
    s_waitcnt lgkmcnt(7)
    v_accvgpr_write_b32 a20, v68
    v_accvgpr_write_b32 a21, v69
    ds_read_b64_tr_b16 v[68:69], v28 offset:36864
    s_waitcnt lgkmcnt(7)
    v_accvgpr_write_b32 a22, v70
    v_accvgpr_write_b32 a23, v71
    ds_read_b64_tr_b16 v[70:71], v28 offset:37376
    s_waitcnt lgkmcnt(7)
    v_accvgpr_write_b32 a24, v72
    v_accvgpr_write_b32 a25, v73
    ds_read_b64_tr_b16 v[72:73], v28 offset:40960
    s_waitcnt lgkmcnt(7)
    v_accvgpr_write_b32 a26, v74
    v_accvgpr_write_b32 a27, v75
    ds_read_b64_tr_b16 v[74:75], v28 offset:41472
    s_waitcnt lgkmcnt(7)
    v_accvgpr_write_b32 a28, v76
    v_accvgpr_write_b32 a29, v77
    ds_read_b64_tr_b16 v[76:77], v28 offset:45056
    s_waitcnt lgkmcnt(7)
    v_accvgpr_write_b32 a30, v78
    v_accvgpr_write_b32 a31, v79
    ds_read_b64_tr_b16 v[78:79], v28 offset:45568
    s_waitcnt lgkmcnt(7)
    v_accvgpr_write_b32 a32, v64
    v_accvgpr_write_b32 a33, v65
    ds_read_b64_tr_b16 v[64:65], v28 offset:49152
    s_waitcnt lgkmcnt(7)
    v_accvgpr_write_b32 a34, v66
    v_accvgpr_write_b32 a35, v67
    ds_read_b64_tr_b16 v[66:67], v28 offset:49664
    s_waitcnt lgkmcnt(7)
    v_accvgpr_write_b32 a36, v68
    v_accvgpr_write_b32 a37, v69
    ds_read_b64_tr_b16 v[68:69], v28 offset:53248
    s_waitcnt lgkmcnt(7)
    v_accvgpr_write_b32 a38, v70
    v_accvgpr_write_b32 a39, v71
    ds_read_b64_tr_b16 v[70:71], v28 offset:53760
    s_waitcnt lgkmcnt(7)
    v_accvgpr_write_b32 a40, v72
    v_accvgpr_write_b32 a41, v73
    ds_read_b64_tr_b16 v[72:73], v28 offset:57344
    s_waitcnt lgkmcnt(7)
    v_accvgpr_write_b32 a42, v74
    v_accvgpr_write_b32 a43, v75
    ds_read_b64_tr_b16 v[74:75], v28 offset:57856
    s_waitcnt lgkmcnt(7)
    v_accvgpr_write_b32 a44, v76
    v_accvgpr_write_b32 a45, v77
    ds_read_b64_tr_b16 v[76:77], v28 offset:61440
    s_waitcnt lgkmcnt(7)
    v_accvgpr_write_b32 a46, v78
    v_accvgpr_write_b32 a47, v79
    ds_read_b64_tr_b16 v[78:79], v28 offset:61952
    s_waitcnt lgkmcnt(7)
    v_accvgpr_write_b32 a48, v64
    v_accvgpr_write_b32 a49, v65
    s_waitcnt lgkmcnt(6)
    v_accvgpr_write_b32 a50, v66
    v_accvgpr_write_b32 a51, v67
    s_waitcnt lgkmcnt(5)
    v_accvgpr_write_b32 a52, v68
    v_accvgpr_write_b32 a53, v69
    s_waitcnt lgkmcnt(4)
    v_accvgpr_write_b32 a54, v70
    v_accvgpr_write_b32 a55, v71
    s_waitcnt lgkmcnt(3)
    v_accvgpr_write_b32 a56, v72
    v_accvgpr_write_b32 a57, v73
    s_waitcnt lgkmcnt(2)
    v_accvgpr_write_b32 a58, v74
    v_accvgpr_write_b32 a59, v75
    s_waitcnt lgkmcnt(1)
    v_accvgpr_write_b32 a60, v76
    v_accvgpr_write_b32 a61, v77
    s_waitcnt lgkmcnt(0)
    v_accvgpr_write_b32 a62, v78
    v_accvgpr_write_b32 a63, v79
    ds_read_b64_tr_b16 v[64:65], v29 offset:0
    ds_read_b64_tr_b16 v[66:67], v29 offset:512
    ds_read_b64_tr_b16 v[68:69], v29 offset:4096
    ds_read_b64_tr_b16 v[70:71], v29 offset:4608
    ds_read_b64_tr_b16 v[72:73], v29 offset:8192
    ds_read_b64_tr_b16 v[74:75], v29 offset:8704
    ds_read_b64_tr_b16 v[76:77], v29 offset:12288
    ds_read_b64_tr_b16 v[78:79], v29 offset:12800
    s_waitcnt lgkmcnt(7)
    v_accvgpr_write_b32 a64, v64
    v_accvgpr_write_b32 a65, v65
    ds_read_b64_tr_b16 v[64:65], v29 offset:16384
    s_waitcnt lgkmcnt(7)
    v_accvgpr_write_b32 a66, v66
    v_accvgpr_write_b32 a67, v67
    ds_read_b64_tr_b16 v[66:67], v29 offset:16896
    s_waitcnt lgkmcnt(7)
    v_accvgpr_write_b32 a68, v68
    v_accvgpr_write_b32 a69, v69
    ds_read_b64_tr_b16 v[68:69], v29 offset:20480
    s_waitcnt lgkmcnt(7)
    v_accvgpr_write_b32 a70, v70
    v_accvgpr_write_b32 a71, v71
    ds_read_b64_tr_b16 v[70:71], v29 offset:20992
    s_waitcnt lgkmcnt(7)
    v_accvgpr_write_b32 a72, v72
    v_accvgpr_write_b32 a73, v73
    ds_read_b64_tr_b16 v[72:73], v29 offset:24576
    s_waitcnt lgkmcnt(7)
    v_accvgpr_write_b32 a74, v74
    v_accvgpr_write_b32 a75, v75
    ds_read_b64_tr_b16 v[74:75], v29 offset:25088
    s_waitcnt lgkmcnt(7)
    v_accvgpr_write_b32 a76, v76
    v_accvgpr_write_b32 a77, v77
    ds_read_b64_tr_b16 v[76:77], v29 offset:28672
    s_waitcnt lgkmcnt(7)
    v_accvgpr_write_b32 a78, v78
    v_accvgpr_write_b32 a79, v79
    ds_read_b64_tr_b16 v[78:79], v29 offset:29184
    s_waitcnt lgkmcnt(7)
    v_accvgpr_write_b32 a80, v64
    v_accvgpr_write_b32 a81, v65
    ds_read_b64_tr_b16 v[64:65], v29 offset:32768
    s_waitcnt lgkmcnt(7)
    v_accvgpr_write_b32 a82, v66
    v_accvgpr_write_b32 a83, v67
    ds_read_b64_tr_b16 v[66:67], v29 offset:33280
    s_waitcnt lgkmcnt(7)
    v_accvgpr_write_b32 a84, v68
    v_accvgpr_write_b32 a85, v69
    ds_read_b64_tr_b16 v[68:69], v29 offset:36864
    s_waitcnt lgkmcnt(7)
    v_accvgpr_write_b32 a86, v70
    v_accvgpr_write_b32 a87, v71
    ds_read_b64_tr_b16 v[70:71], v29 offset:37376
    s_waitcnt lgkmcnt(7)
    v_accvgpr_write_b32 a88, v72
    v_accvgpr_write_b32 a89, v73
    ds_read_b64_tr_b16 v[72:73], v29 offset:40960
    s_waitcnt lgkmcnt(7)
    v_accvgpr_write_b32 a90, v74
    v_accvgpr_write_b32 a91, v75
    ds_read_b64_tr_b16 v[74:75], v29 offset:41472
    s_waitcnt lgkmcnt(7)
    v_accvgpr_write_b32 a92, v76
    v_accvgpr_write_b32 a93, v77
    ds_read_b64_tr_b16 v[76:77], v29 offset:45056
    s_waitcnt lgkmcnt(7)
    v_accvgpr_write_b32 a94, v78
    v_accvgpr_write_b32 a95, v79
    ds_read_b64_tr_b16 v[78:79], v29 offset:45568
    s_waitcnt lgkmcnt(7)
    v_accvgpr_write_b32 a96, v64
    v_accvgpr_write_b32 a97, v65
    ds_read_b64_tr_b16 v[64:65], v29 offset:49152
    s_waitcnt lgkmcnt(7)
    v_accvgpr_write_b32 a98, v66
    v_accvgpr_write_b32 a99, v67
    ds_read_b64_tr_b16 v[66:67], v29 offset:49664
    s_waitcnt lgkmcnt(7)
    v_accvgpr_write_b32 a100, v68
    v_accvgpr_write_b32 a101, v69
    ds_read_b64_tr_b16 v[68:69], v29 offset:53248
    s_waitcnt lgkmcnt(7)
    v_accvgpr_write_b32 a102, v70
    v_accvgpr_write_b32 a103, v71
    ds_read_b64_tr_b16 v[70:71], v29 offset:53760
    s_waitcnt lgkmcnt(7)
    v_accvgpr_write_b32 a104, v72
    v_accvgpr_write_b32 a105, v73
    ds_read_b64_tr_b16 v[72:73], v29 offset:57344
    s_waitcnt lgkmcnt(7)
    v_accvgpr_write_b32 a106, v74
    v_accvgpr_write_b32 a107, v75
    ds_read_b64_tr_b16 v[74:75], v29 offset:57856
    s_waitcnt lgkmcnt(7)
    v_accvgpr_write_b32 a108, v76
    v_accvgpr_write_b32 a109, v77
    ds_read_b64_tr_b16 v[76:77], v29 offset:61440
    s_waitcnt lgkmcnt(7)
    v_accvgpr_write_b32 a110, v78
    v_accvgpr_write_b32 a111, v79
    ds_read_b64_tr_b16 v[78:79], v29 offset:61952
    s_waitcnt lgkmcnt(7)
    v_accvgpr_write_b32 a112, v64
    v_accvgpr_write_b32 a113, v65
    s_waitcnt lgkmcnt(6)
    v_accvgpr_write_b32 a114, v66
    v_accvgpr_write_b32 a115, v67
    s_waitcnt lgkmcnt(5)
    v_accvgpr_write_b32 a116, v68
    v_accvgpr_write_b32 a117, v69
    s_waitcnt lgkmcnt(4)
    v_accvgpr_write_b32 a118, v70
    v_accvgpr_write_b32 a119, v71
    s_waitcnt lgkmcnt(3)
    v_accvgpr_write_b32 a120, v72
    v_accvgpr_write_b32 a121, v73
    s_waitcnt lgkmcnt(2)
    v_accvgpr_write_b32 a122, v74
    v_accvgpr_write_b32 a123, v75
    s_waitcnt lgkmcnt(1)
    v_accvgpr_write_b32 a124, v76
    v_accvgpr_write_b32 a125, v77
    s_waitcnt lgkmcnt(0)
    v_accvgpr_write_b32 a126, v78
    v_accvgpr_write_b32 a127, v79
    s_barrier
    v_lshrrev_b32 v4, 3, v1
    v_lshlrev_b32 v4, 10, v4
    v_and_b32 v5, 7, v1
    v_lshlrev_b32 v5, 4, v5
    v_add_u32 v4, v4, v5
    s_lshl_b32 s61, s58, 16
    v_add_u32 v4, s61, v4
    s_mul_i32 s61, s56, 16384
    s_add_u32 s61, s61, 0
    s_mul_i32 s62, s56, 2048
    s_add_u32 s62, s62, 0
    s_mov_b32 m0, s62
    s_nop 0
    buffer_load_dwordx4 v4, s[48:51], s61 offen lds
    s_add_u32 s61, s61, 8192
    s_add_u32 s62, s62, 1024
    s_mov_b32 m0, s62
    s_nop 0
    buffer_load_dwordx4 v4, s[48:51], s61 offen lds
    v_add_u32 v4, 128, v4
    s_mul_i32 s61, s56, 16384
    s_add_u32 s61, s61, 0
    s_mul_i32 s62, s56, 2048
    s_add_u32 s62, s62, 8192
    s_mov_b32 m0, s62
    s_nop 0
    buffer_load_dwordx4 v4, s[48:51], s61 offen lds
    s_add_u32 s61, s61, 8192
    s_add_u32 s62, s62, 1024
    s_mov_b32 m0, s62
    s_nop 0
    buffer_load_dwordx4 v4, s[48:51], s61 offen lds
    v_add_u32 v4, 128, v4
    s_mul_i32 s61, s56, 16384
    s_add_u32 s61, s61, 0
    s_mul_i32 s62, s56, 2048
    s_add_u32 s62, s62, 16384
    s_mov_b32 m0, s62
    s_nop 0
    buffer_load_dwordx4 v4, s[48:51], s61 offen lds
    s_add_u32 s61, s61, 8192
    s_add_u32 s62, s62, 1024
    s_mov_b32 m0, s62
    s_nop 0
    buffer_load_dwordx4 v4, s[48:51], s61 offen lds
    v_add_u32 v4, 128, v4
    s_mul_i32 s61, s56, 16384
    s_add_u32 s61, s61, 0
    s_mul_i32 s62, s56, 2048
    s_add_u32 s62, s62, 24576
    s_mov_b32 m0, s62
    s_nop 0
    buffer_load_dwordx4 v4, s[48:51], s61 offen lds
    s_add_u32 s61, s61, 8192
    s_add_u32 s62, s62, 1024
    s_mov_b32 m0, s62
    s_nop 0
    buffer_load_dwordx4 v4, s[48:51], s61 offen lds
    v_add_u32 v4, 128, v4
    s_mul_i32 s61, s56, 16384
    s_add_u32 s61, s61, 0
    s_mul_i32 s62, s56, 2048
    s_add_u32 s62, s62, 32768
    s_mov_b32 m0, s62
    s_nop 0
    buffer_load_dwordx4 v4, s[48:51], s61 offen lds
    s_add_u32 s61, s61, 8192
    s_add_u32 s62, s62, 1024
    s_mov_b32 m0, s62
    s_nop 0
    buffer_load_dwordx4 v4, s[48:51], s61 offen lds
    v_add_u32 v4, 128, v4
    s_mul_i32 s61, s56, 16384
    s_add_u32 s61, s61, 0
    s_mul_i32 s62, s56, 2048
    s_add_u32 s62, s62, 40960
    s_mov_b32 m0, s62
    s_nop 0
    buffer_load_dwordx4 v4, s[48:51], s61 offen lds
    s_add_u32 s61, s61, 8192
    s_add_u32 s62, s62, 1024
    s_mov_b32 m0, s62
    s_nop 0
    buffer_load_dwordx4 v4, s[48:51], s61 offen lds
    v_add_u32 v4, 128, v4
    s_mul_i32 s61, s56, 16384
    s_add_u32 s61, s61, 0
    s_mul_i32 s62, s56, 2048
    s_add_u32 s62, s62, 49152
    s_mov_b32 m0, s62
    s_nop 0
    buffer_load_dwordx4 v4, s[48:51], s61 offen lds
    s_add_u32 s61, s61, 8192
    s_add_u32 s62, s62, 1024
    s_mov_b32 m0, s62
    s_nop 0
    buffer_load_dwordx4 v4, s[48:51], s61 offen lds
    v_add_u32 v4, 128, v4
    s_mul_i32 s61, s56, 16384
    s_add_u32 s61, s61, 0
    s_mul_i32 s62, s56, 2048
    s_add_u32 s62, s62, 57344
    s_mov_b32 m0, s62
    s_nop 0
    buffer_load_dwordx4 v4, s[48:51], s61 offen lds
    s_add_u32 s61, s61, 8192
    s_add_u32 s62, s62, 1024
    s_mov_b32 m0, s62
    s_nop 0
    buffer_load_dwordx4 v4, s[48:51], s61 offen lds
    v_lshrrev_b32 v4, 5, v1
    v_lshlrev_b32 v4, 3, v4
    v_bfe_u32 v5, v1, 2, 2
    v_add_u32 v4, v4, v5
    v_lshlrev_b32 v4, 7, v4
    v_and_b32 v5, 1, v1
    v_lshlrev_b32 v5, 5, v5
    v_add_u32 v4, v4, v5
    v_bfe_u32 v5, v1, 1, 1
    v_lshlrev_b32 v5, 3, v5
    v_add_u32 v4, v4, v5
    v_bfe_u32 v5, v1, 4, 1
    v_lshlrev_b32 v5, 4, v5
    v_add_u32 v4, v4, v5
    s_lshl_b32 s61, s56, 14
    v_add_u32 v4, s61, v4
    s_waitcnt vmcnt(0)
    s_barrier
    ds_read_b64_tr_b16 v[64:65], v4 offset:0
    ds_read_b64_tr_b16 v[66:67], v4 offset:512
    ds_read_b64_tr_b16 v[68:69], v4 offset:2048
    ds_read_b64_tr_b16 v[70:71], v4 offset:2560
    ds_read_b64_tr_b16 v[72:73], v4 offset:4096
    ds_read_b64_tr_b16 v[74:75], v4 offset:4608
    ds_read_b64_tr_b16 v[76:77], v4 offset:6144
    ds_read_b64_tr_b16 v[78:79], v4 offset:6656
    s_waitcnt lgkmcnt(7)
    v_accvgpr_write_b32 a128, v64
    v_accvgpr_write_b32 a129, v65
    ds_read_b64_tr_b16 v[64:65], v4 offset:64
    s_waitcnt lgkmcnt(7)
    v_accvgpr_write_b32 a130, v66
    v_accvgpr_write_b32 a131, v67
    ds_read_b64_tr_b16 v[66:67], v4 offset:576
    s_waitcnt lgkmcnt(7)
    v_accvgpr_write_b32 a132, v68
    v_accvgpr_write_b32 a133, v69
    ds_read_b64_tr_b16 v[68:69], v4 offset:2112
    s_waitcnt lgkmcnt(7)
    v_accvgpr_write_b32 a134, v70
    v_accvgpr_write_b32 a135, v71
    ds_read_b64_tr_b16 v[70:71], v4 offset:2624
    s_waitcnt lgkmcnt(7)
    v_accvgpr_write_b32 a136, v72
    v_accvgpr_write_b32 a137, v73
    ds_read_b64_tr_b16 v[72:73], v4 offset:4160
    s_waitcnt lgkmcnt(7)
    v_accvgpr_write_b32 a138, v74
    v_accvgpr_write_b32 a139, v75
    ds_read_b64_tr_b16 v[74:75], v4 offset:4672
    s_waitcnt lgkmcnt(7)
    v_accvgpr_write_b32 a140, v76
    v_accvgpr_write_b32 a141, v77
    ds_read_b64_tr_b16 v[76:77], v4 offset:6208
    s_waitcnt lgkmcnt(7)
    v_accvgpr_write_b32 a142, v78
    v_accvgpr_write_b32 a143, v79
    ds_read_b64_tr_b16 v[78:79], v4 offset:6720
    s_waitcnt lgkmcnt(7)
    v_accvgpr_write_b32 a144, v64
    v_accvgpr_write_b32 a145, v65
    ds_read_b64_tr_b16 v[64:65], v4 offset:8192
    s_waitcnt lgkmcnt(7)
    v_accvgpr_write_b32 a146, v66
    v_accvgpr_write_b32 a147, v67
    ds_read_b64_tr_b16 v[66:67], v4 offset:8704
    s_waitcnt lgkmcnt(7)
    v_accvgpr_write_b32 a148, v68
    v_accvgpr_write_b32 a149, v69
    ds_read_b64_tr_b16 v[68:69], v4 offset:10240
    s_waitcnt lgkmcnt(7)
    v_accvgpr_write_b32 a150, v70
    v_accvgpr_write_b32 a151, v71
    ds_read_b64_tr_b16 v[70:71], v4 offset:10752
    s_waitcnt lgkmcnt(7)
    v_accvgpr_write_b32 a152, v72
    v_accvgpr_write_b32 a153, v73
    ds_read_b64_tr_b16 v[72:73], v4 offset:12288
    s_waitcnt lgkmcnt(7)
    v_accvgpr_write_b32 a154, v74
    v_accvgpr_write_b32 a155, v75
    ds_read_b64_tr_b16 v[74:75], v4 offset:12800
    s_waitcnt lgkmcnt(7)
    v_accvgpr_write_b32 a156, v76
    v_accvgpr_write_b32 a157, v77
    ds_read_b64_tr_b16 v[76:77], v4 offset:14336
    s_waitcnt lgkmcnt(7)
    v_accvgpr_write_b32 a158, v78
    v_accvgpr_write_b32 a159, v79
    ds_read_b64_tr_b16 v[78:79], v4 offset:14848
    s_waitcnt lgkmcnt(7)
    v_accvgpr_write_b32 a160, v64
    v_accvgpr_write_b32 a161, v65
    ds_read_b64_tr_b16 v[64:65], v4 offset:8256
    s_waitcnt lgkmcnt(7)
    v_accvgpr_write_b32 a162, v66
    v_accvgpr_write_b32 a163, v67
    ds_read_b64_tr_b16 v[66:67], v4 offset:8768
    s_waitcnt lgkmcnt(7)
    v_accvgpr_write_b32 a164, v68
    v_accvgpr_write_b32 a165, v69
    ds_read_b64_tr_b16 v[68:69], v4 offset:10304
    s_waitcnt lgkmcnt(7)
    v_accvgpr_write_b32 a166, v70
    v_accvgpr_write_b32 a167, v71
    ds_read_b64_tr_b16 v[70:71], v4 offset:10816
    s_waitcnt lgkmcnt(7)
    v_accvgpr_write_b32 a168, v72
    v_accvgpr_write_b32 a169, v73
    ds_read_b64_tr_b16 v[72:73], v4 offset:12352
    s_waitcnt lgkmcnt(7)
    v_accvgpr_write_b32 a170, v74
    v_accvgpr_write_b32 a171, v75
    ds_read_b64_tr_b16 v[74:75], v4 offset:12864
    s_waitcnt lgkmcnt(7)
    v_accvgpr_write_b32 a172, v76
    v_accvgpr_write_b32 a173, v77
    ds_read_b64_tr_b16 v[76:77], v4 offset:14400
    s_waitcnt lgkmcnt(7)
    v_accvgpr_write_b32 a174, v78
    v_accvgpr_write_b32 a175, v79
    ds_read_b64_tr_b16 v[78:79], v4 offset:14912
    s_waitcnt lgkmcnt(7)
    v_accvgpr_write_b32 a176, v64
    v_accvgpr_write_b32 a177, v65
    s_waitcnt lgkmcnt(6)
    v_accvgpr_write_b32 a178, v66
    v_accvgpr_write_b32 a179, v67
    s_waitcnt lgkmcnt(5)
    v_accvgpr_write_b32 a180, v68
    v_accvgpr_write_b32 a181, v69
    s_waitcnt lgkmcnt(4)
    v_accvgpr_write_b32 a182, v70
    v_accvgpr_write_b32 a183, v71
    s_waitcnt lgkmcnt(3)
    v_accvgpr_write_b32 a184, v72
    v_accvgpr_write_b32 a185, v73
    s_waitcnt lgkmcnt(2)
    v_accvgpr_write_b32 a186, v74
    v_accvgpr_write_b32 a187, v75
    s_waitcnt lgkmcnt(1)
    v_accvgpr_write_b32 a188, v76
    v_accvgpr_write_b32 a189, v77
    s_waitcnt lgkmcnt(0)
    v_accvgpr_write_b32 a190, v78
    v_accvgpr_write_b32 a191, v79
    s_barrier
    v_lshlrev_b32 v6, 4, v1
    s_mul_i32 s62, s56, 8448
    v_add_u32 v7, s62, v6
    s_lshl_b32 s62, s56, 13
    v_add_u32 v6, s62, v6
    v_mul_u32_u24 v8, 1056, v2
    v_lshlrev_b32 v9, 4, v3
    v_add_u32 v8, v8, v9
    v_mul_u32_u24 v9, 144, v2
    v_lshlrev_b32 v10, 3, v3
    v_add_u32 v9, v9, v10
    s_lshl_b32 s61, s56, 5
    s_add_u32 s61, s61, 33792
    v_add_u32 v9, s61, v9
    v_and_b32 v10, 31, v1
    v_mul_u32_u24 v10, 144, v10
    v_lshrrev_b32 v11, 5, v1
    v_lshlrev_b32 v11, 4, v11
    v_add_u32 v10, v10, v11
    v_add_u32 v10, 33792, v10
    s_mul_i32 s61, s56, 8704
    s_add_u32 s61, s61, 40960
    v_and_b32 v11, 31, v1
    v_mul_u32_u24 v11, 272, v11
    v_lshrrev_b32 v30, 5, v1
    v_lshlrev_b32 v30, 5, v30
    v_add_u32 v11, v11, v30
    v_add_u32 v11, s61, v11
    v_mul_u32_u24 v25, 272, v3
    v_lshlrev_b32 v30, 4, v2
    v_add_u32 v25, v25, v30
    v_add_u32 v25, s61, v25
    v_lshlrev_b32 v26, 10, v3
    v_add_u32 v26, v26, v30
    s_lshl_b32 s61, s58, 15
    s_lshl_b32 s62, s56, 8
    s_add_u32 s61, s61, s62
    v_add_u32 v26, s61, v26
    v_add_u32 v27, 4096, v26
    v_add_u32 v28, 8192, v26
    v_add_u32 v29, 12288, v26
    s_mov_b32 s68, 0xbfb8aa3b
    v_lshlrev_b32 v120, 2, v1
    s_cmp_lg_u32 s56, 0
    s_cbranch_scc1 Lcw_138
Lcw_137:
    buffer_load_dword v121, v120, s[36:39], 0 offen sc1
    s_add_u32 s99, s99, 1
    s_cmp_gt_u32 s99, 0x2dc6c0
    s_cbranch_scc0 Lto_139
    s_mov_b32 s3, 2
    s_branch L_abort
Lto_139:
    s_waitcnt vmcnt(0)
    v_readlane_b32 s3, v121, 8
    s_cmp_ge_u32 s3, 256
    s_cbranch_scc1 Lcw_140
    s_sleep 8
    s_branch Lcw_137
Lcw_140:
    v_readlane_b32 s3, v121, s57
    v_mov_b32 v120, 163836
    s_nop 0
    v_mov_b32 v121, s3
    ds_write_b32 v120, v121
    s_waitcnt lgkmcnt(0)
Lcw_138:
    s_barrier
    v_mov_b32 v120, 163836
    ds_read_b32 v121, v120
    s_waitcnt lgkmcnt(0)
    v_readfirstlane_b32 s3, v121
    s_cmp_lt_u32 s3, 32
    s_cselect_b32 s59, 1, 0
    s_barrier
    s_lshl_b32 s61, s60, 2
    s_add_u32 s61, s61, 56
    s_cmp_lg_u32 s56, 0
    s_cbranch_scc1 Ldw_142
    v_mov_b32 v30, s61
    s_mov_b64 exec, 1
Ldw_141:
    buffer_load_dword v31, v30, s[36:39], 0 offen sc1
    s_add_u32 s99, s99, 1
    s_cmp_gt_u32 s99, 0x2dc6c0
    s_cbranch_scc0 Lto_143
    s_mov_b32 s3, 35
    s_branch L_abort
Lto_143:
    s_waitcnt vmcnt(0)
    v_cmp_gt_u32 vcc, 32, v31
    s_cbranch_vccz Ldw_144
    s_sleep 8
    s_branch Ldw_141
Ldw_144:
    s_mov_b64 exec, -1
Ldw_142:
    s_barrier
    s_lshl_b32 s61, s60, 2
    s_add_u32 s61, s61, 64
    s_cmp_lg_u32 s56, 0
    s_cbranch_scc1 Ldw_146
    v_mov_b32 v30, s61
    s_mov_b64 exec, 1
Ldw_145:
    buffer_load_dword v31, v30, s[36:39], 0 offen sc1
    s_add_u32 s99, s99, 1
    s_cmp_gt_u32 s99, 0x2dc6c0
    s_cbranch_scc0 Lto_147
    s_mov_b32 s3, 35
    s_branch L_abort
Lto_147:
    s_waitcnt vmcnt(0)
    v_cmp_gt_u32 vcc, 32, v31
    s_cbranch_vccz Ldw_148
    s_sleep 8
    s_branch Ldw_145
Ldw_148:
    s_mov_b64 exec, -1
Ldw_146:
    s_barrier
    s_cmp_lg_u32 s56, 0
    s_cbranch_scc1 Ldw_150
    v_mov_b32 v30, 72
    s_mov_b64 exec, 1
Ldw_149:
    buffer_load_dword v31, v30, s[36:39], 0 offen sc1
    s_add_u32 s99, s99, 1
    s_cmp_gt_u32 s99, 0x2dc6c0
    s_cbranch_scc0 Lto_151
    s_mov_b32 s3, 35
    s_branch L_abort
Lto_151:
    s_waitcnt vmcnt(0)
    v_cmp_gt_u32 vcc, 32, v31
    s_cbranch_vccz Ldw_152
    s_sleep 8
    s_branch Ldw_149
Ldw_152:
    s_mov_b64 exec, -1
Ldw_150:
    s_barrier
    s_cmp_eq_u32 s59, 1
    s_cbranch_scc1 Lffs_153
    s_mov_b32 s64, 0
    s_lshl_b32 s61, s60, 21
    s_lshl_b32 s62, s64, 15
    s_add_u32 s61, s61, s62
    s_add_u32 s76, s61, 0x800000
    s_add_u32 s77, s76, 4096
    buffer_load_dwordx4 v[128:131], v6, s[32:35], s76 offen offset:0 sc1
    buffer_load_dwordx4 v[132:135], v6, s[32:35], s76 offen offset:1024 sc1
    buffer_load_dwordx4 v[136:139], v6, s[32:35], s76 offen offset:2048 sc1
    buffer_load_dwordx4 v[140:143], v6, s[32:35], s76 offen offset:3072 sc1
    buffer_load_dwordx4 v[144:147], v6, s[32:35], s77 offen offset:0 sc1
    buffer_load_dwordx4 v[148:151], v6, s[32:35], s77 offen offset:1024 sc1
    buffer_load_dwordx4 v[152:155], v6, s[32:35], s77 offen offset:2048 sc1
    buffer_load_dwordx4 v[156:159], v6, s[32:35], s77 offen offset:3072 sc1
    s_waitcnt vmcnt(0)
Lffl_154:
    s_waitcnt vmcnt(8)
    s_branch Lffc_158
Lffc_157:
    s_waitcnt vmcnt(0)
Lffc_158:
    v_max3_u32 v240, v128, v132, v136
    v_max3_u32 v241, v140, v144, v148
    v_max3_u32 v240, v240, v152, v156
    v_max_u32 v240, v240, v241
    v_cmp_eq_u32 vcc, -1, v240
    s_cbranch_vccz Lffk_155
Lffp_156:
    s_lshl_b32 s61, s60, 21
    s_lshl_b32 s62, s64, 15
    s_add_u32 s61, s61, s62
    s_add_u32 s76, s61, 0x800000
    s_add_u32 s77, s76, 4096
    buffer_load_dwordx4 v[156:159], v6, s[32:35], s77 offen offset:3072 sc1
    s_sleep 2
    s_add_u32 s99, s99, 1
    s_cmp_gt_u32 s99, 0x2dc6c0
    s_cbranch_scc0 Lto_159
    s_mov_b32 s3, 32
    s_branch L_abort
Lto_159:
    s_waitcnt vmcnt(0)
    v_cmp_eq_u32 vcc, -1, v156
    s_cbranch_vccnz Lffp_156
    s_lshl_b32 s61, s60, 21
    s_lshl_b32 s62, s64, 15
    s_add_u32 s61, s61, s62
    s_add_u32 s76, s61, 0x800000
    s_add_u32 s77, s76, 4096
    buffer_load_dwordx4 v[128:131], v6, s[32:35], s76 offen offset:0 sc1
    buffer_load_dwordx4 v[132:135], v6, s[32:35], s76 offen offset:1024 sc1
    buffer_load_dwordx4 v[136:139], v6, s[32:35], s76 offen offset:2048 sc1
    buffer_load_dwordx4 v[140:143], v6, s[32:35], s76 offen offset:3072 sc1
    buffer_load_dwordx4 v[144:147], v6, s[32:35], s77 offen offset:0 sc1
    buffer_load_dwordx4 v[148:151], v6, s[32:35], s77 offen offset:1024 sc1
    buffer_load_dwordx4 v[152:155], v6, s[32:35], s77 offen offset:2048 sc1
    s_branch Lffc_157
Lffk_155:
    ds_write_b128 v7, v[128:131] offset:0
    ds_write_b128 v7, v[132:135] offset:1056
    ds_write_b128 v7, v[136:139] offset:2112
    ds_write_b128 v7, v[140:143] offset:3168
    ds_write_b128 v7, v[144:147] offset:4224
    ds_write_b128 v7, v[148:151] offset:5280
    ds_write_b128 v7, v[152:155] offset:6336
    ds_write_b128 v7, v[156:159] offset:7392
    s_add_u32 s72, s64, 1
    s_min_u32 s72, s72, 63
    s_lshr_b32 s75, s64, 2
    s_and_b32 s75, s75, 1
    s_sub_u32 s65, s64, 4
    s_lshl_b32 s61, s60, 7
    s_add_u32 s78, s61, 0x9022c00
    buffer_load_dword v252, v14, s[32:35], s78 offen sc1
    s_waitcnt lgkmcnt(0)
    s_barrier
    ds_read_b128 v[160:163], v8 offset:0
    ds_read_b128 v[164:167], v8 offset:16896
    ds_read_b128 v[168:171], v8 offset:64
    ds_read_b128 v[172:175], v8 offset:16960
    ds_read_b128 v[176:179], v8 offset:128
    ds_read_b128 v[180:183], v8 offset:17024
    s_waitcnt lgkmcnt(5)
    v_mfma_f32_16x16x32_bf16 v[64:67], a[0:3], v[160:163], 0
    v_mfma_f32_16x16x32_bf16 v[72:75], a[64:67], v[160:163], 0
    ds_read_b128 v[160:163], v8 offset:192
    s_waitcnt lgkmcnt(5)
    v_mfma_f32_16x16x32_bf16 v[68:71], a[0:3], v[164:167], 0
    v_mfma_f32_16x16x32_bf16 v[76:79], a[64:67], v[164:167], 0
    ds_read_b128 v[164:167], v8 offset:17088
    s_waitcnt lgkmcnt(5)
    v_mfma_f32_16x16x32_bf16 v[64:67], a[4:7], v[168:171], v[64:67]
    v_mfma_f32_16x16x32_bf16 v[72:75], a[68:71], v[168:171], v[72:75]
    ds_read_b128 v[168:171], v8 offset:256
    s_waitcnt lgkmcnt(5)
    v_mfma_f32_16x16x32_bf16 v[68:71], a[4:7], v[172:175], v[68:71]
    v_mfma_f32_16x16x32_bf16 v[76:79], a[68:71], v[172:175], v[76:79]
    ds_read_b128 v[172:175], v8 offset:17152
    s_waitcnt lgkmcnt(5)
    v_mfma_f32_16x16x32_bf16 v[64:67], a[8:11], v[176:179], v[64:67]
    v_mfma_f32_16x16x32_bf16 v[72:75], a[72:75], v[176:179], v[72:75]
    ds_read_b128 v[176:179], v8 offset:320
    s_waitcnt lgkmcnt(5)
    v_mfma_f32_16x16x32_bf16 v[68:71], a[8:11], v[180:183], v[68:71]
    v_mfma_f32_16x16x32_bf16 v[76:79], a[72:75], v[180:183], v[76:79]
    ds_read_b128 v[180:183], v8 offset:17216
    s_waitcnt lgkmcnt(5)
    v_mfma_f32_16x16x32_bf16 v[64:67], a[12:15], v[160:163], v[64:67]
    v_mfma_f32_16x16x32_bf16 v[72:75], a[76:79], v[160:163], v[72:75]
    ds_read_b128 v[160:163], v8 offset:384
    s_waitcnt lgkmcnt(5)
    v_mfma_f32_16x16x32_bf16 v[68:71], a[12:15], v[164:167], v[68:71]
    v_mfma_f32_16x16x32_bf16 v[76:79], a[76:79], v[164:167], v[76:79]
    ds_read_b128 v[164:167], v8 offset:17280
    s_waitcnt lgkmcnt(5)
    v_mfma_f32_16x16x32_bf16 v[64:67], a[16:19], v[168:171], v[64:67]
    v_mfma_f32_16x16x32_bf16 v[72:75], a[80:83], v[168:171], v[72:75]
    ds_read_b128 v[168:171], v8 offset:448
    s_waitcnt lgkmcnt(5)
    v_mfma_f32_16x16x32_bf16 v[68:71], a[16:19], v[172:175], v[68:71]
    v_mfma_f32_16x16x32_bf16 v[76:79], a[80:83], v[172:175], v[76:79]
    ds_read_b128 v[172:175], v8 offset:17344
    s_waitcnt lgkmcnt(5)
    v_mfma_f32_16x16x32_bf16 v[64:67], a[20:23], v[176:179], v[64:67]
    v_mfma_f32_16x16x32_bf16 v[72:75], a[84:87], v[176:179], v[72:75]
    ds_read_b128 v[176:179], v8 offset:512
    s_waitcnt lgkmcnt(5)
    v_mfma_f32_16x16x32_bf16 v[68:71], a[20:23], v[180:183], v[68:71]
    v_mfma_f32_16x16x32_bf16 v[76:79], a[84:87], v[180:183], v[76:79]
    ds_read_b128 v[180:183], v8 offset:17408
    s_waitcnt lgkmcnt(5)
    v_mfma_f32_16x16x32_bf16 v[64:67], a[24:27], v[160:163], v[64:67]
    v_mfma_f32_16x16x32_bf16 v[72:75], a[88:91], v[160:163], v[72:75]
    s_lshl_b32 s61, s60, 21
    s_lshl_b32 s62, s72, 15
    s_add_u32 s61, s61, s62
    s_add_u32 s76, s61, 0x800000
    s_add_u32 s77, s76, 4096
    ds_read_b128 v[160:163], v8 offset:576
    s_waitcnt lgkmcnt(5)
    v_mfma_f32_16x16x32_bf16 v[68:71], a[24:27], v[164:167], v[68:71]
    v_mfma_f32_16x16x32_bf16 v[76:79], a[88:91], v[164:167], v[76:79]
    buffer_load_dwordx4 v[128:131], v6, s[32:35], s76 offen offset:0 sc1
    ds_read_b128 v[164:167], v8 offset:17472
    s_waitcnt lgkmcnt(5)
    v_mfma_f32_16x16x32_bf16 v[64:67], a[28:31], v[168:171], v[64:67]
    v_mfma_f32_16x16x32_bf16 v[72:75], a[92:95], v[168:171], v[72:75]
    buffer_load_dwordx4 v[132:135], v6, s[32:35], s76 offen offset:1024 sc1
    ds_read_b128 v[168:171], v8 offset:640
    s_waitcnt lgkmcnt(5)
    v_mfma_f32_16x16x32_bf16 v[68:71], a[28:31], v[172:175], v[68:71]
    v_mfma_f32_16x16x32_bf16 v[76:79], a[92:95], v[172:175], v[76:79]
    buffer_load_dwordx4 v[136:139], v6, s[32:35], s76 offen offset:2048 sc1
    ds_read_b128 v[172:175], v8 offset:17536
    s_waitcnt lgkmcnt(5)
    v_mfma_f32_16x16x32_bf16 v[64:67], a[32:35], v[176:179], v[64:67]
    v_mfma_f32_16x16x32_bf16 v[72:75], a[96:99], v[176:179], v[72:75]
    buffer_load_dwordx4 v[140:143], v6, s[32:35], s76 offen offset:3072 sc1
    ds_read_b128 v[176:179], v8 offset:704
    s_waitcnt lgkmcnt(5)
    v_mfma_f32_16x16x32_bf16 v[68:71], a[32:35], v[180:183], v[68:71]
    v_mfma_f32_16x16x32_bf16 v[76:79], a[96:99], v[180:183], v[76:79]
    buffer_load_dwordx4 v[144:147], v6, s[32:35], s77 offen offset:0 sc1
    ds_read_b128 v[180:183], v8 offset:17600
    s_waitcnt lgkmcnt(5)
    v_mfma_f32_16x16x32_bf16 v[64:67], a[36:39], v[160:163], v[64:67]
    v_mfma_f32_16x16x32_bf16 v[72:75], a[100:103], v[160:163], v[72:75]
    buffer_load_dwordx4 v[148:151], v6, s[32:35], s77 offen offset:1024 sc1
    ds_read_b128 v[160:163], v8 offset:768
    s_waitcnt lgkmcnt(5)
    v_mfma_f32_16x16x32_bf16 v[68:71], a[36:39], v[164:167], v[68:71]
    v_mfma_f32_16x16x32_bf16 v[76:79], a[100:103], v[164:167], v[76:79]
    buffer_load_dwordx4 v[152:155], v6, s[32:35], s77 offen offset:2048 sc1
    ds_read_b128 v[164:167], v8 offset:17664
    s_waitcnt lgkmcnt(5)
    v_mfma_f32_16x16x32_bf16 v[64:67], a[40:43], v[168:171], v[64:67]
    v_mfma_f32_16x16x32_bf16 v[72:75], a[104:107], v[168:171], v[72:75]
    buffer_load_dwordx4 v[156:159], v6, s[32:35], s77 offen offset:3072 sc1
    ds_read_b128 v[168:171], v8 offset:832
    s_waitcnt lgkmcnt(5)
    v_mfma_f32_16x16x32_bf16 v[68:71], a[40:43], v[172:175], v[68:71]
    v_mfma_f32_16x16x32_bf16 v[76:79], a[104:107], v[172:175], v[76:79]
    ds_read_b128 v[172:175], v8 offset:17728
    s_waitcnt lgkmcnt(5)
    v_mfma_f32_16x16x32_bf16 v[64:67], a[44:47], v[176:179], v[64:67]
    v_mfma_f32_16x16x32_bf16 v[72:75], a[108:111], v[176:179], v[72:75]
    ds_read_b128 v[176:179], v8 offset:896
    s_waitcnt lgkmcnt(5)
    v_mfma_f32_16x16x32_bf16 v[68:71], a[44:47], v[180:183], v[68:71]
    v_mfma_f32_16x16x32_bf16 v[76:79], a[108:111], v[180:183], v[76:79]
    ds_read_b128 v[180:183], v8 offset:17792
    s_waitcnt lgkmcnt(5)
    v_mfma_f32_16x16x32_bf16 v[64:67], a[48:51], v[160:163], v[64:67]
    v_mfma_f32_16x16x32_bf16 v[72:75], a[112:115], v[160:163], v[72:75]
    ds_read_b128 v[160:163], v8 offset:960
    s_waitcnt lgkmcnt(5)
    v_mfma_f32_16x16x32_bf16 v[68:71], a[48:51], v[164:167], v[68:71]
    v_mfma_f32_16x16x32_bf16 v[76:79], a[112:115], v[164:167], v[76:79]
    ds_read_b128 v[164:167], v8 offset:17856
    s_waitcnt lgkmcnt(5)
    v_mfma_f32_16x16x32_bf16 v[64:67], a[52:55], v[168:171], v[64:67]
    v_mfma_f32_16x16x32_bf16 v[72:75], a[116:119], v[168:171], v[72:75]
    s_waitcnt lgkmcnt(4)
    v_mfma_f32_16x16x32_bf16 v[68:71], a[52:55], v[172:175], v[68:71]
    v_mfma_f32_16x16x32_bf16 v[76:79], a[116:119], v[172:175], v[76:79]
    s_waitcnt lgkmcnt(3)
    v_mfma_f32_16x16x32_bf16 v[64:67], a[56:59], v[176:179], v[64:67]
    v_mfma_f32_16x16x32_bf16 v[72:75], a[120:123], v[176:179], v[72:75]
    s_waitcnt lgkmcnt(2)
    v_mfma_f32_16x16x32_bf16 v[68:71], a[56:59], v[180:183], v[68:71]
    v_mfma_f32_16x16x32_bf16 v[76:79], a[120:123], v[180:183], v[76:79]
    s_waitcnt lgkmcnt(1)
    v_mfma_f32_16x16x32_bf16 v[64:67], a[60:63], v[160:163], v[64:67]
    v_mfma_f32_16x16x32_bf16 v[72:75], a[124:127], v[160:163], v[72:75]
    s_waitcnt lgkmcnt(0)
    v_mfma_f32_16x16x32_bf16 v[68:71], a[60:63], v[164:167], v[68:71]
    v_mfma_f32_16x16x32_bf16 v[76:79], a[124:127], v[164:167], v[76:79]
    s_nop 3
    v_mul_f32 v240, s68, v64
    v_mul_f32 v241, s68, v65
    v_mul_f32 v242, s68, v66
    v_mul_f32 v243, s68, v67
    v_mul_f32 v244, s68, v68
    v_mul_f32 v245, s68, v69
    v_mul_f32 v246, s68, v70
    v_mul_f32 v247, s68, v71
    v_exp_f32 v240, v240
    v_exp_f32 v241, v241
    v_exp_f32 v242, v242
    v_exp_f32 v243, v243
    v_exp_f32 v244, v244
    v_exp_f32 v245, v245
    v_exp_f32 v246, v246
    v_exp_f32 v247, v247
    v_add_f32 v240, 1.0, v240
    v_add_f32 v241, 1.0, v241
    v_add_f32 v242, 1.0, v242
    v_add_f32 v243, 1.0, v243
    v_add_f32 v244, 1.0, v244
    v_add_f32 v245, 1.0, v245
    v_add_f32 v246, 1.0, v246
    v_add_f32 v247, 1.0, v247
    v_rcp_f32 v240, v240
    v_rcp_f32 v241, v241
    v_rcp_f32 v242, v242
    v_rcp_f32 v243, v243
    v_rcp_f32 v244, v244
    v_rcp_f32 v245, v245
    v_rcp_f32 v246, v246
    v_rcp_f32 v247, v247
    v_mul_f32 v64, v64, v72
    v_mul_f32 v65, v65, v73
    v_mul_f32 v66, v66, v74
    v_mul_f32 v67, v67, v75
    v_mul_f32 v68, v68, v76
    v_mul_f32 v69, v69, v77
    v_mul_f32 v70, v70, v78
    v_mul_f32 v71, v71, v79
    v_mul_f32 v64, v64, v240
    v_mul_f32 v65, v65, v241
    v_mul_f32 v66, v66, v242
    v_mul_f32 v67, v67, v243
    v_mul_f32 v68, v68, v244
    v_mul_f32 v69, v69, v245
    v_mul_f32 v70, v70, v246
    v_mul_f32 v71, v71, v247
    v_cvt_pk_bf16_f32 v240, v64, v65
    v_cvt_pk_bf16_f32 v241, v66, v67
    ds_write_b64 v9, v[240:241] offset:0
    v_cvt_pk_bf16_f32 v242, v68, v69
    v_cvt_pk_bf16_f32 v243, v70, v71
    ds_write_b64 v9, v[242:243] offset:2304
    s_cmp_lt_u32 s64, 4
    s_cbranch_scc1 Lffb_160
    s_waitcnt vmcnt(8)
    v_cmp_ge_u32 vcc, s65, v252
    s_and_b32 s3, vcc_lo, -1
    s_cbranch_scc0 Lffb_160
Lpg_161:
    buffer_load_dword v244, v14, s[32:35], s78 offen sc1
    s_sleep 2
    s_add_u32 s99, s99, 1
    s_cmp_gt_u32 s99, 0x2dc6c0
    s_cbranch_scc0 Lto_162
    s_mov_b32 s3, 33
    s_branch L_abort
Lto_162:
    s_waitcnt vmcnt(0)
    v_cmp_ge_u32 vcc, s65, v244
    s_and_b32 vcc_lo, vcc_lo, 0xffffffff
    s_and_b32 vcc_hi, vcc_hi, 0x0
    s_or_b32 s3, vcc_lo, vcc_hi
    s_cbranch_scc1 Lpg_161
Lffb_160:
    s_waitcnt lgkmcnt(0)
    s_barrier
    ds_read_b128 v[160:163], v10 offset:0
    ds_read_b128 v[164:167], v10 offset:32
    ds_read_b128 v[168:171], v10 offset:64
    ds_read_b128 v[172:175], v10 offset:96
    s_and_b32 s3, s64, 3
    s_lshl_b32 s3, s3, 20
    s_lshl_b32 s61, s60, 22
    s_add_u32 s61, s61, s3
    s_add_u32 s67, s61, 0x8400000
    s_waitcnt lgkmcnt(0)
    v_mfma_f32_32x32x16_bf16 v[192:207], a[128:131], v[160:163], 0
    v_mfma_f32_32x32x16_bf16 v[192:207], a[132:135], v[164:167], v[192:207]
    v_mfma_f32_32x32x16_bf16 v[192:207], a[136:139], v[168:171], v[192:207]
    v_mfma_f32_32x32x16_bf16 v[192:207], a[140:143], v[172:175], v[192:207]
    v_mfma_f32_32x32x16_bf16 v[208:223], a[144:147], v[160:163], 0
    v_mfma_f32_32x32x16_bf16 v[208:223], a[148:151], v[164:167], v[208:223]
    v_mfma_f32_32x32x16_bf16 v[208:223], a[152:155], v[168:171], v[208:223]
    s_nop 8
    v_cvt_pk_bf16_f32 v224, v192, v193
    v_cvt_pk_bf16_f32 v225, v194, v195
    v_cvt_pk_bf16_f32 v226, v196, v197
    v_cvt_pk_bf16_f32 v227, v198, v199
    v_cvt_pk_bf16_f32 v228, v200, v201
    v_cvt_pk_bf16_f32 v229, v202, v203
    v_cvt_pk_bf16_f32 v230, v204, v205
    v_cvt_pk_bf16_f32 v231, v206, v207
    v_bfi_b32 v224, 1, s75, v224
    ds_write_b128 v11, v[224:227] offset:0
    v_bfi_b32 v228, 1, s75, v228
    ds_write_b128 v11, v[228:231] offset:16
    v_mfma_f32_32x32x16_bf16 v[208:223], a[156:159], v[172:175], v[208:223]
    v_mfma_f32_32x32x16_bf16 v[192:207], a[160:163], v[160:163], 0
    v_mfma_f32_32x32x16_bf16 v[192:207], a[164:167], v[164:167], v[192:207]
    v_mfma_f32_32x32x16_bf16 v[192:207], a[168:171], v[168:171], v[192:207]
    s_nop 8
    v_cvt_pk_bf16_f32 v232, v208, v209
    v_cvt_pk_bf16_f32 v233, v210, v211
    v_cvt_pk_bf16_f32 v234, v212, v213
    v_cvt_pk_bf16_f32 v235, v214, v215
    v_cvt_pk_bf16_f32 v236, v216, v217
    v_cvt_pk_bf16_f32 v237, v218, v219
    v_cvt_pk_bf16_f32 v238, v220, v221
    v_cvt_pk_bf16_f32 v239, v222, v223
    v_bfi_b32 v232, 1, s75, v232
    ds_write_b128 v11, v[232:235] offset:64
    v_bfi_b32 v236, 1, s75, v236
    ds_write_b128 v11, v[236:239] offset:80
    v_mfma_f32_32x32x16_bf16 v[192:207], a[172:175], v[172:175], v[192:207]
    v_mfma_f32_32x32x16_bf16 v[208:223], a[176:179], v[160:163], 0
    v_mfma_f32_32x32x16_bf16 v[208:223], a[180:183], v[164:167], v[208:223]
    v_mfma_f32_32x32x16_bf16 v[208:223], a[184:187], v[168:171], v[208:223]
    s_nop 8
    v_cvt_pk_bf16_f32 v224, v192, v193
    v_cvt_pk_bf16_f32 v225, v194, v195
    v_cvt_pk_bf16_f32 v226, v196, v197
    v_cvt_pk_bf16_f32 v227, v198, v199
    v_cvt_pk_bf16_f32 v228, v200, v201
    v_cvt_pk_bf16_f32 v229, v202, v203
    v_cvt_pk_bf16_f32 v230, v204, v205
    v_cvt_pk_bf16_f32 v231, v206, v207
    v_bfi_b32 v224, 1, s75, v224
    ds_write_b128 v11, v[224:227] offset:128
    v_bfi_b32 v228, 1, s75, v228
    ds_write_b128 v11, v[228:231] offset:144
    v_mfma_f32_32x32x16_bf16 v[208:223], a[188:191], v[172:175], v[208:223]
    s_nop 11
    v_cvt_pk_bf16_f32 v232, v208, v209
    v_cvt_pk_bf16_f32 v233, v210, v211
    v_cvt_pk_bf16_f32 v234, v212, v213
    v_cvt_pk_bf16_f32 v235, v214, v215
    v_cvt_pk_bf16_f32 v236, v216, v217
    v_cvt_pk_bf16_f32 v237, v218, v219
    v_cvt_pk_bf16_f32 v238, v220, v221
    v_cvt_pk_bf16_f32 v239, v222, v223
    v_bfi_b32 v232, 1, s75, v232
    ds_write_b128 v11, v[232:235] offset:192
    v_bfi_b32 v236, 1, s75, v236
    ds_write_b128 v11, v[236:239] offset:208
    ds_read_b128 v[192:195], v25 offset:0
    ds_read_b128 v[196:199], v25 offset:1088
    ds_read_b128 v[200:203], v25 offset:2176
    ds_read_b128 v[204:207], v25 offset:3264
    ds_read_b128 v[208:211], v25 offset:4352
    ds_read_b128 v[212:215], v25 offset:5440
    ds_read_b128 v[216:219], v25 offset:6528
    ds_read_b128 v[220:223], v25 offset:7616
    s_waitcnt lgkmcnt(7)
    buffer_store_dwordx4 v[192:195], v26, s[32:35], s67 offen
    s_waitcnt lgkmcnt(6)
    buffer_store_dwordx4 v[196:199], v27, s[32:35], s67 offen
    s_waitcnt lgkmcnt(5)
    buffer_store_dwordx4 v[200:203], v28, s[32:35], s67 offen
    s_waitcnt lgkmcnt(4)
    buffer_store_dwordx4 v[204:207], v29, s[32:35], s67 offen
    s_waitcnt lgkmcnt(3)
    s_add_u32 s3, s67, 16384
    buffer_store_dwordx4 v[208:211], v26, s[32:35], s3 offen
    s_waitcnt lgkmcnt(2)
    buffer_store_dwordx4 v[212:215], v27, s[32:35], s3 offen
    s_waitcnt lgkmcnt(1)
    buffer_store_dwordx4 v[216:219], v28, s[32:35], s3 offen
    s_waitcnt lgkmcnt(0)
    buffer_store_dwordx4 v[220:223], v29, s[32:35], s3 offen
    s_add_u32 s64, s64, 1
    s_cmp_lt_u32 s64, 64
    s_cbranch_scc1 Lffl_154
    s_branch L_exit
Lffs_153:
    s_mov_b32 s64, 0
    s_lshl_b32 s61, s60, 21
    s_lshl_b32 s62, s64, 15
    s_add_u32 s61, s61, s62
    s_add_u32 s76, s61, 0x800000
    s_add_u32 s77, s76, 4096
    buffer_load_dwordx4 v[128:131], v6, s[32:35], s76 offen offset:0 sc1
    buffer_load_dwordx4 v[132:135], v6, s[32:35], s76 offen offset:1024 sc1
    buffer_load_dwordx4 v[136:139], v6, s[32:35], s76 offen offset:2048 sc1
    buffer_load_dwordx4 v[140:143], v6, s[32:35], s76 offen offset:3072 sc1
    buffer_load_dwordx4 v[144:147], v6, s[32:35], s77 offen offset:0 sc1
    buffer_load_dwordx4 v[148:151], v6, s[32:35], s77 offen offset:1024 sc1
    buffer_load_dwordx4 v[152:155], v6, s[32:35], s77 offen offset:2048 sc1
    buffer_load_dwordx4 v[156:159], v6, s[32:35], s77 offen offset:3072 sc1
    s_waitcnt vmcnt(0)
Lffl_163:
    s_waitcnt vmcnt(8)
    s_branch Lffc_167
Lffc_166:
    s_waitcnt vmcnt(0)
Lffc_167:
    v_max3_u32 v240, v128, v132, v136
    v_max3_u32 v241, v140, v144, v148
    v_max3_u32 v240, v240, v152, v156
    v_max_u32 v240, v240, v241
    v_cmp_eq_u32 vcc, -1, v240
    s_cbranch_vccz Lffk_164
Lffp_165:
    s_lshl_b32 s61, s60, 21
    s_lshl_b32 s62, s64, 15
    s_add_u32 s61, s61, s62
    s_add_u32 s76, s61, 0x800000
    s_add_u32 s77, s76, 4096
    buffer_load_dwordx4 v[156:159], v6, s[32:35], s77 offen offset:3072 sc1
    s_sleep 2
    s_add_u32 s99, s99, 1
    s_cmp_gt_u32 s99, 0x2dc6c0
    s_cbranch_scc0 Lto_168
    s_mov_b32 s3, 32
    s_branch L_abort
Lto_168:
    s_waitcnt vmcnt(0)
    v_cmp_eq_u32 vcc, -1, v156
    s_cbranch_vccnz Lffp_165
    s_lshl_b32 s61, s60, 21
    s_lshl_b32 s62, s64, 15
    s_add_u32 s61, s61, s62
    s_add_u32 s76, s61, 0x800000
    s_add_u32 s77, s76, 4096
    buffer_load_dwordx4 v[128:131], v6, s[32:35], s76 offen offset:0 sc1
    buffer_load_dwordx4 v[132:135], v6, s[32:35], s76 offen offset:1024 sc1
    buffer_load_dwordx4 v[136:139], v6, s[32:35], s76 offen offset:2048 sc1
    buffer_load_dwordx4 v[140:143], v6, s[32:35], s76 offen offset:3072 sc1
    buffer_load_dwordx4 v[144:147], v6, s[32:35], s77 offen offset:0 sc1
    buffer_load_dwordx4 v[148:151], v6, s[32:35], s77 offen offset:1024 sc1
    buffer_load_dwordx4 v[152:155], v6, s[32:35], s77 offen offset:2048 sc1
    s_branch Lffc_166
Lffk_164:
    ds_write_b128 v7, v[128:131] offset:0
    ds_write_b128 v7, v[132:135] offset:1056
    ds_write_b128 v7, v[136:139] offset:2112
    ds_write_b128 v7, v[140:143] offset:3168
    ds_write_b128 v7, v[144:147] offset:4224
    ds_write_b128 v7, v[148:151] offset:5280
    ds_write_b128 v7, v[152:155] offset:6336
    ds_write_b128 v7, v[156:159] offset:7392
    s_add_u32 s72, s64, 1
    s_min_u32 s72, s72, 63
    s_lshr_b32 s75, s64, 2
    s_and_b32 s75, s75, 1
    s_sub_u32 s65, s64, 4
    s_lshl_b32 s61, s60, 7
    s_add_u32 s78, s61, 0x9022c00
    buffer_load_dword v252, v14, s[32:35], s78 offen sc1
    s_waitcnt lgkmcnt(0)
    s_barrier
    ds_read_b128 v[160:163], v8 offset:0
    ds_read_b128 v[164:167], v8 offset:16896
    ds_read_b128 v[168:171], v8 offset:64
    ds_read_b128 v[172:175], v8 offset:16960
    ds_read_b128 v[176:179], v8 offset:128
    ds_read_b128 v[180:183], v8 offset:17024
    s_waitcnt lgkmcnt(5)
    v_mfma_f32_16x16x32_bf16 v[64:67], a[0:3], v[160:163], 0
    v_mfma_f32_16x16x32_bf16 v[72:75], a[64:67], v[160:163], 0
    ds_read_b128 v[160:163], v8 offset:192
    s_waitcnt lgkmcnt(5)
    v_mfma_f32_16x16x32_bf16 v[68:71], a[0:3], v[164:167], 0
    v_mfma_f32_16x16x32_bf16 v[76:79], a[64:67], v[164:167], 0
    ds_read_b128 v[164:167], v8 offset:17088
    s_waitcnt lgkmcnt(5)
    v_mfma_f32_16x16x32_bf16 v[64:67], a[4:7], v[168:171], v[64:67]
    v_mfma_f32_16x16x32_bf16 v[72:75], a[68:71], v[168:171], v[72:75]
    ds_read_b128 v[168:171], v8 offset:256
    s_waitcnt lgkmcnt(5)
    v_mfma_f32_16x16x32_bf16 v[68:71], a[4:7], v[172:175], v[68:71]
    v_mfma_f32_16x16x32_bf16 v[76:79], a[68:71], v[172:175], v[76:79]
    ds_read_b128 v[172:175], v8 offset:17152
    s_waitcnt lgkmcnt(5)
    v_mfma_f32_16x16x32_bf16 v[64:67], a[8:11], v[176:179], v[64:67]
    v_mfma_f32_16x16x32_bf16 v[72:75], a[72:75], v[176:179], v[72:75]
    ds_read_b128 v[176:179], v8 offset:320
    s_waitcnt lgkmcnt(5)
    v_mfma_f32_16x16x32_bf16 v[68:71], a[8:11], v[180:183], v[68:71]
    v_mfma_f32_16x16x32_bf16 v[76:79], a[72:75], v[180:183], v[76:79]
    ds_read_b128 v[180:183], v8 offset:17216
    s_waitcnt lgkmcnt(5)
    v_mfma_f32_16x16x32_bf16 v[64:67], a[12:15], v[160:163], v[64:67]
    v_mfma_f32_16x16x32_bf16 v[72:75], a[76:79], v[160:163], v[72:75]
    ds_read_b128 v[160:163], v8 offset:384
    s_waitcnt lgkmcnt(5)
    v_mfma_f32_16x16x32_bf16 v[68:71], a[12:15], v[164:167], v[68:71]
    v_mfma_f32_16x16x32_bf16 v[76:79], a[76:79], v[164:167], v[76:79]
    ds_read_b128 v[164:167], v8 offset:17280
    s_waitcnt lgkmcnt(5)
    v_mfma_f32_16x16x32_bf16 v[64:67], a[16:19], v[168:171], v[64:67]
    v_mfma_f32_16x16x32_bf16 v[72:75], a[80:83], v[168:171], v[72:75]
    ds_read_b128 v[168:171], v8 offset:448
    s_waitcnt lgkmcnt(5)
    v_mfma_f32_16x16x32_bf16 v[68:71], a[16:19], v[172:175], v[68:71]
    v_mfma_f32_16x16x32_bf16 v[76:79], a[80:83], v[172:175], v[76:79]
    ds_read_b128 v[172:175], v8 offset:17344
    s_waitcnt lgkmcnt(5)
    v_mfma_f32_16x16x32_bf16 v[64:67], a[20:23], v[176:179], v[64:67]
    v_mfma_f32_16x16x32_bf16 v[72:75], a[84:87], v[176:179], v[72:75]
    ds_read_b128 v[176:179], v8 offset:512
    s_waitcnt lgkmcnt(5)
    v_mfma_f32_16x16x32_bf16 v[68:71], a[20:23], v[180:183], v[68:71]
    v_mfma_f32_16x16x32_bf16 v[76:79], a[84:87], v[180:183], v[76:79]
    ds_read_b128 v[180:183], v8 offset:17408
    s_waitcnt lgkmcnt(5)
    v_mfma_f32_16x16x32_bf16 v[64:67], a[24:27], v[160:163], v[64:67]
    v_mfma_f32_16x16x32_bf16 v[72:75], a[88:91], v[160:163], v[72:75]
    s_lshl_b32 s61, s60, 21
    s_lshl_b32 s62, s72, 15
    s_add_u32 s61, s61, s62
    s_add_u32 s76, s61, 0x800000
    s_add_u32 s77, s76, 4096
    ds_read_b128 v[160:163], v8 offset:576
    s_waitcnt lgkmcnt(5)
    v_mfma_f32_16x16x32_bf16 v[68:71], a[24:27], v[164:167], v[68:71]
    v_mfma_f32_16x16x32_bf16 v[76:79], a[88:91], v[164:167], v[76:79]
    buffer_load_dwordx4 v[128:131], v6, s[32:35], s76 offen offset:0 sc1
    ds_read_b128 v[164:167], v8 offset:17472
    s_waitcnt lgkmcnt(5)
    v_mfma_f32_16x16x32_bf16 v[64:67], a[28:31], v[168:171], v[64:67]
    v_mfma_f32_16x16x32_bf16 v[72:75], a[92:95], v[168:171], v[72:75]
    buffer_load_dwordx4 v[132:135], v6, s[32:35], s76 offen offset:1024 sc1
    ds_read_b128 v[168:171], v8 offset:640
    s_waitcnt lgkmcnt(5)
    v_mfma_f32_16x16x32_bf16 v[68:71], a[28:31], v[172:175], v[68:71]
    v_mfma_f32_16x16x32_bf16 v[76:79], a[92:95], v[172:175], v[76:79]
    buffer_load_dwordx4 v[136:139], v6, s[32:35], s76 offen offset:2048 sc1
    ds_read_b128 v[172:175], v8 offset:17536
    s_waitcnt lgkmcnt(5)
    v_mfma_f32_16x16x32_bf16 v[64:67], a[32:35], v[176:179], v[64:67]
    v_mfma_f32_16x16x32_bf16 v[72:75], a[96:99], v[176:179], v[72:75]
    buffer_load_dwordx4 v[140:143], v6, s[32:35], s76 offen offset:3072 sc1
    ds_read_b128 v[176:179], v8 offset:704
    s_waitcnt lgkmcnt(5)
    v_mfma_f32_16x16x32_bf16 v[68:71], a[32:35], v[180:183], v[68:71]
    v_mfma_f32_16x16x32_bf16 v[76:79], a[96:99], v[180:183], v[76:79]
    buffer_load_dwordx4 v[144:147], v6, s[32:35], s77 offen offset:0 sc1
    ds_read_b128 v[180:183], v8 offset:17600
    s_waitcnt lgkmcnt(5)
    v_mfma_f32_16x16x32_bf16 v[64:67], a[36:39], v[160:163], v[64:67]
    v_mfma_f32_16x16x32_bf16 v[72:75], a[100:103], v[160:163], v[72:75]
    buffer_load_dwordx4 v[148:151], v6, s[32:35], s77 offen offset:1024 sc1
    ds_read_b128 v[160:163], v8 offset:768
    s_waitcnt lgkmcnt(5)
    v_mfma_f32_16x16x32_bf16 v[68:71], a[36:39], v[164:167], v[68:71]
    v_mfma_f32_16x16x32_bf16 v[76:79], a[100:103], v[164:167], v[76:79]
    buffer_load_dwordx4 v[152:155], v6, s[32:35], s77 offen offset:2048 sc1
    ds_read_b128 v[164:167], v8 offset:17664
    s_waitcnt lgkmcnt(5)
    v_mfma_f32_16x16x32_bf16 v[64:67], a[40:43], v[168:171], v[64:67]
    v_mfma_f32_16x16x32_bf16 v[72:75], a[104:107], v[168:171], v[72:75]
    buffer_load_dwordx4 v[156:159], v6, s[32:35], s77 offen offset:3072 sc1
    ds_read_b128 v[168:171], v8 offset:832
    s_waitcnt lgkmcnt(5)
    v_mfma_f32_16x16x32_bf16 v[68:71], a[40:43], v[172:175], v[68:71]
    v_mfma_f32_16x16x32_bf16 v[76:79], a[104:107], v[172:175], v[76:79]
    ds_read_b128 v[172:175], v8 offset:17728
    s_waitcnt lgkmcnt(5)
    v_mfma_f32_16x16x32_bf16 v[64:67], a[44:47], v[176:179], v[64:67]
    v_mfma_f32_16x16x32_bf16 v[72:75], a[108:111], v[176:179], v[72:75]
    ds_read_b128 v[176:179], v8 offset:896
    s_waitcnt lgkmcnt(5)
    v_mfma_f32_16x16x32_bf16 v[68:71], a[44:47], v[180:183], v[68:71]
    v_mfma_f32_16x16x32_bf16 v[76:79], a[108:111], v[180:183], v[76:79]
    ds_read_b128 v[180:183], v8 offset:17792
    s_waitcnt lgkmcnt(5)
    v_mfma_f32_16x16x32_bf16 v[64:67], a[48:51], v[160:163], v[64:67]
    v_mfma_f32_16x16x32_bf16 v[72:75], a[112:115], v[160:163], v[72:75]
    ds_read_b128 v[160:163], v8 offset:960
    s_waitcnt lgkmcnt(5)
    v_mfma_f32_16x16x32_bf16 v[68:71], a[48:51], v[164:167], v[68:71]
    v_mfma_f32_16x16x32_bf16 v[76:79], a[112:115], v[164:167], v[76:79]
    ds_read_b128 v[164:167], v8 offset:17856
    s_waitcnt lgkmcnt(5)
    v_mfma_f32_16x16x32_bf16 v[64:67], a[52:55], v[168:171], v[64:67]
    v_mfma_f32_16x16x32_bf16 v[72:75], a[116:119], v[168:171], v[72:75]
    s_waitcnt lgkmcnt(4)
    v_mfma_f32_16x16x32_bf16 v[68:71], a[52:55], v[172:175], v[68:71]
    v_mfma_f32_16x16x32_bf16 v[76:79], a[116:119], v[172:175], v[76:79]
    s_waitcnt lgkmcnt(3)
    v_mfma_f32_16x16x32_bf16 v[64:67], a[56:59], v[176:179], v[64:67]
    v_mfma_f32_16x16x32_bf16 v[72:75], a[120:123], v[176:179], v[72:75]
    s_waitcnt lgkmcnt(2)
    v_mfma_f32_16x16x32_bf16 v[68:71], a[56:59], v[180:183], v[68:71]
    v_mfma_f32_16x16x32_bf16 v[76:79], a[120:123], v[180:183], v[76:79]
    s_waitcnt lgkmcnt(1)
    v_mfma_f32_16x16x32_bf16 v[64:67], a[60:63], v[160:163], v[64:67]
    v_mfma_f32_16x16x32_bf16 v[72:75], a[124:127], v[160:163], v[72:75]
    s_waitcnt lgkmcnt(0)
    v_mfma_f32_16x16x32_bf16 v[68:71], a[60:63], v[164:167], v[68:71]
    v_mfma_f32_16x16x32_bf16 v[76:79], a[124:127], v[164:167], v[76:79]
    s_nop 3
    v_mul_f32 v240, s68, v64
    v_mul_f32 v241, s68, v65
    v_mul_f32 v242, s68, v66
    v_mul_f32 v243, s68, v67
    v_mul_f32 v244, s68, v68
    v_mul_f32 v245, s68, v69
    v_mul_f32 v246, s68, v70
    v_mul_f32 v247, s68, v71
    v_exp_f32 v240, v240
    v_exp_f32 v241, v241
    v_exp_f32 v242, v242
    v_exp_f32 v243, v243
    v_exp_f32 v244, v244
    v_exp_f32 v245, v245
    v_exp_f32 v246, v246
    v_exp_f32 v247, v247
    v_add_f32 v240, 1.0, v240
    v_add_f32 v241, 1.0, v241
    v_add_f32 v242, 1.0, v242
    v_add_f32 v243, 1.0, v243
    v_add_f32 v244, 1.0, v244
    v_add_f32 v245, 1.0, v245
    v_add_f32 v246, 1.0, v246
    v_add_f32 v247, 1.0, v247
    v_rcp_f32 v240, v240
    v_rcp_f32 v241, v241
    v_rcp_f32 v242, v242
    v_rcp_f32 v243, v243
    v_rcp_f32 v244, v244
    v_rcp_f32 v245, v245
    v_rcp_f32 v246, v246
    v_rcp_f32 v247, v247
    v_mul_f32 v64, v64, v72
    v_mul_f32 v65, v65, v73
    v_mul_f32 v66, v66, v74
    v_mul_f32 v67, v67, v75
    v_mul_f32 v68, v68, v76
    v_mul_f32 v69, v69, v77
    v_mul_f32 v70, v70, v78
    v_mul_f32 v71, v71, v79
    v_mul_f32 v64, v64, v240
    v_mul_f32 v65, v65, v241
    v_mul_f32 v66, v66, v242
    v_mul_f32 v67, v67, v243
    v_mul_f32 v68, v68, v244
    v_mul_f32 v69, v69, v245
    v_mul_f32 v70, v70, v246
    v_mul_f32 v71, v71, v247
    v_cvt_pk_bf16_f32 v240, v64, v65
    v_cvt_pk_bf16_f32 v241, v66, v67
    ds_write_b64 v9, v[240:241] offset:0
    v_cvt_pk_bf16_f32 v242, v68, v69
    v_cvt_pk_bf16_f32 v243, v70, v71
    ds_write_b64 v9, v[242:243] offset:2304
    s_cmp_lt_u32 s64, 4
    s_cbranch_scc1 Lffb_169
    s_waitcnt vmcnt(8)
    v_cmp_ge_u32 vcc, s65, v252
    s_and_b32 s3, vcc_lo, -1
    s_cbranch_scc0 Lffb_169
Lpg_170:
    buffer_load_dword v244, v14, s[32:35], s78 offen sc1
    s_sleep 2
    s_add_u32 s99, s99, 1
    s_cmp_gt_u32 s99, 0x2dc6c0
    s_cbranch_scc0 Lto_171
    s_mov_b32 s3, 33
    s_branch L_abort
Lto_171:
    s_waitcnt vmcnt(0)
    v_cmp_ge_u32 vcc, s65, v244
    s_and_b32 vcc_lo, vcc_lo, 0xffffffff
    s_and_b32 vcc_hi, vcc_hi, 0x0
    s_or_b32 s3, vcc_lo, vcc_hi
    s_cbranch_scc1 Lpg_170
Lffb_169:
    s_waitcnt lgkmcnt(0)
    s_barrier
    ds_read_b128 v[160:163], v10 offset:0
    ds_read_b128 v[164:167], v10 offset:32
    ds_read_b128 v[168:171], v10 offset:64
    ds_read_b128 v[172:175], v10 offset:96
    s_and_b32 s3, s64, 3
    s_lshl_b32 s3, s3, 20
    s_lshl_b32 s61, s60, 22
    s_add_u32 s61, s61, s3
    s_add_u32 s67, s61, 0x8400000
    s_waitcnt lgkmcnt(0)
    v_mfma_f32_32x32x16_bf16 v[192:207], a[128:131], v[160:163], 0
    v_mfma_f32_32x32x16_bf16 v[192:207], a[132:135], v[164:167], v[192:207]
    v_mfma_f32_32x32x16_bf16 v[192:207], a[136:139], v[168:171], v[192:207]
    v_mfma_f32_32x32x16_bf16 v[192:207], a[140:143], v[172:175], v[192:207]
    v_mfma_f32_32x32x16_bf16 v[208:223], a[144:147], v[160:163], 0
    v_mfma_f32_32x32x16_bf16 v[208:223], a[148:151], v[164:167], v[208:223]
    v_mfma_f32_32x32x16_bf16 v[208:223], a[152:155], v[168:171], v[208:223]
    s_nop 8
    v_cvt_pk_bf16_f32 v224, v192, v193
    v_cvt_pk_bf16_f32 v225, v194, v195
    v_cvt_pk_bf16_f32 v226, v196, v197
    v_cvt_pk_bf16_f32 v227, v198, v199
    v_cvt_pk_bf16_f32 v228, v200, v201
    v_cvt_pk_bf16_f32 v229, v202, v203
    v_cvt_pk_bf16_f32 v230, v204, v205
    v_cvt_pk_bf16_f32 v231, v206, v207
    v_bfi_b32 v224, 1, s75, v224
    ds_write_b128 v11, v[224:227] offset:0
    v_bfi_b32 v228, 1, s75, v228
    ds_write_b128 v11, v[228:231] offset:16
    v_mfma_f32_32x32x16_bf16 v[208:223], a[156:159], v[172:175], v[208:223]
    v_mfma_f32_32x32x16_bf16 v[192:207], a[160:163], v[160:163], 0
    v_mfma_f32_32x32x16_bf16 v[192:207], a[164:167], v[164:167], v[192:207]
    v_mfma_f32_32x32x16_bf16 v[192:207], a[168:171], v[168:171], v[192:207]
    s_nop 8
    v_cvt_pk_bf16_f32 v232, v208, v209
    v_cvt_pk_bf16_f32 v233, v210, v211
    v_cvt_pk_bf16_f32 v234, v212, v213
    v_cvt_pk_bf16_f32 v235, v214, v215
    v_cvt_pk_bf16_f32 v236, v216, v217
    v_cvt_pk_bf16_f32 v237, v218, v219
    v_cvt_pk_bf16_f32 v238, v220, v221
    v_cvt_pk_bf16_f32 v239, v222, v223
    v_bfi_b32 v232, 1, s75, v232
    ds_write_b128 v11, v[232:235] offset:64
    v_bfi_b32 v236, 1, s75, v236
    ds_write_b128 v11, v[236:239] offset:80
    v_mfma_f32_32x32x16_bf16 v[192:207], a[172:175], v[172:175], v[192:207]
    v_mfma_f32_32x32x16_bf16 v[208:223], a[176:179], v[160:163], 0
    v_mfma_f32_32x32x16_bf16 v[208:223], a[180:183], v[164:167], v[208:223]
    v_mfma_f32_32x32x16_bf16 v[208:223], a[184:187], v[168:171], v[208:223]
    s_nop 8
    v_cvt_pk_bf16_f32 v224, v192, v193
    v_cvt_pk_bf16_f32 v225, v194, v195
    v_cvt_pk_bf16_f32 v226, v196, v197
    v_cvt_pk_bf16_f32 v227, v198, v199
    v_cvt_pk_bf16_f32 v228, v200, v201
    v_cvt_pk_bf16_f32 v229, v202, v203
    v_cvt_pk_bf16_f32 v230, v204, v205
    v_cvt_pk_bf16_f32 v231, v206, v207
    v_bfi_b32 v224, 1, s75, v224
    ds_write_b128 v11, v[224:227] offset:128
    v_bfi_b32 v228, 1, s75, v228
    ds_write_b128 v11, v[228:231] offset:144
    v_mfma_f32_32x32x16_bf16 v[208:223], a[188:191], v[172:175], v[208:223]
    s_nop 11
    v_cvt_pk_bf16_f32 v232, v208, v209
    v_cvt_pk_bf16_f32 v233, v210, v211
    v_cvt_pk_bf16_f32 v234, v212, v213
    v_cvt_pk_bf16_f32 v235, v214, v215
    v_cvt_pk_bf16_f32 v236, v216, v217
    v_cvt_pk_bf16_f32 v237, v218, v219
    v_cvt_pk_bf16_f32 v238, v220, v221
    v_cvt_pk_bf16_f32 v239, v222, v223
    v_bfi_b32 v232, 1, s75, v232
    ds_write_b128 v11, v[232:235] offset:192
    v_bfi_b32 v236, 1, s75, v236
    ds_write_b128 v11, v[236:239] offset:208
    ds_read_b128 v[192:195], v25 offset:0
    ds_read_b128 v[196:199], v25 offset:1088
    ds_read_b128 v[200:203], v25 offset:2176
    ds_read_b128 v[204:207], v25 offset:3264
    ds_read_b128 v[208:211], v25 offset:4352
    ds_read_b128 v[212:215], v25 offset:5440
    ds_read_b128 v[216:219], v25 offset:6528
    ds_read_b128 v[220:223], v25 offset:7616
    s_waitcnt lgkmcnt(7)
    buffer_store_dwordx4 v[192:195], v26, s[32:35], s67 offen sc1
    s_waitcnt lgkmcnt(6)
    buffer_store_dwordx4 v[196:199], v27, s[32:35], s67 offen sc1
    s_waitcnt lgkmcnt(5)
    buffer_store_dwordx4 v[200:203], v28, s[32:35], s67 offen sc1
    s_waitcnt lgkmcnt(4)
    buffer_store_dwordx4 v[204:207], v29, s[32:35], s67 offen sc1
    s_waitcnt lgkmcnt(3)
    s_add_u32 s3, s67, 16384
    buffer_store_dwordx4 v[208:211], v26, s[32:35], s3 offen sc1
    s_waitcnt lgkmcnt(2)
    buffer_store_dwordx4 v[212:215], v27, s[32:35], s3 offen sc1
    s_waitcnt lgkmcnt(1)
    buffer_store_dwordx4 v[216:219], v28, s[32:35], s3 offen sc1
    s_waitcnt lgkmcnt(0)
    buffer_store_dwordx4 v[220:223], v29, s[32:35], s3 offen sc1
    s_add_u32 s64, s64, 1
    s_cmp_lt_u32 s64, 64
    s_cbranch_scc1 Lffl_163
    s_branch L_exit
L_ff_red:
    s_mov_b32 s40, s26
    s_and_b32 s41, s27, 0xffff
    s_mov_b32 s42, 0x200000
    s_mov_b32 s43, 0x20000
    s_sub_u32 s65, s58, 22
    s_lshl_b32 s65, s65, 2
    s_add_u32 s65, s65, s56
    s_lshl_b32 s61, s65, 10
    v_lshlrev_b32 v4, 15, v3
    v_lshlrev_b32 v5, 4, v2
    v_add_u32 v4, v4, v5
    v_add_u32 v4, s61, v4
    v_mov_b32 v6, 0x40000000
    v_cndmask_b32 v5, v6, v4, s[92:93]
    v_lshlrev_b32 v6, 4, v2
    v_add_u32 v6, s61, v6
    s_lshl_b32 s61, s65, 2
    v_mov_b32 v22, s61
    v_and_b32 v20, 15, v1
    v_mov_b32 v16, 0
    v_cmp_eq_u32 vcc, 0, v20
    v_mov_b32 v21, 0x3f80
    s_nop 0
    v_cndmask_b32 v16, v16, v21, vcc
    v_cmp_eq_u32 vcc, 1, v20
    v_mov_b32 v21, 0x3f800000
    s_nop 0
    v_cndmask_b32 v16, v16, v21, vcc
    v_mov_b32 v17, 0
    v_cmp_eq_u32 vcc, 2, v20
    v_mov_b32 v21, 0x3f80
    s_nop 0
    v_cndmask_b32 v17, v17, v21, vcc
    v_cmp_eq_u32 vcc, 3, v20
    v_mov_b32 v21, 0x3f800000
    s_nop 0
    v_cndmask_b32 v17, v17, v21, vcc
    v_mov_b32 v18, 0
    v_cmp_eq_u32 vcc, 4, v20
    v_mov_b32 v21, 0x3f80
    s_nop 0
    v_cndmask_b32 v18, v18, v21, vcc
    v_cmp_eq_u32 vcc, 5, v20
    v_mov_b32 v21, 0x3f800000
    s_nop 0
    v_cndmask_b32 v18, v18, v21, vcc
    v_mov_b32 v19, 0
    v_cmp_eq_u32 vcc, 6, v20
    v_mov_b32 v21, 0x3f80
    s_nop 0
    v_cndmask_b32 v19, v19, v21, vcc
    v_cmp_eq_u32 vcc, 7, v20
    v_mov_b32 v21, 0x3f800000
    s_nop 0
    v_cndmask_b32 v19, v19, v21, vcc
    v_lshlrev_b32 v120, 2, v1
    s_cmp_lg_u32 s56, 0
    s_cbranch_scc1 Lcw_173
Lcw_172:
    buffer_load_dword v121, v120, s[36:39], 0 offen sc1
    s_add_u32 s99, s99, 1
    s_cmp_gt_u32 s99, 0x2dc6c0
    s_cbranch_scc0 Lto_174
    s_mov_b32 s3, 2
    s_branch L_abort
Lto_174:
    s_waitcnt vmcnt(0)
    v_readlane_b32 s3, v121, 8
    s_cmp_ge_u32 s3, 256
    s_cbranch_scc1 Lcw_175
    s_sleep 8
    s_branch Lcw_172
Lcw_175:
    v_readlane_b32 s3, v121, s57
    v_mov_b32 v120, 163836
    s_nop 0
    v_mov_b32 v121, s3
    ds_write_b32 v120, v121
    s_waitcnt lgkmcnt(0)
Lcw_173:
    s_barrier
    v_mov_b32 v120, 163836
    ds_read_b32 v121, v120
    s_waitcnt lgkmcnt(0)
    v_readfirstlane_b32 s3, v121
    s_cmp_lt_u32 s3, 32
    s_cselect_b32 s59, 1, 0
    s_barrier
    s_lshl_b32 s61, s60, 2
    s_add_u32 s61, s61, 56
    s_cmp_lg_u32 s56, 0
    s_cbranch_scc1 Ldw_177
    v_mov_b32 v30, s61
    s_mov_b64 exec, 1
Ldw_176:
    buffer_load_dword v31, v30, s[36:39], 0 offen sc1
    s_add_u32 s99, s99, 1
    s_cmp_gt_u32 s99, 0x2dc6c0
    s_cbranch_scc0 Lto_178
    s_mov_b32 s3, 35
    s_branch L_abort
Lto_178:
    s_waitcnt vmcnt(0)
    v_cmp_gt_u32 vcc, 32, v31
    s_cbranch_vccz Ldw_179
    s_sleep 8
    s_branch Ldw_176
Ldw_179:
    s_mov_b64 exec, -1
Ldw_177:
    s_barrier
    s_lshl_b32 s61, s60, 2
    s_add_u32 s61, s61, 64
    s_cmp_lg_u32 s56, 0
    s_cbranch_scc1 Ldw_181
    v_mov_b32 v30, s61
    s_mov_b64 exec, 1
Ldw_180:
    buffer_load_dword v31, v30, s[36:39], 0 offen sc1
    s_add_u32 s99, s99, 1
    s_cmp_gt_u32 s99, 0x2dc6c0
    s_cbranch_scc0 Lto_182
    s_mov_b32 s3, 35
    s_branch L_abort
Lto_182:
    s_waitcnt vmcnt(0)
    v_cmp_gt_u32 vcc, 32, v31
    s_cbranch_vccz Ldw_183
    s_sleep 8
    s_branch Ldw_180
Ldw_183:
    s_mov_b64 exec, -1
Ldw_181:
    s_barrier
    s_cmp_lg_u32 s56, 0
    s_cbranch_scc1 Ldw_185
    v_mov_b32 v30, 72
    s_mov_b64 exec, 1
Ldw_184:
    buffer_load_dword v31, v30, s[36:39], 0 offen sc1
    s_add_u32 s99, s99, 1
    s_cmp_gt_u32 s99, 0x2dc6c0
    s_cbranch_scc0 Lto_186
    s_mov_b32 s3, 35
    s_branch L_abort
Lto_186:
    s_waitcnt vmcnt(0)
    v_cmp_gt_u32 vcc, 32, v31
    s_cbranch_vccz Ldw_187
    s_sleep 8
    s_branch Ldw_184
Ldw_187:
    s_mov_b64 exec, -1
Ldw_185:
    s_barrier
    s_cmp_eq_u32 s59, 1
    s_cbranch_scc1 Lffs_188
    s_mov_b32 s64, 0
Lfrl_189:
    s_lshr_b32 s75, s64, 2
    s_and_b32 s75, s75, 1
    s_and_b32 s3, s64, 3
    s_lshl_b32 s3, s3, 20
    s_lshl_b32 s61, s60, 22
    s_add_u32 s61, s61, s3
    s_add_u32 s76, s61, 0x8400000
    s_lshl_b32 s62, s60, 21
    s_lshl_b32 s63, s64, 15
    s_add_u32 s62, s62, s63
    s_add_u32 s77, s62, 0x400000
    buffer_load_dwordx4 v[48:51], v6, s[32:35], s77 offen offset:0 sc1
    buffer_load_dwordx4 v[52:55], v6, s[32:35], s77 offen offset:256 sc1
    buffer_load_dwordx4 v[56:59], v6, s[32:35], s77 offen offset:512 sc1
    buffer_load_dwordx4 v[60:63], v6, s[32:35], s77 offen offset:768 sc1
Lfrp_190:
    buffer_load_dwordx4 v[128:131], v4, s[32:35], s76 offen offset:768 sc1
    s_sleep 1
    s_add_u32 s99, s99, 1
    s_cmp_gt_u32 s99, 0x2dc6c0
    s_cbranch_scc0 Lto_193
    s_mov_b32 s3, 34
    s_branch L_abort
Lto_193:
    s_waitcnt vmcnt(0)
    v_xor_b32 v64, s75, v128
    v_and_b32 v64, 1, v64
    v_cmp_ne_u32 vcc, 0, v64
    s_cbranch_vccnz Lfrp_190
    s_branch Lfra_192
Lfra_191:
    buffer_load_dwordx4 v[48:51], v6, s[32:35], s77 offen offset:0 sc1
    buffer_load_dwordx4 v[52:55], v6, s[32:35], s77 offen offset:256 sc1
    buffer_load_dwordx4 v[56:59], v6, s[32:35], s77 offen offset:512 sc1
    buffer_load_dwordx4 v[60:63], v6, s[32:35], s77 offen offset:768 sc1
Lfra_192:
    s_mov_b32 s61, s76
    buffer_load_dwordx4 v[128:131], v4, s[32:35], s61 offen offset:0 sc1
    buffer_load_dwordx4 v[132:135], v4, s[32:35], s61 offen offset:256 sc1
    buffer_load_dwordx4 v[136:139], v4, s[32:35], s61 offen offset:512 sc1
    buffer_load_dwordx4 v[140:143], v4, s[32:35], s61 offen offset:768 sc1
    s_add_u32 s61, s61, 0x20000
    buffer_load_dwordx4 v[144:147], v4, s[32:35], s61 offen offset:0 sc1
    buffer_load_dwordx4 v[148:151], v4, s[32:35], s61 offen offset:256 sc1
    buffer_load_dwordx4 v[152:155], v4, s[32:35], s61 offen offset:512 sc1
    buffer_load_dwordx4 v[156:159], v4, s[32:35], s61 offen offset:768 sc1
    s_add_u32 s61, s61, 0x20000
    buffer_load_dwordx4 v[160:163], v4, s[32:35], s61 offen offset:0 sc1
    buffer_load_dwordx4 v[164:167], v4, s[32:35], s61 offen offset:256 sc1
    buffer_load_dwordx4 v[168:171], v4, s[32:35], s61 offen offset:512 sc1
    buffer_load_dwordx4 v[172:175], v4, s[32:35], s61 offen offset:768 sc1
    s_add_u32 s61, s61, 0x20000
    buffer_load_dwordx4 v[176:179], v4, s[32:35], s61 offen offset:0 sc1
    buffer_load_dwordx4 v[180:183], v4, s[32:35], s61 offen offset:256 sc1
    buffer_load_dwordx4 v[184:187], v4, s[32:35], s61 offen offset:512 sc1
    buffer_load_dwordx4 v[188:191], v4, s[32:35], s61 offen offset:768 sc1
    s_add_u32 s61, s61, 0x20000
    buffer_load_dwordx4 v[192:195], v4, s[32:35], s61 offen offset:0 sc1
    buffer_load_dwordx4 v[196:199], v4, s[32:35], s61 offen offset:256 sc1
    buffer_load_dwordx4 v[200:203], v4, s[32:35], s61 offen offset:512 sc1
    buffer_load_dwordx4 v[204:207], v4, s[32:35], s61 offen offset:768 sc1
    s_add_u32 s61, s61, 0x20000
    buffer_load_dwordx4 v[208:211], v5, s[32:35], s61 offen offset:0 sc1
    buffer_load_dwordx4 v[212:215], v5, s[32:35], s61 offen offset:256 sc1
    buffer_load_dwordx4 v[216:219], v5, s[32:35], s61 offen offset:512 sc1
    buffer_load_dwordx4 v[220:223], v5, s[32:35], s61 offen offset:768 sc1
    s_add_u32 s99, s99, 1
    s_cmp_gt_u32 s99, 0x2dc6c0
    s_cbranch_scc0 Lto_194
    s_mov_b32 s3, 36
    s_branch L_abort
Lto_194:
    v_mov_b32 v64, 0
    v_mov_b32 v65, 0
    s_waitcnt vmcnt(23)
    v_mfma_f32_16x16x32_bf16 v[32:35], v[16:19], v[128:131], 0
    v_xor_b32 v66, s75, v128
    v_or_b32 v64, v64, v66
    s_waitcnt vmcnt(22)
    v_mfma_f32_16x16x32_bf16 v[36:39], v[16:19], v[132:135], 0
    v_xor_b32 v66, s75, v132
    v_or_b32 v64, v64, v66
    s_waitcnt vmcnt(21)
    v_mfma_f32_16x16x32_bf16 v[40:43], v[16:19], v[136:139], 0
    v_xor_b32 v66, s75, v136
    v_or_b32 v64, v64, v66
    s_waitcnt vmcnt(20)
    v_mfma_f32_16x16x32_bf16 v[44:47], v[16:19], v[140:143], 0
    v_xor_b32 v66, s75, v140
    v_or_b32 v64, v64, v66
    s_waitcnt vmcnt(19)
    v_mfma_f32_16x16x32_bf16 v[32:35], v[16:19], v[144:147], v[32:35]
    v_xor_b32 v66, s75, v144
    v_or_b32 v64, v64, v66
    s_waitcnt vmcnt(18)
    v_mfma_f32_16x16x32_bf16 v[36:39], v[16:19], v[148:151], v[36:39]
    v_xor_b32 v66, s75, v148
    v_or_b32 v64, v64, v66
    s_waitcnt vmcnt(17)
    v_mfma_f32_16x16x32_bf16 v[40:43], v[16:19], v[152:155], v[40:43]
    v_xor_b32 v66, s75, v152
    v_or_b32 v64, v64, v66
    s_waitcnt vmcnt(16)
    v_mfma_f32_16x16x32_bf16 v[44:47], v[16:19], v[156:159], v[44:47]
    v_xor_b32 v66, s75, v156
    v_or_b32 v64, v64, v66
    s_waitcnt vmcnt(15)
    v_mfma_f32_16x16x32_bf16 v[32:35], v[16:19], v[160:163], v[32:35]
    v_xor_b32 v66, s75, v160
    v_or_b32 v64, v64, v66
    s_waitcnt vmcnt(14)
    v_mfma_f32_16x16x32_bf16 v[36:39], v[16:19], v[164:167], v[36:39]
    v_xor_b32 v66, s75, v164
    v_or_b32 v64, v64, v66
    s_waitcnt vmcnt(13)
    v_mfma_f32_16x16x32_bf16 v[40:43], v[16:19], v[168:171], v[40:43]
    v_xor_b32 v66, s75, v168
    v_or_b32 v64, v64, v66
    s_waitcnt vmcnt(12)
    v_mfma_f32_16x16x32_bf16 v[44:47], v[16:19], v[172:175], v[44:47]
    v_xor_b32 v66, s75, v172
    v_or_b32 v64, v64, v66
    s_waitcnt vmcnt(11)
    v_mfma_f32_16x16x32_bf16 v[32:35], v[16:19], v[176:179], v[32:35]
    v_xor_b32 v66, s75, v176
    v_or_b32 v64, v64, v66
    s_waitcnt vmcnt(10)
    v_mfma_f32_16x16x32_bf16 v[36:39], v[16:19], v[180:183], v[36:39]
    v_xor_b32 v66, s75, v180
    v_or_b32 v64, v64, v66
    s_waitcnt vmcnt(9)
    v_mfma_f32_16x16x32_bf16 v[40:43], v[16:19], v[184:187], v[40:43]
    v_xor_b32 v66, s75, v184
    v_or_b32 v64, v64, v66
    s_waitcnt vmcnt(8)
    v_mfma_f32_16x16x32_bf16 v[44:47], v[16:19], v[188:191], v[44:47]
    v_xor_b32 v66, s75, v188
    v_or_b32 v64, v64, v66
    s_waitcnt vmcnt(7)
    v_mfma_f32_16x16x32_bf16 v[32:35], v[16:19], v[192:195], v[32:35]
    v_xor_b32 v66, s75, v192
    v_or_b32 v64, v64, v66
    s_waitcnt vmcnt(6)
    v_mfma_f32_16x16x32_bf16 v[36:39], v[16:19], v[196:199], v[36:39]
    v_xor_b32 v66, s75, v196
    v_or_b32 v64, v64, v66
    s_waitcnt vmcnt(5)
    v_mfma_f32_16x16x32_bf16 v[40:43], v[16:19], v[200:203], v[40:43]
    v_xor_b32 v66, s75, v200
    v_or_b32 v64, v64, v66
    s_waitcnt vmcnt(4)
    v_mfma_f32_16x16x32_bf16 v[44:47], v[16:19], v[204:207], v[44:47]
    v_xor_b32 v66, s75, v204
    v_or_b32 v64, v64, v66
    s_waitcnt vmcnt(3)
    v_mfma_f32_16x16x32_bf16 v[32:35], v[16:19], v[208:211], v[32:35]
    v_xor_b32 v66, s75, v208
    v_or_b32 v65, v65, v66
    s_waitcnt vmcnt(2)
    v_mfma_f32_16x16x32_bf16 v[36:39], v[16:19], v[212:215], v[36:39]
    v_xor_b32 v66, s75, v212
    v_or_b32 v65, v65, v66
    s_waitcnt vmcnt(1)
    v_mfma_f32_16x16x32_bf16 v[40:43], v[16:19], v[216:219], v[40:43]
    v_xor_b32 v66, s75, v216
    v_or_b32 v65, v65, v66
    s_waitcnt vmcnt(0)
    v_mfma_f32_16x16x32_bf16 v[44:47], v[16:19], v[220:223], v[44:47]
    v_xor_b32 v66, s75, v220
    v_or_b32 v65, v65, v66
    v_mov_b32 v66, 0
    v_cndmask_b32 v65, v66, v65, s[92:93]
    v_or_b32 v64, v64, v65
    v_and_b32 v64, 1, v64
    s_waitcnt vmcnt(0)
    v_max3_u32 v65, v48, v52, v56
    v_max_u32 v65, v65, v60
    v_cmp_ne_u32 vcc, 0, v64
    v_cmp_eq_u32 s[62:63], -1, v65
    s_or_b64 vcc, vcc, s[62:63]
    s_cbranch_vccnz Lfra_191
    s_add_u32 s62, s64, 1
    v_mov_b32 v64, s62
    s_lshl_b32 s61, s60, 7
    s_add_u32 s61, s61, 0x9022c00
    s_mov_b64 exec, 1
    buffer_store_dword v64, v22, s[32:35], s61 offen
    s_mov_b64 exec, -1
    s_lshl_b32 s63, s64, 15
    v_permlane16_swap_b32 v48, v50
    v_permlane16_swap_b32 v49, v51
    v_permlane16_swap_b32 v52, v54
    v_permlane16_swap_b32 v53, v55
    v_permlane16_swap_b32 v56, v58
    v_permlane16_swap_b32 v57, v59
    v_permlane16_swap_b32 v60, v62
    v_permlane16_swap_b32 v61, v63
    v_lshlrev_b32 v64, 16, v48
    v_and_b32 v65, 0xffff0000, v48
    v_lshlrev_b32 v66, 16, v49
    v_and_b32 v67, 0xffff0000, v49
    v_lshlrev_b32 v68, 16, v52
    v_and_b32 v69, 0xffff0000, v52
    v_lshlrev_b32 v70, 16, v53
    v_and_b32 v71, 0xffff0000, v53
    v_lshlrev_b32 v72, 16, v56
    v_and_b32 v73, 0xffff0000, v56
    v_lshlrev_b32 v74, 16, v57
    v_and_b32 v75, 0xffff0000, v57
    v_lshlrev_b32 v76, 16, v60
    v_and_b32 v77, 0xffff0000, v60
    v_lshlrev_b32 v78, 16, v61
    v_and_b32 v79, 0xffff0000, v61
    v_add_f32 v32, v32, v64
    v_add_f32 v33, v33, v65
    v_add_f32 v34, v34, v66
    v_add_f32 v35, v35, v67
    v_add_f32 v36, v36, v68
    v_add_f32 v37, v37, v69
    v_add_f32 v38, v38, v70
    v_add_f32 v39, v39, v71
    v_add_f32 v40, v40, v72
    v_add_f32 v41, v41, v73
    v_add_f32 v42, v42, v74
    v_add_f32 v43, v43, v75
    v_add_f32 v44, v44, v76
    v_add_f32 v45, v45, v77
    v_add_f32 v46, v46, v78
    v_add_f32 v47, v47, v79
    v_cvt_pk_bf16_f32 v48, v32, v33
    v_cvt_pk_bf16_f32 v49, v34, v35
    v_cvt_pk_bf16_f32 v52, v36, v37
    v_cvt_pk_bf16_f32 v53, v38, v39
    v_cvt_pk_bf16_f32 v56, v40, v41
    v_cvt_pk_bf16_f32 v57, v42, v43
    v_cvt_pk_bf16_f32 v60, v44, v45
    v_cvt_pk_bf16_f32 v61, v46, v47
    s_cmp_eq_u32 s60, 1
    s_cbranch_scc1 Lfro_195
    v_lshlrev_b32 v32, 16, v48
    v_and_b32 v33, 0xffff0000, v48
    v_lshlrev_b32 v34, 16, v49
    v_and_b32 v35, 0xffff0000, v49
    v_lshlrev_b32 v36, 16, v52
    v_and_b32 v37, 0xffff0000, v52
    v_lshlrev_b32 v38, 16, v53
    v_and_b32 v39, 0xffff0000, v53
    v_lshlrev_b32 v40, 16, v56
    v_and_b32 v41, 0xffff0000, v56
    v_lshlrev_b32 v42, 16, v57
    v_and_b32 v43, 0xffff0000, v57
    v_lshlrev_b32 v44, 16, v60
    v_and_b32 v45, 0xffff0000, v60
    v_lshlrev_b32 v46, 16, v61
    v_and_b32 v47, 0xffff0000, v61
    s_add_u32 s62, s63, 0xc00000
    s_add_u32 s63, s63, 0x200000
    v_add_f32 v64, v32, v33
    v_add_f32 v64, v64, v34
    v_add_f32 v64, v64, v35
    v_add_f32 v64, v64, v36
    v_add_f32 v64, v64, v37
    v_add_f32 v64, v64, v38
    v_add_f32 v64, v64, v39
    v_add_f32 v64, v64, v40
    v_add_f32 v64, v64, v41
    v_add_f32 v64, v64, v42
    v_add_f32 v64, v64, v43
    v_add_f32 v64, v64, v44
    v_add_f32 v64, v64, v45
    v_add_f32 v64, v64, v46
    v_add_f32 v64, v64, v47
    v_mov_b32 v66, 0
    v_cndmask_b32 v64, v66, v64, s[92:93]
    s_nop 1
    v_add_f32 v64, v64, v64 row_ror:8 row_mask:0xf bank_mask:0xf
    s_nop 1
    v_add_f32 v64, v64, v64 row_ror:4 row_mask:0xf bank_mask:0xf
    s_nop 1
    v_add_f32 v64, v64, v64 row_ror:2 row_mask:0xf bank_mask:0xf
    s_nop 1
    v_add_f32 v64, v64, v64 row_ror:1 row_mask:0xf bank_mask:0xf
    v_mov_b32 v65, v64
    s_nop 1
    v_permlane16_swap_b32 v64, v65
    v_add_f32 v64, v64, v65
    v_mov_b32 v65, v64
    s_nop 1
    v_permlane32_swap_b32 v64, v65
    v_add_f32 v64, v64, v65
    v_mul_f32 v64, 0x3b000000, v64
    v_sub_f32 v32, v32, v64
    v_sub_f32 v33, v33, v64
    v_sub_f32 v34, v34, v64
    v_sub_f32 v35, v35, v64
    v_sub_f32 v36, v36, v64
    v_sub_f32 v37, v37, v64
    v_sub_f32 v38, v38, v64
    v_sub_f32 v39, v39, v64
    v_sub_f32 v40, v40, v64
    v_sub_f32 v41, v41, v64
    v_sub_f32 v42, v42, v64
    v_sub_f32 v43, v43, v64
    v_sub_f32 v44, v44, v64
    v_sub_f32 v45, v45, v64
    v_sub_f32 v46, v46, v64
    v_sub_f32 v47, v47, v64
    v_mul_f32 v64, v32, v32
    v_fmac_f32 v64, v33, v33
    v_fmac_f32 v64, v34, v34
    v_fmac_f32 v64, v35, v35
    v_fmac_f32 v64, v36, v36
    v_fmac_f32 v64, v37, v37
    v_fmac_f32 v64, v38, v38
    v_fmac_f32 v64, v39, v39
    v_fmac_f32 v64, v40, v40
    v_fmac_f32 v64, v41, v41
    v_fmac_f32 v64, v42, v42
    v_fmac_f32 v64, v43, v43
    v_fmac_f32 v64, v44, v44
    v_fmac_f32 v64, v45, v45
    v_fmac_f32 v64, v46, v46
    v_fmac_f32 v64, v47, v47
    v_cndmask_b32 v64, v66, v64, s[92:93]
    s_nop 1
    v_add_f32 v64, v64, v64 row_ror:8 row_mask:0xf bank_mask:0xf
    s_nop 1
    v_add_f32 v64, v64, v64 row_ror:4 row_mask:0xf bank_mask:0xf
    s_nop 1
    v_add_f32 v64, v64, v64 row_ror:2 row_mask:0xf bank_mask:0xf
    s_nop 1
    v_add_f32 v64, v64, v64 row_ror:1 row_mask:0xf bank_mask:0xf
    v_mov_b32 v65, v64
    s_nop 1
    v_permlane16_swap_b32 v64, v65
    v_add_f32 v64, v64, v65
    v_mov_b32 v65, v64
    s_nop 1
    v_permlane32_swap_b32 v64, v65
    v_add_f32 v64, v64, v65
    v_mov_b32 v65, 0x3727c5ac
    v_fmac_f32 v65, 0x3b000000, v64
    v_rsq_f32 v65, v65
    s_nop 0
    v_mul_f32 v32, v32, v65
    v_mul_f32 v33, v33, v65
    v_mul_f32 v34, v34, v65
    v_mul_f32 v35, v35, v65
    v_mul_f32 v36, v36, v65
    v_mul_f32 v37, v37, v65
    v_mul_f32 v38, v38, v65
    v_mul_f32 v39, v39, v65
    v_mul_f32 v40, v40, v65
    v_mul_f32 v41, v41, v65
    v_mul_f32 v42, v42, v65
    v_mul_f32 v43, v43, v65
    v_mul_f32 v44, v44, v65
    v_mul_f32 v45, v45, v65
    v_mul_f32 v46, v46, v65
    v_mul_f32 v47, v47, v65
    v_cvt_pk_bf16_f32 v96, v32, v33
    v_cvt_pk_bf16_f32 v97, v34, v35
    v_cvt_pk_bf16_f32 v100, v36, v37
    v_cvt_pk_bf16_f32 v101, v38, v39
    v_cvt_pk_bf16_f32 v104, v40, v41
    v_cvt_pk_bf16_f32 v105, v42, v43
    v_cvt_pk_bf16_f32 v108, v44, v45
    v_cvt_pk_bf16_f32 v109, v46, v47
    v_mov_b64 v[98:99], v[96:97]
    s_nop 1
    v_permlane16_swap_b32 v96, v98
    v_permlane16_swap_b32 v97, v99
    v_mov_b64 v[102:103], v[100:101]
    s_nop 1
    v_permlane16_swap_b32 v100, v102
    v_permlane16_swap_b32 v101, v103
    v_mov_b64 v[106:107], v[104:105]
    s_nop 1
    v_permlane16_swap_b32 v104, v106
    v_permlane16_swap_b32 v105, v107
    v_mov_b64 v[110:111], v[108:109]
    s_nop 1
    v_permlane16_swap_b32 v108, v110
    v_permlane16_swap_b32 v109, v111
    v_mov_b64 v[50:51], v[48:49]
    s_nop 1
    v_permlane16_swap_b32 v48, v50
    v_permlane16_swap_b32 v49, v51
    v_mov_b64 v[54:55], v[52:53]
    s_nop 1
    v_permlane16_swap_b32 v52, v54
    v_permlane16_swap_b32 v53, v55
    v_mov_b64 v[58:59], v[56:57]
    s_nop 1
    v_permlane16_swap_b32 v56, v58
    v_permlane16_swap_b32 v57, v59
    v_mov_b64 v[62:63], v[60:61]
    s_nop 1
    v_permlane16_swap_b32 v60, v62
    v_permlane16_swap_b32 v61, v63
    s_mov_b64 exec, 0xffff
    buffer_store_dwordx4 v[96:99], v6, s[32:35], s63 offen offset:0 sc1
    buffer_store_dwordx4 v[100:103], v6, s[32:35], s63 offen offset:256 sc1
    buffer_store_dwordx4 v[104:107], v6, s[32:35], s63 offen offset:512 sc1
    buffer_store_dwordx4 v[108:111], v6, s[32:35], s63 offen offset:768 sc1
    buffer_store_dwordx4 v[48:51], v6, s[32:35], s62 offen offset:0 sc1
    buffer_store_dwordx4 v[52:55], v6, s[32:35], s62 offen offset:256 sc1
    buffer_store_dwordx4 v[56:59], v6, s[32:35], s62 offen offset:512 sc1
    buffer_store_dwordx4 v[60:63], v6, s[32:35], s62 offen offset:768 sc1
    s_mov_b64 exec, -1
    s_branch Lfrf_196
Lfro_195:
    v_mov_b64 v[50:51], v[48:49]
    s_nop 1
    v_permlane16_swap_b32 v48, v50
    v_permlane16_swap_b32 v49, v51
    v_mov_b64 v[54:55], v[52:53]
    s_nop 1
    v_permlane16_swap_b32 v52, v54
    v_permlane16_swap_b32 v53, v55
    v_mov_b64 v[58:59], v[56:57]
    s_nop 1
    v_permlane16_swap_b32 v56, v58
    v_permlane16_swap_b32 v57, v59
    v_mov_b64 v[62:63], v[60:61]
    s_nop 1
    v_permlane16_swap_b32 v60, v62
    v_permlane16_swap_b32 v61, v63
    s_mov_b64 exec, 0xffff
    buffer_store_dwordx4 v[48:51], v6, s[40:43], s63 offen offset:0
    buffer_store_dwordx4 v[52:55], v6, s[40:43], s63 offen offset:256
    buffer_store_dwordx4 v[56:59], v6, s[40:43], s63 offen offset:512
    buffer_store_dwordx4 v[60:63], v6, s[40:43], s63 offen offset:768
    s_mov_b64 exec, -1
Lfrf_196:
    s_add_u32 s64, s64, 1
    s_cmp_lt_u32 s64, 64
    s_cbranch_scc1 Lfrl_189
    s_branch L_exit
Lffs_188:
    s_mov_b32 s64, 0
Lfrl_197:
    s_lshr_b32 s75, s64, 2
    s_and_b32 s75, s75, 1
    s_and_b32 s3, s64, 3
    s_lshl_b32 s3, s3, 20
    s_lshl_b32 s61, s60, 22
    s_add_u32 s61, s61, s3
    s_add_u32 s76, s61, 0x8400000
    s_lshl_b32 s62, s60, 21
    s_lshl_b32 s63, s64, 15
    s_add_u32 s62, s62, s63
    s_add_u32 s77, s62, 0x400000
    buffer_load_dwordx4 v[48:51], v6, s[32:35], s77 offen offset:0 sc1
    buffer_load_dwordx4 v[52:55], v6, s[32:35], s77 offen offset:256 sc1
    buffer_load_dwordx4 v[56:59], v6, s[32:35], s77 offen offset:512 sc1
    buffer_load_dwordx4 v[60:63], v6, s[32:35], s77 offen offset:768 sc1
Lfrp_198:
    buffer_load_dwordx4 v[128:131], v4, s[32:35], s76 offen offset:768 sc1
    s_sleep 1
    s_add_u32 s99, s99, 1
    s_cmp_gt_u32 s99, 0x2dc6c0
    s_cbranch_scc0 Lto_201
    s_mov_b32 s3, 34
    s_branch L_abort
Lto_201:
    s_waitcnt vmcnt(0)
    v_xor_b32 v64, s75, v128
    v_and_b32 v64, 1, v64
    v_cmp_ne_u32 vcc, 0, v64
    s_cbranch_vccnz Lfrp_198
    s_branch Lfra_200
Lfra_199:
    buffer_load_dwordx4 v[48:51], v6, s[32:35], s77 offen offset:0 sc1
    buffer_load_dwordx4 v[52:55], v6, s[32:35], s77 offen offset:256 sc1
    buffer_load_dwordx4 v[56:59], v6, s[32:35], s77 offen offset:512 sc1
    buffer_load_dwordx4 v[60:63], v6, s[32:35], s77 offen offset:768 sc1
Lfra_200:
    s_mov_b32 s61, s76
    buffer_load_dwordx4 v[128:131], v4, s[32:35], s61 offen offset:0 sc1
    buffer_load_dwordx4 v[132:135], v4, s[32:35], s61 offen offset:256 sc1
    buffer_load_dwordx4 v[136:139], v4, s[32:35], s61 offen offset:512 sc1
    buffer_load_dwordx4 v[140:143], v4, s[32:35], s61 offen offset:768 sc1
    s_add_u32 s61, s61, 0x20000
    buffer_load_dwordx4 v[144:147], v4, s[32:35], s61 offen offset:0 sc1
    buffer_load_dwordx4 v[148:151], v4, s[32:35], s61 offen offset:256 sc1
    buffer_load_dwordx4 v[152:155], v4, s[32:35], s61 offen offset:512 sc1
    buffer_load_dwordx4 v[156:159], v4, s[32:35], s61 offen offset:768 sc1
    s_add_u32 s61, s61, 0x20000
    buffer_load_dwordx4 v[160:163], v4, s[32:35], s61 offen offset:0 sc1
    buffer_load_dwordx4 v[164:167], v4, s[32:35], s61 offen offset:256 sc1
    buffer_load_dwordx4 v[168:171], v4, s[32:35], s61 offen offset:512 sc1
    buffer_load_dwordx4 v[172:175], v4, s[32:35], s61 offen offset:768 sc1
    s_add_u32 s61, s61, 0x20000
    buffer_load_dwordx4 v[176:179], v4, s[32:35], s61 offen offset:0 sc1
    buffer_load_dwordx4 v[180:183], v4, s[32:35], s61 offen offset:256 sc1
    buffer_load_dwordx4 v[184:187], v4, s[32:35], s61 offen offset:512 sc1
    buffer_load_dwordx4 v[188:191], v4, s[32:35], s61 offen offset:768 sc1
    s_add_u32 s61, s61, 0x20000
    buffer_load_dwordx4 v[192:195], v4, s[32:35], s61 offen offset:0 sc1
    buffer_load_dwordx4 v[196:199], v4, s[32:35], s61 offen offset:256 sc1
    buffer_load_dwordx4 v[200:203], v4, s[32:35], s61 offen offset:512 sc1
    buffer_load_dwordx4 v[204:207], v4, s[32:35], s61 offen offset:768 sc1
    s_add_u32 s61, s61, 0x20000
    buffer_load_dwordx4 v[208:211], v5, s[32:35], s61 offen offset:0 sc1
    buffer_load_dwordx4 v[212:215], v5, s[32:35], s61 offen offset:256 sc1
    buffer_load_dwordx4 v[216:219], v5, s[32:35], s61 offen offset:512 sc1
    buffer_load_dwordx4 v[220:223], v5, s[32:35], s61 offen offset:768 sc1
    s_add_u32 s99, s99, 1
    s_cmp_gt_u32 s99, 0x2dc6c0
    s_cbranch_scc0 Lto_202
    s_mov_b32 s3, 36
    s_branch L_abort
Lto_202:
    v_mov_b32 v64, 0
    v_mov_b32 v65, 0
    s_waitcnt vmcnt(23)
    v_mfma_f32_16x16x32_bf16 v[32:35], v[16:19], v[128:131], 0
    v_xor_b32 v66, s75, v128
    v_or_b32 v64, v64, v66
    s_waitcnt vmcnt(22)
    v_mfma_f32_16x16x32_bf16 v[36:39], v[16:19], v[132:135], 0
    v_xor_b32 v66, s75, v132
    v_or_b32 v64, v64, v66
    s_waitcnt vmcnt(21)
    v_mfma_f32_16x16x32_bf16 v[40:43], v[16:19], v[136:139], 0
    v_xor_b32 v66, s75, v136
    v_or_b32 v64, v64, v66
    s_waitcnt vmcnt(20)
    v_mfma_f32_16x16x32_bf16 v[44:47], v[16:19], v[140:143], 0
    v_xor_b32 v66, s75, v140
    v_or_b32 v64, v64, v66
    s_waitcnt vmcnt(19)
    v_mfma_f32_16x16x32_bf16 v[32:35], v[16:19], v[144:147], v[32:35]
    v_xor_b32 v66, s75, v144
    v_or_b32 v64, v64, v66
    s_waitcnt vmcnt(18)
    v_mfma_f32_16x16x32_bf16 v[36:39], v[16:19], v[148:151], v[36:39]
    v_xor_b32 v66, s75, v148
    v_or_b32 v64, v64, v66
    s_waitcnt vmcnt(17)
    v_mfma_f32_16x16x32_bf16 v[40:43], v[16:19], v[152:155], v[40:43]
    v_xor_b32 v66, s75, v152
    v_or_b32 v64, v64, v66
    s_waitcnt vmcnt(16)
    v_mfma_f32_16x16x32_bf16 v[44:47], v[16:19], v[156:159], v[44:47]
    v_xor_b32 v66, s75, v156
    v_or_b32 v64, v64, v66
    s_waitcnt vmcnt(15)
    v_mfma_f32_16x16x32_bf16 v[32:35], v[16:19], v[160:163], v[32:35]
    v_xor_b32 v66, s75, v160
    v_or_b32 v64, v64, v66
    s_waitcnt vmcnt(14)
    v_mfma_f32_16x16x32_bf16 v[36:39], v[16:19], v[164:167], v[36:39]
    v_xor_b32 v66, s75, v164
    v_or_b32 v64, v64, v66
    s_waitcnt vmcnt(13)
    v_mfma_f32_16x16x32_bf16 v[40:43], v[16:19], v[168:171], v[40:43]
    v_xor_b32 v66, s75, v168
    v_or_b32 v64, v64, v66
    s_waitcnt vmcnt(12)
    v_mfma_f32_16x16x32_bf16 v[44:47], v[16:19], v[172:175], v[44:47]
    v_xor_b32 v66, s75, v172
    v_or_b32 v64, v64, v66
    s_waitcnt vmcnt(11)
    v_mfma_f32_16x16x32_bf16 v[32:35], v[16:19], v[176:179], v[32:35]
    v_xor_b32 v66, s75, v176
    v_or_b32 v64, v64, v66
    s_waitcnt vmcnt(10)
    v_mfma_f32_16x16x32_bf16 v[36:39], v[16:19], v[180:183], v[36:39]
    v_xor_b32 v66, s75, v180
    v_or_b32 v64, v64, v66
    s_waitcnt vmcnt(9)
    v_mfma_f32_16x16x32_bf16 v[40:43], v[16:19], v[184:187], v[40:43]
    v_xor_b32 v66, s75, v184
    v_or_b32 v64, v64, v66
    s_waitcnt vmcnt(8)
    v_mfma_f32_16x16x32_bf16 v[44:47], v[16:19], v[188:191], v[44:47]
    v_xor_b32 v66, s75, v188
    v_or_b32 v64, v64, v66
    s_waitcnt vmcnt(7)
    v_mfma_f32_16x16x32_bf16 v[32:35], v[16:19], v[192:195], v[32:35]
    v_xor_b32 v66, s75, v192
    v_or_b32 v64, v64, v66
    s_waitcnt vmcnt(6)
    v_mfma_f32_16x16x32_bf16 v[36:39], v[16:19], v[196:199], v[36:39]
    v_xor_b32 v66, s75, v196
    v_or_b32 v64, v64, v66
    s_waitcnt vmcnt(5)
    v_mfma_f32_16x16x32_bf16 v[40:43], v[16:19], v[200:203], v[40:43]
    v_xor_b32 v66, s75, v200
    v_or_b32 v64, v64, v66
    s_waitcnt vmcnt(4)
    v_mfma_f32_16x16x32_bf16 v[44:47], v[16:19], v[204:207], v[44:47]
    v_xor_b32 v66, s75, v204
    v_or_b32 v64, v64, v66
    s_waitcnt vmcnt(3)
    v_mfma_f32_16x16x32_bf16 v[32:35], v[16:19], v[208:211], v[32:35]
    v_xor_b32 v66, s75, v208
    v_or_b32 v65, v65, v66
    s_waitcnt vmcnt(2)
    v_mfma_f32_16x16x32_bf16 v[36:39], v[16:19], v[212:215], v[36:39]
    v_xor_b32 v66, s75, v212
    v_or_b32 v65, v65, v66
    s_waitcnt vmcnt(1)
    v_mfma_f32_16x16x32_bf16 v[40:43], v[16:19], v[216:219], v[40:43]
    v_xor_b32 v66, s75, v216
    v_or_b32 v65, v65, v66
    s_waitcnt vmcnt(0)
    v_mfma_f32_16x16x32_bf16 v[44:47], v[16:19], v[220:223], v[44:47]
    v_xor_b32 v66, s75, v220
    v_or_b32 v65, v65, v66
    v_mov_b32 v66, 0
    v_cndmask_b32 v65, v66, v65, s[92:93]
    v_or_b32 v64, v64, v65
    v_and_b32 v64, 1, v64
    s_waitcnt vmcnt(0)
    v_max3_u32 v65, v48, v52, v56
    v_max_u32 v65, v65, v60
    v_cmp_ne_u32 vcc, 0, v64
    v_cmp_eq_u32 s[62:63], -1, v65
    s_or_b64 vcc, vcc, s[62:63]
    s_cbranch_vccnz Lfra_199
    s_add_u32 s62, s64, 1
    v_mov_b32 v64, s62
    s_lshl_b32 s61, s60, 7
    s_add_u32 s61, s61, 0x9022c00
    s_mov_b64 exec, 1
    buffer_store_dword v64, v22, s[32:35], s61 offen sc1
    s_mov_b64 exec, -1
    s_lshl_b32 s63, s64, 15
    v_permlane16_swap_b32 v48, v50
    v_permlane16_swap_b32 v49, v51
    v_permlane16_swap_b32 v52, v54
    v_permlane16_swap_b32 v53, v55
    v_permlane16_swap_b32 v56, v58
    v_permlane16_swap_b32 v57, v59
    v_permlane16_swap_b32 v60, v62
    v_permlane16_swap_b32 v61, v63
    v_lshlrev_b32 v64, 16, v48
    v_and_b32 v65, 0xffff0000, v48
    v_lshlrev_b32 v66, 16, v49
    v_and_b32 v67, 0xffff0000, v49
    v_lshlrev_b32 v68, 16, v52
    v_and_b32 v69, 0xffff0000, v52
    v_lshlrev_b32 v70, 16, v53
    v_and_b32 v71, 0xffff0000, v53
    v_lshlrev_b32 v72, 16, v56
    v_and_b32 v73, 0xffff0000, v56
    v_lshlrev_b32 v74, 16, v57
    v_and_b32 v75, 0xffff0000, v57
    v_lshlrev_b32 v76, 16, v60
    v_and_b32 v77, 0xffff0000, v60
    v_lshlrev_b32 v78, 16, v61
    v_and_b32 v79, 0xffff0000, v61
    v_add_f32 v32, v32, v64
    v_add_f32 v33, v33, v65
    v_add_f32 v34, v34, v66
    v_add_f32 v35, v35, v67
    v_add_f32 v36, v36, v68
    v_add_f32 v37, v37, v69
    v_add_f32 v38, v38, v70
    v_add_f32 v39, v39, v71
    v_add_f32 v40, v40, v72
    v_add_f32 v41, v41, v73
    v_add_f32 v42, v42, v74
    v_add_f32 v43, v43, v75
    v_add_f32 v44, v44, v76
    v_add_f32 v45, v45, v77
    v_add_f32 v46, v46, v78
    v_add_f32 v47, v47, v79
    v_cvt_pk_bf16_f32 v48, v32, v33
    v_cvt_pk_bf16_f32 v49, v34, v35
    v_cvt_pk_bf16_f32 v52, v36, v37
    v_cvt_pk_bf16_f32 v53, v38, v39
    v_cvt_pk_bf16_f32 v56, v40, v41
    v_cvt_pk_bf16_f32 v57, v42, v43
    v_cvt_pk_bf16_f32 v60, v44, v45
    v_cvt_pk_bf16_f32 v61, v46, v47
    s_cmp_eq_u32 s60, 1
    s_cbranch_scc1 Lfro_203
    v_lshlrev_b32 v32, 16, v48
    v_and_b32 v33, 0xffff0000, v48
    v_lshlrev_b32 v34, 16, v49
    v_and_b32 v35, 0xffff0000, v49
    v_lshlrev_b32 v36, 16, v52
    v_and_b32 v37, 0xffff0000, v52
    v_lshlrev_b32 v38, 16, v53
    v_and_b32 v39, 0xffff0000, v53
    v_lshlrev_b32 v40, 16, v56
    v_and_b32 v41, 0xffff0000, v56
    v_lshlrev_b32 v42, 16, v57
    v_and_b32 v43, 0xffff0000, v57
    v_lshlrev_b32 v44, 16, v60
    v_and_b32 v45, 0xffff0000, v60
    v_lshlrev_b32 v46, 16, v61
    v_and_b32 v47, 0xffff0000, v61
    s_add_u32 s62, s63, 0xc00000
    s_add_u32 s63, s63, 0x200000
    v_add_f32 v64, v32, v33
    v_add_f32 v64, v64, v34
    v_add_f32 v64, v64, v35
    v_add_f32 v64, v64, v36
    v_add_f32 v64, v64, v37
    v_add_f32 v64, v64, v38
    v_add_f32 v64, v64, v39
    v_add_f32 v64, v64, v40
    v_add_f32 v64, v64, v41
    v_add_f32 v64, v64, v42
    v_add_f32 v64, v64, v43
    v_add_f32 v64, v64, v44
    v_add_f32 v64, v64, v45
    v_add_f32 v64, v64, v46
    v_add_f32 v64, v64, v47
    v_mov_b32 v66, 0
    v_cndmask_b32 v64, v66, v64, s[92:93]
    s_nop 1
    v_add_f32 v64, v64, v64 row_ror:8 row_mask:0xf bank_mask:0xf
    s_nop 1
    v_add_f32 v64, v64, v64 row_ror:4 row_mask:0xf bank_mask:0xf
    s_nop 1
    v_add_f32 v64, v64, v64 row_ror:2 row_mask:0xf bank_mask:0xf
    s_nop 1
    v_add_f32 v64, v64, v64 row_ror:1 row_mask:0xf bank_mask:0xf
    v_mov_b32 v65, v64
    s_nop 1
    v_permlane16_swap_b32 v64, v65
    v_add_f32 v64, v64, v65
    v_mov_b32 v65, v64
    s_nop 1
    v_permlane32_swap_b32 v64, v65
    v_add_f32 v64, v64, v65
    v_mul_f32 v64, 0x3b000000, v64
    v_sub_f32 v32, v32, v64
    v_sub_f32 v33, v33, v64
    v_sub_f32 v34, v34, v64
    v_sub_f32 v35, v35, v64
    v_sub_f32 v36, v36, v64
    v_sub_f32 v37, v37, v64
    v_sub_f32 v38, v38, v64
    v_sub_f32 v39, v39, v64
    v_sub_f32 v40, v40, v64
    v_sub_f32 v41, v41, v64
    v_sub_f32 v42, v42, v64
    v_sub_f32 v43, v43, v64
    v_sub_f32 v44, v44, v64
    v_sub_f32 v45, v45, v64
    v_sub_f32 v46, v46, v64
    v_sub_f32 v47, v47, v64
    v_mul_f32 v64, v32, v32
    v_fmac_f32 v64, v33, v33
    v_fmac_f32 v64, v34, v34
    v_fmac_f32 v64, v35, v35
    v_fmac_f32 v64, v36, v36
    v_fmac_f32 v64, v37, v37
    v_fmac_f32 v64, v38, v38
    v_fmac_f32 v64, v39, v39
    v_fmac_f32 v64, v40, v40
    v_fmac_f32 v64, v41, v41
    v_fmac_f32 v64, v42, v42
    v_fmac_f32 v64, v43, v43
    v_fmac_f32 v64, v44, v44
    v_fmac_f32 v64, v45, v45
    v_fmac_f32 v64, v46, v46
    v_fmac_f32 v64, v47, v47
    v_cndmask_b32 v64, v66, v64, s[92:93]
    s_nop 1
    v_add_f32 v64, v64, v64 row_ror:8 row_mask:0xf bank_mask:0xf
    s_nop 1
    v_add_f32 v64, v64, v64 row_ror:4 row_mask:0xf bank_mask:0xf
    s_nop 1
    v_add_f32 v64, v64, v64 row_ror:2 row_mask:0xf bank_mask:0xf
    s_nop 1
    v_add_f32 v64, v64, v64 row_ror:1 row_mask:0xf bank_mask:0xf
    v_mov_b32 v65, v64
    s_nop 1
    v_permlane16_swap_b32 v64, v65
    v_add_f32 v64, v64, v65
    v_mov_b32 v65, v64
    s_nop 1
    v_permlane32_swap_b32 v64, v65
    v_add_f32 v64, v64, v65
    v_mov_b32 v65, 0x3727c5ac
    v_fmac_f32 v65, 0x3b000000, v64
    v_rsq_f32 v65, v65
    s_nop 0
    v_mul_f32 v32, v32, v65
    v_mul_f32 v33, v33, v65
    v_mul_f32 v34, v34, v65
    v_mul_f32 v35, v35, v65
    v_mul_f32 v36, v36, v65
    v_mul_f32 v37, v37, v65
    v_mul_f32 v38, v38, v65
    v_mul_f32 v39, v39, v65
    v_mul_f32 v40, v40, v65
    v_mul_f32 v41, v41, v65
    v_mul_f32 v42, v42, v65
    v_mul_f32 v43, v43, v65
    v_mul_f32 v44, v44, v65
    v_mul_f32 v45, v45, v65
    v_mul_f32 v46, v46, v65
    v_mul_f32 v47, v47, v65
    v_cvt_pk_bf16_f32 v96, v32, v33
    v_cvt_pk_bf16_f32 v97, v34, v35
    v_cvt_pk_bf16_f32 v100, v36, v37
    v_cvt_pk_bf16_f32 v101, v38, v39
    v_cvt_pk_bf16_f32 v104, v40, v41
    v_cvt_pk_bf16_f32 v105, v42, v43
    v_cvt_pk_bf16_f32 v108, v44, v45
    v_cvt_pk_bf16_f32 v109, v46, v47
    v_mov_b64 v[98:99], v[96:97]
    s_nop 1
    v_permlane16_swap_b32 v96, v98
    v_permlane16_swap_b32 v97, v99
    v_mov_b64 v[102:103], v[100:101]
    s_nop 1
    v_permlane16_swap_b32 v100, v102
    v_permlane16_swap_b32 v101, v103
    v_mov_b64 v[106:107], v[104:105]
    s_nop 1
    v_permlane16_swap_b32 v104, v106
    v_permlane16_swap_b32 v105, v107
    v_mov_b64 v[110:111], v[108:109]
    s_nop 1
    v_permlane16_swap_b32 v108, v110
    v_permlane16_swap_b32 v109, v111
    v_mov_b64 v[50:51], v[48:49]
    s_nop 1
    v_permlane16_swap_b32 v48, v50
    v_permlane16_swap_b32 v49, v51
    v_mov_b64 v[54:55], v[52:53]
    s_nop 1
    v_permlane16_swap_b32 v52, v54
    v_permlane16_swap_b32 v53, v55
    v_mov_b64 v[58:59], v[56:57]
    s_nop 1
    v_permlane16_swap_b32 v56, v58
    v_permlane16_swap_b32 v57, v59
    v_mov_b64 v[62:63], v[60:61]
    s_nop 1
    v_permlane16_swap_b32 v60, v62
    v_permlane16_swap_b32 v61, v63
    s_mov_b64 exec, 0xffff
    buffer_store_dwordx4 v[96:99], v6, s[32:35], s63 offen offset:0 sc1
    buffer_store_dwordx4 v[100:103], v6, s[32:35], s63 offen offset:256 sc1
    buffer_store_dwordx4 v[104:107], v6, s[32:35], s63 offen offset:512 sc1
    buffer_store_dwordx4 v[108:111], v6, s[32:35], s63 offen offset:768 sc1
    buffer_store_dwordx4 v[48:51], v6, s[32:35], s62 offen offset:0 sc1
    buffer_store_dwordx4 v[52:55], v6, s[32:35], s62 offen offset:256 sc1
    buffer_store_dwordx4 v[56:59], v6, s[32:35], s62 offen offset:512 sc1
    buffer_store_dwordx4 v[60:63], v6, s[32:35], s62 offen offset:768 sc1
    s_mov_b64 exec, -1
    s_branch Lfrf_204
Lfro_203:
    v_mov_b64 v[50:51], v[48:49]
    s_nop 1
    v_permlane16_swap_b32 v48, v50
    v_permlane16_swap_b32 v49, v51
    v_mov_b64 v[54:55], v[52:53]
    s_nop 1
    v_permlane16_swap_b32 v52, v54
    v_permlane16_swap_b32 v53, v55
    v_mov_b64 v[58:59], v[56:57]
    s_nop 1
    v_permlane16_swap_b32 v56, v58
    v_permlane16_swap_b32 v57, v59
    v_mov_b64 v[62:63], v[60:61]
    s_nop 1
    v_permlane16_swap_b32 v60, v62
    v_permlane16_swap_b32 v61, v63
    s_mov_b64 exec, 0xffff
    buffer_store_dwordx4 v[48:51], v6, s[40:43], s63 offen offset:0
    buffer_store_dwordx4 v[52:55], v6, s[40:43], s63 offen offset:256
    buffer_store_dwordx4 v[56:59], v6, s[40:43], s63 offen offset:512
    buffer_store_dwordx4 v[60:63], v6, s[40:43], s63 offen offset:768
    s_mov_b64 exec, -1
Lfrf_204:
    s_add_u32 s64, s64, 1
    s_cmp_lt_u32 s64, 64
    s_cbranch_scc1 Lfrl_197
    s_branch L_exit
    s_branch L_exit
L_role_ao:
    s_lshr_b32 s60, s57, 1
    s_sub_u32 s60, s60, 2
    s_mov_b32 s40, s14
    s_and_b32 s41, s15, 0xffff
    s_mov_b32 s42, 0x400000
    s_mov_b32 s43, 0x20000
    s_mov_b32 s44, s4
    s_and_b32 s45, s5, 0xffff
    s_mov_b32 s46, 0x200000
    s_mov_b32 s47, 0x20000
    s_cmp_eq_u32 s60, 0
    s_cbranch_scc1 Lao_205
    s_add_u32 s44, s30, 0xc00000
    s_addc_u32 s3, s31, 0
    s_and_b32 s45, s3, 0xffff
Lao_205:
    v_lshrrev_b32 v4, 3, v1
    v_lshlrev_b32 v4, 10, v4
    v_and_b32 v5, 7, v1
    v_lshlrev_b32 v5, 4, v5
    v_add_u32 v4, v4, v5
    s_lshr_b32 s61, s58, 2
    s_lshl_b32 s61, s61, 19
    s_and_b32 s62, s58, 3
    s_lshl_b32 s62, s62, 8
    s_add_u32 s61, s61, s62
    v_add_u32 v4, s61, v4
    v_add_u32 v5, 128, v4
    s_mul_i32 s61, s56, 131072
    s_add_u32 s61, s61, 0
    s_mul_i32 s62, s56, 16384
    s_add_u32 s62, s62, 0
    s_mov_b32 m0, s62
    s_nop 0
    buffer_load_dwordx4 v4, s[40:43], s61 offen lds
    s_add_u32 s61, s61, 8192
    s_add_u32 s62, s62, 1024
    s_mov_b32 m0, s62
    s_nop 0
    buffer_load_dwordx4 v4, s[40:43], s61 offen lds
    s_add_u32 s61, s61, 8192
    s_add_u32 s62, s62, 1024
    s_mov_b32 m0, s62
    s_nop 0
    buffer_load_dwordx4 v4, s[40:43], s61 offen lds
    s_add_u32 s61, s61, 8192
    s_add_u32 s62, s62, 1024
    s_mov_b32 m0, s62
    s_nop 0
    buffer_load_dwordx4 v4, s[40:43], s61 offen lds
    s_add_u32 s61, s61, 8192
    s_add_u32 s62, s62, 1024
    s_mov_b32 m0, s62
    s_nop 0
    buffer_load_dwordx4 v4, s[40:43], s61 offen lds
    s_add_u32 s61, s61, 8192
    s_add_u32 s62, s62, 1024
    s_mov_b32 m0, s62
    s_nop 0
    buffer_load_dwordx4 v4, s[40:43], s61 offen lds
    s_add_u32 s61, s61, 8192
    s_add_u32 s62, s62, 1024
    s_mov_b32 m0, s62
    s_nop 0
    buffer_load_dwordx4 v4, s[40:43], s61 offen lds
    s_add_u32 s61, s61, 8192
    s_add_u32 s62, s62, 1024
    s_mov_b32 m0, s62
    s_nop 0
    buffer_load_dwordx4 v4, s[40:43], s61 offen lds
    s_add_u32 s61, s61, 8192
    s_add_u32 s62, s62, 1024
    s_mov_b32 m0, s62
    s_nop 0
    buffer_load_dwordx4 v4, s[40:43], s61 offen lds
    s_add_u32 s61, s61, 8192
    s_add_u32 s62, s62, 1024
    s_mov_b32 m0, s62
    s_nop 0
    buffer_load_dwordx4 v4, s[40:43], s61 offen lds
    s_add_u32 s61, s61, 8192
    s_add_u32 s62, s62, 1024
    s_mov_b32 m0, s62
    s_nop 0
    buffer_load_dwordx4 v4, s[40:43], s61 offen lds
    s_add_u32 s61, s61, 8192
    s_add_u32 s62, s62, 1024
    s_mov_b32 m0, s62
    s_nop 0
    buffer_load_dwordx4 v4, s[40:43], s61 offen lds
    s_add_u32 s61, s61, 8192
    s_add_u32 s62, s62, 1024
    s_mov_b32 m0, s62
    s_nop 0
    buffer_load_dwordx4 v4, s[40:43], s61 offen lds
    s_add_u32 s61, s61, 8192
    s_add_u32 s62, s62, 1024
    s_mov_b32 m0, s62
    s_nop 0
    buffer_load_dwordx4 v4, s[40:43], s61 offen lds
    s_add_u32 s61, s61, 8192
    s_add_u32 s62, s62, 1024
    s_mov_b32 m0, s62
    s_nop 0
    buffer_load_dwordx4 v4, s[40:43], s61 offen lds
    s_add_u32 s61, s61, 8192
    s_add_u32 s62, s62, 1024
    s_mov_b32 m0, s62
    s_nop 0
    buffer_load_dwordx4 v4, s[40:43], s61 offen lds
    s_mul_i32 s61, s56, 131072
    s_add_u32 s61, s61, 0
    s_mul_i32 s62, s56, 16384
    s_add_u32 s62, s62, 65536
    s_mov_b32 m0, s62
    s_nop 0
    buffer_load_dwordx4 v5, s[40:43], s61 offen lds
    s_add_u32 s61, s61, 8192
    s_add_u32 s62, s62, 1024
    s_mov_b32 m0, s62
    s_nop 0
    buffer_load_dwordx4 v5, s[40:43], s61 offen lds
    s_add_u32 s61, s61, 8192
    s_add_u32 s62, s62, 1024
    s_mov_b32 m0, s62
    s_nop 0
    buffer_load_dwordx4 v5, s[40:43], s61 offen lds
    s_add_u32 s61, s61, 8192
    s_add_u32 s62, s62, 1024
    s_mov_b32 m0, s62
    s_nop 0
    buffer_load_dwordx4 v5, s[40:43], s61 offen lds
    s_add_u32 s61, s61, 8192
    s_add_u32 s62, s62, 1024
    s_mov_b32 m0, s62
    s_nop 0
    buffer_load_dwordx4 v5, s[40:43], s61 offen lds
    s_add_u32 s61, s61, 8192
    s_add_u32 s62, s62, 1024
    s_mov_b32 m0, s62
    s_nop 0
    buffer_load_dwordx4 v5, s[40:43], s61 offen lds
    s_add_u32 s61, s61, 8192
    s_add_u32 s62, s62, 1024
    s_mov_b32 m0, s62
    s_nop 0
    buffer_load_dwordx4 v5, s[40:43], s61 offen lds
    s_add_u32 s61, s61, 8192
    s_add_u32 s62, s62, 1024
    s_mov_b32 m0, s62
    s_nop 0
    buffer_load_dwordx4 v5, s[40:43], s61 offen lds
    s_add_u32 s61, s61, 8192
    s_add_u32 s62, s62, 1024
    s_mov_b32 m0, s62
    s_nop 0
    buffer_load_dwordx4 v5, s[40:43], s61 offen lds
    s_add_u32 s61, s61, 8192
    s_add_u32 s62, s62, 1024
    s_mov_b32 m0, s62
    s_nop 0
    buffer_load_dwordx4 v5, s[40:43], s61 offen lds
    s_add_u32 s61, s61, 8192
    s_add_u32 s62, s62, 1024
    s_mov_b32 m0, s62
    s_nop 0
    buffer_load_dwordx4 v5, s[40:43], s61 offen lds
    s_add_u32 s61, s61, 8192
    s_add_u32 s62, s62, 1024
    s_mov_b32 m0, s62
    s_nop 0
    buffer_load_dwordx4 v5, s[40:43], s61 offen lds
    s_add_u32 s61, s61, 8192
    s_add_u32 s62, s62, 1024
    s_mov_b32 m0, s62
    s_nop 0
    buffer_load_dwordx4 v5, s[40:43], s61 offen lds
    s_add_u32 s61, s61, 8192
    s_add_u32 s62, s62, 1024
    s_mov_b32 m0, s62
    s_nop 0
    buffer_load_dwordx4 v5, s[40:43], s61 offen lds
    s_add_u32 s61, s61, 8192
    s_add_u32 s62, s62, 1024
    s_mov_b32 m0, s62
    s_nop 0
    buffer_load_dwordx4 v5, s[40:43], s61 offen lds
    s_add_u32 s61, s61, 8192
    s_add_u32 s62, s62, 1024
    s_mov_b32 m0, s62
    s_nop 0
    buffer_load_dwordx4 v5, s[40:43], s61 offen lds
    v_lshrrev_b32 v4, 5, v1
    v_lshlrev_b32 v4, 3, v4
    v_bfe_u32 v5, v1, 2, 2
    v_add_u32 v4, v4, v5
    v_lshlrev_b32 v4, 7, v4
    v_and_b32 v5, 1, v1
    v_lshlrev_b32 v5, 5, v5
    v_add_u32 v4, v4, v5
    v_bfe_u32 v5, v1, 1, 1
    v_lshlrev_b32 v5, 3, v5
    v_add_u32 v4, v4, v5
    v_bfe_u32 v5, v1, 4, 1
    v_lshlrev_b32 v5, 4, v5
    v_add_u32 v4, v4, v5
    s_lshr_b32 s61, s56, 1
    s_lshl_b32 s61, s61, 16
    s_and_b32 s62, s56, 1
    s_lshl_b32 s62, s62, 6
    s_add_u32 s61, s61, s62
    v_add_u32 v4, s61, v4
    s_waitcnt vmcnt(0)
    s_barrier
    ds_read_b64_tr_b16 v[64:65], v4 offset:0
    ds_read_b64_tr_b16 v[66:67], v4 offset:512
    ds_read_b64_tr_b16 v[68:69], v4 offset:2048
    ds_read_b64_tr_b16 v[70:71], v4 offset:2560
    ds_read_b64_tr_b16 v[72:73], v4 offset:4096
    ds_read_b64_tr_b16 v[74:75], v4 offset:4608
    ds_read_b64_tr_b16 v[76:77], v4 offset:6144
    ds_read_b64_tr_b16 v[78:79], v4 offset:6656
    s_waitcnt lgkmcnt(7)
    v_accvgpr_write_b32 a0, v64
    v_accvgpr_write_b32 a1, v65
    ds_read_b64_tr_b16 v[64:65], v4 offset:8192
    s_waitcnt lgkmcnt(7)
    v_accvgpr_write_b32 a2, v66
    v_accvgpr_write_b32 a3, v67
    ds_read_b64_tr_b16 v[66:67], v4 offset:8704
    s_waitcnt lgkmcnt(7)
    v_accvgpr_write_b32 a4, v68
    v_accvgpr_write_b32 a5, v69
    ds_read_b64_tr_b16 v[68:69], v4 offset:10240
    s_waitcnt lgkmcnt(7)
    v_accvgpr_write_b32 a6, v70
    v_accvgpr_write_b32 a7, v71
    ds_read_b64_tr_b16 v[70:71], v4 offset:10752
    s_waitcnt lgkmcnt(7)
    v_accvgpr_write_b32 a8, v72
    v_accvgpr_write_b32 a9, v73
    ds_read_b64_tr_b16 v[72:73], v4 offset:12288
    s_waitcnt lgkmcnt(7)
    v_accvgpr_write_b32 a10, v74
    v_accvgpr_write_b32 a11, v75
    ds_read_b64_tr_b16 v[74:75], v4 offset:12800
    s_waitcnt lgkmcnt(7)
    v_accvgpr_write_b32 a12, v76
    v_accvgpr_write_b32 a13, v77
    ds_read_b64_tr_b16 v[76:77], v4 offset:14336
    s_waitcnt lgkmcnt(7)
    v_accvgpr_write_b32 a14, v78
    v_accvgpr_write_b32 a15, v79
    ds_read_b64_tr_b16 v[78:79], v4 offset:14848
    s_waitcnt lgkmcnt(7)
    v_accvgpr_write_b32 a16, v64
    v_accvgpr_write_b32 a17, v65
    ds_read_b64_tr_b16 v[64:65], v4 offset:16384
    s_waitcnt lgkmcnt(7)
    v_accvgpr_write_b32 a18, v66
    v_accvgpr_write_b32 a19, v67
    ds_read_b64_tr_b16 v[66:67], v4 offset:16896
    s_waitcnt lgkmcnt(7)
    v_accvgpr_write_b32 a20, v68
    v_accvgpr_write_b32 a21, v69
    ds_read_b64_tr_b16 v[68:69], v4 offset:18432
    s_waitcnt lgkmcnt(7)
    v_accvgpr_write_b32 a22, v70
    v_accvgpr_write_b32 a23, v71
    ds_read_b64_tr_b16 v[70:71], v4 offset:18944
    s_waitcnt lgkmcnt(7)
    v_accvgpr_write_b32 a24, v72
    v_accvgpr_write_b32 a25, v73
    ds_read_b64_tr_b16 v[72:73], v4 offset:20480
    s_waitcnt lgkmcnt(7)
    v_accvgpr_write_b32 a26, v74
    v_accvgpr_write_b32 a27, v75
    ds_read_b64_tr_b16 v[74:75], v4 offset:20992
    s_waitcnt lgkmcnt(7)
    v_accvgpr_write_b32 a28, v76
    v_accvgpr_write_b32 a29, v77
    ds_read_b64_tr_b16 v[76:77], v4 offset:22528
    s_waitcnt lgkmcnt(7)
    v_accvgpr_write_b32 a30, v78
    v_accvgpr_write_b32 a31, v79
    ds_read_b64_tr_b16 v[78:79], v4 offset:23040
    s_waitcnt lgkmcnt(7)
    v_accvgpr_write_b32 a32, v64
    v_accvgpr_write_b32 a33, v65
    ds_read_b64_tr_b16 v[64:65], v4 offset:24576
    s_waitcnt lgkmcnt(7)
    v_accvgpr_write_b32 a34, v66
    v_accvgpr_write_b32 a35, v67
    ds_read_b64_tr_b16 v[66:67], v4 offset:25088
    s_waitcnt lgkmcnt(7)
    v_accvgpr_write_b32 a36, v68
    v_accvgpr_write_b32 a37, v69
    ds_read_b64_tr_b16 v[68:69], v4 offset:26624
    s_waitcnt lgkmcnt(7)
    v_accvgpr_write_b32 a38, v70
    v_accvgpr_write_b32 a39, v71
    ds_read_b64_tr_b16 v[70:71], v4 offset:27136
    s_waitcnt lgkmcnt(7)
    v_accvgpr_write_b32 a40, v72
    v_accvgpr_write_b32 a41, v73
    ds_read_b64_tr_b16 v[72:73], v4 offset:28672
    s_waitcnt lgkmcnt(7)
    v_accvgpr_write_b32 a42, v74
    v_accvgpr_write_b32 a43, v75
    ds_read_b64_tr_b16 v[74:75], v4 offset:29184
    s_waitcnt lgkmcnt(7)
    v_accvgpr_write_b32 a44, v76
    v_accvgpr_write_b32 a45, v77
    ds_read_b64_tr_b16 v[76:77], v4 offset:30720
    s_waitcnt lgkmcnt(7)
    v_accvgpr_write_b32 a46, v78
    v_accvgpr_write_b32 a47, v79
    ds_read_b64_tr_b16 v[78:79], v4 offset:31232
    s_waitcnt lgkmcnt(7)
    v_accvgpr_write_b32 a48, v64
    v_accvgpr_write_b32 a49, v65
    ds_read_b64_tr_b16 v[64:65], v4 offset:32768
    s_waitcnt lgkmcnt(7)
    v_accvgpr_write_b32 a50, v66
    v_accvgpr_write_b32 a51, v67
    ds_read_b64_tr_b16 v[66:67], v4 offset:33280
    s_waitcnt lgkmcnt(7)
    v_accvgpr_write_b32 a52, v68
    v_accvgpr_write_b32 a53, v69
    ds_read_b64_tr_b16 v[68:69], v4 offset:34816
    s_waitcnt lgkmcnt(7)
    v_accvgpr_write_b32 a54, v70
    v_accvgpr_write_b32 a55, v71
    ds_read_b64_tr_b16 v[70:71], v4 offset:35328
    s_waitcnt lgkmcnt(7)
    v_accvgpr_write_b32 a56, v72
    v_accvgpr_write_b32 a57, v73
    ds_read_b64_tr_b16 v[72:73], v4 offset:36864
    s_waitcnt lgkmcnt(7)
    v_accvgpr_write_b32 a58, v74
    v_accvgpr_write_b32 a59, v75
    ds_read_b64_tr_b16 v[74:75], v4 offset:37376
    s_waitcnt lgkmcnt(7)
    v_accvgpr_write_b32 a60, v76
    v_accvgpr_write_b32 a61, v77
    ds_read_b64_tr_b16 v[76:77], v4 offset:38912
    s_waitcnt lgkmcnt(7)
    v_accvgpr_write_b32 a62, v78
    v_accvgpr_write_b32 a63, v79
    ds_read_b64_tr_b16 v[78:79], v4 offset:39424
    s_waitcnt lgkmcnt(7)
    v_accvgpr_write_b32 a64, v64
    v_accvgpr_write_b32 a65, v65
    ds_read_b64_tr_b16 v[64:65], v4 offset:40960
    s_waitcnt lgkmcnt(7)
    v_accvgpr_write_b32 a66, v66
    v_accvgpr_write_b32 a67, v67
    ds_read_b64_tr_b16 v[66:67], v4 offset:41472
    s_waitcnt lgkmcnt(7)
    v_accvgpr_write_b32 a68, v68
    v_accvgpr_write_b32 a69, v69
    ds_read_b64_tr_b16 v[68:69], v4 offset:43008
    s_waitcnt lgkmcnt(7)
    v_accvgpr_write_b32 a70, v70
    v_accvgpr_write_b32 a71, v71
    ds_read_b64_tr_b16 v[70:71], v4 offset:43520
    s_waitcnt lgkmcnt(7)
    v_accvgpr_write_b32 a72, v72
    v_accvgpr_write_b32 a73, v73
    ds_read_b64_tr_b16 v[72:73], v4 offset:45056
    s_waitcnt lgkmcnt(7)
    v_accvgpr_write_b32 a74, v74
    v_accvgpr_write_b32 a75, v75
    ds_read_b64_tr_b16 v[74:75], v4 offset:45568
    s_waitcnt lgkmcnt(7)
    v_accvgpr_write_b32 a76, v76
    v_accvgpr_write_b32 a77, v77
    ds_read_b64_tr_b16 v[76:77], v4 offset:47104
    s_waitcnt lgkmcnt(7)
    v_accvgpr_write_b32 a78, v78
    v_accvgpr_write_b32 a79, v79
    ds_read_b64_tr_b16 v[78:79], v4 offset:47616
    s_waitcnt lgkmcnt(7)
    v_accvgpr_write_b32 a80, v64
    v_accvgpr_write_b32 a81, v65
    ds_read_b64_tr_b16 v[64:65], v4 offset:49152
    s_waitcnt lgkmcnt(7)
    v_accvgpr_write_b32 a82, v66
    v_accvgpr_write_b32 a83, v67
    ds_read_b64_tr_b16 v[66:67], v4 offset:49664
    s_waitcnt lgkmcnt(7)
    v_accvgpr_write_b32 a84, v68
    v_accvgpr_write_b32 a85, v69
    ds_read_b64_tr_b16 v[68:69], v4 offset:51200
    s_waitcnt lgkmcnt(7)
    v_accvgpr_write_b32 a86, v70
    v_accvgpr_write_b32 a87, v71
    ds_read_b64_tr_b16 v[70:71], v4 offset:51712
    s_waitcnt lgkmcnt(7)
    v_accvgpr_write_b32 a88, v72
    v_accvgpr_write_b32 a89, v73
    ds_read_b64_tr_b16 v[72:73], v4 offset:53248
    s_waitcnt lgkmcnt(7)
    v_accvgpr_write_b32 a90, v74
    v_accvgpr_write_b32 a91, v75
    ds_read_b64_tr_b16 v[74:75], v4 offset:53760
    s_waitcnt lgkmcnt(7)
    v_accvgpr_write_b32 a92, v76
    v_accvgpr_write_b32 a93, v77
    ds_read_b64_tr_b16 v[76:77], v4 offset:55296
    s_waitcnt lgkmcnt(7)
    v_accvgpr_write_b32 a94, v78
    v_accvgpr_write_b32 a95, v79
    ds_read_b64_tr_b16 v[78:79], v4 offset:55808
    s_waitcnt lgkmcnt(7)
    v_accvgpr_write_b32 a96, v64
    v_accvgpr_write_b32 a97, v65
    ds_read_b64_tr_b16 v[64:65], v4 offset:57344
    s_waitcnt lgkmcnt(7)
    v_accvgpr_write_b32 a98, v66
    v_accvgpr_write_b32 a99, v67
    ds_read_b64_tr_b16 v[66:67], v4 offset:57856
    s_waitcnt lgkmcnt(7)
    v_accvgpr_write_b32 a100, v68
    v_accvgpr_write_b32 a101, v69
    ds_read_b64_tr_b16 v[68:69], v4 offset:59392
    s_waitcnt lgkmcnt(7)
    v_accvgpr_write_b32 a102, v70
    v_accvgpr_write_b32 a103, v71
    ds_read_b64_tr_b16 v[70:71], v4 offset:59904
    s_waitcnt lgkmcnt(7)
    v_accvgpr_write_b32 a104, v72
    v_accvgpr_write_b32 a105, v73
    ds_read_b64_tr_b16 v[72:73], v4 offset:61440
    s_waitcnt lgkmcnt(7)
    v_accvgpr_write_b32 a106, v74
    v_accvgpr_write_b32 a107, v75
    ds_read_b64_tr_b16 v[74:75], v4 offset:61952
    s_waitcnt lgkmcnt(7)
    v_accvgpr_write_b32 a108, v76
    v_accvgpr_write_b32 a109, v77
    ds_read_b64_tr_b16 v[76:77], v4 offset:63488
    s_waitcnt lgkmcnt(7)
    v_accvgpr_write_b32 a110, v78
    v_accvgpr_write_b32 a111, v79
    ds_read_b64_tr_b16 v[78:79], v4 offset:64000
    s_waitcnt lgkmcnt(7)
    v_accvgpr_write_b32 a112, v64
    v_accvgpr_write_b32 a113, v65
    s_waitcnt lgkmcnt(6)
    v_accvgpr_write_b32 a114, v66
    v_accvgpr_write_b32 a115, v67
    s_waitcnt lgkmcnt(5)
    v_accvgpr_write_b32 a116, v68
    v_accvgpr_write_b32 a117, v69
    s_waitcnt lgkmcnt(4)
    v_accvgpr_write_b32 a118, v70
    v_accvgpr_write_b32 a119, v71
    s_waitcnt lgkmcnt(3)
    v_accvgpr_write_b32 a120, v72
    v_accvgpr_write_b32 a121, v73
    s_waitcnt lgkmcnt(2)
    v_accvgpr_write_b32 a122, v74
    v_accvgpr_write_b32 a123, v75
    s_waitcnt lgkmcnt(1)
    v_accvgpr_write_b32 a124, v76
    v_accvgpr_write_b32 a125, v77
    s_waitcnt lgkmcnt(0)
    v_accvgpr_write_b32 a126, v78
    v_accvgpr_write_b32 a127, v79
    s_barrier
    s_lshr_b32 s60, s57, 1
    s_sub_u32 s60, s60, 2
    v_mov_b32 v40, -1
    v_mov_b32 v41, -1
    v_mov_b32 v42, -1
    v_mov_b32 v43, -1
    v_and_b32 v44, 127, v0
    v_lshlrev_b32 v44, 4, v44
    v_lshrrev_b32 v45, 7, v0
    v_lshlrev_b32 v45, 23, v45
    v_add_u32 v44, v44, v45
    s_lshl_b32 s61, s60, 22
    s_lshl_b32 s62, s58, 11
    s_add_u32 s61, s61, s62
    s_add_u32 s61, s61, 0x10c0000
    buffer_store_dwordx4 v[40:43], v44, s[32:35], s61 offen sc1
    s_add_u32 s61, s61, 0x10000
    buffer_store_dwordx4 v[40:43], v44, s[32:35], s61 offen sc1
    s_add_u32 s61, s61, 0x10000
    buffer_store_dwordx4 v[40:43], v44, s[32:35], s61 offen sc1
    s_add_u32 s61, s61, 0x10000
    buffer_store_dwordx4 v[40:43], v44, s[32:35], s61 offen sc1
    s_add_u32 s61, s61, 0x10000
    buffer_store_dwordx4 v[40:43], v44, s[32:35], s61 offen sc1
    s_add_u32 s61, s61, 0x10000
    buffer_store_dwordx4 v[40:43], v44, s[32:35], s61 offen sc1
    s_add_u32 s61, s61, 0x10000
    buffer_store_dwordx4 v[40:43], v44, s[32:35], s61 offen sc1
    s_add_u32 s61, s61, 0x10000
    buffer_store_dwordx4 v[40:43], v44, s[32:35], s61 offen sc1
    s_add_u32 s61, s61, 0x10000
    buffer_store_dwordx4 v[40:43], v44, s[32:35], s61 offen sc1
    s_add_u32 s61, s61, 0x10000
    buffer_store_dwordx4 v[40:43], v44, s[32:35], s61 offen sc1
    s_add_u32 s61, s61, 0x10000
    buffer_store_dwordx4 v[40:43], v44, s[32:35], s61 offen sc1
    s_add_u32 s61, s61, 0x10000
    buffer_store_dwordx4 v[40:43], v44, s[32:35], s61 offen sc1
    s_add_u32 s61, s61, 0x10000
    buffer_store_dwordx4 v[40:43], v44, s[32:35], s61 offen sc1
    s_add_u32 s61, s61, 0x10000
    buffer_store_dwordx4 v[40:43], v44, s[32:35], s61 offen sc1
    s_add_u32 s61, s61, 0x10000
    buffer_store_dwordx4 v[40:43], v44, s[32:35], s61 offen sc1
    s_add_u32 s61, s61, 0x10000
    buffer_store_dwordx4 v[40:43], v44, s[32:35], s61 offen sc1
    s_add_u32 s61, s61, 0x10000
    buffer_store_dwordx4 v[40:43], v44, s[32:35], s61 offen sc1
    s_add_u32 s61, s61, 0x10000
    buffer_store_dwordx4 v[40:43], v44, s[32:35], s61 offen sc1
    s_add_u32 s61, s61, 0x10000
    buffer_store_dwordx4 v[40:43], v44, s[32:35], s61 offen sc1
    s_add_u32 s61, s61, 0x10000
    buffer_store_dwordx4 v[40:43], v44, s[32:35], s61 offen sc1
    s_add_u32 s61, s61, 0x10000
    buffer_store_dwordx4 v[40:43], v44, s[32:35], s61 offen sc1
    s_add_u32 s61, s61, 0x10000
    buffer_store_dwordx4 v[40:43], v44, s[32:35], s61 offen sc1
    s_add_u32 s61, s61, 0x10000
    buffer_store_dwordx4 v[40:43], v44, s[32:35], s61 offen sc1
    s_add_u32 s61, s61, 0x10000
    buffer_store_dwordx4 v[40:43], v44, s[32:35], s61 offen sc1
    s_add_u32 s61, s61, 0x10000
    buffer_store_dwordx4 v[40:43], v44, s[32:35], s61 offen sc1
    s_add_u32 s61, s61, 0x10000
    buffer_store_dwordx4 v[40:43], v44, s[32:35], s61 offen sc1
    s_add_u32 s61, s61, 0x10000
    buffer_store_dwordx4 v[40:43], v44, s[32:35], s61 offen sc1
    s_add_u32 s61, s61, 0x10000
    buffer_store_dwordx4 v[40:43], v44, s[32:35], s61 offen sc1
    s_add_u32 s61, s61, 0x10000
    buffer_store_dwordx4 v[40:43], v44, s[32:35], s61 offen sc1
    s_add_u32 s61, s61, 0x10000
    buffer_store_dwordx4 v[40:43], v44, s[32:35], s61 offen sc1
    s_add_u32 s61, s61, 0x10000
    buffer_store_dwordx4 v[40:43], v44, s[32:35], s61 offen sc1
    s_add_u32 s61, s61, 0x10000
    buffer_store_dwordx4 v[40:43], v44, s[32:35], s61 offen sc1
    s_add_u32 s61, s61, 0x10000
    buffer_store_dwordx4 v[40:43], v44, s[32:35], s61 offen sc1
    s_add_u32 s61, s61, 0x10000
    buffer_store_dwordx4 v[40:43], v44, s[32:35], s61 offen sc1
    s_add_u32 s61, s61, 0x10000
    buffer_store_dwordx4 v[40:43], v44, s[32:35], s61 offen sc1
    s_add_u32 s61, s61, 0x10000
    buffer_store_dwordx4 v[40:43], v44, s[32:35], s61 offen sc1
    s_add_u32 s61, s61, 0x10000
    buffer_store_dwordx4 v[40:43], v44, s[32:35], s61 offen sc1
    s_add_u32 s61, s61, 0x10000
    buffer_store_dwordx4 v[40:43], v44, s[32:35], s61 offen sc1
    s_add_u32 s61, s61, 0x10000
    buffer_store_dwordx4 v[40:43], v44, s[32:35], s61 offen sc1
    s_add_u32 s61, s61, 0x10000
    buffer_store_dwordx4 v[40:43], v44, s[32:35], s61 offen sc1
    s_add_u32 s61, s61, 0x10000
    buffer_store_dwordx4 v[40:43], v44, s[32:35], s61 offen sc1
    s_add_u32 s61, s61, 0x10000
    buffer_store_dwordx4 v[40:43], v44, s[32:35], s61 offen sc1
    s_add_u32 s61, s61, 0x10000
    buffer_store_dwordx4 v[40:43], v44, s[32:35], s61 offen sc1
    s_add_u32 s61, s61, 0x10000
    buffer_store_dwordx4 v[40:43], v44, s[32:35], s61 offen sc1
    s_add_u32 s61, s61, 0x10000
    buffer_store_dwordx4 v[40:43], v44, s[32:35], s61 offen sc1
    s_add_u32 s61, s61, 0x10000
    buffer_store_dwordx4 v[40:43], v44, s[32:35], s61 offen sc1
    s_add_u32 s61, s61, 0x10000
    buffer_store_dwordx4 v[40:43], v44, s[32:35], s61 offen sc1
    s_add_u32 s61, s61, 0x10000
    buffer_store_dwordx4 v[40:43], v44, s[32:35], s61 offen sc1
    s_add_u32 s61, s61, 0x10000
    buffer_store_dwordx4 v[40:43], v44, s[32:35], s61 offen sc1
    s_add_u32 s61, s61, 0x10000
    buffer_store_dwordx4 v[40:43], v44, s[32:35], s61 offen sc1
    s_add_u32 s61, s61, 0x10000
    buffer_store_dwordx4 v[40:43], v44, s[32:35], s61 offen sc1
    s_add_u32 s61, s61, 0x10000
    buffer_store_dwordx4 v[40:43], v44, s[32:35], s61 offen sc1
    s_waitcnt vmcnt(0)
    s_barrier
    s_lshl_b32 s61, s60, 2
    s_add_u32 s61, s61, 80
    s_cmp_lg_u32 s56, 0
    s_cbranch_scc1 Lda_206
    v_mov_b32 v120, s61
    v_mov_b32 v121, 1
    s_mov_b64 exec, 1
    buffer_atomic_add v121, v120, s[36:39], 0 offen
    s_mov_b64 exec, -1
Lda_206:
    v_and_b32 v2, 15, v1
    v_lshrrev_b32 v3, 4, v1
    v_lshlrev_b32 v10, 4, v1
    s_and_b32 s65, s56, 1
    s_lshr_b32 s66, s56, 1
    s_lshl_b32 s62, s58, 13
    s_lshl_b32 s61, s56, 11
    s_add_u32 s61, s61, s62
    v_add_u32 v4, s61, v10
    s_mul_i32 s61, s66, 24576
    s_add_u32 s61, s61, 86272
    v_add_u32 v6, s61, v10
    s_lshl_b32 s62, s65, 12
    v_add_u32 v5, s62, v6
    s_lshl_b32 s62, s58, 11
    s_lshl_b32 s61, s66, 16
    s_add_u32 s62, s62, s61
    v_and_b32 v7, 7, v2
    v_lshlrev_b32 v7, 4, v7
    v_lshlrev_b32 v8, 7, v3
    v_add_u32 v7, v7, v8
    v_add_u32 v7, s62, v7
    v_lshlrev_b32 v8, 4, v2
    v_and_b32 v9, 1, v3
    v_lshlrev_b32 v9, 8, v9
    v_add_u32 v8, v8, v9
    v_add_u32 v8, s62, v8
    v_lshrrev_b32 v9, 1, v3
    v_lshlrev_b32 v9, 10, v9
    v_and_b32 v11, 1, v3
    v_lshlrev_b32 v11, 9, v11
    v_add_u32 v9, v9, v11
    v_lshlrev_b32 v11, 4, v2
    v_add_u32 v9, v9, v11
    s_lshl_b32 s61, s58, 13
    s_lshl_b32 s62, s66, 18
    s_add_u32 s61, s61, s62
    s_lshl_b32 s62, s65, 8
    s_add_u32 s61, s61, s62
    v_add_u32 v9, s61, v9
    s_and_b32 s61, s58, 28
    s_add_u32 s61, s61, s56
    s_lshl_b32 s61, s61, 13
    v_add_u32 v11, s61, v10
    s_lshl_b32 s61, s56, 13
    v_add_u32 v25, s61, v10
    s_mul_i32 s61, s56, 5120
    s_add_u32 s61, s61, 65792
    v_and_b32 v26, 31, v1
    v_mul_u32_u24 v26, 80, v26
    v_lshrrev_b32 v27, 5, v1
    v_lshlrev_b32 v27, 5, v27
    v_add_u32 v26, v26, v27
    v_add_u32 v26, s61, v26
    v_lshrrev_b32 v27, 2, v1
    v_mul_u32_u24 v27, 80, v27
    v_and_b32 v28, 3, v1
    v_lshlrev_b32 v28, 4, v28
    v_add_u32 v27, v27, v28
    v_add_u32 v27, s61, v27
    v_lshrrev_b32 v29, 2, v1
    v_lshlrev_b32 v29, 10, v29
    v_add_u32 v28, v28, v29
    s_lshr_b32 s61, s58, 2
    s_lshl_b32 s61, s61, 15
    s_and_b32 s62, s58, 3
    s_lshl_b32 s62, s62, 8
    s_add_u32 s61, s61, s62
    s_lshl_b32 s62, s56, 6
    s_add_u32 s61, s61, s62
    v_add_u32 v28, s61, v28
    s_lshl_b32 s62, s56, 8
    s_lshl_b32 s61, s58, 10
    s_add_u32 s61, s61, s62
    v_lshlrev_b32 v12, 15, v3
    v_lshlrev_b32 v13, 4, v2
    v_add_u32 v12, v12, v13
    v_add_u32 v12, s61, v12
    v_lshrrev_b32 v14, 5, v1
    v_lshlrev_b32 v14, 15, v14
    v_add_u32 v13, v13, v14
    v_add_u32 v13, s61, v13
    v_and_b32 v14, 7, v1
    v_lshlrev_b32 v14, 2, v14
    v_bfe_u32 v15, v1, 3, 1
    v_lshlrev_b32 v15, 10, v15
    v_add_u32 v14, v14, v15
    v_bfe_u32 v31, v1, 1, 1
    v_lshlrev_b32 v31, 18, v31
    v_and_b32 v30, 1, v1
    v_lshlrev_b32 v30, 8, v30
    v_add_u32 v31, v31, v30
    s_and_b32 s61, s58, 28
    s_add_u32 s61, s61, s56
    s_lshl_b32 s61, s61, 13
    s_add_u32 s61, s61, 7920
    v_add_u32 v31, s61, v31
    v_and_b32 v32, 15, v1
    v_mov_b32 v16, 0
    v_cmp_eq_u32 vcc, 0, v32
    v_mov_b32 v33, 0x3f80
    s_nop 0
    v_cndmask_b32 v16, v16, v33, vcc
    v_cmp_eq_u32 vcc, 1, v32
    v_mov_b32 v33, 0x3f800000
    s_nop 0
    v_cndmask_b32 v16, v16, v33, vcc
    v_mov_b32 v17, 0
    v_cmp_eq_u32 vcc, 2, v32
    v_mov_b32 v33, 0x3f80
    s_nop 0
    v_cndmask_b32 v17, v17, v33, vcc
    v_cmp_eq_u32 vcc, 3, v32
    v_mov_b32 v33, 0x3f800000
    s_nop 0
    v_cndmask_b32 v17, v17, v33, vcc
    v_mov_b32 v18, 0
    v_cmp_eq_u32 vcc, 4, v32
    v_mov_b32 v33, 0x3f80
    s_nop 0
    v_cndmask_b32 v18, v18, v33, vcc
    v_cmp_eq_u32 vcc, 5, v32
    v_mov_b32 v33, 0x3f800000
    s_nop 0
    v_cndmask_b32 v18, v18, v33, vcc
    v_mov_b32 v19, 0
    v_cmp_eq_u32 vcc, 6, v32
    v_mov_b32 v33, 0x3f80
    s_nop 0
    v_cndmask_b32 v19, v19, v33, vcc
    v_cmp_eq_u32 vcc, 7, v32
    v_mov_b32 v33, 0x3f800000
    s_nop 0
    v_cndmask_b32 v19, v19, v33, vcc
    v_mov_b32 v20, v16 row_ror:8 row_mask:0xf bank_mask:0xf
    v_mov_b32 v21, v17 row_ror:8 row_mask:0xf bank_mask:0xf
    v_mov_b32 v22, v18 row_ror:8 row_mask:0xf bank_mask:0xf
    v_mov_b32 v23, v19 row_ror:8 row_mask:0xf bank_mask:0xf
    v_lshlrev_b32 v30, 2, v3
    v_sub_u32 v30, v2, v30
    s_lshl_b32 s61, s65, 4
    v_add_u32 v30, s61, v30
    v_cmp_le_i32 s[76:77], 0, v30
    v_cmp_le_i32 s[78:79], 1, v30
    v_cmp_le_i32 s[80:81], 2, v30
    v_cmp_le_i32 s[82:83], 3, v30
    v_cmp_le_i32 s[84:85], 16, v30
    v_cmp_le_i32 s[86:87], 17, v30
    v_cmp_le_i32 s[88:89], 18, v30
    v_cmp_le_i32 s[90:91], 19, v30
    s_mov_b32 s92, -1
    s_mov_b32 s93, 0
    s_mov_b32 s68, 0x3e0293ee
    s_mov_b32 s94, 0x3b000000
    v_mov_b32 v15, 0xff800000
    v_lshrrev_b32 v24, 5, v1
    v_lshlrev_b32 v24, 4, v24
    v_and_b32 v29, 3, v1
    v_lshlrev_b32 v29, 5, v29
    v_add_u32 v29, v29, v24
    v_add_u32 v29, 65536, v29
    s_lshl_b32 s61, s56, 5
    s_add_u32 s61, s61, 65536
    v_add_u32 v24, s61, v24
    v_mov_b64 v[32:33], 0
    v_mov_b64 v[34:35], 0
    ds_write_b128 v29, v[32:35]
    ds_write_b128 v29, v[32:35] offset:128
    s_waitcnt lgkmcnt(0)
    v_lshlrev_b32 v120, 2, v1
    s_cmp_lg_u32 s56, 0
    s_cbranch_scc1 Lcw_208
Lcw_207:
    buffer_load_dword v121, v120, s[36:39], 0 offen sc1
    s_add_u32 s99, s99, 1
    s_cmp_gt_u32 s99, 0x2dc6c0
    s_cbranch_scc0 Lto_209
    s_mov_b32 s3, 2
    s_branch L_abort
Lto_209:
    s_waitcnt vmcnt(0)
    v_readlane_b32 s3, v121, 8
    s_cmp_ge_u32 s3, 256
    s_cbranch_scc1 Lcw_210
    s_sleep 8
    s_branch Lcw_207
Lcw_210:
    v_readlane_b32 s3, v121, s57
    v_mov_b32 v120, 163836
    s_nop 0
    v_mov_b32 v121, s3
    ds_write_b32 v120, v121
    s_waitcnt lgkmcnt(0)
Lcw_208:
    s_barrier
    v_mov_b32 v120, 163836
    ds_read_b32 v121, v120
    s_waitcnt lgkmcnt(0)
    v_readfirstlane_b32 s3, v121
    s_cmp_lt_u32 s3, 32
    s_cselect_b32 s59, 1, 0
    s_barrier
    s_lshl_b32 s61, s60, 2
    s_add_u32 s61, s61, 48
    s_cmp_lg_u32 s56, 0
    s_cbranch_scc1 Ldw_212
    v_mov_b32 v32, s61
    s_mov_b64 exec, 1
Ldw_211:
    buffer_load_dword v33, v32, s[36:39], 0 offen sc1
    s_add_u32 s99, s99, 1
    s_cmp_gt_u32 s99, 0x2dc6c0
    s_cbranch_scc0 Lto_213
    s_mov_b32 s3, 23
    s_branch L_abort
Lto_213:
    s_waitcnt vmcnt(0)
    v_cmp_gt_u32 vcc, 32, v33
    s_cbranch_vccz Ldw_214
    s_sleep 8
    s_branch Ldw_211
Ldw_214:
    s_mov_b64 exec, -1
Ldw_212:
    s_barrier
    s_lshl_b32 s61, s60, 2
    s_add_u32 s61, s61, 56
    s_cmp_lg_u32 s56, 0
    s_cbranch_scc1 Ldw_216
    v_mov_b32 v32, s61
    s_mov_b64 exec, 1
Ldw_215:
    buffer_load_dword v33, v32, s[36:39], 0 offen sc1
    s_add_u32 s99, s99, 1
    s_cmp_gt_u32 s99, 0x2dc6c0
    s_cbranch_scc0 Lto_217
    s_mov_b32 s3, 26
    s_branch L_abort
Lto_217:
    s_waitcnt vmcnt(0)
    v_cmp_gt_u32 vcc, 32, v33
    s_cbranch_vccz Ldw_218
    s_sleep 8
    s_branch Ldw_215
Ldw_218:
    s_mov_b64 exec, -1
Ldw_216:
    s_barrier
    s_cmp_lg_u32 s56, 0
    s_cbranch_scc1 Ldw_220
    v_mov_b32 v32, 72
    s_mov_b64 exec, 1
Ldw_219:
    buffer_load_dword v33, v32, s[36:39], 0 offen sc1
    s_add_u32 s99, s99, 1
    s_cmp_gt_u32 s99, 0x2dc6c0
    s_cbranch_scc0 Lto_221
    s_mov_b32 s3, 27
    s_branch L_abort
Lto_221:
    s_waitcnt vmcnt(0)
    v_cmp_gt_u32 vcc, 32, v33
    s_cbranch_vccz Ldw_222
    s_sleep 8
    s_branch Ldw_219
Ldw_222:
    s_mov_b64 exec, -1
Ldw_220:
    s_barrier
    s_cmp_eq_u32 s59, 1
    s_cbranch_scc1 Laos_223
    s_lshl_b32 s61, s60, 16
    s_lshl_b32 s62, s58, 5
    s_add_u32 s61, s61, s62
    s_add_u32 s73, s61, 0x9000000
    s_mov_b32 s64, 0
    s_mov_b32 s67, 0
    s_mov_b32 s69, 0
    s_mov_b32 s71, 0
    s_mov_b32 s101, 0
    s_mov_b32 s100, 0x8000000
    s_mov_b32 s70, 0
    v_mov_b32 v30, 0
Lpg_224:
    buffer_load_dword v112, v14, s[32:35], s73 offen sc1
    s_sleep 2
    s_add_u32 s99, s99, 1
    s_cmp_gt_u32 s99, 0x2dc6c0
    s_cbranch_scc0 Lto_225
    s_mov_b32 s3, 20
    s_branch L_abort
Lto_225:
    s_waitcnt vmcnt(0)
    v_cmp_ge_u32 vcc, s67, v112
    s_and_b32 vcc_lo, vcc_lo, 0xffff
    s_and_b32 vcc_hi, vcc_hi, 0x0
    s_or_b32 s3, vcc_lo, vcc_hi
    s_cbranch_scc1 Lpg_224
    s_min_u32 s62, s64, 31
    s_lshl_b32 s61, s60, 24
    s_lshl_b32 s62, s62, 19
    s_add_u32 s61, s61, s62
    s_lshl_b32 s74, s56, 11
    s_add_u32 s62, s61, 0x2000000
    s_add_u32 m0, s74, 86272
    s_nop 0
    buffer_load_dwordx4 v4, s[32:35], s62 offen offset:0 lds
    buffer_load_dwordx4 v4, s[32:35], s62 offen offset:1024 lds
    s_add_u32 s62, s61, 0x4000000
    s_add_u32 m0, s74, 94464
    s_nop 0
    buffer_load_dwordx4 v4, s[32:35], s62 offen offset:0 lds
    buffer_load_dwordx4 v4, s[32:35], s62 offen offset:1024 lds
    s_add_u32 s62, s61, 0x6000000
    s_add_u32 m0, s74, 102656
    s_nop 0
    buffer_load_dwordx4 v4, s[32:35], s62 offen offset:0 lds
    buffer_load_dwordx4 v4, s[32:35], s62 offen offset:1024 lds
    s_add_u32 s62, s61, 0x2040000
    s_add_u32 m0, s74, 110848
    s_nop 0
    buffer_load_dwordx4 v4, s[32:35], s62 offen offset:0 lds
    buffer_load_dwordx4 v4, s[32:35], s62 offen offset:1024 lds
    s_add_u32 s62, s61, 0x4040000
    s_add_u32 m0, s74, 119040
    s_nop 0
    buffer_load_dwordx4 v4, s[32:35], s62 offen offset:0 lds
    buffer_load_dwordx4 v4, s[32:35], s62 offen offset:1024 lds
    s_add_u32 s62, s61, 0x6040000
    s_add_u32 m0, s74, 127232
    s_nop 0
    buffer_load_dwordx4 v4, s[32:35], s62 offen offset:0 lds
    buffer_load_dwordx4 v4, s[32:35], s62 offen offset:1024 lds
    s_waitcnt vmcnt(0)
    s_barrier
    ds_read_b128 v[32:35], v5 offset:0
    ds_read_b128 v[48:51], v6 offset:8192
    ds_read_b128 v[64:67], v6 offset:12288
    ds_read_b128 v[36:39], v5 offset:1024
    ds_read_b128 v[52:55], v6 offset:9216
    ds_read_b128 v[68:71], v6 offset:13312
    ds_read_b128 v[40:43], v5 offset:2048
    ds_read_b128 v[56:59], v6 offset:10240
    ds_read_b128 v[72:75], v6 offset:14336
    ds_read_b128 v[44:47], v5 offset:3072
    ds_read_b128 v[60:63], v6 offset:11264
    ds_read_b128 v[76:79], v6 offset:15360
    ds_read_b128 v[80:83], v6 offset:16384
    ds_read_b128 v[84:87], v6 offset:17408
    ds_read_b128 v[88:91], v6 offset:18432
    ds_read_b128 v[92:95], v6 offset:19456
    ds_read_b128 v[96:99], v6 offset:20480
    ds_read_b128 v[100:103], v6 offset:21504
    ds_read_b128 v[104:107], v6 offset:22528
    ds_read_b128 v[108:111], v6 offset:23552
    s_waitcnt lgkmcnt(0)
    v_mfma_f32_16x16x32_bf16 v[112:115], v[48:51], v[32:35], 0
    v_mfma_f32_16x16x32_bf16 v[116:119], v[64:67], v[32:35], 0
    v_mfma_f32_16x16x32_bf16 v[112:115], v[52:55], v[36:39], v[112:115]
    v_mfma_f32_16x16x32_bf16 v[116:119], v[68:71], v[36:39], v[116:119]
    v_mfma_f32_16x16x32_bf16 v[112:115], v[56:59], v[40:43], v[112:115]
    v_mfma_f32_16x16x32_bf16 v[116:119], v[72:75], v[40:43], v[116:119]
    v_mfma_f32_16x16x32_bf16 v[112:115], v[60:63], v[44:47], v[112:115]
    v_mfma_f32_16x16x32_bf16 v[116:119], v[76:79], v[44:47], v[116:119]
    s_nop 6
    v_cndmask_b32 v112, v15, v112, s[76:77]
    v_cndmask_b32 v113, v15, v113, s[78:79]
    v_cndmask_b32 v114, v15, v114, s[80:81]
    v_cndmask_b32 v115, v15, v115, s[82:83]
    v_cndmask_b32 v116, v15, v116, s[84:85]
    v_cndmask_b32 v117, v15, v117, s[86:87]
    v_cndmask_b32 v118, v15, v118, s[88:89]
    v_cndmask_b32 v119, v15, v119, s[90:91]
    v_max3_f32 v196, v112, v113, v114
    v_max3_f32 v197, v115, v116, v117
    v_max3_f32 v196, v196, v118, v119
    v_max_f32 v196, v196, v197
    v_mov_b32 v197, v196
    s_nop 1
    v_permlane16_swap_b32 v196, v197
    v_max_f32 v196, v196, v197
    v_mov_b32 v197, v196
    s_nop 1
    v_permlane32_swap_b32 v196, v197
    v_max_f32 v196, v196, v197
    v_mul_f32 v196, s68, v196
    v_fma_f32 v112, v112, s68, -v196
    v_fma_f32 v113, v113, s68, -v196
    v_fma_f32 v114, v114, s68, -v196
    v_fma_f32 v115, v115, s68, -v196
    v_fma_f32 v116, v116, s68, -v196
    v_fma_f32 v117, v117, s68, -v196
    v_fma_f32 v118, v118, s68, -v196
    v_fma_f32 v119, v119, s68, -v196
    v_exp_f32 v112, v112
    v_exp_f32 v113, v113
    v_exp_f32 v114, v114
    v_exp_f32 v115, v115
    v_exp_f32 v116, v116
    v_exp_f32 v117, v117
    v_exp_f32 v118, v118
    v_exp_f32 v119, v119
    v_cvt_pk_bf16_f32 v120, v112, v113
    v_cvt_pk_bf16_f32 v121, v114, v115
    v_cvt_pk_bf16_f32 v122, v116, v117
    v_cvt_pk_bf16_f32 v123, v118, v119
    v_add_f32 v197, v112, v113
    v_add_f32 v197, v197, v114
    v_add_f32 v197, v197, v115
    v_add_f32 v197, v197, v116
    v_add_f32 v197, v197, v117
    v_add_f32 v197, v197, v118
    v_add_f32 v197, v197, v119
    v_mfma_f32_16x16x32_bf16 v[128:131], v[80:83], v[120:123], 0
    v_mfma_f32_16x16x32_bf16 v[132:135], v[84:87], v[120:123], 0
    v_mfma_f32_16x16x32_bf16 v[136:139], v[88:91], v[120:123], 0
    v_mfma_f32_16x16x32_bf16 v[140:143], v[92:95], v[120:123], 0
    v_mfma_f32_16x16x32_bf16 v[144:147], v[96:99], v[120:123], 0
    v_mfma_f32_16x16x32_bf16 v[148:151], v[100:103], v[120:123], 0
    v_mfma_f32_16x16x32_bf16 v[152:155], v[104:107], v[120:123], 0
    v_mfma_f32_16x16x32_bf16 v[156:159], v[108:111], v[120:123], 0
    s_barrier
    s_lshl_b32 s61, s60, 22
    s_lshl_b32 s62, s64, 17
    s_add_u32 s61, s61, s62
    s_add_u32 s62, s61, 0x1800000
    s_add_u32 s61, s61, 0x1000000
    buffer_load_dwordx4 v[160:163], v7, s[32:35], s61 offen offset:0 sc1
    buffer_load_dwordx4 v[164:167], v7, s[32:35], s61 offen offset:512 sc1
    buffer_load_dwordx4 v[168:171], v7, s[32:35], s61 offen offset:1024 sc1
    buffer_load_dwordx4 v[172:175], v7, s[32:35], s61 offen offset:1536 sc1
    buffer_load_dwordx4 v[176:179], v8, s[32:35], s62 offen offset:0 sc1
    buffer_load_dwordx4 v[180:183], v8, s[32:35], s62 offen offset:512 sc1
    buffer_load_dwordx4 v[184:187], v8, s[32:35], s62 offen offset:1024 sc1
    buffer_load_dwordx4 v[188:191], v8, s[32:35], s62 offen offset:1536 sc1
    s_waitcnt vmcnt(0)
Laol_226:
    s_add_u32 s72, s64, 1
    s_waitcnt vmcnt(4)
    v_max3_u32 v112, v160, v164, v168
    v_max3_u32 v113, v172, v176, v180
    v_max3_u32 v112, v112, v184, v188
    v_max_u32 v112, v112, v113
    v_cmp_eq_u32 vcc, -1, v112
    s_cbranch_vccz LaoA_227
    s_mov_b32 s62, 0
Laq_231:
    s_cmp_eq_u32 s71, 0
    s_cbranch_scc1 Laq_230
    s_add_u32 s99, s99, 1
    s_cmp_gt_u32 s99, 0x2dc6c0
    s_cbranch_scc0 Lto_232
    s_mov_b32 s3, 22
    s_branch L_abort
Lto_232:
    s_cmp_eq_u32 s71, 2
    s_cbranch_scc1 Laq_229
    s_lshl_b32 s63, s101, 16
    buffer_load_dwordx4 v[64:67], v13, s[44:47], s63 offen sc1
    buffer_load_dwordx4 v[48:51], v12, s[32:35], s100 offen sc1
    s_add_u32 s74, s100, 0x20000
    buffer_load_dwordx4 v[52:55], v12, s[32:35], s74 offen sc1
    s_add_u32 s74, s100, 0x40000
    buffer_load_dwordx4 v[56:59], v12, s[32:35], s74 offen sc1
    s_add_u32 s74, s100, 0x60000
    buffer_load_dwordx4 v[60:63], v12, s[32:35], s74 offen sc1
    s_waitcnt vmcnt(0)
    v_mfma_f32_16x16x32_bf16 v[72:75], v[16:19], v[48:51], 0
    v_mfma_f32_16x16x32_bf16 v[72:75], v[16:19], v[52:55], v[72:75]
    v_mfma_f32_16x16x32_bf16 v[72:75], v[20:23], v[56:59], v[72:75]
    v_mfma_f32_16x16x32_bf16 v[72:75], v[20:23], v[60:63], v[72:75]
    v_xor_b32 v68, s70, v48
    v_xor_b32 v69, s70, v52
    v_xor_b32 v70, s70, v56
    v_xor_b32 v71, s70, v60
    v_or3_b32 v68, v68, v69, v70
    v_or_b32 v68, v68, v71
    v_and_b32 v68, 1, v68
    v_cmp_ne_u32 s[18:19], 0, v68
    v_cmp_eq_u32 vcc, -1, v64
    s_or_b64 s[18:19], s[18:19], vcc
    s_cmp_eq_u64 s[18:19], 0
    s_cselect_b32 s67, s71, 0
    s_and_b32 s67, s67, 1
    v_permlane16_swap_b32 v64, v66
    v_permlane16_swap_b32 v65, v67
    v_lshlrev_b32 v68, 16, v64
    v_and_b32 v69, 0xffff0000, v64
    v_lshlrev_b32 v70, 16, v65
    v_and_b32 v71, 0xffff0000, v65
    v_add_f32 v72, v72, v68
    v_add_f32 v73, v73, v69
    v_add_f32 v74, v74, v70
    v_add_f32 v75, v75, v71
    v_cvt_pk_bf16_f32 v64, v72, v73
    v_cvt_pk_bf16_f32 v65, v74, v75
    v_lshlrev_b32 v72, 16, v64
    v_and_b32 v73, 0xffff0000, v64
    v_lshlrev_b32 v74, 16, v65
    v_and_b32 v75, 0xffff0000, v65
    v_add_f32 v68, v72, v73
    v_add_f32 v69, v74, v75
    v_add_f32 v68, v68, v69
    v_mul_f32 v69, v72, v72
    v_fmac_f32 v69, v73, v73
    v_fmac_f32 v69, v74, v74
    v_fmac_f32 v69, v75, v75
    v_add_f32 v68, v68, v68 row_ror:8 row_mask:0xf bank_mask:0xf
    s_nop 0
    v_add_f32 v69, v69, v69 row_ror:8 row_mask:0xf bank_mask:0xf
    v_add_f32 v68, v68, v68 row_ror:4 row_mask:0xf bank_mask:0xf
    s_nop 0
    v_add_f32 v69, v69, v69 row_ror:4 row_mask:0xf bank_mask:0xf
    v_add_f32 v68, v68, v68 row_ror:2 row_mask:0xf bank_mask:0xf
    s_nop 0
    v_add_f32 v69, v69, v69 row_ror:2 row_mask:0xf bank_mask:0xf
    v_add_f32 v68, v68, v68 row_ror:1 row_mask:0xf bank_mask:0xf
    s_nop 0
    v_add_f32 v69, v69, v69 row_ror:1 row_mask:0xf bank_mask:0xf
    v_mov_b64 v[70:71], v[68:69]
    s_nop 1
    v_permlane16_swap_b32 v68, v70
    v_permlane16_swap_b32 v69, v71
    v_add_f32 v68, v68, v70
    v_add_f32 v69, v69, v71
    s_add_u32 s16, s101, 1
    v_mov_b32 v70, s16
    s_and_b32 s3, s101, 1
    s_lshl_b32 s3, s3, 7
    v_add_u32 v48, s3, v24
    s_mov_b32 exec_lo, s67
    s_mov_b32 exec_hi, s67
    ds_write_b96 v48, v[68:70]
    s_mov_b64 exec, -1
    v_mov_b64 v[66:67], v[64:65]
    s_nop 1
    v_permlane16_swap_b32 v64, v66
    v_permlane16_swap_b32 v65, v67
    s_lshl_b32 s61, s60, 21
    s_lshl_b32 s63, s101, 16
    s_add_u32 s61, s61, s63
    s_add_u32 s61, s61, 0x400000
    s_mul_i32 s3, s67, 0xffff
    s_mov_b32 exec_lo, s3
    s_mov_b32 exec_hi, s3
    buffer_store_dwordx4 v[64:67], v13, s[32:35], s61 offen sc1
    s_sub_u32 s3, 0, s67
    s_mov_b32 exec_lo, s3
    s_mov_b32 exec_hi, s3
    v_mov_b64 v[192:193], v[72:73]
    v_mov_b64 v[194:195], v[74:75]
    s_mov_b64 exec, -1
    s_add_u32 s71, s71, s67
    s_waitcnt lgkmcnt(0)
    s_branch Laq_231
Laq_229:
    s_add_u32 s62, s62, 1
    s_cmp_gt_u32 s62, 5
    s_cbranch_scc1 Laq_230
    s_add_u32 s16, s101, 1
    s_and_b32 s3, s101, 1
    s_lshl_b32 s3, s3, 7
    v_add_u32 v48, s3, v29
    ds_read_b128 v[68:71], v48
    s_lshl_b32 s61, s60, 21
    s_lshl_b32 s63, s101, 16
    s_add_u32 s61, s61, s63
    s_add_u32 s17, s61, 0x800000
    s_cmp_eq_u32 s71, 2
    s_cselect_b32 s67, 1, 0
    s_waitcnt lgkmcnt(0)
    v_cmp_ne_u32 vcc, s16, v70
    s_cmp_eq_u64 vcc, 0
    s_cselect_b32 s67, s67, 0
    v_add_f32 v68, v68, v68 quad_perm:[1,0,3,2] row_mask:0xf bank_mask:0xf
    v_add_f32 v69, v69, v69 quad_perm:[1,0,3,2] row_mask:0xf bank_mask:0xf
    s_nop 0
    v_add_f32 v68, v68, v68 quad_perm:[2,3,0,1] row_mask:0xf bank_mask:0xf
    v_add_f32 v69, v69, v69 quad_perm:[2,3,0,1] row_mask:0xf bank_mask:0xf
    v_mul_f32 v68, 0x3b000000, v68
    v_mul_f32 v70, v68, v68
    v_fma_f32 v69, v69, s94, -v70
    v_max_f32 v69, 0, v69
    v_add_f32 v69, 0x3727c5ac, v69
    v_rsq_f32 v69, v69
    v_sub_f32 v52, v192, v68
    v_sub_f32 v53, v193, v68
    v_sub_f32 v54, v194, v68
    v_sub_f32 v55, v195, v68
    v_mul_f32 v52, v52, v69
    v_mul_f32 v53, v53, v69
    v_mul_f32 v54, v54, v69
    v_mul_f32 v55, v55, v69
    v_cvt_pk_bf16_f32 v48, v52, v53
    v_cvt_pk_bf16_f32 v49, v54, v55
    v_mov_b64 v[50:51], v[48:49]
    s_nop 1
    v_permlane16_swap_b32 v48, v50
    v_permlane16_swap_b32 v49, v51
    s_mul_i32 s3, s67, 0xffff
    s_mov_b32 exec_lo, s3
    s_mov_b32 exec_hi, s3
    buffer_store_dwordx4 v[48:51], v13, s[32:35], s17 offen sc1
    s_mov_b64 exec, -1
    s_cmp_eq_u32 s67, 1
    s_cselect_b32 s71, 0, s71
    s_waitcnt lgkmcnt(0)
    s_branch Laq_231
Laq_230:
    s_nop 0
Lakm_228:
    s_cmp_lg_u32 s71, 2
    s_cbranch_scc1 Laq_233
    s_add_u32 s16, s101, 1
    s_and_b32 s3, s101, 1
    s_lshl_b32 s3, s3, 7
    v_add_u32 v48, s3, v29
    ds_read_b128 v[68:71], v48
    s_lshl_b32 s61, s60, 21
    s_lshl_b32 s63, s101, 16
    s_add_u32 s61, s61, s63
    s_add_u32 s17, s61, 0x800000
    s_cmp_eq_u32 s71, 2
    s_cselect_b32 s67, 1, 0
    s_waitcnt lgkmcnt(0)
    v_cmp_ne_u32 vcc, s16, v70
    s_cmp_eq_u64 vcc, 0
    s_cselect_b32 s67, s67, 0
    v_add_f32 v68, v68, v68 quad_perm:[1,0,3,2] row_mask:0xf bank_mask:0xf
    v_add_f32 v69, v69, v69 quad_perm:[1,0,3,2] row_mask:0xf bank_mask:0xf
    s_nop 0
    v_add_f32 v68, v68, v68 quad_perm:[2,3,0,1] row_mask:0xf bank_mask:0xf
    v_add_f32 v69, v69, v69 quad_perm:[2,3,0,1] row_mask:0xf bank_mask:0xf
    v_mul_f32 v68, 0x3b000000, v68
    v_mul_f32 v70, v68, v68
    v_fma_f32 v69, v69, s94, -v70
    v_max_f32 v69, 0, v69
    v_add_f32 v69, 0x3727c5ac, v69
    v_rsq_f32 v69, v69
    v_sub_f32 v52, v192, v68
    v_sub_f32 v53, v193, v68
    v_sub_f32 v54, v194, v68
    v_sub_f32 v55, v195, v68
    v_mul_f32 v52, v52, v69
    v_mul_f32 v53, v53, v69
    v_mul_f32 v54, v54, v69
    v_mul_f32 v55, v55, v69
    v_cvt_pk_bf16_f32 v48, v52, v53
    v_cvt_pk_bf16_f32 v49, v54, v55
    v_mov_b64 v[50:51], v[48:49]
    s_nop 1
    v_permlane16_swap_b32 v48, v50
    v_permlane16_swap_b32 v49, v51
    s_mul_i32 s3, s67, 0xffff
    s_mov_b32 exec_lo, s3
    s_mov_b32 exec_hi, s3
    buffer_store_dwordx4 v[48:51], v13, s[32:35], s17 offen sc1
    s_mov_b64 exec, -1
    s_cmp_eq_u32 s67, 1
    s_cselect_b32 s71, 0, s71
    s_waitcnt lgkmcnt(0)
Laq_233:
    s_lshl_b32 s61, s60, 22
    s_lshl_b32 s62, s64, 17
    s_add_u32 s61, s61, s62
    s_add_u32 s62, s61, 0x1800000
    s_add_u32 s61, s61, 0x1000000
    buffer_load_dwordx4 v[160:163], v7, s[32:35], s61 offen offset:0 sc1
    buffer_load_dwordx4 v[164:167], v7, s[32:35], s61 offen offset:512 sc1
    buffer_load_dwordx4 v[168:171], v7, s[32:35], s61 offen offset:1024 sc1
    buffer_load_dwordx4 v[172:175], v7, s[32:35], s61 offen offset:1536 sc1
    buffer_load_dwordx4 v[176:179], v8, s[32:35], s62 offen offset:0 sc1
    buffer_load_dwordx4 v[180:183], v8, s[32:35], s62 offen offset:512 sc1
    buffer_load_dwordx4 v[184:187], v8, s[32:35], s62 offen offset:1024 sc1
    buffer_load_dwordx4 v[188:191], v8, s[32:35], s62 offen offset:1536 sc1
    s_sleep 2
    s_add_u32 s99, s99, 1
    s_cmp_gt_u32 s99, 0x2dc6c0
    s_cbranch_scc0 Lto_234
    s_mov_b32 s3, 21
    s_branch L_abort
Lto_234:
    s_waitcnt vmcnt(0)
    v_max3_u32 v112, v160, v164, v168
    v_max3_u32 v113, v172, v176, v180
    v_max3_u32 v112, v112, v184, v188
    v_max_u32 v112, v112, v113
    v_cmp_eq_u32 vcc, -1, v112
    s_cbranch_vccnz Lakm_228
LaoA_227:
    s_nop 3
    v_mfma_f32_16x16x32_bf16 v[120:123], v[160:163], v[32:35], 0
    v_mfma_f32_16x16x32_bf16 v[120:123], v[164:167], v[36:39], v[120:123]
    v_mfma_f32_16x16x32_bf16 v[120:123], v[168:171], v[40:43], v[120:123]
    v_mfma_f32_16x16x32_bf16 v[120:123], v[172:175], v[44:47], v[120:123]
    s_lshr_b32 s75, s64, 1
    s_and_b32 s75, s75, 1
    s_and_b32 s3, s64, 1
    s_lshl_b32 s3, s3, 19
    s_lshl_b32 s61, s60, 21
    s_add_u32 s61, s61, s3
    s_add_u32 s98, s61, 0x8000000
    s_add_u32 s95, s98, 0x100000
    v_cndmask_b32 v120, v15, v120, s[92:93]
    v_cndmask_b32 v121, v15, v121, s[92:93]
    v_cndmask_b32 v122, v15, v122, s[92:93]
    v_cndmask_b32 v123, v15, v123, s[92:93]
    v_max3_f32 v112, v120, v121, v122
    v_max_f32 v112, v112, v123
    v_mov_b32 v114, v112
    s_nop 1
    v_permlane16_swap_b32 v112, v114
    v_max_f32 v112, v112, v114
    v_mov_b32 v114, v112
    s_nop 1
    v_permlane32_swap_b32 v112, v114
    v_max_f32 v112, v112, v114
    v_mul_f32 v112, s68, v112
    v_max_f32 v112, v112, v196
    v_sub_f32 v113, v196, v112
    v_fma_f32 v120, v120, s68, -v112
    v_fma_f32 v121, v121, s68, -v112
    v_fma_f32 v122, v122, s68, -v112
    v_fma_f32 v123, v123, s68, -v112
    v_exp_f32 v113, v113
    v_exp_f32 v120, v120
    v_exp_f32 v121, v121
    v_exp_f32 v122, v122
    v_exp_f32 v123, v123
    v_mul_f32 v197, v197, v113
    v_add_f32 v197, v197, v120
    v_add_f32 v197, v197, v121
    v_add_f32 v197, v197, v122
    v_add_f32 v197, v197, v123
    v_mov_b32 v114, v197
    s_nop 1
    v_permlane16_swap_b32 v197, v114
    v_add_f32 v197, v197, v114
    v_mov_b32 v114, v197
    s_nop 1
    v_permlane32_swap_b32 v197, v114
    v_add_f32 v197, v197, v114
    v_rcp_f32 v197, v197
    s_nop 0
    v_mul_f32 v113, v113, v197
    v_mov_b32 v112, v113
    v_mul_f32 v120, v120, v197
    v_mul_f32 v121, v121, v197
    v_mul_f32 v122, v122, v197
    v_mul_f32 v123, v123, v197
    v_cvt_pk_bf16_f32 v116, v120, v121
    v_cvt_pk_bf16_f32 v117, v122, v123
    s_add_u32 s74, s95, 4096
    v_pk_mul_f32 v[128:129], v[128:129], v[112:113]
    v_pk_mul_f32 v[130:131], v[130:131], v[112:113]
    v_pk_mul_f32 v[132:133], v[132:133], v[112:113]
    v_pk_mul_f32 v[134:135], v[134:135], v[112:113]
    v_pk_mul_f32 v[136:137], v[136:137], v[112:113]
    v_pk_mul_f32 v[138:139], v[138:139], v[112:113]
    v_pk_mul_f32 v[140:141], v[140:141], v[112:113]
    v_pk_mul_f32 v[142:143], v[142:143], v[112:113]
    v_pk_mul_f32 v[144:145], v[144:145], v[112:113]
    v_pk_mul_f32 v[146:147], v[146:147], v[112:113]
    v_pk_mul_f32 v[148:149], v[148:149], v[112:113]
    v_pk_mul_f32 v[150:151], v[150:151], v[112:113]
    v_pk_mul_f32 v[152:153], v[152:153], v[112:113]
    v_pk_mul_f32 v[154:155], v[154:155], v[112:113]
    v_pk_mul_f32 v[156:157], v[156:157], v[112:113]
    v_pk_mul_f32 v[158:159], v[158:159], v[112:113]
    v_mfma_f32_16x16x16_bf16 v[128:131], v[176:177], v[116:117], v[128:131]
    v_mfma_f32_16x16x16_bf16 v[132:135], v[178:179], v[116:117], v[132:135]
    v_mfma_f32_16x16x16_bf16 v[136:139], v[180:181], v[116:117], v[136:139]
    v_mfma_f32_16x16x16_bf16 v[140:143], v[182:183], v[116:117], v[140:143]
    v_mfma_f32_16x16x16_bf16 v[144:147], v[184:185], v[116:117], v[144:147]
    v_mfma_f32_16x16x16_bf16 v[148:151], v[186:187], v[116:117], v[148:151]
    v_mfma_f32_16x16x16_bf16 v[152:155], v[188:189], v[116:117], v[152:155]
    v_mfma_f32_16x16x16_bf16 v[156:159], v[190:191], v[116:117], v[156:159]
    s_nop 1
    v_cvt_pk_bf16_f32 v160, v128, v132
    v_cvt_pk_bf16_f32 v161, v129, v133
    v_cvt_pk_bf16_f32 v162, v130, v134
    v_cvt_pk_bf16_f32 v163, v131, v135
    v_bfi_b32 v160, 1, s75, v160
    buffer_store_dwordx4 v[160:163], v9, s[32:35], s95 offen offset:0
    v_cvt_pk_bf16_f32 v164, v136, v140
    v_cvt_pk_bf16_f32 v165, v137, v141
    v_cvt_pk_bf16_f32 v166, v138, v142
    v_cvt_pk_bf16_f32 v167, v139, v143
    v_bfi_b32 v164, 1, s75, v164
    buffer_store_dwordx4 v[164:167], v9, s[32:35], s95 offen offset:2048
    v_cvt_pk_bf16_f32 v168, v144, v148
    v_cvt_pk_bf16_f32 v169, v145, v149
    v_cvt_pk_bf16_f32 v170, v146, v150
    v_cvt_pk_bf16_f32 v171, v147, v151
    v_bfi_b32 v168, 1, s75, v168
    buffer_store_dwordx4 v[168:171], v9, s[32:35], s74 offen offset:0
    v_cvt_pk_bf16_f32 v172, v152, v156
    v_cvt_pk_bf16_f32 v173, v153, v157
    v_cvt_pk_bf16_f32 v174, v154, v158
    v_cvt_pk_bf16_f32 v175, v155, v159
    v_bfi_b32 v172, 1, s75, v172
    buffer_store_dwordx4 v[172:175], v9, s[32:35], s74 offen offset:2048
    s_cmp_ge_u32 s69, s72
    s_cbranch_scc1 Laoh_235
    s_mov_b32 s3, s72
    s_min_u32 s3, s3, 31
    s_lshl_b32 s3, s3, 11
    s_add_u32 s74, s3, s73
    s_mov_b32 s67, 0
Lpg_236:
    buffer_load_dword v112, v14, s[32:35], s74 offen sc1
    s_sleep 2
    s_add_u32 s99, s99, 1
    s_cmp_gt_u32 s99, 0x2dc6c0
    s_cbranch_scc0 Lto_237
    s_mov_b32 s3, 20
    s_branch L_abort
Lto_237:
    s_waitcnt vmcnt(0)
    v_cmp_ge_u32 vcc, s67, v112
    s_and_b32 vcc_lo, vcc_lo, 0xffff
    s_and_b32 vcc_hi, vcc_hi, 0x0
    s_or_b32 s3, vcc_lo, vcc_hi
    s_cbranch_scc1 Lpg_236
    s_min_u32 s62, s72, 31
    s_lshl_b32 s61, s60, 24
    s_lshl_b32 s62, s62, 19
    s_add_u32 s61, s61, s62
    s_lshl_b32 s74, s56, 11
    s_add_u32 s62, s61, 0x2000000
    s_add_u32 m0, s74, 86272
    s_nop 0
    buffer_load_dwordx4 v4, s[32:35], s62 offen offset:0 lds
    buffer_load_dwordx4 v4, s[32:35], s62 offen offset:1024 lds
    s_add_u32 s62, s61, 0x4000000
    s_add_u32 m0, s74, 94464
    s_nop 0
    buffer_load_dwordx4 v4, s[32:35], s62 offen offset:0 lds
    buffer_load_dwordx4 v4, s[32:35], s62 offen offset:1024 lds
    s_add_u32 s62, s61, 0x6000000
    s_add_u32 m0, s74, 102656
    s_nop 0
    buffer_load_dwordx4 v4, s[32:35], s62 offen offset:0 lds
    buffer_load_dwordx4 v4, s[32:35], s62 offen offset:1024 lds
    s_add_u32 s62, s61, 0x2040000
    s_add_u32 m0, s74, 110848
    s_nop 0
    buffer_load_dwordx4 v4, s[32:35], s62 offen offset:0 lds
    buffer_load_dwordx4 v4, s[32:35], s62 offen offset:1024 lds
    s_add_u32 s62, s61, 0x4040000
    s_add_u32 m0, s74, 119040
    s_nop 0
    buffer_load_dwordx4 v4, s[32:35], s62 offen offset:0 lds
    buffer_load_dwordx4 v4, s[32:35], s62 offen offset:1024 lds
    s_add_u32 s62, s61, 0x6040000
    s_add_u32 m0, s74, 127232
    s_nop 0
    buffer_load_dwordx4 v4, s[32:35], s62 offen offset:0 lds
    buffer_load_dwordx4 v4, s[32:35], s62 offen offset:1024 lds
    s_mov_b32 s69, s72
Laoh_235:
    s_mov_b32 s66, 0
Laop_239:
    s_mov_b64 exec, 15
    buffer_load_dword v112, v31, s[32:35], s95 offen sc1
    s_mov_b64 exec, -1
    s_add_u32 s99, s99, 1
    s_cmp_gt_u32 s99, 0x2dc6c0
    s_cbranch_scc0 Lto_241
    s_mov_b32 s3, 28
    s_branch L_abort
Lto_241:
    s_waitcnt vmcnt(0)
    v_xor_b32 v112, s75, v112
    v_and_b32 v112, 1, v112
    v_cmp_ne_u32 vcc, 0, v112
    s_and_b32 s3, vcc_lo, 15
    s_cbranch_scc0 Laox_238
    s_cmp_lg_u32 s71, 2
    s_cbranch_scc1 Laq_242
    s_add_u32 s16, s101, 1
    s_and_b32 s3, s101, 1
    s_lshl_b32 s3, s3, 7
    v_add_u32 v48, s3, v29
    ds_read_b128 v[68:71], v48
    s_lshl_b32 s61, s60, 21
    s_lshl_b32 s63, s101, 16
    s_add_u32 s61, s61, s63
    s_add_u32 s17, s61, 0x800000
    s_cmp_eq_u32 s71, 2
    s_cselect_b32 s67, 1, 0
    s_waitcnt lgkmcnt(0)
    v_cmp_ne_u32 vcc, s16, v70
    s_cmp_eq_u64 vcc, 0
    s_cselect_b32 s67, s67, 0
    v_add_f32 v68, v68, v68 quad_perm:[1,0,3,2] row_mask:0xf bank_mask:0xf
    v_add_f32 v69, v69, v69 quad_perm:[1,0,3,2] row_mask:0xf bank_mask:0xf
    s_nop 0
    v_add_f32 v68, v68, v68 quad_perm:[2,3,0,1] row_mask:0xf bank_mask:0xf
    v_add_f32 v69, v69, v69 quad_perm:[2,3,0,1] row_mask:0xf bank_mask:0xf
    v_mul_f32 v68, 0x3b000000, v68
    v_mul_f32 v70, v68, v68
    v_fma_f32 v69, v69, s94, -v70
    v_max_f32 v69, 0, v69
    v_add_f32 v69, 0x3727c5ac, v69
    v_rsq_f32 v69, v69
    v_sub_f32 v52, v192, v68
    v_sub_f32 v53, v193, v68
    v_sub_f32 v54, v194, v68
    v_sub_f32 v55, v195, v68
    v_mul_f32 v52, v52, v69
    v_mul_f32 v53, v53, v69
    v_mul_f32 v54, v54, v69
    v_mul_f32 v55, v55, v69
    v_cvt_pk_bf16_f32 v48, v52, v53
    v_cvt_pk_bf16_f32 v49, v54, v55
    v_mov_b64 v[50:51], v[48:49]
    s_nop 1
    v_permlane16_swap_b32 v48, v50
    v_permlane16_swap_b32 v49, v51
    s_mul_i32 s3, s67, 0xffff
    s_mov_b32 exec_lo, s3
    s_mov_b32 exec_hi, s3
    buffer_store_dwordx4 v[48:51], v13, s[32:35], s17 offen sc1
    s_mov_b64 exec, -1
    s_cmp_eq_u32 s67, 1
    s_cselect_b32 s71, 0, s71
    s_waitcnt lgkmcnt(0)
Laq_242:
    s_nop 0
    s_add_u32 s66, s66, 1
    s_cmp_lg_u32 s66, 6
    s_cbranch_scc1 Laop_239
    s_mov_b32 s62, 0
Laq_245:
    s_cmp_eq_u32 s71, 0
    s_cbranch_scc1 Laq_244
    s_add_u32 s99, s99, 1
    s_cmp_gt_u32 s99, 0x2dc6c0
    s_cbranch_scc0 Lto_246
    s_mov_b32 s3, 22
    s_branch L_abort
Lto_246:
    s_cmp_eq_u32 s71, 2
    s_cbranch_scc1 Laq_243
    s_lshl_b32 s63, s101, 16
    buffer_load_dwordx4 v[64:67], v13, s[44:47], s63 offen sc1
    buffer_load_dwordx4 v[48:51], v12, s[32:35], s100 offen sc1
    s_add_u32 s74, s100, 0x20000
    buffer_load_dwordx4 v[52:55], v12, s[32:35], s74 offen sc1
    s_add_u32 s74, s100, 0x40000
    buffer_load_dwordx4 v[56:59], v12, s[32:35], s74 offen sc1
    s_add_u32 s74, s100, 0x60000
    buffer_load_dwordx4 v[60:63], v12, s[32:35], s74 offen sc1
    s_waitcnt vmcnt(0)
    v_mfma_f32_16x16x32_bf16 v[72:75], v[16:19], v[48:51], 0
    v_mfma_f32_16x16x32_bf16 v[72:75], v[16:19], v[52:55], v[72:75]
    v_mfma_f32_16x16x32_bf16 v[72:75], v[20:23], v[56:59], v[72:75]
    v_mfma_f32_16x16x32_bf16 v[72:75], v[20:23], v[60:63], v[72:75]
    v_xor_b32 v68, s70, v48
    v_xor_b32 v69, s70, v52
    v_xor_b32 v70, s70, v56
    v_xor_b32 v71, s70, v60
    v_or3_b32 v68, v68, v69, v70
    v_or_b32 v68, v68, v71
    v_and_b32 v68, 1, v68
    v_cmp_ne_u32 s[18:19], 0, v68
    v_cmp_eq_u32 vcc, -1, v64
    s_or_b64 s[18:19], s[18:19], vcc
    s_cmp_eq_u64 s[18:19], 0
    s_cselect_b32 s67, s71, 0
    s_and_b32 s67, s67, 1
    v_permlane16_swap_b32 v64, v66
    v_permlane16_swap_b32 v65, v67
    v_lshlrev_b32 v68, 16, v64
    v_and_b32 v69, 0xffff0000, v64
    v_lshlrev_b32 v70, 16, v65
    v_and_b32 v71, 0xffff0000, v65
    v_add_f32 v72, v72, v68
    v_add_f32 v73, v73, v69
    v_add_f32 v74, v74, v70
    v_add_f32 v75, v75, v71
    v_cvt_pk_bf16_f32 v64, v72, v73
    v_cvt_pk_bf16_f32 v65, v74, v75
    v_lshlrev_b32 v72, 16, v64
    v_and_b32 v73, 0xffff0000, v64
    v_lshlrev_b32 v74, 16, v65
    v_and_b32 v75, 0xffff0000, v65
    v_add_f32 v68, v72, v73
    v_add_f32 v69, v74, v75
    v_add_f32 v68, v68, v69
    v_mul_f32 v69, v72, v72
    v_fmac_f32 v69, v73, v73
    v_fmac_f32 v69, v74, v74
    v_fmac_f32 v69, v75, v75
    v_add_f32 v68, v68, v68 row_ror:8 row_mask:0xf bank_mask:0xf
    s_nop 0
    v_add_f32 v69, v69, v69 row_ror:8 row_mask:0xf bank_mask:0xf
    v_add_f32 v68, v68, v68 row_ror:4 row_mask:0xf bank_mask:0xf
    s_nop 0
    v_add_f32 v69, v69, v69 row_ror:4 row_mask:0xf bank_mask:0xf
    v_add_f32 v68, v68, v68 row_ror:2 row_mask:0xf bank_mask:0xf
    s_nop 0
    v_add_f32 v69, v69, v69 row_ror:2 row_mask:0xf bank_mask:0xf
    v_add_f32 v68, v68, v68 row_ror:1 row_mask:0xf bank_mask:0xf
    s_nop 0
    v_add_f32 v69, v69, v69 row_ror:1 row_mask:0xf bank_mask:0xf
    v_mov_b64 v[70:71], v[68:69]
    s_nop 1
    v_permlane16_swap_b32 v68, v70
    v_permlane16_swap_b32 v69, v71
    v_add_f32 v68, v68, v70
    v_add_f32 v69, v69, v71
    s_add_u32 s16, s101, 1
    v_mov_b32 v70, s16
    s_and_b32 s3, s101, 1
    s_lshl_b32 s3, s3, 7
    v_add_u32 v48, s3, v24
    s_mov_b32 exec_lo, s67
    s_mov_b32 exec_hi, s67
    ds_write_b96 v48, v[68:70]
    s_mov_b64 exec, -1
    v_mov_b64 v[66:67], v[64:65]
    s_nop 1
    v_permlane16_swap_b32 v64, v66
    v_permlane16_swap_b32 v65, v67
    s_lshl_b32 s61, s60, 21
    s_lshl_b32 s63, s101, 16
    s_add_u32 s61, s61, s63
    s_add_u32 s61, s61, 0x400000
    s_mul_i32 s3, s67, 0xffff
    s_mov_b32 exec_lo, s3
    s_mov_b32 exec_hi, s3
    buffer_store_dwordx4 v[64:67], v13, s[32:35], s61 offen sc1
    s_sub_u32 s3, 0, s67
    s_mov_b32 exec_lo, s3
    s_mov_b32 exec_hi, s3
    v_mov_b64 v[192:193], v[72:73]
    v_mov_b64 v[194:195], v[74:75]
    s_mov_b64 exec, -1
    s_add_u32 s71, s71, s67
    s_waitcnt lgkmcnt(0)
    s_branch Laq_245
Laq_243:
    s_add_u32 s62, s62, 1
    s_cmp_gt_u32 s62, 5
    s_cbranch_scc1 Laq_244
    s_add_u32 s16, s101, 1
    s_and_b32 s3, s101, 1
    s_lshl_b32 s3, s3, 7
    v_add_u32 v48, s3, v29
    ds_read_b128 v[68:71], v48
    s_lshl_b32 s61, s60, 21
    s_lshl_b32 s63, s101, 16
    s_add_u32 s61, s61, s63
    s_add_u32 s17, s61, 0x800000
    s_cmp_eq_u32 s71, 2
    s_cselect_b32 s67, 1, 0
    s_waitcnt lgkmcnt(0)
    v_cmp_ne_u32 vcc, s16, v70
    s_cmp_eq_u64 vcc, 0
    s_cselect_b32 s67, s67, 0
    v_add_f32 v68, v68, v68 quad_perm:[1,0,3,2] row_mask:0xf bank_mask:0xf
    v_add_f32 v69, v69, v69 quad_perm:[1,0,3,2] row_mask:0xf bank_mask:0xf
    s_nop 0
    v_add_f32 v68, v68, v68 quad_perm:[2,3,0,1] row_mask:0xf bank_mask:0xf
    v_add_f32 v69, v69, v69 quad_perm:[2,3,0,1] row_mask:0xf bank_mask:0xf
    v_mul_f32 v68, 0x3b000000, v68
    v_mul_f32 v70, v68, v68
    v_fma_f32 v69, v69, s94, -v70
    v_max_f32 v69, 0, v69
    v_add_f32 v69, 0x3727c5ac, v69
    v_rsq_f32 v69, v69
    v_sub_f32 v52, v192, v68
    v_sub_f32 v53, v193, v68
    v_sub_f32 v54, v194, v68
    v_sub_f32 v55, v195, v68
    v_mul_f32 v52, v52, v69
    v_mul_f32 v53, v53, v69
    v_mul_f32 v54, v54, v69
    v_mul_f32 v55, v55, v69
    v_cvt_pk_bf16_f32 v48, v52, v53
    v_cvt_pk_bf16_f32 v49, v54, v55
    v_mov_b64 v[50:51], v[48:49]
    s_nop 1
    v_permlane16_swap_b32 v48, v50
    v_permlane16_swap_b32 v49, v51
    s_mul_i32 s3, s67, 0xffff
    s_mov_b32 exec_lo, s3
    s_mov_b32 exec_hi, s3
    buffer_store_dwordx4 v[48:51], v13, s[32:35], s17 offen sc1
    s_mov_b64 exec, -1
    s_cmp_eq_u32 s67, 1
    s_cselect_b32 s71, 0, s71
    s_waitcnt lgkmcnt(0)
    s_branch Laq_245
Laq_244:
    s_branch Laop_239
Laox_238:
    s_lshl_b32 s63, s56, 13
    s_add_u32 s74, s95, 0x0
    s_add_u32 m0, s63, 0
    s_nop 0
    buffer_load_dwordx4 v11, s[32:35], s74 offen offset:0 sc1 lds
    buffer_load_dwordx4 v11, s[32:35], s74 offen offset:1024 sc1 lds
    buffer_load_dwordx4 v11, s[32:35], s74 offen offset:2048 sc1 lds
    buffer_load_dwordx4 v11, s[32:35], s74 offen offset:3072 sc1 lds
    s_add_u32 s74, s95, 0x1000
    s_add_u32 m0, s63, 4096
    s_nop 0
    buffer_load_dwordx4 v11, s[32:35], s74 offen offset:0 sc1 lds
    buffer_load_dwordx4 v11, s[32:35], s74 offen offset:1024 sc1 lds
    buffer_load_dwordx4 v11, s[32:35], s74 offen offset:2048 sc1 lds
    buffer_load_dwordx4 v11, s[32:35], s74 offen offset:3072 sc1 lds
    s_add_u32 s74, s95, 0x40000
    s_add_u32 m0, s63, 32768
    s_nop 0
    buffer_load_dwordx4 v11, s[32:35], s74 offen offset:0 sc1 lds
    buffer_load_dwordx4 v11, s[32:35], s74 offen offset:1024 sc1 lds
    buffer_load_dwordx4 v11, s[32:35], s74 offen offset:2048 sc1 lds
    buffer_load_dwordx4 v11, s[32:35], s74 offen offset:3072 sc1 lds
    s_add_u32 s74, s95, 0x41000
    s_add_u32 m0, s63, 36864
    s_nop 0
    buffer_load_dwordx4 v11, s[32:35], s74 offen offset:0 sc1 lds
    buffer_load_dwordx4 v11, s[32:35], s74 offen offset:1024 sc1 lds
    buffer_load_dwordx4 v11, s[32:35], s74 offen offset:2048 sc1 lds
    buffer_load_dwordx4 v11, s[32:35], s74 offen offset:3072 sc1 lds
    s_add_u32 s99, s99, 1
    s_cmp_gt_u32 s99, 0x2dc6c0
    s_cbranch_scc0 Lto_247
    s_mov_b32 s3, 24
    s_branch L_abort
Lto_247:
    s_waitcnt vmcnt(0)
    ds_read_b32 v48, v25 offset:0
    ds_read_b32 v49, v25 offset:1024
    ds_read_b32 v50, v25 offset:2048
    ds_read_b32 v51, v25 offset:3072
    ds_read_b32 v52, v25 offset:4096
    ds_read_b32 v53, v25 offset:5120
    ds_read_b32 v54, v25 offset:6144
    ds_read_b32 v55, v25 offset:7168
    ds_read_b32 v56, v25 offset:32768
    ds_read_b32 v57, v25 offset:33792
    ds_read_b32 v58, v25 offset:34816
    ds_read_b32 v59, v25 offset:35840
    ds_read_b32 v60, v25 offset:36864
    ds_read_b32 v61, v25 offset:37888
    ds_read_b32 v62, v25 offset:38912
    ds_read_b32 v63, v25 offset:39936
    s_cmp_eq_u32 s75, 0
    s_waitcnt lgkmcnt(0)
    s_cbranch_scc0 Laot_248
    v_or3_b32 v48, v48, v49, v50
    v_or3_b32 v48, v48, v51, v52
    v_or3_b32 v48, v48, v53, v54
    v_or3_b32 v48, v48, v55, v56
    v_or3_b32 v48, v48, v57, v58
    v_or3_b32 v48, v48, v59, v60
    v_or3_b32 v48, v48, v61, v62
    v_or_b32 v48, v48, v63
    s_branch Laot_249
Laot_248:
    v_and_b32 v48, v48, v49
    v_and_b32 v48, v48, v50
    v_and_b32 v48, v48, v51
    v_and_b32 v48, v48, v52
    v_and_b32 v48, v48, v53
    v_and_b32 v48, v48, v54
    v_and_b32 v48, v48, v55
    v_and_b32 v48, v48, v56
    v_and_b32 v48, v48, v57
    v_and_b32 v48, v48, v58
    v_and_b32 v48, v48, v59
    v_and_b32 v48, v48, v60
    v_and_b32 v48, v48, v61
    v_and_b32 v48, v48, v62
    v_and_b32 v48, v48, v63
    v_not_b32 v48, v48
Laot_249:
    v_and_b32 v48, 1, v48
    v_cmp_ne_u32 vcc, 0, v48
    s_cbranch_vccnz Laox_238
    s_lshl_b32 s63, s101, 16
    buffer_load_dwordx4 v[176:179], v13, s[44:47], s63 offen sc1
    buffer_load_dwordx4 v[160:163], v12, s[32:35], s100 offen sc1
    s_add_u32 s74, s100, 0x20000
    buffer_load_dwordx4 v[164:167], v12, s[32:35], s74 offen sc1
    s_add_u32 s74, s100, 0x40000
    buffer_load_dwordx4 v[168:171], v12, s[32:35], s74 offen sc1
    s_add_u32 s74, s100, 0x60000
    buffer_load_dwordx4 v[172:175], v12, s[32:35], s74 offen sc1
    s_add_u32 s3, s64, 2
    s_min_u32 s3, s3, 31
    s_lshl_b32 s3, s3, 11
    s_add_u32 s74, s3, s73
    buffer_load_dword v30, v14, s[32:35], s74 offen sc1
    s_waitcnt lgkmcnt(0)
    s_barrier
    ds_read_b128 v[200:203], v10 offset:0
    ds_read_b128 v[204:207], v10 offset:32768
    ds_read_b128 v[208:211], v10 offset:1024
    ds_read_b128 v[212:215], v10 offset:33792
    ds_read_b128 v[216:219], v10 offset:2048
    s_min_u32 s65, s72, 31
    ds_read_b128 v[220:223], v10 offset:34816
    s_waitcnt lgkmcnt(4)
    v_mfma_f32_32x32x16_bf16 v[224:239], a[0:3], v[200:203], 0
    ds_read_b128 v[32:35], v5 offset:0
    ds_read_b128 v[48:51], v6 offset:8192
    ds_read_b128 v[64:67], v6 offset:12288
    ds_read_b128 v[200:203], v10 offset:3072
    v_mfma_f32_32x32x16_bf16 v[240:255], a[0:3], v[204:207], 0
    ds_read_b128 v[36:39], v5 offset:1024
    ds_read_b128 v[52:55], v6 offset:9216
    ds_read_b128 v[68:71], v6 offset:13312
    ds_read_b128 v[204:207], v10 offset:35840
    s_waitcnt lgkmcnt(10)
    v_mfma_f32_32x32x16_bf16 v[224:239], a[4:7], v[208:211], v[224:239]
    ds_read_b128 v[40:43], v5 offset:2048
    ds_read_b128 v[56:59], v6 offset:10240
    ds_read_b128 v[72:75], v6 offset:14336
    ds_read_b128 v[208:211], v10 offset:4096
    v_mfma_f32_32x32x16_bf16 v[240:255], a[4:7], v[212:215], v[240:255]
    ds_read_b128 v[44:47], v5 offset:3072
    ds_read_b128 v[60:63], v6 offset:11264
    ds_read_b128 v[76:79], v6 offset:15360
    ds_read_b128 v[212:215], v10 offset:36864
    s_waitcnt lgkmcnt(15)
    v_mfma_f32_32x32x16_bf16 v[224:239], a[8:11], v[216:219], v[224:239]
    ds_read_b128 v[80:83], v6 offset:16384
    ds_read_b128 v[84:87], v6 offset:17408
    ds_read_b128 v[88:91], v6 offset:18432
    ds_read_b128 v[216:219], v10 offset:5120
    v_mfma_f32_32x32x16_bf16 v[240:255], a[8:11], v[220:223], v[240:255]
    ds_read_b128 v[92:95], v6 offset:19456
    ds_read_b128 v[96:99], v6 offset:20480
    ds_read_b128 v[100:103], v6 offset:21504
    ds_read_b128 v[220:223], v10 offset:37888
    s_waitcnt lgkmcnt(15)
    v_mfma_f32_32x32x16_bf16 v[224:239], a[12:15], v[200:203], v[224:239]
    ds_read_b128 v[104:107], v6 offset:22528
    ds_read_b128 v[108:111], v6 offset:23552
    ds_read_b128 v[200:203], v10 offset:6144
    v_mfma_f32_32x32x16_bf16 v[240:255], a[12:15], v[204:207], v[240:255]
    ds_read_b128 v[204:207], v10 offset:38912
    s_waitcnt lgkmcnt(12)
    v_mfma_f32_32x32x16_bf16 v[224:239], a[16:19], v[208:211], v[224:239]
    s_waitcnt lgkmcnt(2)
    s_barrier
    v_mfma_f32_16x16x32_bf16 v[112:115], v[48:51], v[32:35], 0
    v_mfma_f32_16x16x32_bf16 v[116:119], v[64:67], v[32:35], 0
    v_mfma_f32_16x16x32_bf16 v[112:115], v[52:55], v[36:39], v[112:115]
    v_mfma_f32_16x16x32_bf16 v[116:119], v[68:71], v[36:39], v[116:119]
    v_mfma_f32_16x16x32_bf16 v[112:115], v[56:59], v[40:43], v[112:115]
    ds_read_b128 v[208:211], v10 offset:7168
    v_mfma_f32_32x32x16_bf16 v[240:255], a[16:19], v[212:215], v[240:255]
    v_mfma_f32_16x16x32_bf16 v[116:119], v[72:75], v[40:43], v[116:119]
    v_mfma_f32_16x16x32_bf16 v[112:115], v[60:63], v[44:47], v[112:115]
    v_mfma_f32_16x16x32_bf16 v[116:119], v[76:79], v[44:47], v[116:119]
    s_waitcnt vmcnt(0)
    ds_read_b128 v[212:215], v10 offset:39936
    v_mfma_f32_32x32x16_bf16 v[224:239], a[20:23], v[216:219], v[224:239]
    v_mfma_f32_16x16x32_bf16 v[184:187], v[16:19], v[160:163], 0
    v_mfma_f32_16x16x32_bf16 v[184:187], v[16:19], v[164:167], v[184:187]
    v_mfma_f32_16x16x32_bf16 v[184:187], v[20:23], v[168:171], v[184:187]
    v_mfma_f32_16x16x32_bf16 v[184:187], v[20:23], v[172:175], v[184:187]
    v_xor_b32 v180, s70, v160
    ds_read_b128 v[216:219], v10 offset:8192
    v_mfma_f32_32x32x16_bf16 v[240:255], a[20:23], v[220:223], v[240:255]
    v_xor_b32 v181, s70, v164
    v_xor_b32 v182, s70, v168
    v_xor_b32 v183, s70, v172
    v_or3_b32 v180, v180, v181, v182
    v_or_b32 v180, v180, v183
    ds_read_b128 v[220:223], v10 offset:40960
    s_waitcnt lgkmcnt(4)
    v_mfma_f32_32x32x16_bf16 v[224:239], a[24:27], v[200:203], v[224:239]
    v_and_b32 v180, 1, v180
    v_cmp_ne_u32 s[18:19], 0, v180
    v_cmp_eq_u32 vcc, -1, v176
    s_or_b64 s[18:19], s[18:19], vcc
    s_cmp_eq_u64 s[18:19], 0
    s_cselect_b32 s67, s71, 0
    s_and_b32 s67, s67, 1
    ds_read_b128 v[200:203], v10 offset:9216
    v_mfma_f32_32x32x16_bf16 v[240:255], a[24:27], v[204:207], v[240:255]
    v_permlane16_swap_b32 v176, v178
    v_permlane16_swap_b32 v177, v179
    v_lshlrev_b32 v180, 16, v176
    v_and_b32 v181, 0xffff0000, v176
    v_lshlrev_b32 v182, 16, v177
    ds_read_b128 v[204:207], v10 offset:41984
    s_waitcnt lgkmcnt(4)
    v_mfma_f32_32x32x16_bf16 v[224:239], a[28:31], v[208:211], v[224:239]
    v_and_b32 v183, 0xffff0000, v177
    v_add_f32 v184, v184, v180
    v_add_f32 v185, v185, v181
    v_add_f32 v186, v186, v182
    v_add_f32 v187, v187, v183
    s_cmp_lg_u32 s56, 0
    s_cbranch_scc1 Laow_250
    s_add_u32 s66, s64, 2
    v_cmp_eq_u32 vcc, 0, v30
    s_and_b32 s3, vcc_lo, 0xffff
    s_cbranch_scc1 Laow_250
    s_min_u32 s62, s66, 31
    s_lshl_b32 s61, s60, 24
    s_lshl_b32 s62, s62, 19
    s_add_u32 s61, s61, s62
    s_lshl_b32 s74, s56, 11
    s_add_u32 s62, s61, 0x2000000
    s_add_u32 m0, s74, 86272
    s_nop 0
    buffer_load_dwordx4 v4, s[32:35], s62 offen offset:0 lds
    buffer_load_dwordx4 v4, s[32:35], s62 offen offset:1024 lds
    s_add_u32 s62, s61, 0x4000000
    s_add_u32 m0, s74, 94464
    s_nop 0
    buffer_load_dwordx4 v4, s[32:35], s62 offen offset:0 lds
    buffer_load_dwordx4 v4, s[32:35], s62 offen offset:1024 lds
    s_add_u32 s62, s61, 0x6000000
    s_add_u32 m0, s74, 102656
    s_nop 0
    buffer_load_dwordx4 v4, s[32:35], s62 offen offset:0 lds
    buffer_load_dwordx4 v4, s[32:35], s62 offen offset:1024 lds
    s_add_u32 s62, s61, 0x2040000
    s_add_u32 m0, s74, 110848
    s_nop 0
    buffer_load_dwordx4 v4, s[32:35], s62 offen offset:0 lds
    buffer_load_dwordx4 v4, s[32:35], s62 offen offset:1024 lds
    s_add_u32 s62, s61, 0x4040000
    s_add_u32 m0, s74, 119040
    s_nop 0
    buffer_load_dwordx4 v4, s[32:35], s62 offen offset:0 lds
    buffer_load_dwordx4 v4, s[32:35], s62 offen offset:1024 lds
    s_add_u32 s62, s61, 0x6040000
    s_add_u32 m0, s74, 127232
    s_nop 0
    buffer_load_dwordx4 v4, s[32:35], s62 offen offset:0 lds
    buffer_load_dwordx4 v4, s[32:35], s62 offen offset:1024 lds
    s_mov_b32 s69, s66
Laow_250:
    ds_read_b128 v[208:211], v10 offset:10240
    v_mfma_f32_32x32x16_bf16 v[240:255], a[28:31], v[212:215], v[240:255]
    v_cvt_pk_bf16_f32 v176, v184, v185
    v_cvt_pk_bf16_f32 v177, v186, v187
    v_lshlrev_b32 v184, 16, v176
    v_and_b32 v185, 0xffff0000, v176
    v_lshlrev_b32 v186, 16, v177
    ds_read_b128 v[212:215], v10 offset:43008
    s_waitcnt lgkmcnt(4)
    v_mfma_f32_32x32x16_bf16 v[224:239], a[32:35], v[216:219], v[224:239]
    v_and_b32 v187, 0xffff0000, v177
    v_add_f32 v180, v184, v185
    v_add_f32 v181, v186, v187
    v_add_f32 v180, v180, v181
    v_mul_f32 v181, v184, v184
    ds_read_b128 v[216:219], v10 offset:11264
    v_mfma_f32_32x32x16_bf16 v[240:255], a[32:35], v[220:223], v[240:255]
    v_fmac_f32 v181, v185, v185
    v_fmac_f32 v181, v186, v186
    v_fmac_f32 v181, v187, v187
    v_add_f32 v180, v180, v180 row_ror:8 row_mask:0xf bank_mask:0xf
    ds_read_b128 v[220:223], v10 offset:44032
    s_waitcnt lgkmcnt(4)
    v_mfma_f32_32x32x16_bf16 v[224:239], a[36:39], v[200:203], v[224:239]
    v_add_f32 v181, v181, v181 row_ror:8 row_mask:0xf bank_mask:0xf
    v_add_f32 v180, v180, v180 row_ror:4 row_mask:0xf bank_mask:0xf
    s_cmp_lg_u32 s56, 1
    s_cbranch_scc1 Laow_251
    s_add_u32 s66, s64, 2
    v_cmp_eq_u32 vcc, 0, v30
    s_and_b32 s3, vcc_lo, 0xffff
    s_cbranch_scc1 Laow_251
    s_min_u32 s62, s66, 31
    s_lshl_b32 s61, s60, 24
    s_lshl_b32 s62, s62, 19
    s_add_u32 s61, s61, s62
    s_lshl_b32 s74, s56, 11
    s_add_u32 s62, s61, 0x2000000
    s_add_u32 m0, s74, 86272
    s_nop 0
    buffer_load_dwordx4 v4, s[32:35], s62 offen offset:0 lds
    buffer_load_dwordx4 v4, s[32:35], s62 offen offset:1024 lds
    s_add_u32 s62, s61, 0x4000000
    s_add_u32 m0, s74, 94464
    s_nop 0
    buffer_load_dwordx4 v4, s[32:35], s62 offen offset:0 lds
    buffer_load_dwordx4 v4, s[32:35], s62 offen offset:1024 lds
    s_add_u32 s62, s61, 0x6000000
    s_add_u32 m0, s74, 102656
    s_nop 0
    buffer_load_dwordx4 v4, s[32:35], s62 offen offset:0 lds
    buffer_load_dwordx4 v4, s[32:35], s62 offen offset:1024 lds
    s_add_u32 s62, s61, 0x2040000
    s_add_u32 m0, s74, 110848
    s_nop 0
    buffer_load_dwordx4 v4, s[32:35], s62 offen offset:0 lds
    buffer_load_dwordx4 v4, s[32:35], s62 offen offset:1024 lds
    s_add_u32 s62, s61, 0x4040000
    s_add_u32 m0, s74, 119040
    s_nop 0
    buffer_load_dwordx4 v4, s[32:35], s62 offen offset:0 lds
    buffer_load_dwordx4 v4, s[32:35], s62 offen offset:1024 lds
    s_add_u32 s62, s61, 0x6040000
    s_add_u32 m0, s74, 127232
    s_nop 0
    buffer_load_dwordx4 v4, s[32:35], s62 offen offset:0 lds
    buffer_load_dwordx4 v4, s[32:35], s62 offen offset:1024 lds
    s_mov_b32 s69, s66
Laow_251:
    ds_read_b128 v[200:203], v10 offset:12288
    v_mfma_f32_32x32x16_bf16 v[240:255], a[36:39], v[204:207], v[240:255]
    v_add_f32 v181, v181, v181 row_ror:4 row_mask:0xf bank_mask:0xf
    v_add_f32 v180, v180, v180 row_ror:2 row_mask:0xf bank_mask:0xf
    ds_read_b128 v[204:207], v10 offset:45056
    s_waitcnt lgkmcnt(4)
    v_mfma_f32_32x32x16_bf16 v[224:239], a[40:43], v[208:211], v[224:239]
    v_add_f32 v181, v181, v181 row_ror:2 row_mask:0xf bank_mask:0xf
    v_add_f32 v180, v180, v180 row_ror:1 row_mask:0xf bank_mask:0xf
    ds_read_b128 v[208:211], v10 offset:13312
    v_mfma_f32_32x32x16_bf16 v[240:255], a[40:43], v[212:215], v[240:255]
    v_add_f32 v181, v181, v181 row_ror:1 row_mask:0xf bank_mask:0xf
    v_mov_b64 v[182:183], v[180:181]
    ds_read_b128 v[212:215], v10 offset:46080
    s_waitcnt lgkmcnt(4)
    v_mfma_f32_32x32x16_bf16 v[224:239], a[44:47], v[216:219], v[224:239]
    v_permlane16_swap_b32 v180, v182
    v_permlane16_swap_b32 v181, v183
    v_add_f32 v180, v180, v182
    v_add_f32 v181, v181, v183
    s_add_u32 s16, s101, 1
    v_mov_b32 v182, s16
    s_and_b32 s3, s101, 1
    s_lshl_b32 s3, s3, 7
    v_add_u32 v160, s3, v24
    s_mov_b32 exec_lo, s67
    s_mov_b32 exec_hi, s67
    ds_write_b96 v160, v[180:182]
    s_mov_b64 exec, -1
    s_cmp_lg_u32 s56, 2
    s_cbranch_scc1 Laow_252
    s_add_u32 s66, s64, 2
    v_cmp_eq_u32 vcc, 0, v30
    s_and_b32 s3, vcc_lo, 0xffff
    s_cbranch_scc1 Laow_252
    s_min_u32 s62, s66, 31
    s_lshl_b32 s61, s60, 24
    s_lshl_b32 s62, s62, 19
    s_add_u32 s61, s61, s62
    s_lshl_b32 s74, s56, 11
    s_add_u32 s62, s61, 0x2000000
    s_add_u32 m0, s74, 86272
    s_nop 0
    buffer_load_dwordx4 v4, s[32:35], s62 offen offset:0 lds
    buffer_load_dwordx4 v4, s[32:35], s62 offen offset:1024 lds
    s_add_u32 s62, s61, 0x4000000
    s_add_u32 m0, s74, 94464
    s_nop 0
    buffer_load_dwordx4 v4, s[32:35], s62 offen offset:0 lds
    buffer_load_dwordx4 v4, s[32:35], s62 offen offset:1024 lds
    s_add_u32 s62, s61, 0x6000000
    s_add_u32 m0, s74, 102656
    s_nop 0
    buffer_load_dwordx4 v4, s[32:35], s62 offen offset:0 lds
    buffer_load_dwordx4 v4, s[32:35], s62 offen offset:1024 lds
    s_add_u32 s62, s61, 0x2040000
    s_add_u32 m0, s74, 110848
    s_nop 0
    buffer_load_dwordx4 v4, s[32:35], s62 offen offset:0 lds
    buffer_load_dwordx4 v4, s[32:35], s62 offen offset:1024 lds
    s_add_u32 s62, s61, 0x4040000
    s_add_u32 m0, s74, 119040
    s_nop 0
    buffer_load_dwordx4 v4, s[32:35], s62 offen offset:0 lds
    buffer_load_dwordx4 v4, s[32:35], s62 offen offset:1024 lds
    s_add_u32 s62, s61, 0x6040000
    s_add_u32 m0, s74, 127232
    s_nop 0
    buffer_load_dwordx4 v4, s[32:35], s62 offen offset:0 lds
    buffer_load_dwordx4 v4, s[32:35], s62 offen offset:1024 lds
    s_mov_b32 s69, s66
Laow_252:
    ds_read_b128 v[216:219], v10 offset:14336
    v_mfma_f32_32x32x16_bf16 v[240:255], a[44:47], v[220:223], v[240:255]
    v_mov_b64 v[178:179], v[176:177]
    ds_read_b128 v[220:223], v10 offset:47104
    s_waitcnt lgkmcnt(5)
    v_mfma_f32_32x32x16_bf16 v[224:239], a[48:51], v[200:203], v[224:239]
    v_permlane16_swap_b32 v176, v178
    v_permlane16_swap_b32 v177, v179
    s_lshl_b32 s61, s60, 21
    s_lshl_b32 s63, s101, 16
    s_add_u32 s61, s61, s63
    s_add_u32 s61, s61, 0x400000
    s_mul_i32 s3, s67, 0xffff
    s_mov_b32 exec_lo, s3
    s_mov_b32 exec_hi, s3
    buffer_store_dwordx4 v[176:179], v13, s[32:35], s61 offen sc1
    s_sub_u32 s3, 0, s67
    s_mov_b32 exec_lo, s3
    s_mov_b32 exec_hi, s3
    v_mov_b64 v[192:193], v[184:185]
    v_mov_b64 v[194:195], v[186:187]
    s_mov_b64 exec, -1
    s_add_u32 s71, s71, s67
    ds_read_b128 v[200:203], v10 offset:15360
    v_mfma_f32_32x32x16_bf16 v[240:255], a[48:51], v[204:207], v[240:255]
    v_cndmask_b32 v112, v15, v112, s[76:77]
    v_cndmask_b32 v113, v15, v113, s[78:79]
    v_cndmask_b32 v114, v15, v114, s[80:81]
    v_cndmask_b32 v115, v15, v115, s[82:83]
    v_cndmask_b32 v116, v15, v116, s[84:85]
    ds_read_b128 v[204:207], v10 offset:48128
    s_waitcnt lgkmcnt(5)
    v_mfma_f32_32x32x16_bf16 v[224:239], a[52:55], v[208:211], v[224:239]
    v_cndmask_b32 v117, v15, v117, s[86:87]
    v_cndmask_b32 v118, v15, v118, s[88:89]
    v_cndmask_b32 v119, v15, v119, s[90:91]
    v_max3_f32 v196, v112, v113, v114
    v_max3_f32 v197, v115, v116, v117
    s_cmp_lg_u32 s56, 3
    s_cbranch_scc1 Laow_253
    s_add_u32 s66, s64, 2
    v_cmp_eq_u32 vcc, 0, v30
    s_and_b32 s3, vcc_lo, 0xffff
    s_cbranch_scc1 Laow_253
    s_min_u32 s62, s66, 31
    s_lshl_b32 s61, s60, 24
    s_lshl_b32 s62, s62, 19
    s_add_u32 s61, s61, s62
    s_lshl_b32 s74, s56, 11
    s_add_u32 s62, s61, 0x2000000
    s_add_u32 m0, s74, 86272
    s_nop 0
    buffer_load_dwordx4 v4, s[32:35], s62 offen offset:0 lds
    buffer_load_dwordx4 v4, s[32:35], s62 offen offset:1024 lds
    s_add_u32 s62, s61, 0x4000000
    s_add_u32 m0, s74, 94464
    s_nop 0
    buffer_load_dwordx4 v4, s[32:35], s62 offen offset:0 lds
    buffer_load_dwordx4 v4, s[32:35], s62 offen offset:1024 lds
    s_add_u32 s62, s61, 0x6000000
    s_add_u32 m0, s74, 102656
    s_nop 0
    buffer_load_dwordx4 v4, s[32:35], s62 offen offset:0 lds
    buffer_load_dwordx4 v4, s[32:35], s62 offen offset:1024 lds
    s_add_u32 s62, s61, 0x2040000
    s_add_u32 m0, s74, 110848
    s_nop 0
    buffer_load_dwordx4 v4, s[32:35], s62 offen offset:0 lds
    buffer_load_dwordx4 v4, s[32:35], s62 offen offset:1024 lds
    s_add_u32 s62, s61, 0x4040000
    s_add_u32 m0, s74, 119040
    s_nop 0
    buffer_load_dwordx4 v4, s[32:35], s62 offen offset:0 lds
    buffer_load_dwordx4 v4, s[32:35], s62 offen offset:1024 lds
    s_add_u32 s62, s61, 0x6040000
    s_add_u32 m0, s74, 127232
    s_nop 0
    buffer_load_dwordx4 v4, s[32:35], s62 offen offset:0 lds
    buffer_load_dwordx4 v4, s[32:35], s62 offen offset:1024 lds
    s_mov_b32 s69, s66
Laow_253:
    ds_read_b128 v[208:211], v10 offset:16384
    v_mfma_f32_32x32x16_bf16 v[240:255], a[52:55], v[212:215], v[240:255]
    v_max3_f32 v196, v196, v118, v119
    v_max_f32 v196, v196, v197
    v_mov_b32 v197, v196
    ds_read_b128 v[212:215], v10 offset:49152
    s_waitcnt lgkmcnt(4)
    v_mfma_f32_32x32x16_bf16 v[224:239], a[56:59], v[216:219], v[224:239]
    v_permlane16_swap_b32 v196, v197
    v_max_f32 v196, v196, v197
    v_mov_b32 v197, v196
    s_add_u32 s16, s101, 1
    s_and_b32 s3, s101, 1
    s_lshl_b32 s3, s3, 7
    v_add_u32 v160, s3, v29
    ds_read_b128 v[180:183], v160
    s_lshl_b32 s61, s60, 21
    s_lshl_b32 s63, s101, 16
    s_add_u32 s61, s61, s63
    s_add_u32 s17, s61, 0x800000
    s_cmp_eq_u32 s71, 2
    s_cselect_b32 s67, 1, 0
    s_waitcnt lgkmcnt(0)
    v_cmp_ne_u32 vcc, s16, v182
    s_cmp_eq_u64 vcc, 0
    s_cselect_b32 s67, s67, 0
    ds_read_b128 v[216:219], v10 offset:17408
    v_mfma_f32_32x32x16_bf16 v[240:255], a[56:59], v[220:223], v[240:255]
    v_add_f32 v180, v180, v180 quad_perm:[1,0,3,2] row_mask:0xf bank_mask:0xf
    v_add_f32 v181, v181, v181 quad_perm:[1,0,3,2] row_mask:0xf bank_mask:0xf
    ds_read_b128 v[220:223], v10 offset:50176
    v_mfma_f32_32x32x16_bf16 v[224:239], a[60:63], v[200:203], v[224:239]
    v_add_f32 v180, v180, v180 quad_perm:[2,3,0,1] row_mask:0xf bank_mask:0xf
    v_add_f32 v181, v181, v181 quad_perm:[2,3,0,1] row_mask:0xf bank_mask:0xf
    v_mul_f32 v180, 0x3b000000, v180
    v_mul_f32 v182, v180, v180
    v_fma_f32 v181, v181, s94, -v182
    ds_read_b128 v[200:203], v10 offset:18432
    v_mfma_f32_32x32x16_bf16 v[240:255], a[60:63], v[204:207], v[240:255]
    v_max_f32 v181, 0, v181
    v_add_f32 v181, 0x3727c5ac, v181
    v_rsq_f32 v181, v181
    v_sub_f32 v164, v192, v180
    v_sub_f32 v165, v193, v180
    ds_read_b128 v[204:207], v10 offset:51200
    v_mfma_f32_32x32x16_bf16 v[224:239], a[64:67], v[208:211], v[224:239]
    v_sub_f32 v166, v194, v180
    v_sub_f32 v167, v195, v180
    v_mul_f32 v164, v164, v181
    v_mul_f32 v165, v165, v181
    v_mul_f32 v166, v166, v181
    ds_read_b128 v[208:211], v10 offset:19456
    v_mfma_f32_32x32x16_bf16 v[240:255], a[64:67], v[212:215], v[240:255]
    v_mul_f32 v167, v167, v181
    v_cvt_pk_bf16_f32 v160, v164, v165
    v_cvt_pk_bf16_f32 v161, v166, v167
    v_mov_b64 v[162:163], v[160:161]
    ds_read_b128 v[212:215], v10 offset:52224
    s_waitcnt lgkmcnt(4)
    v_mfma_f32_32x32x16_bf16 v[224:239], a[68:71], v[216:219], v[224:239]
    v_permlane16_swap_b32 v160, v162
    v_permlane16_swap_b32 v161, v163
    s_mul_i32 s3, s67, 0xffff
    s_mov_b32 exec_lo, s3
    s_mov_b32 exec_hi, s3
    buffer_store_dwordx4 v[160:163], v13, s[32:35], s17 offen sc1
    s_mov_b64 exec, -1
    s_cmp_eq_u32 s67, 1
    s_cselect_b32 s71, 0, s71
    ds_read_b128 v[216:219], v10 offset:20480
    v_mfma_f32_32x32x16_bf16 v[240:255], a[68:71], v[220:223], v[240:255]
    v_permlane32_swap_b32 v196, v197
    v_max_f32 v196, v196, v197
    v_mul_f32 v196, s68, v196
    v_fma_f32 v112, v112, s68, -v196
    v_fma_f32 v113, v113, s68, -v196
    ds_read_b128 v[220:223], v10 offset:53248
    s_waitcnt lgkmcnt(4)
    v_mfma_f32_32x32x16_bf16 v[224:239], a[72:75], v[200:203], v[224:239]
    v_fma_f32 v114, v114, s68, -v196
    v_fma_f32 v115, v115, s68, -v196
    v_fma_f32 v116, v116, s68, -v196
    v_fma_f32 v117, v117, s68, -v196
    v_fma_f32 v118, v118, s68, -v196
    ds_read_b128 v[200:203], v10 offset:21504
    v_mfma_f32_32x32x16_bf16 v[240:255], a[72:75], v[204:207], v[240:255]
    v_fma_f32 v119, v119, s68, -v196
    v_exp_f32 v112, v112
    v_exp_f32 v113, v113
    v_exp_f32 v114, v114
    v_exp_f32 v115, v115
    ds_read_b128 v[204:207], v10 offset:54272
    s_waitcnt lgkmcnt(4)
    v_mfma_f32_32x32x16_bf16 v[224:239], a[76:79], v[208:211], v[224:239]
    v_exp_f32 v116, v116
    v_exp_f32 v117, v117
    v_exp_f32 v118, v118
    v_exp_f32 v119, v119
    v_cvt_pk_bf16_f32 v120, v112, v113
    ds_read_b128 v[208:211], v10 offset:22528
    v_mfma_f32_32x32x16_bf16 v[240:255], a[76:79], v[212:215], v[240:255]
    v_cvt_pk_bf16_f32 v121, v114, v115
    v_cvt_pk_bf16_f32 v122, v116, v117
    v_cvt_pk_bf16_f32 v123, v118, v119
    v_add_f32 v197, v112, v113
    v_add_f32 v197, v197, v114
    ds_read_b128 v[212:215], v10 offset:55296
    s_waitcnt lgkmcnt(4)
    v_mfma_f32_32x32x16_bf16 v[224:239], a[80:83], v[216:219], v[224:239]
    v_add_f32 v197, v197, v115
    v_add_f32 v197, v197, v116
    v_add_f32 v197, v197, v117
    v_add_f32 v197, v197, v118
    v_add_f32 v197, v197, v119
    ds_read_b128 v[216:219], v10 offset:23552
    v_mfma_f32_32x32x16_bf16 v[240:255], a[80:83], v[220:223], v[240:255]
    v_mfma_f32_16x16x32_bf16 v[128:131], v[80:83], v[120:123], 0
    v_mfma_f32_16x16x32_bf16 v[132:135], v[84:87], v[120:123], 0
    v_mfma_f32_16x16x32_bf16 v[136:139], v[88:91], v[120:123], 0
    v_mfma_f32_16x16x32_bf16 v[140:143], v[92:95], v[120:123], 0
    v_mfma_f32_16x16x32_bf16 v[144:147], v[96:99], v[120:123], 0
    ds_read_b128 v[220:223], v10 offset:56320
    s_waitcnt lgkmcnt(4)
    v_mfma_f32_32x32x16_bf16 v[224:239], a[84:87], v[200:203], v[224:239]
    v_mfma_f32_16x16x32_bf16 v[148:151], v[100:103], v[120:123], 0
    v_mfma_f32_16x16x32_bf16 v[152:155], v[104:107], v[120:123], 0
    v_mfma_f32_16x16x32_bf16 v[156:159], v[108:111], v[120:123], 0
    ds_read_b128 v[200:203], v10 offset:24576
    v_mfma_f32_32x32x16_bf16 v[240:255], a[84:87], v[204:207], v[240:255]
    ds_read_b128 v[204:207], v10 offset:57344
    s_waitcnt lgkmcnt(4)
    v_mfma_f32_32x32x16_bf16 v[224:239], a[88:91], v[208:211], v[224:239]
    ds_read_b128 v[208:211], v10 offset:25600
    v_mfma_f32_32x32x16_bf16 v[240:255], a[88:91], v[212:215], v[240:255]
    ds_read_b128 v[212:215], v10 offset:58368
    s_waitcnt lgkmcnt(4)
    v_mfma_f32_32x32x16_bf16 v[224:239], a[92:95], v[216:219], v[224:239]
    ds_read_b128 v[216:219], v10 offset:26624
    v_mfma_f32_32x32x16_bf16 v[240:255], a[92:95], v[220:223], v[240:255]
    ds_read_b128 v[220:223], v10 offset:59392
    s_waitcnt lgkmcnt(4)
    v_mfma_f32_32x32x16_bf16 v[224:239], a[96:99], v[200:203], v[224:239]
    ds_read_b128 v[200:203], v10 offset:27648
    v_mfma_f32_32x32x16_bf16 v[240:255], a[96:99], v[204:207], v[240:255]
    ds_read_b128 v[204:207], v10 offset:60416
    s_waitcnt lgkmcnt(4)
    v_mfma_f32_32x32x16_bf16 v[224:239], a[100:103], v[208:211], v[224:239]
    s_cmp_lg_u32 s56, 0
    s_cbranch_scc1 Laow_254
    s_lshl_b32 s61, s60, 22
    s_lshl_b32 s62, s65, 17
    s_add_u32 s61, s61, s62
    s_add_u32 s62, s61, 0x1800000
    s_add_u32 s61, s61, 0x1000000
    buffer_load_dwordx4 v[160:163], v7, s[32:35], s61 offen offset:0 sc1
    buffer_load_dwordx4 v[164:167], v7, s[32:35], s61 offen offset:512 sc1
    buffer_load_dwordx4 v[168:171], v7, s[32:35], s61 offen offset:1024 sc1
    buffer_load_dwordx4 v[172:175], v7, s[32:35], s61 offen offset:1536 sc1
    buffer_load_dwordx4 v[176:179], v8, s[32:35], s62 offen offset:0 sc1
    buffer_load_dwordx4 v[180:183], v8, s[32:35], s62 offen offset:512 sc1
    buffer_load_dwordx4 v[184:187], v8, s[32:35], s62 offen offset:1024 sc1
    buffer_load_dwordx4 v[188:191], v8, s[32:35], s62 offen offset:1536 sc1
Laow_254:
    ds_read_b128 v[208:211], v10 offset:28672
    v_mfma_f32_32x32x16_bf16 v[240:255], a[100:103], v[212:215], v[240:255]
    ds_read_b128 v[212:215], v10 offset:61440
    s_waitcnt lgkmcnt(4)
    v_mfma_f32_32x32x16_bf16 v[224:239], a[104:107], v[216:219], v[224:239]
    ds_read_b128 v[216:219], v10 offset:29696
    v_mfma_f32_32x32x16_bf16 v[240:255], a[104:107], v[220:223], v[240:255]
    s_cmp_lg_u32 s56, 1
    s_cbranch_scc1 Laow_255
    s_lshl_b32 s61, s60, 22
    s_lshl_b32 s62, s65, 17
    s_add_u32 s61, s61, s62
    s_add_u32 s62, s61, 0x1800000
    s_add_u32 s61, s61, 0x1000000
    buffer_load_dwordx4 v[160:163], v7, s[32:35], s61 offen offset:0 sc1
    buffer_load_dwordx4 v[164:167], v7, s[32:35], s61 offen offset:512 sc1
    buffer_load_dwordx4 v[168:171], v7, s[32:35], s61 offen offset:1024 sc1
    buffer_load_dwordx4 v[172:175], v7, s[32:35], s61 offen offset:1536 sc1
    buffer_load_dwordx4 v[176:179], v8, s[32:35], s62 offen offset:0 sc1
    buffer_load_dwordx4 v[180:183], v8, s[32:35], s62 offen offset:512 sc1
    buffer_load_dwordx4 v[184:187], v8, s[32:35], s62 offen offset:1024 sc1
    buffer_load_dwordx4 v[188:191], v8, s[32:35], s62 offen offset:1536 sc1
Laow_255:
    ds_read_b128 v[220:223], v10 offset:62464
    s_waitcnt lgkmcnt(4)
    v_mfma_f32_32x32x16_bf16 v[224:239], a[108:111], v[200:203], v[224:239]
    ds_read_b128 v[200:203], v10 offset:30720
    v_mfma_f32_32x32x16_bf16 v[240:255], a[108:111], v[204:207], v[240:255]
    ds_read_b128 v[204:207], v10 offset:63488
    s_waitcnt lgkmcnt(4)
    v_mfma_f32_32x32x16_bf16 v[224:239], a[112:115], v[208:211], v[224:239]
    s_cmp_lg_u32 s56, 2
    s_cbranch_scc1 Laow_256
    s_lshl_b32 s61, s60, 22
    s_lshl_b32 s62, s65, 17
    s_add_u32 s61, s61, s62
    s_add_u32 s62, s61, 0x1800000
    s_add_u32 s61, s61, 0x1000000
    buffer_load_dwordx4 v[160:163], v7, s[32:35], s61 offen offset:0 sc1
    buffer_load_dwordx4 v[164:167], v7, s[32:35], s61 offen offset:512 sc1
    buffer_load_dwordx4 v[168:171], v7, s[32:35], s61 offen offset:1024 sc1
    buffer_load_dwordx4 v[172:175], v7, s[32:35], s61 offen offset:1536 sc1
    buffer_load_dwordx4 v[176:179], v8, s[32:35], s62 offen offset:0 sc1
    buffer_load_dwordx4 v[180:183], v8, s[32:35], s62 offen offset:512 sc1
    buffer_load_dwordx4 v[184:187], v8, s[32:35], s62 offen offset:1024 sc1
    buffer_load_dwordx4 v[188:191], v8, s[32:35], s62 offen offset:1536 sc1
Laow_256:
    ds_read_b128 v[208:211], v10 offset:31744
    v_mfma_f32_32x32x16_bf16 v[240:255], a[112:115], v[212:215], v[240:255]
    ds_read_b128 v[212:215], v10 offset:64512
    s_waitcnt lgkmcnt(4)
    v_mfma_f32_32x32x16_bf16 v[224:239], a[116:119], v[216:219], v[224:239]
    v_mfma_f32_32x32x16_bf16 v[240:255], a[116:119], v[220:223], v[240:255]
    s_cmp_lg_u32 s56, 3
    s_cbranch_scc1 Laow_257
    s_lshl_b32 s61, s60, 22
    s_lshl_b32 s62, s65, 17
    s_add_u32 s61, s61, s62
    s_add_u32 s62, s61, 0x1800000
    s_add_u32 s61, s61, 0x1000000
    buffer_load_dwordx4 v[160:163], v7, s[32:35], s61 offen offset:0 sc1
    buffer_load_dwordx4 v[164:167], v7, s[32:35], s61 offen offset:512 sc1
    buffer_load_dwordx4 v[168:171], v7, s[32:35], s61 offen offset:1024 sc1
    buffer_load_dwordx4 v[172:175], v7, s[32:35], s61 offen offset:1536 sc1
    buffer_load_dwordx4 v[176:179], v8, s[32:35], s62 offen offset:0 sc1
    buffer_load_dwordx4 v[180:183], v8, s[32:35], s62 offen offset:512 sc1
    buffer_load_dwordx4 v[184:187], v8, s[32:35], s62 offen offset:1024 sc1
    buffer_load_dwordx4 v[188:191], v8, s[32:35], s62 offen offset:1536 sc1
Laow_257:
    s_waitcnt lgkmcnt(2)
    v_mfma_f32_32x32x16_bf16 v[224:239], a[120:123], v[200:203], v[224:239]
    v_mfma_f32_32x32x16_bf16 v[240:255], a[120:123], v[204:207], v[240:255]
    s_waitcnt lgkmcnt(0)
    v_mfma_f32_32x32x16_bf16 v[224:239], a[124:127], v[208:211], v[224:239]
    v_mfma_f32_32x32x16_bf16 v[240:255], a[124:127], v[212:215], v[240:255]
    s_waitcnt lgkmcnt(0)
    s_mov_b32 s62, 0
Laq_260:
    s_cmp_eq_u32 s71, 0
    s_cbranch_scc1 Laq_259
    s_add_u32 s99, s99, 1
    s_cmp_gt_u32 s99, 0x2dc6c0
    s_cbranch_scc0 Lto_261
    s_mov_b32 s3, 22
    s_branch L_abort
Lto_261:
    s_cmp_eq_u32 s71, 2
    s_cbranch_scc1 Laq_258
    s_lshl_b32 s63, s101, 16
    buffer_load_dwordx4 v[64:67], v13, s[44:47], s63 offen sc1
    buffer_load_dwordx4 v[48:51], v12, s[32:35], s100 offen sc1
    s_add_u32 s74, s100, 0x20000
    buffer_load_dwordx4 v[52:55], v12, s[32:35], s74 offen sc1
    s_add_u32 s74, s100, 0x40000
    buffer_load_dwordx4 v[56:59], v12, s[32:35], s74 offen sc1
    s_add_u32 s74, s100, 0x60000
    buffer_load_dwordx4 v[60:63], v12, s[32:35], s74 offen sc1
    s_waitcnt vmcnt(0)
    v_mfma_f32_16x16x32_bf16 v[72:75], v[16:19], v[48:51], 0
    v_mfma_f32_16x16x32_bf16 v[72:75], v[16:19], v[52:55], v[72:75]
    v_mfma_f32_16x16x32_bf16 v[72:75], v[20:23], v[56:59], v[72:75]
    v_mfma_f32_16x16x32_bf16 v[72:75], v[20:23], v[60:63], v[72:75]
    v_xor_b32 v68, s70, v48
    v_xor_b32 v69, s70, v52
    v_xor_b32 v70, s70, v56
    v_xor_b32 v71, s70, v60
    v_or3_b32 v68, v68, v69, v70
    v_or_b32 v68, v68, v71
    v_and_b32 v68, 1, v68
    v_cmp_ne_u32 s[18:19], 0, v68
    v_cmp_eq_u32 vcc, -1, v64
    s_or_b64 s[18:19], s[18:19], vcc
    s_cmp_eq_u64 s[18:19], 0
    s_cselect_b32 s67, s71, 0
    s_and_b32 s67, s67, 1
    v_permlane16_swap_b32 v64, v66
    v_permlane16_swap_b32 v65, v67
    v_lshlrev_b32 v68, 16, v64
    v_and_b32 v69, 0xffff0000, v64
    v_lshlrev_b32 v70, 16, v65
    v_and_b32 v71, 0xffff0000, v65
    v_add_f32 v72, v72, v68
    v_add_f32 v73, v73, v69
    v_add_f32 v74, v74, v70
    v_add_f32 v75, v75, v71
    v_cvt_pk_bf16_f32 v64, v72, v73
    v_cvt_pk_bf16_f32 v65, v74, v75
    v_lshlrev_b32 v72, 16, v64
    v_and_b32 v73, 0xffff0000, v64
    v_lshlrev_b32 v74, 16, v65
    v_and_b32 v75, 0xffff0000, v65
    v_add_f32 v68, v72, v73
    v_add_f32 v69, v74, v75
    v_add_f32 v68, v68, v69
    v_mul_f32 v69, v72, v72
    v_fmac_f32 v69, v73, v73
    v_fmac_f32 v69, v74, v74
    v_fmac_f32 v69, v75, v75
    v_add_f32 v68, v68, v68 row_ror:8 row_mask:0xf bank_mask:0xf
    s_nop 0
    v_add_f32 v69, v69, v69 row_ror:8 row_mask:0xf bank_mask:0xf
    v_add_f32 v68, v68, v68 row_ror:4 row_mask:0xf bank_mask:0xf
    s_nop 0
    v_add_f32 v69, v69, v69 row_ror:4 row_mask:0xf bank_mask:0xf
    v_add_f32 v68, v68, v68 row_ror:2 row_mask:0xf bank_mask:0xf
    s_nop 0
    v_add_f32 v69, v69, v69 row_ror:2 row_mask:0xf bank_mask:0xf
    v_add_f32 v68, v68, v68 row_ror:1 row_mask:0xf bank_mask:0xf
    s_nop 0
    v_add_f32 v69, v69, v69 row_ror:1 row_mask:0xf bank_mask:0xf
    v_mov_b64 v[70:71], v[68:69]
    s_nop 1
    v_permlane16_swap_b32 v68, v70
    v_permlane16_swap_b32 v69, v71
    v_add_f32 v68, v68, v70
    v_add_f32 v69, v69, v71
    s_add_u32 s16, s101, 1
    v_mov_b32 v70, s16
    s_and_b32 s3, s101, 1
    s_lshl_b32 s3, s3, 7
    v_add_u32 v48, s3, v24
    s_mov_b32 exec_lo, s67
    s_mov_b32 exec_hi, s67
    ds_write_b96 v48, v[68:70]
    s_mov_b64 exec, -1
    v_mov_b64 v[66:67], v[64:65]
    s_nop 1
    v_permlane16_swap_b32 v64, v66
    v_permlane16_swap_b32 v65, v67
    s_lshl_b32 s61, s60, 21
    s_lshl_b32 s63, s101, 16
    s_add_u32 s61, s61, s63
    s_add_u32 s61, s61, 0x400000
    s_mul_i32 s3, s67, 0xffff
    s_mov_b32 exec_lo, s3
    s_mov_b32 exec_hi, s3
    buffer_store_dwordx4 v[64:67], v13, s[32:35], s61 offen sc1
    s_sub_u32 s3, 0, s67
    s_mov_b32 exec_lo, s3
    s_mov_b32 exec_hi, s3
    v_mov_b64 v[192:193], v[72:73]
    v_mov_b64 v[194:195], v[74:75]
    s_mov_b64 exec, -1
    s_add_u32 s71, s71, s67
    s_waitcnt lgkmcnt(0)
    s_branch Laq_260
Laq_258:
    s_nop 2
    s_add_u32 s16, s101, 1
    s_and_b32 s3, s101, 1
    s_lshl_b32 s3, s3, 7
    v_add_u32 v48, s3, v29
    ds_read_b128 v[68:71], v48
    s_lshl_b32 s61, s60, 21
    s_lshl_b32 s63, s101, 16
    s_add_u32 s61, s61, s63
    s_add_u32 s17, s61, 0x800000
    s_cmp_eq_u32 s71, 2
    s_cselect_b32 s67, 1, 0
    s_waitcnt lgkmcnt(0)
    v_cmp_ne_u32 vcc, s16, v70
    s_cmp_eq_u64 vcc, 0
    s_cselect_b32 s67, s67, 0
    v_add_f32 v68, v68, v68 quad_perm:[1,0,3,2] row_mask:0xf bank_mask:0xf
    v_add_f32 v69, v69, v69 quad_perm:[1,0,3,2] row_mask:0xf bank_mask:0xf
    s_nop 0
    v_add_f32 v68, v68, v68 quad_perm:[2,3,0,1] row_mask:0xf bank_mask:0xf
    v_add_f32 v69, v69, v69 quad_perm:[2,3,0,1] row_mask:0xf bank_mask:0xf
    v_mul_f32 v68, 0x3b000000, v68
    v_mul_f32 v70, v68, v68
    v_fma_f32 v69, v69, s94, -v70
    v_max_f32 v69, 0, v69
    v_add_f32 v69, 0x3727c5ac, v69
    v_rsq_f32 v69, v69
    v_sub_f32 v52, v192, v68
    v_sub_f32 v53, v193, v68
    v_sub_f32 v54, v194, v68
    v_sub_f32 v55, v195, v68
    v_mul_f32 v52, v52, v69
    v_mul_f32 v53, v53, v69
    v_mul_f32 v54, v54, v69
    v_mul_f32 v55, v55, v69
    v_cvt_pk_bf16_f32 v48, v52, v53
    v_cvt_pk_bf16_f32 v49, v54, v55
    v_mov_b64 v[50:51], v[48:49]
    s_nop 1
    v_permlane16_swap_b32 v48, v50
    v_permlane16_swap_b32 v49, v51
    s_mul_i32 s3, s67, 0xffff
    s_mov_b32 exec_lo, s3
    s_mov_b32 exec_hi, s3
    buffer_store_dwordx4 v[48:51], v13, s[32:35], s17 offen sc1
    s_mov_b64 exec, -1
    s_cmp_eq_u32 s67, 1
    s_cselect_b32 s71, 0, s71
    s_waitcnt lgkmcnt(0)
    s_branch Laq_260
Laq_259:
    s_nop 7
    v_cvt_pk_bf16_f32 v200, v224, v225
    v_cvt_pk_bf16_f32 v201, v226, v227
    v_cvt_pk_bf16_f32 v202, v228, v229
    v_cvt_pk_bf16_f32 v203, v230, v231
    v_cvt_pk_bf16_f32 v204, v232, v233
    v_cvt_pk_bf16_f32 v205, v234, v235
    v_cvt_pk_bf16_f32 v206, v236, v237
    v_cvt_pk_bf16_f32 v207, v238, v239
    v_bfi_b32 v200, 1, s75, v200
    ds_write_b128 v26, v[200:203] offset:0
    v_bfi_b32 v204, 1, s75, v204
    ds_write_b128 v26, v[204:207] offset:16
    v_cvt_pk_bf16_f32 v208, v240, v241
    v_cvt_pk_bf16_f32 v209, v242, v243
    v_cvt_pk_bf16_f32 v210, v244, v245
    v_cvt_pk_bf16_f32 v211, v246, v247
    v_cvt_pk_bf16_f32 v212, v248, v249
    v_cvt_pk_bf16_f32 v213, v250, v251
    v_cvt_pk_bf16_f32 v214, v252, v253
    v_cvt_pk_bf16_f32 v215, v254, v255
    v_bfi_b32 v208, 1, s75, v208
    ds_write_b128 v26, v[208:211] offset:2560
    v_bfi_b32 v212, 1, s75, v212
    ds_write_b128 v26, v[212:215] offset:2576
    ds_read_b128 v[224:227], v27 offset:0
    ds_read_b128 v[228:231], v27 offset:1280
    ds_read_b128 v[232:235], v27 offset:2560
    ds_read_b128 v[236:239], v27 offset:3840
    s_mov_b32 s71, 1
    s_mov_b32 s70, s75
    s_mov_b32 s100, s98
    s_mov_b32 s101, s64
    s_barrier
    s_add_u32 s74, s98, 0x0
    s_waitcnt lgkmcnt(3)
    buffer_store_dwordx4 v[224:227], v28, s[32:35], s74 offen
    s_add_u32 s74, s98, 0x4000
    s_waitcnt lgkmcnt(2)
    buffer_store_dwordx4 v[228:231], v28, s[32:35], s74 offen
    s_add_u32 s74, s98, 0x40000
    s_waitcnt lgkmcnt(1)
    buffer_store_dwordx4 v[232:235], v28, s[32:35], s74 offen
    s_add_u32 s74, s98, 0x44000
    s_waitcnt lgkmcnt(0)
    buffer_store_dwordx4 v[236:239], v28, s[32:35], s74 offen
    s_add_u32 s64, s64, 1
    s_cmp_lt_u32 s64, 32
    s_cbranch_scc1 Laol_226
    s_mov_b32 s62, 0
Laq_264:
    s_cmp_eq_u32 s71, 0
    s_cbranch_scc1 Laq_263
    s_add_u32 s99, s99, 1
    s_cmp_gt_u32 s99, 0x2dc6c0
    s_cbranch_scc0 Lto_265
    s_mov_b32 s3, 22
    s_branch L_abort
Lto_265:
    s_cmp_eq_u32 s71, 2
    s_cbranch_scc1 Laq_262
    s_lshl_b32 s63, s101, 16
    buffer_load_dwordx4 v[64:67], v13, s[44:47], s63 offen sc1
    buffer_load_dwordx4 v[48:51], v12, s[32:35], s100 offen sc1
    s_add_u32 s74, s100, 0x20000
    buffer_load_dwordx4 v[52:55], v12, s[32:35], s74 offen sc1
    s_add_u32 s74, s100, 0x40000
    buffer_load_dwordx4 v[56:59], v12, s[32:35], s74 offen sc1
    s_add_u32 s74, s100, 0x60000
    buffer_load_dwordx4 v[60:63], v12, s[32:35], s74 offen sc1
    s_waitcnt vmcnt(0)
    v_mfma_f32_16x16x32_bf16 v[72:75], v[16:19], v[48:51], 0
    v_mfma_f32_16x16x32_bf16 v[72:75], v[16:19], v[52:55], v[72:75]
    v_mfma_f32_16x16x32_bf16 v[72:75], v[20:23], v[56:59], v[72:75]
    v_mfma_f32_16x16x32_bf16 v[72:75], v[20:23], v[60:63], v[72:75]
    v_xor_b32 v68, s70, v48
    v_xor_b32 v69, s70, v52
    v_xor_b32 v70, s70, v56
    v_xor_b32 v71, s70, v60
    v_or3_b32 v68, v68, v69, v70
    v_or_b32 v68, v68, v71
    v_and_b32 v68, 1, v68
    v_cmp_ne_u32 s[18:19], 0, v68
    v_cmp_eq_u32 vcc, -1, v64
    s_or_b64 s[18:19], s[18:19], vcc
    s_cmp_eq_u64 s[18:19], 0
    s_cselect_b32 s67, s71, 0
    s_and_b32 s67, s67, 1
    v_permlane16_swap_b32 v64, v66
    v_permlane16_swap_b32 v65, v67
    v_lshlrev_b32 v68, 16, v64
    v_and_b32 v69, 0xffff0000, v64
    v_lshlrev_b32 v70, 16, v65
    v_and_b32 v71, 0xffff0000, v65
    v_add_f32 v72, v72, v68
    v_add_f32 v73, v73, v69
    v_add_f32 v74, v74, v70
    v_add_f32 v75, v75, v71
    v_cvt_pk_bf16_f32 v64, v72, v73
    v_cvt_pk_bf16_f32 v65, v74, v75
    v_lshlrev_b32 v72, 16, v64
    v_and_b32 v73, 0xffff0000, v64
    v_lshlrev_b32 v74, 16, v65
    v_and_b32 v75, 0xffff0000, v65
    v_add_f32 v68, v72, v73
    v_add_f32 v69, v74, v75
    v_add_f32 v68, v68, v69
    v_mul_f32 v69, v72, v72
    v_fmac_f32 v69, v73, v73
    v_fmac_f32 v69, v74, v74
    v_fmac_f32 v69, v75, v75
    v_add_f32 v68, v68, v68 row_ror:8 row_mask:0xf bank_mask:0xf
    s_nop 0
    v_add_f32 v69, v69, v69 row_ror:8 row_mask:0xf bank_mask:0xf
    v_add_f32 v68, v68, v68 row_ror:4 row_mask:0xf bank_mask:0xf
    s_nop 0
    v_add_f32 v69, v69, v69 row_ror:4 row_mask:0xf bank_mask:0xf
    v_add_f32 v68, v68, v68 row_ror:2 row_mask:0xf bank_mask:0xf
    s_nop 0
    v_add_f32 v69, v69, v69 row_ror:2 row_mask:0xf bank_mask:0xf
    v_add_f32 v68, v68, v68 row_ror:1 row_mask:0xf bank_mask:0xf
    s_nop 0
    v_add_f32 v69, v69, v69 row_ror:1 row_mask:0xf bank_mask:0xf
    v_mov_b64 v[70:71], v[68:69]
    s_nop 1
    v_permlane16_swap_b32 v68, v70
    v_permlane16_swap_b32 v69, v71
    v_add_f32 v68, v68, v70
    v_add_f32 v69, v69, v71
    s_add_u32 s16, s101, 1
    v_mov_b32 v70, s16
    s_and_b32 s3, s101, 1
    s_lshl_b32 s3, s3, 7
    v_add_u32 v48, s3, v24
    s_mov_b32 exec_lo, s67
    s_mov_b32 exec_hi, s67
    ds_write_b96 v48, v[68:70]
    s_mov_b64 exec, -1
    v_mov_b64 v[66:67], v[64:65]
    s_nop 1
    v_permlane16_swap_b32 v64, v66
    v_permlane16_swap_b32 v65, v67
    s_lshl_b32 s61, s60, 21
    s_lshl_b32 s63, s101, 16
    s_add_u32 s61, s61, s63
    s_add_u32 s61, s61, 0x400000
    s_mul_i32 s3, s67, 0xffff
    s_mov_b32 exec_lo, s3
    s_mov_b32 exec_hi, s3
    buffer_store_dwordx4 v[64:67], v13, s[32:35], s61 offen sc1
    s_sub_u32 s3, 0, s67
    s_mov_b32 exec_lo, s3
    s_mov_b32 exec_hi, s3
    v_mov_b64 v[192:193], v[72:73]
    v_mov_b64 v[194:195], v[74:75]
    s_mov_b64 exec, -1
    s_add_u32 s71, s71, s67
    s_waitcnt lgkmcnt(0)
    s_branch Laq_264
Laq_262:
    s_add_u32 s16, s101, 1
    s_and_b32 s3, s101, 1
    s_lshl_b32 s3, s3, 7
    v_add_u32 v48, s3, v29
    ds_read_b128 v[68:71], v48
    s_lshl_b32 s61, s60, 21
    s_lshl_b32 s63, s101, 16
    s_add_u32 s61, s61, s63
    s_add_u32 s17, s61, 0x800000
    s_cmp_eq_u32 s71, 2
    s_cselect_b32 s67, 1, 0
    s_waitcnt lgkmcnt(0)
    v_cmp_ne_u32 vcc, s16, v70
    s_cmp_eq_u64 vcc, 0
    s_cselect_b32 s67, s67, 0
    v_add_f32 v68, v68, v68 quad_perm:[1,0,3,2] row_mask:0xf bank_mask:0xf
    v_add_f32 v69, v69, v69 quad_perm:[1,0,3,2] row_mask:0xf bank_mask:0xf
    s_nop 0
    v_add_f32 v68, v68, v68 quad_perm:[2,3,0,1] row_mask:0xf bank_mask:0xf
    v_add_f32 v69, v69, v69 quad_perm:[2,3,0,1] row_mask:0xf bank_mask:0xf
    v_mul_f32 v68, 0x3b000000, v68
    v_mul_f32 v70, v68, v68
    v_fma_f32 v69, v69, s94, -v70
    v_max_f32 v69, 0, v69
    v_add_f32 v69, 0x3727c5ac, v69
    v_rsq_f32 v69, v69
    v_sub_f32 v52, v192, v68
    v_sub_f32 v53, v193, v68
    v_sub_f32 v54, v194, v68
    v_sub_f32 v55, v195, v68
    v_mul_f32 v52, v52, v69
    v_mul_f32 v53, v53, v69
    v_mul_f32 v54, v54, v69
    v_mul_f32 v55, v55, v69
    v_cvt_pk_bf16_f32 v48, v52, v53
    v_cvt_pk_bf16_f32 v49, v54, v55
    v_mov_b64 v[50:51], v[48:49]
    s_nop 1
    v_permlane16_swap_b32 v48, v50
    v_permlane16_swap_b32 v49, v51
    s_mul_i32 s3, s67, 0xffff
    s_mov_b32 exec_lo, s3
    s_mov_b32 exec_hi, s3
    buffer_store_dwordx4 v[48:51], v13, s[32:35], s17 offen sc1
    s_mov_b64 exec, -1
    s_cmp_eq_u32 s67, 1
    s_cselect_b32 s71, 0, s71
    s_waitcnt lgkmcnt(0)
    s_branch Laq_264
Laq_263:
    s_branch L_exit
Laos_223:
    s_lshl_b32 s61, s60, 16
    s_lshl_b32 s62, s58, 5
    s_add_u32 s61, s61, s62
    s_add_u32 s73, s61, 0x9000000
    s_mov_b32 s64, 0
    s_mov_b32 s67, 0
    s_mov_b32 s69, 0
    s_mov_b32 s71, 0
    s_mov_b32 s101, 0
    s_mov_b32 s100, 0x8000000
    s_mov_b32 s70, 0
    v_mov_b32 v30, 0
Lpg_266:
    buffer_load_dword v112, v14, s[32:35], s73 offen sc1
    s_sleep 2
    s_add_u32 s99, s99, 1
    s_cmp_gt_u32 s99, 0x2dc6c0
    s_cbranch_scc0 Lto_267
    s_mov_b32 s3, 20
    s_branch L_abort
Lto_267:
    s_waitcnt vmcnt(0)
    v_cmp_ge_u32 vcc, s67, v112
    s_and_b32 vcc_lo, vcc_lo, 0xffff
    s_and_b32 vcc_hi, vcc_hi, 0x0
    s_or_b32 s3, vcc_lo, vcc_hi
    s_cbranch_scc1 Lpg_266
    s_min_u32 s62, s64, 31
    s_lshl_b32 s61, s60, 24
    s_lshl_b32 s62, s62, 19
    s_add_u32 s61, s61, s62
    s_lshl_b32 s74, s56, 11
    s_add_u32 s62, s61, 0x2000000
    s_add_u32 m0, s74, 86272
    s_nop 0
    buffer_load_dwordx4 v4, s[32:35], s62 offen offset:0 lds
    buffer_load_dwordx4 v4, s[32:35], s62 offen offset:1024 lds
    s_add_u32 s62, s61, 0x4000000
    s_add_u32 m0, s74, 94464
    s_nop 0
    buffer_load_dwordx4 v4, s[32:35], s62 offen offset:0 lds
    buffer_load_dwordx4 v4, s[32:35], s62 offen offset:1024 lds
    s_add_u32 s62, s61, 0x6000000
    s_add_u32 m0, s74, 102656
    s_nop 0
    buffer_load_dwordx4 v4, s[32:35], s62 offen offset:0 lds
    buffer_load_dwordx4 v4, s[32:35], s62 offen offset:1024 lds
    s_add_u32 s62, s61, 0x2040000
    s_add_u32 m0, s74, 110848
    s_nop 0
    buffer_load_dwordx4 v4, s[32:35], s62 offen offset:0 lds
    buffer_load_dwordx4 v4, s[32:35], s62 offen offset:1024 lds
    s_add_u32 s62, s61, 0x4040000
    s_add_u32 m0, s74, 119040
    s_nop 0
    buffer_load_dwordx4 v4, s[32:35], s62 offen offset:0 lds
    buffer_load_dwordx4 v4, s[32:35], s62 offen offset:1024 lds
    s_add_u32 s62, s61, 0x6040000
    s_add_u32 m0, s74, 127232
    s_nop 0
    buffer_load_dwordx4 v4, s[32:35], s62 offen offset:0 lds
    buffer_load_dwordx4 v4, s[32:35], s62 offen offset:1024 lds
    s_waitcnt vmcnt(0)
    s_barrier
    ds_read_b128 v[32:35], v5 offset:0
    ds_read_b128 v[48:51], v6 offset:8192
    ds_read_b128 v[64:67], v6 offset:12288
    ds_read_b128 v[36:39], v5 offset:1024
    ds_read_b128 v[52:55], v6 offset:9216
    ds_read_b128 v[68:71], v6 offset:13312
    ds_read_b128 v[40:43], v5 offset:2048
    ds_read_b128 v[56:59], v6 offset:10240
    ds_read_b128 v[72:75], v6 offset:14336
    ds_read_b128 v[44:47], v5 offset:3072
    ds_read_b128 v[60:63], v6 offset:11264
    ds_read_b128 v[76:79], v6 offset:15360
    ds_read_b128 v[80:83], v6 offset:16384
    ds_read_b128 v[84:87], v6 offset:17408
    ds_read_b128 v[88:91], v6 offset:18432
    ds_read_b128 v[92:95], v6 offset:19456
    ds_read_b128 v[96:99], v6 offset:20480
    ds_read_b128 v[100:103], v6 offset:21504
    ds_read_b128 v[104:107], v6 offset:22528
    ds_read_b128 v[108:111], v6 offset:23552
    s_waitcnt lgkmcnt(0)
    v_mfma_f32_16x16x32_bf16 v[112:115], v[48:51], v[32:35], 0
    v_mfma_f32_16x16x32_bf16 v[116:119], v[64:67], v[32:35], 0
    v_mfma_f32_16x16x32_bf16 v[112:115], v[52:55], v[36:39], v[112:115]
    v_mfma_f32_16x16x32_bf16 v[116:119], v[68:71], v[36:39], v[116:119]
    v_mfma_f32_16x16x32_bf16 v[112:115], v[56:59], v[40:43], v[112:115]
    v_mfma_f32_16x16x32_bf16 v[116:119], v[72:75], v[40:43], v[116:119]
    v_mfma_f32_16x16x32_bf16 v[112:115], v[60:63], v[44:47], v[112:115]
    v_mfma_f32_16x16x32_bf16 v[116:119], v[76:79], v[44:47], v[116:119]
    s_nop 6
    v_cndmask_b32 v112, v15, v112, s[76:77]
    v_cndmask_b32 v113, v15, v113, s[78:79]
    v_cndmask_b32 v114, v15, v114, s[80:81]
    v_cndmask_b32 v115, v15, v115, s[82:83]
    v_cndmask_b32 v116, v15, v116, s[84:85]
    v_cndmask_b32 v117, v15, v117, s[86:87]
    v_cndmask_b32 v118, v15, v118, s[88:89]
    v_cndmask_b32 v119, v15, v119, s[90:91]
    v_max3_f32 v196, v112, v113, v114
    v_max3_f32 v197, v115, v116, v117
    v_max3_f32 v196, v196, v118, v119
    v_max_f32 v196, v196, v197
    v_mov_b32 v197, v196
    s_nop 1
    v_permlane16_swap_b32 v196, v197
    v_max_f32 v196, v196, v197
    v_mov_b32 v197, v196
    s_nop 1
    v_permlane32_swap_b32 v196, v197
    v_max_f32 v196, v196, v197
    v_mul_f32 v196, s68, v196
    v_fma_f32 v112, v112, s68, -v196
    v_fma_f32 v113, v113, s68, -v196
    v_fma_f32 v114, v114, s68, -v196
    v_fma_f32 v115, v115, s68, -v196
    v_fma_f32 v116, v116, s68, -v196
    v_fma_f32 v117, v117, s68, -v196
    v_fma_f32 v118, v118, s68, -v196
    v_fma_f32 v119, v119, s68, -v196
    v_exp_f32 v112, v112
    v_exp_f32 v113, v113
    v_exp_f32 v114, v114
    v_exp_f32 v115, v115
    v_exp_f32 v116, v116
    v_exp_f32 v117, v117
    v_exp_f32 v118, v118
    v_exp_f32 v119, v119
    v_cvt_pk_bf16_f32 v120, v112, v113
    v_cvt_pk_bf16_f32 v121, v114, v115
    v_cvt_pk_bf16_f32 v122, v116, v117
    v_cvt_pk_bf16_f32 v123, v118, v119
    v_add_f32 v197, v112, v113
    v_add_f32 v197, v197, v114
    v_add_f32 v197, v197, v115
    v_add_f32 v197, v197, v116
    v_add_f32 v197, v197, v117
    v_add_f32 v197, v197, v118
    v_add_f32 v197, v197, v119
    v_mfma_f32_16x16x32_bf16 v[128:131], v[80:83], v[120:123], 0
    v_mfma_f32_16x16x32_bf16 v[132:135], v[84:87], v[120:123], 0
    v_mfma_f32_16x16x32_bf16 v[136:139], v[88:91], v[120:123], 0
    v_mfma_f32_16x16x32_bf16 v[140:143], v[92:95], v[120:123], 0
    v_mfma_f32_16x16x32_bf16 v[144:147], v[96:99], v[120:123], 0
    v_mfma_f32_16x16x32_bf16 v[148:151], v[100:103], v[120:123], 0
    v_mfma_f32_16x16x32_bf16 v[152:155], v[104:107], v[120:123], 0
    v_mfma_f32_16x16x32_bf16 v[156:159], v[108:111], v[120:123], 0
    s_barrier
    s_lshl_b32 s61, s60, 22
    s_lshl_b32 s62, s64, 17
    s_add_u32 s61, s61, s62
    s_add_u32 s62, s61, 0x1800000
    s_add_u32 s61, s61, 0x1000000
    buffer_load_dwordx4 v[160:163], v7, s[32:35], s61 offen offset:0 sc1
    buffer_load_dwordx4 v[164:167], v7, s[32:35], s61 offen offset:512 sc1
    buffer_load_dwordx4 v[168:171], v7, s[32:35], s61 offen offset:1024 sc1
    buffer_load_dwordx4 v[172:175], v7, s[32:35], s61 offen offset:1536 sc1
    buffer_load_dwordx4 v[176:179], v8, s[32:35], s62 offen offset:0 sc1
    buffer_load_dwordx4 v[180:183], v8, s[32:35], s62 offen offset:512 sc1
    buffer_load_dwordx4 v[184:187], v8, s[32:35], s62 offen offset:1024 sc1
    buffer_load_dwordx4 v[188:191], v8, s[32:35], s62 offen offset:1536 sc1
    s_waitcnt vmcnt(0)
Laol_268:
    s_add_u32 s72, s64, 1
    s_waitcnt vmcnt(4)
    v_max3_u32 v112, v160, v164, v168
    v_max3_u32 v113, v172, v176, v180
    v_max3_u32 v112, v112, v184, v188
    v_max_u32 v112, v112, v113
    v_cmp_eq_u32 vcc, -1, v112
    s_cbranch_vccz LaoA_269
    s_mov_b32 s62, 0
Laq_273:
    s_cmp_eq_u32 s71, 0
    s_cbranch_scc1 Laq_272
    s_add_u32 s99, s99, 1
    s_cmp_gt_u32 s99, 0x2dc6c0
    s_cbranch_scc0 Lto_274
    s_mov_b32 s3, 22
    s_branch L_abort
Lto_274:
    s_cmp_eq_u32 s71, 2
    s_cbranch_scc1 Laq_271
    s_lshl_b32 s63, s101, 16
    buffer_load_dwordx4 v[64:67], v13, s[44:47], s63 offen sc1
    buffer_load_dwordx4 v[48:51], v12, s[32:35], s100 offen sc1
    s_add_u32 s74, s100, 0x20000
    buffer_load_dwordx4 v[52:55], v12, s[32:35], s74 offen sc1
    s_add_u32 s74, s100, 0x40000
    buffer_load_dwordx4 v[56:59], v12, s[32:35], s74 offen sc1
    s_add_u32 s74, s100, 0x60000
    buffer_load_dwordx4 v[60:63], v12, s[32:35], s74 offen sc1
    s_waitcnt vmcnt(0)
    v_mfma_f32_16x16x32_bf16 v[72:75], v[16:19], v[48:51], 0
    v_mfma_f32_16x16x32_bf16 v[72:75], v[16:19], v[52:55], v[72:75]
    v_mfma_f32_16x16x32_bf16 v[72:75], v[20:23], v[56:59], v[72:75]
    v_mfma_f32_16x16x32_bf16 v[72:75], v[20:23], v[60:63], v[72:75]
    v_xor_b32 v68, s70, v48
    v_xor_b32 v69, s70, v52
    v_xor_b32 v70, s70, v56
    v_xor_b32 v71, s70, v60
    v_or3_b32 v68, v68, v69, v70
    v_or_b32 v68, v68, v71
    v_and_b32 v68, 1, v68
    v_cmp_ne_u32 s[18:19], 0, v68
    v_cmp_eq_u32 vcc, -1, v64
    s_or_b64 s[18:19], s[18:19], vcc
    s_cmp_eq_u64 s[18:19], 0
    s_cselect_b32 s67, s71, 0
    s_and_b32 s67, s67, 1
    v_permlane16_swap_b32 v64, v66
    v_permlane16_swap_b32 v65, v67
    v_lshlrev_b32 v68, 16, v64
    v_and_b32 v69, 0xffff0000, v64
    v_lshlrev_b32 v70, 16, v65
    v_and_b32 v71, 0xffff0000, v65
    v_add_f32 v72, v72, v68
    v_add_f32 v73, v73, v69
    v_add_f32 v74, v74, v70
    v_add_f32 v75, v75, v71
    v_cvt_pk_bf16_f32 v64, v72, v73
    v_cvt_pk_bf16_f32 v65, v74, v75
    v_lshlrev_b32 v72, 16, v64
    v_and_b32 v73, 0xffff0000, v64
    v_lshlrev_b32 v74, 16, v65
    v_and_b32 v75, 0xffff0000, v65
    v_add_f32 v68, v72, v73
    v_add_f32 v69, v74, v75
    v_add_f32 v68, v68, v69
    v_mul_f32 v69, v72, v72
    v_fmac_f32 v69, v73, v73
    v_fmac_f32 v69, v74, v74
    v_fmac_f32 v69, v75, v75
    v_add_f32 v68, v68, v68 row_ror:8 row_mask:0xf bank_mask:0xf
    s_nop 0
    v_add_f32 v69, v69, v69 row_ror:8 row_mask:0xf bank_mask:0xf
    v_add_f32 v68, v68, v68 row_ror:4 row_mask:0xf bank_mask:0xf
    s_nop 0
    v_add_f32 v69, v69, v69 row_ror:4 row_mask:0xf bank_mask:0xf
    v_add_f32 v68, v68, v68 row_ror:2 row_mask:0xf bank_mask:0xf
    s_nop 0
    v_add_f32 v69, v69, v69 row_ror:2 row_mask:0xf bank_mask:0xf
    v_add_f32 v68, v68, v68 row_ror:1 row_mask:0xf bank_mask:0xf
    s_nop 0
    v_add_f32 v69, v69, v69 row_ror:1 row_mask:0xf bank_mask:0xf
    v_mov_b64 v[70:71], v[68:69]
    s_nop 1
    v_permlane16_swap_b32 v68, v70
    v_permlane16_swap_b32 v69, v71
    v_add_f32 v68, v68, v70
    v_add_f32 v69, v69, v71
    s_add_u32 s16, s101, 1
    v_mov_b32 v70, s16
    s_and_b32 s3, s101, 1
    s_lshl_b32 s3, s3, 7
    v_add_u32 v48, s3, v24
    s_mov_b32 exec_lo, s67
    s_mov_b32 exec_hi, s67
    ds_write_b96 v48, v[68:70]
    s_mov_b64 exec, -1
    v_mov_b64 v[66:67], v[64:65]
    s_nop 1
    v_permlane16_swap_b32 v64, v66
    v_permlane16_swap_b32 v65, v67
    s_lshl_b32 s61, s60, 21
    s_lshl_b32 s63, s101, 16
    s_add_u32 s61, s61, s63
    s_add_u32 s61, s61, 0x400000
    s_mul_i32 s3, s67, 0xffff
    s_mov_b32 exec_lo, s3
    s_mov_b32 exec_hi, s3
    buffer_store_dwordx4 v[64:67], v13, s[32:35], s61 offen sc1
    s_sub_u32 s3, 0, s67
    s_mov_b32 exec_lo, s3
    s_mov_b32 exec_hi, s3
    v_mov_b64 v[192:193], v[72:73]
    v_mov_b64 v[194:195], v[74:75]
    s_mov_b64 exec, -1
    s_add_u32 s71, s71, s67
    s_waitcnt lgkmcnt(0)
    s_branch Laq_273
Laq_271:
    s_add_u32 s62, s62, 1
    s_cmp_gt_u32 s62, 5
    s_cbranch_scc1 Laq_272
    s_add_u32 s16, s101, 1
    s_and_b32 s3, s101, 1
    s_lshl_b32 s3, s3, 7
    v_add_u32 v48, s3, v29
    ds_read_b128 v[68:71], v48
    s_lshl_b32 s61, s60, 21
    s_lshl_b32 s63, s101, 16
    s_add_u32 s61, s61, s63
    s_add_u32 s17, s61, 0x800000
    s_cmp_eq_u32 s71, 2
    s_cselect_b32 s67, 1, 0
    s_waitcnt lgkmcnt(0)
    v_cmp_ne_u32 vcc, s16, v70
    s_cmp_eq_u64 vcc, 0
    s_cselect_b32 s67, s67, 0
    v_add_f32 v68, v68, v68 quad_perm:[1,0,3,2] row_mask:0xf bank_mask:0xf
    v_add_f32 v69, v69, v69 quad_perm:[1,0,3,2] row_mask:0xf bank_mask:0xf
    s_nop 0
    v_add_f32 v68, v68, v68 quad_perm:[2,3,0,1] row_mask:0xf bank_mask:0xf
    v_add_f32 v69, v69, v69 quad_perm:[2,3,0,1] row_mask:0xf bank_mask:0xf
    v_mul_f32 v68, 0x3b000000, v68
    v_mul_f32 v70, v68, v68
    v_fma_f32 v69, v69, s94, -v70
    v_max_f32 v69, 0, v69
    v_add_f32 v69, 0x3727c5ac, v69
    v_rsq_f32 v69, v69
    v_sub_f32 v52, v192, v68
    v_sub_f32 v53, v193, v68
    v_sub_f32 v54, v194, v68
    v_sub_f32 v55, v195, v68
    v_mul_f32 v52, v52, v69
    v_mul_f32 v53, v53, v69
    v_mul_f32 v54, v54, v69
    v_mul_f32 v55, v55, v69
    v_cvt_pk_bf16_f32 v48, v52, v53
    v_cvt_pk_bf16_f32 v49, v54, v55
    v_mov_b64 v[50:51], v[48:49]
    s_nop 1
    v_permlane16_swap_b32 v48, v50
    v_permlane16_swap_b32 v49, v51
    s_mul_i32 s3, s67, 0xffff
    s_mov_b32 exec_lo, s3
    s_mov_b32 exec_hi, s3
    buffer_store_dwordx4 v[48:51], v13, s[32:35], s17 offen sc1
    s_mov_b64 exec, -1
    s_cmp_eq_u32 s67, 1
    s_cselect_b32 s71, 0, s71
    s_waitcnt lgkmcnt(0)
    s_branch Laq_273
Laq_272:
    s_nop 0
Lakm_270:
    s_cmp_lg_u32 s71, 2
    s_cbranch_scc1 Laq_275
    s_add_u32 s16, s101, 1
    s_and_b32 s3, s101, 1
    s_lshl_b32 s3, s3, 7
    v_add_u32 v48, s3, v29
    ds_read_b128 v[68:71], v48
    s_lshl_b32 s61, s60, 21
    s_lshl_b32 s63, s101, 16
    s_add_u32 s61, s61, s63
    s_add_u32 s17, s61, 0x800000
    s_cmp_eq_u32 s71, 2
    s_cselect_b32 s67, 1, 0
    s_waitcnt lgkmcnt(0)
    v_cmp_ne_u32 vcc, s16, v70
    s_cmp_eq_u64 vcc, 0
    s_cselect_b32 s67, s67, 0
    v_add_f32 v68, v68, v68 quad_perm:[1,0,3,2] row_mask:0xf bank_mask:0xf
    v_add_f32 v69, v69, v69 quad_perm:[1,0,3,2] row_mask:0xf bank_mask:0xf
    s_nop 0
    v_add_f32 v68, v68, v68 quad_perm:[2,3,0,1] row_mask:0xf bank_mask:0xf
    v_add_f32 v69, v69, v69 quad_perm:[2,3,0,1] row_mask:0xf bank_mask:0xf
    v_mul_f32 v68, 0x3b000000, v68
    v_mul_f32 v70, v68, v68
    v_fma_f32 v69, v69, s94, -v70
    v_max_f32 v69, 0, v69
    v_add_f32 v69, 0x3727c5ac, v69
    v_rsq_f32 v69, v69
    v_sub_f32 v52, v192, v68
    v_sub_f32 v53, v193, v68
    v_sub_f32 v54, v194, v68
    v_sub_f32 v55, v195, v68
    v_mul_f32 v52, v52, v69
    v_mul_f32 v53, v53, v69
    v_mul_f32 v54, v54, v69
    v_mul_f32 v55, v55, v69
    v_cvt_pk_bf16_f32 v48, v52, v53
    v_cvt_pk_bf16_f32 v49, v54, v55
    v_mov_b64 v[50:51], v[48:49]
    s_nop 1
    v_permlane16_swap_b32 v48, v50
    v_permlane16_swap_b32 v49, v51
    s_mul_i32 s3, s67, 0xffff
    s_mov_b32 exec_lo, s3
    s_mov_b32 exec_hi, s3
    buffer_store_dwordx4 v[48:51], v13, s[32:35], s17 offen sc1
    s_mov_b64 exec, -1
    s_cmp_eq_u32 s67, 1
    s_cselect_b32 s71, 0, s71
    s_waitcnt lgkmcnt(0)
Laq_275:
    s_lshl_b32 s61, s60, 22
    s_lshl_b32 s62, s64, 17
    s_add_u32 s61, s61, s62
    s_add_u32 s62, s61, 0x1800000
    s_add_u32 s61, s61, 0x1000000
    buffer_load_dwordx4 v[160:163], v7, s[32:35], s61 offen offset:0 sc1
    buffer_load_dwordx4 v[164:167], v7, s[32:35], s61 offen offset:512 sc1
    buffer_load_dwordx4 v[168:171], v7, s[32:35], s61 offen offset:1024 sc1
    buffer_load_dwordx4 v[172:175], v7, s[32:35], s61 offen offset:1536 sc1
    buffer_load_dwordx4 v[176:179], v8, s[32:35], s62 offen offset:0 sc1
    buffer_load_dwordx4 v[180:183], v8, s[32:35], s62 offen offset:512 sc1
    buffer_load_dwordx4 v[184:187], v8, s[32:35], s62 offen offset:1024 sc1
    buffer_load_dwordx4 v[188:191], v8, s[32:35], s62 offen offset:1536 sc1
    s_sleep 2
    s_add_u32 s99, s99, 1
    s_cmp_gt_u32 s99, 0x2dc6c0
    s_cbranch_scc0 Lto_276
    s_mov_b32 s3, 21
    s_branch L_abort
Lto_276:
    s_waitcnt vmcnt(0)
    v_max3_u32 v112, v160, v164, v168
    v_max3_u32 v113, v172, v176, v180
    v_max3_u32 v112, v112, v184, v188
    v_max_u32 v112, v112, v113
    v_cmp_eq_u32 vcc, -1, v112
    s_cbranch_vccnz Lakm_270
LaoA_269:
    s_nop 3
    v_mfma_f32_16x16x32_bf16 v[120:123], v[160:163], v[32:35], 0
    v_mfma_f32_16x16x32_bf16 v[120:123], v[164:167], v[36:39], v[120:123]
    v_mfma_f32_16x16x32_bf16 v[120:123], v[168:171], v[40:43], v[120:123]
    v_mfma_f32_16x16x32_bf16 v[120:123], v[172:175], v[44:47], v[120:123]
    s_lshr_b32 s75, s64, 1
    s_and_b32 s75, s75, 1
    s_and_b32 s3, s64, 1
    s_lshl_b32 s3, s3, 19
    s_lshl_b32 s61, s60, 21
    s_add_u32 s61, s61, s3
    s_add_u32 s98, s61, 0x8000000
    s_add_u32 s95, s98, 0x100000
    v_cndmask_b32 v120, v15, v120, s[92:93]
    v_cndmask_b32 v121, v15, v121, s[92:93]
    v_cndmask_b32 v122, v15, v122, s[92:93]
    v_cndmask_b32 v123, v15, v123, s[92:93]
    v_max3_f32 v112, v120, v121, v122
    v_max_f32 v112, v112, v123
    v_mov_b32 v114, v112
    s_nop 1
    v_permlane16_swap_b32 v112, v114
    v_max_f32 v112, v112, v114
    v_mov_b32 v114, v112
    s_nop 1
    v_permlane32_swap_b32 v112, v114
    v_max_f32 v112, v112, v114
    v_mul_f32 v112, s68, v112
    v_max_f32 v112, v112, v196
    v_sub_f32 v113, v196, v112
    v_fma_f32 v120, v120, s68, -v112
    v_fma_f32 v121, v121, s68, -v112
    v_fma_f32 v122, v122, s68, -v112
    v_fma_f32 v123, v123, s68, -v112
    v_exp_f32 v113, v113
    v_exp_f32 v120, v120
    v_exp_f32 v121, v121
    v_exp_f32 v122, v122
    v_exp_f32 v123, v123
    v_mul_f32 v197, v197, v113
    v_add_f32 v197, v197, v120
    v_add_f32 v197, v197, v121
    v_add_f32 v197, v197, v122
    v_add_f32 v197, v197, v123
    v_mov_b32 v114, v197
    s_nop 1
    v_permlane16_swap_b32 v197, v114
    v_add_f32 v197, v197, v114
    v_mov_b32 v114, v197
    s_nop 1
    v_permlane32_swap_b32 v197, v114
    v_add_f32 v197, v197, v114
    v_rcp_f32 v197, v197
    s_nop 0
    v_mul_f32 v113, v113, v197
    v_mov_b32 v112, v113
    v_mul_f32 v120, v120, v197
    v_mul_f32 v121, v121, v197
    v_mul_f32 v122, v122, v197
    v_mul_f32 v123, v123, v197
    v_cvt_pk_bf16_f32 v116, v120, v121
    v_cvt_pk_bf16_f32 v117, v122, v123
    s_add_u32 s74, s95, 4096
    v_pk_mul_f32 v[128:129], v[128:129], v[112:113]
    v_pk_mul_f32 v[130:131], v[130:131], v[112:113]
    v_pk_mul_f32 v[132:133], v[132:133], v[112:113]
    v_pk_mul_f32 v[134:135], v[134:135], v[112:113]
    v_pk_mul_f32 v[136:137], v[136:137], v[112:113]
    v_pk_mul_f32 v[138:139], v[138:139], v[112:113]
    v_pk_mul_f32 v[140:141], v[140:141], v[112:113]
    v_pk_mul_f32 v[142:143], v[142:143], v[112:113]
    v_pk_mul_f32 v[144:145], v[144:145], v[112:113]
    v_pk_mul_f32 v[146:147], v[146:147], v[112:113]
    v_pk_mul_f32 v[148:149], v[148:149], v[112:113]
    v_pk_mul_f32 v[150:151], v[150:151], v[112:113]
    v_pk_mul_f32 v[152:153], v[152:153], v[112:113]
    v_pk_mul_f32 v[154:155], v[154:155], v[112:113]
    v_pk_mul_f32 v[156:157], v[156:157], v[112:113]
    v_pk_mul_f32 v[158:159], v[158:159], v[112:113]
    v_mfma_f32_16x16x16_bf16 v[128:131], v[176:177], v[116:117], v[128:131]
    v_mfma_f32_16x16x16_bf16 v[132:135], v[178:179], v[116:117], v[132:135]
    v_mfma_f32_16x16x16_bf16 v[136:139], v[180:181], v[116:117], v[136:139]
    v_mfma_f32_16x16x16_bf16 v[140:143], v[182:183], v[116:117], v[140:143]
    v_mfma_f32_16x16x16_bf16 v[144:147], v[184:185], v[116:117], v[144:147]
    v_mfma_f32_16x16x16_bf16 v[148:151], v[186:187], v[116:117], v[148:151]
    v_mfma_f32_16x16x16_bf16 v[152:155], v[188:189], v[116:117], v[152:155]
    v_mfma_f32_16x16x16_bf16 v[156:159], v[190:191], v[116:117], v[156:159]
    s_nop 1
    v_cvt_pk_bf16_f32 v160, v128, v132
    v_cvt_pk_bf16_f32 v161, v129, v133
    v_cvt_pk_bf16_f32 v162, v130, v134
    v_cvt_pk_bf16_f32 v163, v131, v135
    v_bfi_b32 v160, 1, s75, v160
    buffer_store_dwordx4 v[160:163], v9, s[32:35], s95 offen offset:0 sc1
    v_cvt_pk_bf16_f32 v164, v136, v140
    v_cvt_pk_bf16_f32 v165, v137, v141
    v_cvt_pk_bf16_f32 v166, v138, v142
    v_cvt_pk_bf16_f32 v167, v139, v143
    v_bfi_b32 v164, 1, s75, v164
    buffer_store_dwordx4 v[164:167], v9, s[32:35], s95 offen offset:2048 sc1
    v_cvt_pk_bf16_f32 v168, v144, v148
    v_cvt_pk_bf16_f32 v169, v145, v149
    v_cvt_pk_bf16_f32 v170, v146, v150
    v_cvt_pk_bf16_f32 v171, v147, v151
    v_bfi_b32 v168, 1, s75, v168
    buffer_store_dwordx4 v[168:171], v9, s[32:35], s74 offen offset:0 sc1
    v_cvt_pk_bf16_f32 v172, v152, v156
    v_cvt_pk_bf16_f32 v173, v153, v157
    v_cvt_pk_bf16_f32 v174, v154, v158
    v_cvt_pk_bf16_f32 v175, v155, v159
    v_bfi_b32 v172, 1, s75, v172
    buffer_store_dwordx4 v[172:175], v9, s[32:35], s74 offen offset:2048 sc1
    s_cmp_ge_u32 s69, s72
    s_cbranch_scc1 Laoh_277
    s_mov_b32 s3, s72
    s_min_u32 s3, s3, 31
    s_lshl_b32 s3, s3, 11
    s_add_u32 s74, s3, s73
    s_mov_b32 s67, 0
Lpg_278:
    buffer_load_dword v112, v14, s[32:35], s74 offen sc1
    s_sleep 2
    s_add_u32 s99, s99, 1
    s_cmp_gt_u32 s99, 0x2dc6c0
    s_cbranch_scc0 Lto_279
    s_mov_b32 s3, 20
    s_branch L_abort
Lto_279:
    s_waitcnt vmcnt(0)
    v_cmp_ge_u32 vcc, s67, v112
    s_and_b32 vcc_lo, vcc_lo, 0xffff
    s_and_b32 vcc_hi, vcc_hi, 0x0
    s_or_b32 s3, vcc_lo, vcc_hi
    s_cbranch_scc1 Lpg_278
    s_min_u32 s62, s72, 31
    s_lshl_b32 s61, s60, 24
    s_lshl_b32 s62, s62, 19
    s_add_u32 s61, s61, s62
    s_lshl_b32 s74, s56, 11
    s_add_u32 s62, s61, 0x2000000
    s_add_u32 m0, s74, 86272
    s_nop 0
    buffer_load_dwordx4 v4, s[32:35], s62 offen offset:0 lds
    buffer_load_dwordx4 v4, s[32:35], s62 offen offset:1024 lds
    s_add_u32 s62, s61, 0x4000000
    s_add_u32 m0, s74, 94464
    s_nop 0
    buffer_load_dwordx4 v4, s[32:35], s62 offen offset:0 lds
    buffer_load_dwordx4 v4, s[32:35], s62 offen offset:1024 lds
    s_add_u32 s62, s61, 0x6000000
    s_add_u32 m0, s74, 102656
    s_nop 0
    buffer_load_dwordx4 v4, s[32:35], s62 offen offset:0 lds
    buffer_load_dwordx4 v4, s[32:35], s62 offen offset:1024 lds
    s_add_u32 s62, s61, 0x2040000
    s_add_u32 m0, s74, 110848
    s_nop 0
    buffer_load_dwordx4 v4, s[32:35], s62 offen offset:0 lds
    buffer_load_dwordx4 v4, s[32:35], s62 offen offset:1024 lds
    s_add_u32 s62, s61, 0x4040000
    s_add_u32 m0, s74, 119040
    s_nop 0
    buffer_load_dwordx4 v4, s[32:35], s62 offen offset:0 lds
    buffer_load_dwordx4 v4, s[32:35], s62 offen offset:1024 lds
    s_add_u32 s62, s61, 0x6040000
    s_add_u32 m0, s74, 127232
    s_nop 0
    buffer_load_dwordx4 v4, s[32:35], s62 offen offset:0 lds
    buffer_load_dwordx4 v4, s[32:35], s62 offen offset:1024 lds
    s_mov_b32 s69, s72
Laoh_277:
    s_mov_b32 s66, 0
Laop_281:
    s_mov_b64 exec, 15
    buffer_load_dword v112, v31, s[32:35], s95 offen sc1
    s_mov_b64 exec, -1
    s_add_u32 s99, s99, 1
    s_cmp_gt_u32 s99, 0x2dc6c0
    s_cbranch_scc0 Lto_283
    s_mov_b32 s3, 28
    s_branch L_abort
Lto_283:
    s_waitcnt vmcnt(0)
    v_xor_b32 v112, s75, v112
    v_and_b32 v112, 1, v112
    v_cmp_ne_u32 vcc, 0, v112
    s_and_b32 s3, vcc_lo, 15
    s_cbranch_scc0 Laox_280
    s_cmp_lg_u32 s71, 2
    s_cbranch_scc1 Laq_284
    s_add_u32 s16, s101, 1
    s_and_b32 s3, s101, 1
    s_lshl_b32 s3, s3, 7
    v_add_u32 v48, s3, v29
    ds_read_b128 v[68:71], v48
    s_lshl_b32 s61, s60, 21
    s_lshl_b32 s63, s101, 16
    s_add_u32 s61, s61, s63
    s_add_u32 s17, s61, 0x800000
    s_cmp_eq_u32 s71, 2
    s_cselect_b32 s67, 1, 0
    s_waitcnt lgkmcnt(0)
    v_cmp_ne_u32 vcc, s16, v70
    s_cmp_eq_u64 vcc, 0
    s_cselect_b32 s67, s67, 0
    v_add_f32 v68, v68, v68 quad_perm:[1,0,3,2] row_mask:0xf bank_mask:0xf
    v_add_f32 v69, v69, v69 quad_perm:[1,0,3,2] row_mask:0xf bank_mask:0xf
    s_nop 0
    v_add_f32 v68, v68, v68 quad_perm:[2,3,0,1] row_mask:0xf bank_mask:0xf
    v_add_f32 v69, v69, v69 quad_perm:[2,3,0,1] row_mask:0xf bank_mask:0xf
    v_mul_f32 v68, 0x3b000000, v68
    v_mul_f32 v70, v68, v68
    v_fma_f32 v69, v69, s94, -v70
    v_max_f32 v69, 0, v69
    v_add_f32 v69, 0x3727c5ac, v69
    v_rsq_f32 v69, v69
    v_sub_f32 v52, v192, v68
    v_sub_f32 v53, v193, v68
    v_sub_f32 v54, v194, v68
    v_sub_f32 v55, v195, v68
    v_mul_f32 v52, v52, v69
    v_mul_f32 v53, v53, v69
    v_mul_f32 v54, v54, v69
    v_mul_f32 v55, v55, v69
    v_cvt_pk_bf16_f32 v48, v52, v53
    v_cvt_pk_bf16_f32 v49, v54, v55
    v_mov_b64 v[50:51], v[48:49]
    s_nop 1
    v_permlane16_swap_b32 v48, v50
    v_permlane16_swap_b32 v49, v51
    s_mul_i32 s3, s67, 0xffff
    s_mov_b32 exec_lo, s3
    s_mov_b32 exec_hi, s3
    buffer_store_dwordx4 v[48:51], v13, s[32:35], s17 offen sc1
    s_mov_b64 exec, -1
    s_cmp_eq_u32 s67, 1
    s_cselect_b32 s71, 0, s71
    s_waitcnt lgkmcnt(0)
Laq_284:
    s_nop 0
    s_add_u32 s66, s66, 1
    s_cmp_lg_u32 s66, 6
    s_cbranch_scc1 Laop_281
    s_mov_b32 s62, 0
Laq_287:
    s_cmp_eq_u32 s71, 0
    s_cbranch_scc1 Laq_286
    s_add_u32 s99, s99, 1
    s_cmp_gt_u32 s99, 0x2dc6c0
    s_cbranch_scc0 Lto_288
    s_mov_b32 s3, 22
    s_branch L_abort
Lto_288:
    s_cmp_eq_u32 s71, 2
    s_cbranch_scc1 Laq_285
    s_lshl_b32 s63, s101, 16
    buffer_load_dwordx4 v[64:67], v13, s[44:47], s63 offen sc1
    buffer_load_dwordx4 v[48:51], v12, s[32:35], s100 offen sc1
    s_add_u32 s74, s100, 0x20000
    buffer_load_dwordx4 v[52:55], v12, s[32:35], s74 offen sc1
    s_add_u32 s74, s100, 0x40000
    buffer_load_dwordx4 v[56:59], v12, s[32:35], s74 offen sc1
    s_add_u32 s74, s100, 0x60000
    buffer_load_dwordx4 v[60:63], v12, s[32:35], s74 offen sc1
    s_waitcnt vmcnt(0)
    v_mfma_f32_16x16x32_bf16 v[72:75], v[16:19], v[48:51], 0
    v_mfma_f32_16x16x32_bf16 v[72:75], v[16:19], v[52:55], v[72:75]
    v_mfma_f32_16x16x32_bf16 v[72:75], v[20:23], v[56:59], v[72:75]
    v_mfma_f32_16x16x32_bf16 v[72:75], v[20:23], v[60:63], v[72:75]
    v_xor_b32 v68, s70, v48
    v_xor_b32 v69, s70, v52
    v_xor_b32 v70, s70, v56
    v_xor_b32 v71, s70, v60
    v_or3_b32 v68, v68, v69, v70
    v_or_b32 v68, v68, v71
    v_and_b32 v68, 1, v68
    v_cmp_ne_u32 s[18:19], 0, v68
    v_cmp_eq_u32 vcc, -1, v64
    s_or_b64 s[18:19], s[18:19], vcc
    s_cmp_eq_u64 s[18:19], 0
    s_cselect_b32 s67, s71, 0
    s_and_b32 s67, s67, 1
    v_permlane16_swap_b32 v64, v66
    v_permlane16_swap_b32 v65, v67
    v_lshlrev_b32 v68, 16, v64
    v_and_b32 v69, 0xffff0000, v64
    v_lshlrev_b32 v70, 16, v65
    v_and_b32 v71, 0xffff0000, v65
    v_add_f32 v72, v72, v68
    v_add_f32 v73, v73, v69
    v_add_f32 v74, v74, v70
    v_add_f32 v75, v75, v71
    v_cvt_pk_bf16_f32 v64, v72, v73
    v_cvt_pk_bf16_f32 v65, v74, v75
    v_lshlrev_b32 v72, 16, v64
    v_and_b32 v73, 0xffff0000, v64
    v_lshlrev_b32 v74, 16, v65
    v_and_b32 v75, 0xffff0000, v65
    v_add_f32 v68, v72, v73
    v_add_f32 v69, v74, v75
    v_add_f32 v68, v68, v69
    v_mul_f32 v69, v72, v72
    v_fmac_f32 v69, v73, v73
    v_fmac_f32 v69, v74, v74
    v_fmac_f32 v69, v75, v75
    v_add_f32 v68, v68, v68 row_ror:8 row_mask:0xf bank_mask:0xf
    s_nop 0
    v_add_f32 v69, v69, v69 row_ror:8 row_mask:0xf bank_mask:0xf
    v_add_f32 v68, v68, v68 row_ror:4 row_mask:0xf bank_mask:0xf
    s_nop 0
    v_add_f32 v69, v69, v69 row_ror:4 row_mask:0xf bank_mask:0xf
    v_add_f32 v68, v68, v68 row_ror:2 row_mask:0xf bank_mask:0xf
    s_nop 0
    v_add_f32 v69, v69, v69 row_ror:2 row_mask:0xf bank_mask:0xf
    v_add_f32 v68, v68, v68 row_ror:1 row_mask:0xf bank_mask:0xf
    s_nop 0
    v_add_f32 v69, v69, v69 row_ror:1 row_mask:0xf bank_mask:0xf
    v_mov_b64 v[70:71], v[68:69]
    s_nop 1
    v_permlane16_swap_b32 v68, v70
    v_permlane16_swap_b32 v69, v71
    v_add_f32 v68, v68, v70
    v_add_f32 v69, v69, v71
    s_add_u32 s16, s101, 1
    v_mov_b32 v70, s16
    s_and_b32 s3, s101, 1
    s_lshl_b32 s3, s3, 7
    v_add_u32 v48, s3, v24
    s_mov_b32 exec_lo, s67
    s_mov_b32 exec_hi, s67
    ds_write_b96 v48, v[68:70]
    s_mov_b64 exec, -1
    v_mov_b64 v[66:67], v[64:65]
    s_nop 1
    v_permlane16_swap_b32 v64, v66
    v_permlane16_swap_b32 v65, v67
    s_lshl_b32 s61, s60, 21
    s_lshl_b32 s63, s101, 16
    s_add_u32 s61, s61, s63
    s_add_u32 s61, s61, 0x400000
    s_mul_i32 s3, s67, 0xffff
    s_mov_b32 exec_lo, s3
    s_mov_b32 exec_hi, s3
    buffer_store_dwordx4 v[64:67], v13, s[32:35], s61 offen sc1
    s_sub_u32 s3, 0, s67
    s_mov_b32 exec_lo, s3
    s_mov_b32 exec_hi, s3
    v_mov_b64 v[192:193], v[72:73]
    v_mov_b64 v[194:195], v[74:75]
    s_mov_b64 exec, -1
    s_add_u32 s71, s71, s67
    s_waitcnt lgkmcnt(0)
    s_branch Laq_287
Laq_285:
    s_add_u32 s62, s62, 1
    s_cmp_gt_u32 s62, 5
    s_cbranch_scc1 Laq_286
    s_add_u32 s16, s101, 1
    s_and_b32 s3, s101, 1
    s_lshl_b32 s3, s3, 7
    v_add_u32 v48, s3, v29
    ds_read_b128 v[68:71], v48
    s_lshl_b32 s61, s60, 21
    s_lshl_b32 s63, s101, 16
    s_add_u32 s61, s61, s63
    s_add_u32 s17, s61, 0x800000
    s_cmp_eq_u32 s71, 2
    s_cselect_b32 s67, 1, 0
    s_waitcnt lgkmcnt(0)
    v_cmp_ne_u32 vcc, s16, v70
    s_cmp_eq_u64 vcc, 0
    s_cselect_b32 s67, s67, 0
    v_add_f32 v68, v68, v68 quad_perm:[1,0,3,2] row_mask:0xf bank_mask:0xf
    v_add_f32 v69, v69, v69 quad_perm:[1,0,3,2] row_mask:0xf bank_mask:0xf
    s_nop 0
    v_add_f32 v68, v68, v68 quad_perm:[2,3,0,1] row_mask:0xf bank_mask:0xf
    v_add_f32 v69, v69, v69 quad_perm:[2,3,0,1] row_mask:0xf bank_mask:0xf
    v_mul_f32 v68, 0x3b000000, v68
    v_mul_f32 v70, v68, v68
    v_fma_f32 v69, v69, s94, -v70
    v_max_f32 v69, 0, v69
    v_add_f32 v69, 0x3727c5ac, v69
    v_rsq_f32 v69, v69
    v_sub_f32 v52, v192, v68
    v_sub_f32 v53, v193, v68
    v_sub_f32 v54, v194, v68
    v_sub_f32 v55, v195, v68
    v_mul_f32 v52, v52, v69
    v_mul_f32 v53, v53, v69
    v_mul_f32 v54, v54, v69
    v_mul_f32 v55, v55, v69
    v_cvt_pk_bf16_f32 v48, v52, v53
    v_cvt_pk_bf16_f32 v49, v54, v55
    v_mov_b64 v[50:51], v[48:49]
    s_nop 1
    v_permlane16_swap_b32 v48, v50
    v_permlane16_swap_b32 v49, v51
    s_mul_i32 s3, s67, 0xffff
    s_mov_b32 exec_lo, s3
    s_mov_b32 exec_hi, s3
    buffer_store_dwordx4 v[48:51], v13, s[32:35], s17 offen sc1
    s_mov_b64 exec, -1
    s_cmp_eq_u32 s67, 1
    s_cselect_b32 s71, 0, s71
    s_waitcnt lgkmcnt(0)
    s_branch Laq_287
Laq_286:
    s_branch Laop_281
Laox_280:
    s_lshl_b32 s63, s56, 13
    s_add_u32 s74, s95, 0x0
    s_add_u32 m0, s63, 0
    s_nop 0
    buffer_load_dwordx4 v11, s[32:35], s74 offen offset:0 sc1 lds
    buffer_load_dwordx4 v11, s[32:35], s74 offen offset:1024 sc1 lds
    buffer_load_dwordx4 v11, s[32:35], s74 offen offset:2048 sc1 lds
    buffer_load_dwordx4 v11, s[32:35], s74 offen offset:3072 sc1 lds
    s_add_u32 s74, s95, 0x1000
    s_add_u32 m0, s63, 4096
    s_nop 0
    buffer_load_dwordx4 v11, s[32:35], s74 offen offset:0 sc1 lds
    buffer_load_dwordx4 v11, s[32:35], s74 offen offset:1024 sc1 lds
    buffer_load_dwordx4 v11, s[32:35], s74 offen offset:2048 sc1 lds
    buffer_load_dwordx4 v11, s[32:35], s74 offen offset:3072 sc1 lds
    s_add_u32 s74, s95, 0x40000
    s_add_u32 m0, s63, 32768
    s_nop 0
    buffer_load_dwordx4 v11, s[32:35], s74 offen offset:0 sc1 lds
    buffer_load_dwordx4 v11, s[32:35], s74 offen offset:1024 sc1 lds
    buffer_load_dwordx4 v11, s[32:35], s74 offen offset:2048 sc1 lds
    buffer_load_dwordx4 v11, s[32:35], s74 offen offset:3072 sc1 lds
    s_add_u32 s74, s95, 0x41000
    s_add_u32 m0, s63, 36864
    s_nop 0
    buffer_load_dwordx4 v11, s[32:35], s74 offen offset:0 sc1 lds
    buffer_load_dwordx4 v11, s[32:35], s74 offen offset:1024 sc1 lds
    buffer_load_dwordx4 v11, s[32:35], s74 offen offset:2048 sc1 lds
    buffer_load_dwordx4 v11, s[32:35], s74 offen offset:3072 sc1 lds
    s_add_u32 s99, s99, 1
    s_cmp_gt_u32 s99, 0x2dc6c0
    s_cbranch_scc0 Lto_289
    s_mov_b32 s3, 24
    s_branch L_abort
Lto_289:
    s_waitcnt vmcnt(0)
    ds_read_b32 v48, v25 offset:0
    ds_read_b32 v49, v25 offset:1024
    ds_read_b32 v50, v25 offset:2048
    ds_read_b32 v51, v25 offset:3072
    ds_read_b32 v52, v25 offset:4096
    ds_read_b32 v53, v25 offset:5120
    ds_read_b32 v54, v25 offset:6144
    ds_read_b32 v55, v25 offset:7168
    ds_read_b32 v56, v25 offset:32768
    ds_read_b32 v57, v25 offset:33792
    ds_read_b32 v58, v25 offset:34816
    ds_read_b32 v59, v25 offset:35840
    ds_read_b32 v60, v25 offset:36864
    ds_read_b32 v61, v25 offset:37888
    ds_read_b32 v62, v25 offset:38912
    ds_read_b32 v63, v25 offset:39936
    s_cmp_eq_u32 s75, 0
    s_waitcnt lgkmcnt(0)
    s_cbranch_scc0 Laot_290
    v_or3_b32 v48, v48, v49, v50
    v_or3_b32 v48, v48, v51, v52
    v_or3_b32 v48, v48, v53, v54
    v_or3_b32 v48, v48, v55, v56
    v_or3_b32 v48, v48, v57, v58
    v_or3_b32 v48, v48, v59, v60
    v_or3_b32 v48, v48, v61, v62
    v_or_b32 v48, v48, v63
    s_branch Laot_291
Laot_290:
    v_and_b32 v48, v48, v49
    v_and_b32 v48, v48, v50
    v_and_b32 v48, v48, v51
    v_and_b32 v48, v48, v52
    v_and_b32 v48, v48, v53
    v_and_b32 v48, v48, v54
    v_and_b32 v48, v48, v55
    v_and_b32 v48, v48, v56
    v_and_b32 v48, v48, v57
    v_and_b32 v48, v48, v58
    v_and_b32 v48, v48, v59
    v_and_b32 v48, v48, v60
    v_and_b32 v48, v48, v61
    v_and_b32 v48, v48, v62
    v_and_b32 v48, v48, v63
    v_not_b32 v48, v48
Laot_291:
    v_and_b32 v48, 1, v48
    v_cmp_ne_u32 vcc, 0, v48
    s_cbranch_vccnz Laox_280
    s_lshl_b32 s63, s101, 16
    buffer_load_dwordx4 v[176:179], v13, s[44:47], s63 offen sc1
    buffer_load_dwordx4 v[160:163], v12, s[32:35], s100 offen sc1
    s_add_u32 s74, s100, 0x20000
    buffer_load_dwordx4 v[164:167], v12, s[32:35], s74 offen sc1
    s_add_u32 s74, s100, 0x40000
    buffer_load_dwordx4 v[168:171], v12, s[32:35], s74 offen sc1
    s_add_u32 s74, s100, 0x60000
    buffer_load_dwordx4 v[172:175], v12, s[32:35], s74 offen sc1
    s_add_u32 s3, s64, 2
    s_min_u32 s3, s3, 31
    s_lshl_b32 s3, s3, 11
    s_add_u32 s74, s3, s73
    buffer_load_dword v30, v14, s[32:35], s74 offen sc1
    s_waitcnt lgkmcnt(0)
    s_barrier
    ds_read_b128 v[200:203], v10 offset:0
    ds_read_b128 v[204:207], v10 offset:32768
    ds_read_b128 v[208:211], v10 offset:1024
    ds_read_b128 v[212:215], v10 offset:33792
    ds_read_b128 v[216:219], v10 offset:2048
    s_min_u32 s65, s72, 31
    ds_read_b128 v[220:223], v10 offset:34816
    s_waitcnt lgkmcnt(4)
    v_mfma_f32_32x32x16_bf16 v[224:239], a[0:3], v[200:203], 0
    ds_read_b128 v[32:35], v5 offset:0
    ds_read_b128 v[48:51], v6 offset:8192
    ds_read_b128 v[64:67], v6 offset:12288
    ds_read_b128 v[200:203], v10 offset:3072
    v_mfma_f32_32x32x16_bf16 v[240:255], a[0:3], v[204:207], 0
    ds_read_b128 v[36:39], v5 offset:1024
    ds_read_b128 v[52:55], v6 offset:9216
    ds_read_b128 v[68:71], v6 offset:13312
    ds_read_b128 v[204:207], v10 offset:35840
    s_waitcnt lgkmcnt(10)
    v_mfma_f32_32x32x16_bf16 v[224:239], a[4:7], v[208:211], v[224:239]
    ds_read_b128 v[40:43], v5 offset:2048
    ds_read_b128 v[56:59], v6 offset:10240
    ds_read_b128 v[72:75], v6 offset:14336
    ds_read_b128 v[208:211], v10 offset:4096
    v_mfma_f32_32x32x16_bf16 v[240:255], a[4:7], v[212:215], v[240:255]
    ds_read_b128 v[44:47], v5 offset:3072
    ds_read_b128 v[60:63], v6 offset:11264
    ds_read_b128 v[76:79], v6 offset:15360
    ds_read_b128 v[212:215], v10 offset:36864
    s_waitcnt lgkmcnt(15)
    v_mfma_f32_32x32x16_bf16 v[224:239], a[8:11], v[216:219], v[224:239]
    ds_read_b128 v[80:83], v6 offset:16384
    ds_read_b128 v[84:87], v6 offset:17408
    ds_read_b128 v[88:91], v6 offset:18432
    ds_read_b128 v[216:219], v10 offset:5120
    v_mfma_f32_32x32x16_bf16 v[240:255], a[8:11], v[220:223], v[240:255]
    ds_read_b128 v[92:95], v6 offset:19456
    ds_read_b128 v[96:99], v6 offset:20480
    ds_read_b128 v[100:103], v6 offset:21504
    ds_read_b128 v[220:223], v10 offset:37888
    s_waitcnt lgkmcnt(15)
    v_mfma_f32_32x32x16_bf16 v[224:239], a[12:15], v[200:203], v[224:239]
    ds_read_b128 v[104:107], v6 offset:22528
    ds_read_b128 v[108:111], v6 offset:23552
    ds_read_b128 v[200:203], v10 offset:6144
    v_mfma_f32_32x32x16_bf16 v[240:255], a[12:15], v[204:207], v[240:255]
    ds_read_b128 v[204:207], v10 offset:38912
    s_waitcnt lgkmcnt(12)
    v_mfma_f32_32x32x16_bf16 v[224:239], a[16:19], v[208:211], v[224:239]
    s_waitcnt lgkmcnt(2)
    s_barrier
    v_mfma_f32_16x16x32_bf16 v[112:115], v[48:51], v[32:35], 0
    v_mfma_f32_16x16x32_bf16 v[116:119], v[64:67], v[32:35], 0
    v_mfma_f32_16x16x32_bf16 v[112:115], v[52:55], v[36:39], v[112:115]
    v_mfma_f32_16x16x32_bf16 v[116:119], v[68:71], v[36:39], v[116:119]
    v_mfma_f32_16x16x32_bf16 v[112:115], v[56:59], v[40:43], v[112:115]
    ds_read_b128 v[208:211], v10 offset:7168
    v_mfma_f32_32x32x16_bf16 v[240:255], a[16:19], v[212:215], v[240:255]
    v_mfma_f32_16x16x32_bf16 v[116:119], v[72:75], v[40:43], v[116:119]
    v_mfma_f32_16x16x32_bf16 v[112:115], v[60:63], v[44:47], v[112:115]
    v_mfma_f32_16x16x32_bf16 v[116:119], v[76:79], v[44:47], v[116:119]
    s_waitcnt vmcnt(0)
    ds_read_b128 v[212:215], v10 offset:39936
    v_mfma_f32_32x32x16_bf16 v[224:239], a[20:23], v[216:219], v[224:239]
    v_mfma_f32_16x16x32_bf16 v[184:187], v[16:19], v[160:163], 0
    v_mfma_f32_16x16x32_bf16 v[184:187], v[16:19], v[164:167], v[184:187]
    v_mfma_f32_16x16x32_bf16 v[184:187], v[20:23], v[168:171], v[184:187]
    v_mfma_f32_16x16x32_bf16 v[184:187], v[20:23], v[172:175], v[184:187]
    v_xor_b32 v180, s70, v160
    ds_read_b128 v[216:219], v10 offset:8192
    v_mfma_f32_32x32x16_bf16 v[240:255], a[20:23], v[220:223], v[240:255]
    v_xor_b32 v181, s70, v164
    v_xor_b32 v182, s70, v168
    v_xor_b32 v183, s70, v172
    v_or3_b32 v180, v180, v181, v182
    v_or_b32 v180, v180, v183
    ds_read_b128 v[220:223], v10 offset:40960
    s_waitcnt lgkmcnt(4)
    v_mfma_f32_32x32x16_bf16 v[224:239], a[24:27], v[200:203], v[224:239]
    v_and_b32 v180, 1, v180
    v_cmp_ne_u32 s[18:19], 0, v180
    v_cmp_eq_u32 vcc, -1, v176
    s_or_b64 s[18:19], s[18:19], vcc
    s_cmp_eq_u64 s[18:19], 0
    s_cselect_b32 s67, s71, 0
    s_and_b32 s67, s67, 1
    ds_read_b128 v[200:203], v10 offset:9216
    v_mfma_f32_32x32x16_bf16 v[240:255], a[24:27], v[204:207], v[240:255]
    v_permlane16_swap_b32 v176, v178
    v_permlane16_swap_b32 v177, v179
    v_lshlrev_b32 v180, 16, v176
    v_and_b32 v181, 0xffff0000, v176
    v_lshlrev_b32 v182, 16, v177
    ds_read_b128 v[204:207], v10 offset:41984
    s_waitcnt lgkmcnt(4)
    v_mfma_f32_32x32x16_bf16 v[224:239], a[28:31], v[208:211], v[224:239]
    v_and_b32 v183, 0xffff0000, v177
    v_add_f32 v184, v184, v180
    v_add_f32 v185, v185, v181
    v_add_f32 v186, v186, v182
    v_add_f32 v187, v187, v183
    s_cmp_lg_u32 s56, 0
    s_cbranch_scc1 Laow_292
    s_add_u32 s66, s64, 2
    v_cmp_eq_u32 vcc, 0, v30
    s_and_b32 s3, vcc_lo, 0xffff
    s_cbranch_scc1 Laow_292
    s_min_u32 s62, s66, 31
    s_lshl_b32 s61, s60, 24
    s_lshl_b32 s62, s62, 19
    s_add_u32 s61, s61, s62
    s_lshl_b32 s74, s56, 11
    s_add_u32 s62, s61, 0x2000000
    s_add_u32 m0, s74, 86272
    s_nop 0
    buffer_load_dwordx4 v4, s[32:35], s62 offen offset:0 lds
    buffer_load_dwordx4 v4, s[32:35], s62 offen offset:1024 lds
    s_add_u32 s62, s61, 0x4000000
    s_add_u32 m0, s74, 94464
    s_nop 0
    buffer_load_dwordx4 v4, s[32:35], s62 offen offset:0 lds
    buffer_load_dwordx4 v4, s[32:35], s62 offen offset:1024 lds
    s_add_u32 s62, s61, 0x6000000
    s_add_u32 m0, s74, 102656
    s_nop 0
    buffer_load_dwordx4 v4, s[32:35], s62 offen offset:0 lds
    buffer_load_dwordx4 v4, s[32:35], s62 offen offset:1024 lds
    s_add_u32 s62, s61, 0x2040000
    s_add_u32 m0, s74, 110848
    s_nop 0
    buffer_load_dwordx4 v4, s[32:35], s62 offen offset:0 lds
    buffer_load_dwordx4 v4, s[32:35], s62 offen offset:1024 lds
    s_add_u32 s62, s61, 0x4040000
    s_add_u32 m0, s74, 119040
    s_nop 0
    buffer_load_dwordx4 v4, s[32:35], s62 offen offset:0 lds
    buffer_load_dwordx4 v4, s[32:35], s62 offen offset:1024 lds
    s_add_u32 s62, s61, 0x6040000
    s_add_u32 m0, s74, 127232
    s_nop 0
    buffer_load_dwordx4 v4, s[32:35], s62 offen offset:0 lds
    buffer_load_dwordx4 v4, s[32:35], s62 offen offset:1024 lds
    s_mov_b32 s69, s66
Laow_292:
    ds_read_b128 v[208:211], v10 offset:10240
    v_mfma_f32_32x32x16_bf16 v[240:255], a[28:31], v[212:215], v[240:255]
    v_cvt_pk_bf16_f32 v176, v184, v185
    v_cvt_pk_bf16_f32 v177, v186, v187
    v_lshlrev_b32 v184, 16, v176
    v_and_b32 v185, 0xffff0000, v176
    v_lshlrev_b32 v186, 16, v177
    ds_read_b128 v[212:215], v10 offset:43008
    s_waitcnt lgkmcnt(4)
    v_mfma_f32_32x32x16_bf16 v[224:239], a[32:35], v[216:219], v[224:239]
    v_and_b32 v187, 0xffff0000, v177
    v_add_f32 v180, v184, v185
    v_add_f32 v181, v186, v187
    v_add_f32 v180, v180, v181
    v_mul_f32 v181, v184, v184
    ds_read_b128 v[216:219], v10 offset:11264
    v_mfma_f32_32x32x16_bf16 v[240:255], a[32:35], v[220:223], v[240:255]
    v_fmac_f32 v181, v185, v185
    v_fmac_f32 v181, v186, v186
    v_fmac_f32 v181, v187, v187
    v_add_f32 v180, v180, v180 row_ror:8 row_mask:0xf bank_mask:0xf
    ds_read_b128 v[220:223], v10 offset:44032
    s_waitcnt lgkmcnt(4)
    v_mfma_f32_32x32x16_bf16 v[224:239], a[36:39], v[200:203], v[224:239]
    v_add_f32 v181, v181, v181 row_ror:8 row_mask:0xf bank_mask:0xf
    v_add_f32 v180, v180, v180 row_ror:4 row_mask:0xf bank_mask:0xf
    s_cmp_lg_u32 s56, 1
    s_cbranch_scc1 Laow_293
    s_add_u32 s66, s64, 2
    v_cmp_eq_u32 vcc, 0, v30
    s_and_b32 s3, vcc_lo, 0xffff
    s_cbranch_scc1 Laow_293
    s_min_u32 s62, s66, 31
    s_lshl_b32 s61, s60, 24
    s_lshl_b32 s62, s62, 19
    s_add_u32 s61, s61, s62
    s_lshl_b32 s74, s56, 11
    s_add_u32 s62, s61, 0x2000000
    s_add_u32 m0, s74, 86272
    s_nop 0
    buffer_load_dwordx4 v4, s[32:35], s62 offen offset:0 lds
    buffer_load_dwordx4 v4, s[32:35], s62 offen offset:1024 lds
    s_add_u32 s62, s61, 0x4000000
    s_add_u32 m0, s74, 94464
    s_nop 0
    buffer_load_dwordx4 v4, s[32:35], s62 offen offset:0 lds
    buffer_load_dwordx4 v4, s[32:35], s62 offen offset:1024 lds
    s_add_u32 s62, s61, 0x6000000
    s_add_u32 m0, s74, 102656
    s_nop 0
    buffer_load_dwordx4 v4, s[32:35], s62 offen offset:0 lds
    buffer_load_dwordx4 v4, s[32:35], s62 offen offset:1024 lds
    s_add_u32 s62, s61, 0x2040000
    s_add_u32 m0, s74, 110848
    s_nop 0
    buffer_load_dwordx4 v4, s[32:35], s62 offen offset:0 lds
    buffer_load_dwordx4 v4, s[32:35], s62 offen offset:1024 lds
    s_add_u32 s62, s61, 0x4040000
    s_add_u32 m0, s74, 119040
    s_nop 0
    buffer_load_dwordx4 v4, s[32:35], s62 offen offset:0 lds
    buffer_load_dwordx4 v4, s[32:35], s62 offen offset:1024 lds
    s_add_u32 s62, s61, 0x6040000
    s_add_u32 m0, s74, 127232
    s_nop 0
    buffer_load_dwordx4 v4, s[32:35], s62 offen offset:0 lds
    buffer_load_dwordx4 v4, s[32:35], s62 offen offset:1024 lds
    s_mov_b32 s69, s66
Laow_293:
    ds_read_b128 v[200:203], v10 offset:12288
    v_mfma_f32_32x32x16_bf16 v[240:255], a[36:39], v[204:207], v[240:255]
    v_add_f32 v181, v181, v181 row_ror:4 row_mask:0xf bank_mask:0xf
    v_add_f32 v180, v180, v180 row_ror:2 row_mask:0xf bank_mask:0xf
    ds_read_b128 v[204:207], v10 offset:45056
    s_waitcnt lgkmcnt(4)
    v_mfma_f32_32x32x16_bf16 v[224:239], a[40:43], v[208:211], v[224:239]
    v_add_f32 v181, v181, v181 row_ror:2 row_mask:0xf bank_mask:0xf
    v_add_f32 v180, v180, v180 row_ror:1 row_mask:0xf bank_mask:0xf
    ds_read_b128 v[208:211], v10 offset:13312
    v_mfma_f32_32x32x16_bf16 v[240:255], a[40:43], v[212:215], v[240:255]
    v_add_f32 v181, v181, v181 row_ror:1 row_mask:0xf bank_mask:0xf
    v_mov_b64 v[182:183], v[180:181]
    ds_read_b128 v[212:215], v10 offset:46080
    s_waitcnt lgkmcnt(4)
    v_mfma_f32_32x32x16_bf16 v[224:239], a[44:47], v[216:219], v[224:239]
    v_permlane16_swap_b32 v180, v182
    v_permlane16_swap_b32 v181, v183
    v_add_f32 v180, v180, v182
    v_add_f32 v181, v181, v183
    s_add_u32 s16, s101, 1
    v_mov_b32 v182, s16
    s_and_b32 s3, s101, 1
    s_lshl_b32 s3, s3, 7
    v_add_u32 v160, s3, v24
    s_mov_b32 exec_lo, s67
    s_mov_b32 exec_hi, s67
    ds_write_b96 v160, v[180:182]
    s_mov_b64 exec, -1
    s_cmp_lg_u32 s56, 2
    s_cbranch_scc1 Laow_294
    s_add_u32 s66, s64, 2
    v_cmp_eq_u32 vcc, 0, v30
    s_and_b32 s3, vcc_lo, 0xffff
    s_cbranch_scc1 Laow_294
    s_min_u32 s62, s66, 31
    s_lshl_b32 s61, s60, 24
    s_lshl_b32 s62, s62, 19
    s_add_u32 s61, s61, s62
    s_lshl_b32 s74, s56, 11
    s_add_u32 s62, s61, 0x2000000
    s_add_u32 m0, s74, 86272
    s_nop 0
    buffer_load_dwordx4 v4, s[32:35], s62 offen offset:0 lds
    buffer_load_dwordx4 v4, s[32:35], s62 offen offset:1024 lds
    s_add_u32 s62, s61, 0x4000000
    s_add_u32 m0, s74, 94464
    s_nop 0
    buffer_load_dwordx4 v4, s[32:35], s62 offen offset:0 lds
    buffer_load_dwordx4 v4, s[32:35], s62 offen offset:1024 lds
    s_add_u32 s62, s61, 0x6000000
    s_add_u32 m0, s74, 102656
    s_nop 0
    buffer_load_dwordx4 v4, s[32:35], s62 offen offset:0 lds
    buffer_load_dwordx4 v4, s[32:35], s62 offen offset:1024 lds
    s_add_u32 s62, s61, 0x2040000
    s_add_u32 m0, s74, 110848
    s_nop 0
    buffer_load_dwordx4 v4, s[32:35], s62 offen offset:0 lds
    buffer_load_dwordx4 v4, s[32:35], s62 offen offset:1024 lds
    s_add_u32 s62, s61, 0x4040000
    s_add_u32 m0, s74, 119040
    s_nop 0
    buffer_load_dwordx4 v4, s[32:35], s62 offen offset:0 lds
    buffer_load_dwordx4 v4, s[32:35], s62 offen offset:1024 lds
    s_add_u32 s62, s61, 0x6040000
    s_add_u32 m0, s74, 127232
    s_nop 0
    buffer_load_dwordx4 v4, s[32:35], s62 offen offset:0 lds
    buffer_load_dwordx4 v4, s[32:35], s62 offen offset:1024 lds
    s_mov_b32 s69, s66
Laow_294:
    ds_read_b128 v[216:219], v10 offset:14336
    v_mfma_f32_32x32x16_bf16 v[240:255], a[44:47], v[220:223], v[240:255]
    v_mov_b64 v[178:179], v[176:177]
    ds_read_b128 v[220:223], v10 offset:47104
    s_waitcnt lgkmcnt(5)
    v_mfma_f32_32x32x16_bf16 v[224:239], a[48:51], v[200:203], v[224:239]
    v_permlane16_swap_b32 v176, v178
    v_permlane16_swap_b32 v177, v179
    s_lshl_b32 s61, s60, 21
    s_lshl_b32 s63, s101, 16
    s_add_u32 s61, s61, s63
    s_add_u32 s61, s61, 0x400000
    s_mul_i32 s3, s67, 0xffff
    s_mov_b32 exec_lo, s3
    s_mov_b32 exec_hi, s3
    buffer_store_dwordx4 v[176:179], v13, s[32:35], s61 offen sc1
    s_sub_u32 s3, 0, s67
    s_mov_b32 exec_lo, s3
    s_mov_b32 exec_hi, s3
    v_mov_b64 v[192:193], v[184:185]
    v_mov_b64 v[194:195], v[186:187]
    s_mov_b64 exec, -1
    s_add_u32 s71, s71, s67
    ds_read_b128 v[200:203], v10 offset:15360
    v_mfma_f32_32x32x16_bf16 v[240:255], a[48:51], v[204:207], v[240:255]
    v_cndmask_b32 v112, v15, v112, s[76:77]
    v_cndmask_b32 v113, v15, v113, s[78:79]
    v_cndmask_b32 v114, v15, v114, s[80:81]
    v_cndmask_b32 v115, v15, v115, s[82:83]
    v_cndmask_b32 v116, v15, v116, s[84:85]
    ds_read_b128 v[204:207], v10 offset:48128
    s_waitcnt lgkmcnt(5)
    v_mfma_f32_32x32x16_bf16 v[224:239], a[52:55], v[208:211], v[224:239]
    v_cndmask_b32 v117, v15, v117, s[86:87]
    v_cndmask_b32 v118, v15, v118, s[88:89]
    v_cndmask_b32 v119, v15, v119, s[90:91]
    v_max3_f32 v196, v112, v113, v114
    v_max3_f32 v197, v115, v116, v117
    s_cmp_lg_u32 s56, 3
    s_cbranch_scc1 Laow_295
    s_add_u32 s66, s64, 2
    v_cmp_eq_u32 vcc, 0, v30
    s_and_b32 s3, vcc_lo, 0xffff
    s_cbranch_scc1 Laow_295
    s_min_u32 s62, s66, 31
    s_lshl_b32 s61, s60, 24
    s_lshl_b32 s62, s62, 19
    s_add_u32 s61, s61, s62
    s_lshl_b32 s74, s56, 11
    s_add_u32 s62, s61, 0x2000000
    s_add_u32 m0, s74, 86272
    s_nop 0
    buffer_load_dwordx4 v4, s[32:35], s62 offen offset:0 lds
    buffer_load_dwordx4 v4, s[32:35], s62 offen offset:1024 lds
    s_add_u32 s62, s61, 0x4000000
    s_add_u32 m0, s74, 94464
    s_nop 0
    buffer_load_dwordx4 v4, s[32:35], s62 offen offset:0 lds
    buffer_load_dwordx4 v4, s[32:35], s62 offen offset:1024 lds
    s_add_u32 s62, s61, 0x6000000
    s_add_u32 m0, s74, 102656
    s_nop 0
    buffer_load_dwordx4 v4, s[32:35], s62 offen offset:0 lds
    buffer_load_dwordx4 v4, s[32:35], s62 offen offset:1024 lds
    s_add_u32 s62, s61, 0x2040000
    s_add_u32 m0, s74, 110848
    s_nop 0
    buffer_load_dwordx4 v4, s[32:35], s62 offen offset:0 lds
    buffer_load_dwordx4 v4, s[32:35], s62 offen offset:1024 lds
    s_add_u32 s62, s61, 0x4040000
    s_add_u32 m0, s74, 119040
    s_nop 0
    buffer_load_dwordx4 v4, s[32:35], s62 offen offset:0 lds
    buffer_load_dwordx4 v4, s[32:35], s62 offen offset:1024 lds
    s_add_u32 s62, s61, 0x6040000
    s_add_u32 m0, s74, 127232
    s_nop 0
    buffer_load_dwordx4 v4, s[32:35], s62 offen offset:0 lds
    buffer_load_dwordx4 v4, s[32:35], s62 offen offset:1024 lds
    s_mov_b32 s69, s66
Laow_295:
    ds_read_b128 v[208:211], v10 offset:16384
    v_mfma_f32_32x32x16_bf16 v[240:255], a[52:55], v[212:215], v[240:255]
    v_max3_f32 v196, v196, v118, v119
    v_max_f32 v196, v196, v197
    v_mov_b32 v197, v196
    ds_read_b128 v[212:215], v10 offset:49152
    s_waitcnt lgkmcnt(4)
    v_mfma_f32_32x32x16_bf16 v[224:239], a[56:59], v[216:219], v[224:239]
    v_permlane16_swap_b32 v196, v197
    v_max_f32 v196, v196, v197
    v_mov_b32 v197, v196
    s_add_u32 s16, s101, 1
    s_and_b32 s3, s101, 1
    s_lshl_b32 s3, s3, 7
    v_add_u32 v160, s3, v29
    ds_read_b128 v[180:183], v160
    s_lshl_b32 s61, s60, 21
    s_lshl_b32 s63, s101, 16
    s_add_u32 s61, s61, s63
    s_add_u32 s17, s61, 0x800000
    s_cmp_eq_u32 s71, 2
    s_cselect_b32 s67, 1, 0
    s_waitcnt lgkmcnt(0)
    v_cmp_ne_u32 vcc, s16, v182
    s_cmp_eq_u64 vcc, 0
    s_cselect_b32 s67, s67, 0
    ds_read_b128 v[216:219], v10 offset:17408
    v_mfma_f32_32x32x16_bf16 v[240:255], a[56:59], v[220:223], v[240:255]
    v_add_f32 v180, v180, v180 quad_perm:[1,0,3,2] row_mask:0xf bank_mask:0xf
    v_add_f32 v181, v181, v181 quad_perm:[1,0,3,2] row_mask:0xf bank_mask:0xf
    ds_read_b128 v[220:223], v10 offset:50176
    v_mfma_f32_32x32x16_bf16 v[224:239], a[60:63], v[200:203], v[224:239]
    v_add_f32 v180, v180, v180 quad_perm:[2,3,0,1] row_mask:0xf bank_mask:0xf
    v_add_f32 v181, v181, v181 quad_perm:[2,3,0,1] row_mask:0xf bank_mask:0xf
    v_mul_f32 v180, 0x3b000000, v180
    v_mul_f32 v182, v180, v180
    v_fma_f32 v181, v181, s94, -v182
    ds_read_b128 v[200:203], v10 offset:18432
    v_mfma_f32_32x32x16_bf16 v[240:255], a[60:63], v[204:207], v[240:255]
    v_max_f32 v181, 0, v181
    v_add_f32 v181, 0x3727c5ac, v181
    v_rsq_f32 v181, v181
    v_sub_f32 v164, v192, v180
    v_sub_f32 v165, v193, v180
    ds_read_b128 v[204:207], v10 offset:51200
    v_mfma_f32_32x32x16_bf16 v[224:239], a[64:67], v[208:211], v[224:239]
    v_sub_f32 v166, v194, v180
    v_sub_f32 v167, v195, v180
    v_mul_f32 v164, v164, v181
    v_mul_f32 v165, v165, v181
    v_mul_f32 v166, v166, v181
    ds_read_b128 v[208:211], v10 offset:19456
    v_mfma_f32_32x32x16_bf16 v[240:255], a[64:67], v[212:215], v[240:255]
    v_mul_f32 v167, v167, v181
    v_cvt_pk_bf16_f32 v160, v164, v165
    v_cvt_pk_bf16_f32 v161, v166, v167
    v_mov_b64 v[162:163], v[160:161]
    ds_read_b128 v[212:215], v10 offset:52224
    s_waitcnt lgkmcnt(4)
    v_mfma_f32_32x32x16_bf16 v[224:239], a[68:71], v[216:219], v[224:239]
    v_permlane16_swap_b32 v160, v162
    v_permlane16_swap_b32 v161, v163
    s_mul_i32 s3, s67, 0xffff
    s_mov_b32 exec_lo, s3
    s_mov_b32 exec_hi, s3
    buffer_store_dwordx4 v[160:163], v13, s[32:35], s17 offen sc1
    s_mov_b64 exec, -1
    s_cmp_eq_u32 s67, 1
    s_cselect_b32 s71, 0, s71
    ds_read_b128 v[216:219], v10 offset:20480
    v_mfma_f32_32x32x16_bf16 v[240:255], a[68:71], v[220:223], v[240:255]
    v_permlane32_swap_b32 v196, v197
    v_max_f32 v196, v196, v197
    v_mul_f32 v196, s68, v196
    v_fma_f32 v112, v112, s68, -v196
    v_fma_f32 v113, v113, s68, -v196
    ds_read_b128 v[220:223], v10 offset:53248
    s_waitcnt lgkmcnt(4)
    v_mfma_f32_32x32x16_bf16 v[224:239], a[72:75], v[200:203], v[224:239]
    v_fma_f32 v114, v114, s68, -v196
    v_fma_f32 v115, v115, s68, -v196
    v_fma_f32 v116, v116, s68, -v196
    v_fma_f32 v117, v117, s68, -v196
    v_fma_f32 v118, v118, s68, -v196
    ds_read_b128 v[200:203], v10 offset:21504
    v_mfma_f32_32x32x16_bf16 v[240:255], a[72:75], v[204:207], v[240:255]
    v_fma_f32 v119, v119, s68, -v196
    v_exp_f32 v112, v112
    v_exp_f32 v113, v113
    v_exp_f32 v114, v114
    v_exp_f32 v115, v115
    ds_read_b128 v[204:207], v10 offset:54272
    s_waitcnt lgkmcnt(4)
    v_mfma_f32_32x32x16_bf16 v[224:239], a[76:79], v[208:211], v[224:239]
    v_exp_f32 v116, v116
    v_exp_f32 v117, v117
    v_exp_f32 v118, v118
    v_exp_f32 v119, v119
    v_cvt_pk_bf16_f32 v120, v112, v113
    ds_read_b128 v[208:211], v10 offset:22528
    v_mfma_f32_32x32x16_bf16 v[240:255], a[76:79], v[212:215], v[240:255]
    v_cvt_pk_bf16_f32 v121, v114, v115
    v_cvt_pk_bf16_f32 v122, v116, v117
    v_cvt_pk_bf16_f32 v123, v118, v119
    v_add_f32 v197, v112, v113
    v_add_f32 v197, v197, v114
    ds_read_b128 v[212:215], v10 offset:55296
    s_waitcnt lgkmcnt(4)
    v_mfma_f32_32x32x16_bf16 v[224:239], a[80:83], v[216:219], v[224:239]
    v_add_f32 v197, v197, v115
    v_add_f32 v197, v197, v116
    v_add_f32 v197, v197, v117
    v_add_f32 v197, v197, v118
    v_add_f32 v197, v197, v119
    ds_read_b128 v[216:219], v10 offset:23552
    v_mfma_f32_32x32x16_bf16 v[240:255], a[80:83], v[220:223], v[240:255]
    v_mfma_f32_16x16x32_bf16 v[128:131], v[80:83], v[120:123], 0
    v_mfma_f32_16x16x32_bf16 v[132:135], v[84:87], v[120:123], 0
    v_mfma_f32_16x16x32_bf16 v[136:139], v[88:91], v[120:123], 0
    v_mfma_f32_16x16x32_bf16 v[140:143], v[92:95], v[120:123], 0
    v_mfma_f32_16x16x32_bf16 v[144:147], v[96:99], v[120:123], 0
    ds_read_b128 v[220:223], v10 offset:56320
    s_waitcnt lgkmcnt(4)
    v_mfma_f32_32x32x16_bf16 v[224:239], a[84:87], v[200:203], v[224:239]
    v_mfma_f32_16x16x32_bf16 v[148:151], v[100:103], v[120:123], 0
    v_mfma_f32_16x16x32_bf16 v[152:155], v[104:107], v[120:123], 0
    v_mfma_f32_16x16x32_bf16 v[156:159], v[108:111], v[120:123], 0
    ds_read_b128 v[200:203], v10 offset:24576
    v_mfma_f32_32x32x16_bf16 v[240:255], a[84:87], v[204:207], v[240:255]
    ds_read_b128 v[204:207], v10 offset:57344
    s_waitcnt lgkmcnt(4)
    v_mfma_f32_32x32x16_bf16 v[224:239], a[88:91], v[208:211], v[224:239]
    ds_read_b128 v[208:211], v10 offset:25600
    v_mfma_f32_32x32x16_bf16 v[240:255], a[88:91], v[212:215], v[240:255]
    ds_read_b128 v[212:215], v10 offset:58368
    s_waitcnt lgkmcnt(4)
    v_mfma_f32_32x32x16_bf16 v[224:239], a[92:95], v[216:219], v[224:239]
    ds_read_b128 v[216:219], v10 offset:26624
    v_mfma_f32_32x32x16_bf16 v[240:255], a[92:95], v[220:223], v[240:255]
    ds_read_b128 v[220:223], v10 offset:59392
    s_waitcnt lgkmcnt(4)
    v_mfma_f32_32x32x16_bf16 v[224:239], a[96:99], v[200:203], v[224:239]
    ds_read_b128 v[200:203], v10 offset:27648
    v_mfma_f32_32x32x16_bf16 v[240:255], a[96:99], v[204:207], v[240:255]
    ds_read_b128 v[204:207], v10 offset:60416
    s_waitcnt lgkmcnt(4)
    v_mfma_f32_32x32x16_bf16 v[224:239], a[100:103], v[208:211], v[224:239]
    s_cmp_lg_u32 s56, 0
    s_cbranch_scc1 Laow_296
    s_lshl_b32 s61, s60, 22
    s_lshl_b32 s62, s65, 17
    s_add_u32 s61, s61, s62
    s_add_u32 s62, s61, 0x1800000
    s_add_u32 s61, s61, 0x1000000
    buffer_load_dwordx4 v[160:163], v7, s[32:35], s61 offen offset:0 sc1
    buffer_load_dwordx4 v[164:167], v7, s[32:35], s61 offen offset:512 sc1
    buffer_load_dwordx4 v[168:171], v7, s[32:35], s61 offen offset:1024 sc1
    buffer_load_dwordx4 v[172:175], v7, s[32:35], s61 offen offset:1536 sc1
    buffer_load_dwordx4 v[176:179], v8, s[32:35], s62 offen offset:0 sc1
    buffer_load_dwordx4 v[180:183], v8, s[32:35], s62 offen offset:512 sc1
    buffer_load_dwordx4 v[184:187], v8, s[32:35], s62 offen offset:1024 sc1
    buffer_load_dwordx4 v[188:191], v8, s[32:35], s62 offen offset:1536 sc1
Laow_296:
    ds_read_b128 v[208:211], v10 offset:28672
    v_mfma_f32_32x32x16_bf16 v[240:255], a[100:103], v[212:215], v[240:255]
    ds_read_b128 v[212:215], v10 offset:61440
    s_waitcnt lgkmcnt(4)
    v_mfma_f32_32x32x16_bf16 v[224:239], a[104:107], v[216:219], v[224:239]
    ds_read_b128 v[216:219], v10 offset:29696
    v_mfma_f32_32x32x16_bf16 v[240:255], a[104:107], v[220:223], v[240:255]
    s_cmp_lg_u32 s56, 1
    s_cbranch_scc1 Laow_297
    s_lshl_b32 s61, s60, 22
    s_lshl_b32 s62, s65, 17
    s_add_u32 s61, s61, s62
    s_add_u32 s62, s61, 0x1800000
    s_add_u32 s61, s61, 0x1000000
    buffer_load_dwordx4 v[160:163], v7, s[32:35], s61 offen offset:0 sc1
    buffer_load_dwordx4 v[164:167], v7, s[32:35], s61 offen offset:512 sc1
    buffer_load_dwordx4 v[168:171], v7, s[32:35], s61 offen offset:1024 sc1
    buffer_load_dwordx4 v[172:175], v7, s[32:35], s61 offen offset:1536 sc1
    buffer_load_dwordx4 v[176:179], v8, s[32:35], s62 offen offset:0 sc1
    buffer_load_dwordx4 v[180:183], v8, s[32:35], s62 offen offset:512 sc1
    buffer_load_dwordx4 v[184:187], v8, s[32:35], s62 offen offset:1024 sc1
    buffer_load_dwordx4 v[188:191], v8, s[32:35], s62 offen offset:1536 sc1
Laow_297:
    ds_read_b128 v[220:223], v10 offset:62464
    s_waitcnt lgkmcnt(4)
    v_mfma_f32_32x32x16_bf16 v[224:239], a[108:111], v[200:203], v[224:239]
    ds_read_b128 v[200:203], v10 offset:30720
    v_mfma_f32_32x32x16_bf16 v[240:255], a[108:111], v[204:207], v[240:255]
    ds_read_b128 v[204:207], v10 offset:63488
    s_waitcnt lgkmcnt(4)
    v_mfma_f32_32x32x16_bf16 v[224:239], a[112:115], v[208:211], v[224:239]
    s_cmp_lg_u32 s56, 2
    s_cbranch_scc1 Laow_298
    s_lshl_b32 s61, s60, 22
    s_lshl_b32 s62, s65, 17
    s_add_u32 s61, s61, s62
    s_add_u32 s62, s61, 0x1800000
    s_add_u32 s61, s61, 0x1000000
    buffer_load_dwordx4 v[160:163], v7, s[32:35], s61 offen offset:0 sc1
    buffer_load_dwordx4 v[164:167], v7, s[32:35], s61 offen offset:512 sc1
    buffer_load_dwordx4 v[168:171], v7, s[32:35], s61 offen offset:1024 sc1
    buffer_load_dwordx4 v[172:175], v7, s[32:35], s61 offen offset:1536 sc1
    buffer_load_dwordx4 v[176:179], v8, s[32:35], s62 offen offset:0 sc1
    buffer_load_dwordx4 v[180:183], v8, s[32:35], s62 offen offset:512 sc1
    buffer_load_dwordx4 v[184:187], v8, s[32:35], s62 offen offset:1024 sc1
    buffer_load_dwordx4 v[188:191], v8, s[32:35], s62 offen offset:1536 sc1
Laow_298:
    ds_read_b128 v[208:211], v10 offset:31744
    v_mfma_f32_32x32x16_bf16 v[240:255], a[112:115], v[212:215], v[240:255]
    ds_read_b128 v[212:215], v10 offset:64512
    s_waitcnt lgkmcnt(4)
    v_mfma_f32_32x32x16_bf16 v[224:239], a[116:119], v[216:219], v[224:239]
    v_mfma_f32_32x32x16_bf16 v[240:255], a[116:119], v[220:223], v[240:255]
    s_cmp_lg_u32 s56, 3
    s_cbranch_scc1 Laow_299
    s_lshl_b32 s61, s60, 22
    s_lshl_b32 s62, s65, 17
    s_add_u32 s61, s61, s62
    s_add_u32 s62, s61, 0x1800000
    s_add_u32 s61, s61, 0x1000000
    buffer_load_dwordx4 v[160:163], v7, s[32:35], s61 offen offset:0 sc1
    buffer_load_dwordx4 v[164:167], v7, s[32:35], s61 offen offset:512 sc1
    buffer_load_dwordx4 v[168:171], v7, s[32:35], s61 offen offset:1024 sc1
    buffer_load_dwordx4 v[172:175], v7, s[32:35], s61 offen offset:1536 sc1
    buffer_load_dwordx4 v[176:179], v8, s[32:35], s62 offen offset:0 sc1
    buffer_load_dwordx4 v[180:183], v8, s[32:35], s62 offen offset:512 sc1
    buffer_load_dwordx4 v[184:187], v8, s[32:35], s62 offen offset:1024 sc1
    buffer_load_dwordx4 v[188:191], v8, s[32:35], s62 offen offset:1536 sc1
Laow_299:
    s_waitcnt lgkmcnt(2)
    v_mfma_f32_32x32x16_bf16 v[224:239], a[120:123], v[200:203], v[224:239]
    v_mfma_f32_32x32x16_bf16 v[240:255], a[120:123], v[204:207], v[240:255]
    s_waitcnt lgkmcnt(0)
    v_mfma_f32_32x32x16_bf16 v[224:239], a[124:127], v[208:211], v[224:239]
    v_mfma_f32_32x32x16_bf16 v[240:255], a[124:127], v[212:215], v[240:255]
    s_waitcnt lgkmcnt(0)
    s_mov_b32 s62, 0
Laq_302:
    s_cmp_eq_u32 s71, 0
    s_cbranch_scc1 Laq_301
    s_add_u32 s99, s99, 1
    s_cmp_gt_u32 s99, 0x2dc6c0
    s_cbranch_scc0 Lto_303
    s_mov_b32 s3, 22
    s_branch L_abort
Lto_303:
    s_cmp_eq_u32 s71, 2
    s_cbranch_scc1 Laq_300
    s_lshl_b32 s63, s101, 16
    buffer_load_dwordx4 v[64:67], v13, s[44:47], s63 offen sc1
    buffer_load_dwordx4 v[48:51], v12, s[32:35], s100 offen sc1
    s_add_u32 s74, s100, 0x20000
    buffer_load_dwordx4 v[52:55], v12, s[32:35], s74 offen sc1
    s_add_u32 s74, s100, 0x40000
    buffer_load_dwordx4 v[56:59], v12, s[32:35], s74 offen sc1
    s_add_u32 s74, s100, 0x60000
    buffer_load_dwordx4 v[60:63], v12, s[32:35], s74 offen sc1
    s_waitcnt vmcnt(0)
    v_mfma_f32_16x16x32_bf16 v[72:75], v[16:19], v[48:51], 0
    v_mfma_f32_16x16x32_bf16 v[72:75], v[16:19], v[52:55], v[72:75]
    v_mfma_f32_16x16x32_bf16 v[72:75], v[20:23], v[56:59], v[72:75]
    v_mfma_f32_16x16x32_bf16 v[72:75], v[20:23], v[60:63], v[72:75]
    v_xor_b32 v68, s70, v48
    v_xor_b32 v69, s70, v52
    v_xor_b32 v70, s70, v56
    v_xor_b32 v71, s70, v60
    v_or3_b32 v68, v68, v69, v70
    v_or_b32 v68, v68, v71
    v_and_b32 v68, 1, v68
    v_cmp_ne_u32 s[18:19], 0, v68
    v_cmp_eq_u32 vcc, -1, v64
    s_or_b64 s[18:19], s[18:19], vcc
    s_cmp_eq_u64 s[18:19], 0
    s_cselect_b32 s67, s71, 0
    s_and_b32 s67, s67, 1
    v_permlane16_swap_b32 v64, v66
    v_permlane16_swap_b32 v65, v67
    v_lshlrev_b32 v68, 16, v64
    v_and_b32 v69, 0xffff0000, v64
    v_lshlrev_b32 v70, 16, v65
    v_and_b32 v71, 0xffff0000, v65
    v_add_f32 v72, v72, v68
    v_add_f32 v73, v73, v69
    v_add_f32 v74, v74, v70
    v_add_f32 v75, v75, v71
    v_cvt_pk_bf16_f32 v64, v72, v73
    v_cvt_pk_bf16_f32 v65, v74, v75
    v_lshlrev_b32 v72, 16, v64
    v_and_b32 v73, 0xffff0000, v64
    v_lshlrev_b32 v74, 16, v65
    v_and_b32 v75, 0xffff0000, v65
    v_add_f32 v68, v72, v73
    v_add_f32 v69, v74, v75
    v_add_f32 v68, v68, v69
    v_mul_f32 v69, v72, v72
    v_fmac_f32 v69, v73, v73
    v_fmac_f32 v69, v74, v74
    v_fmac_f32 v69, v75, v75
    v_add_f32 v68, v68, v68 row_ror:8 row_mask:0xf bank_mask:0xf
    s_nop 0
    v_add_f32 v69, v69, v69 row_ror:8 row_mask:0xf bank_mask:0xf
    v_add_f32 v68, v68, v68 row_ror:4 row_mask:0xf bank_mask:0xf
    s_nop 0
    v_add_f32 v69, v69, v69 row_ror:4 row_mask:0xf bank_mask:0xf
    v_add_f32 v68, v68, v68 row_ror:2 row_mask:0xf bank_mask:0xf
    s_nop 0
    v_add_f32 v69, v69, v69 row_ror:2 row_mask:0xf bank_mask:0xf
    v_add_f32 v68, v68, v68 row_ror:1 row_mask:0xf bank_mask:0xf
    s_nop 0
    v_add_f32 v69, v69, v69 row_ror:1 row_mask:0xf bank_mask:0xf
    v_mov_b64 v[70:71], v[68:69]
    s_nop 1
    v_permlane16_swap_b32 v68, v70
    v_permlane16_swap_b32 v69, v71
    v_add_f32 v68, v68, v70
    v_add_f32 v69, v69, v71
    s_add_u32 s16, s101, 1
    v_mov_b32 v70, s16
    s_and_b32 s3, s101, 1
    s_lshl_b32 s3, s3, 7
    v_add_u32 v48, s3, v24
    s_mov_b32 exec_lo, s67
    s_mov_b32 exec_hi, s67
    ds_write_b96 v48, v[68:70]
    s_mov_b64 exec, -1
    v_mov_b64 v[66:67], v[64:65]
    s_nop 1
    v_permlane16_swap_b32 v64, v66
    v_permlane16_swap_b32 v65, v67
    s_lshl_b32 s61, s60, 21
    s_lshl_b32 s63, s101, 16
    s_add_u32 s61, s61, s63
    s_add_u32 s61, s61, 0x400000
    s_mul_i32 s3, s67, 0xffff
    s_mov_b32 exec_lo, s3
    s_mov_b32 exec_hi, s3
    buffer_store_dwordx4 v[64:67], v13, s[32:35], s61 offen sc1
    s_sub_u32 s3, 0, s67
    s_mov_b32 exec_lo, s3
    s_mov_b32 exec_hi, s3
    v_mov_b64 v[192:193], v[72:73]
    v_mov_b64 v[194:195], v[74:75]
    s_mov_b64 exec, -1
    s_add_u32 s71, s71, s67
    s_waitcnt lgkmcnt(0)
    s_branch Laq_302
Laq_300:
    s_nop 2
    s_add_u32 s16, s101, 1
    s_and_b32 s3, s101, 1
    s_lshl_b32 s3, s3, 7
    v_add_u32 v48, s3, v29
    ds_read_b128 v[68:71], v48
    s_lshl_b32 s61, s60, 21
    s_lshl_b32 s63, s101, 16
    s_add_u32 s61, s61, s63
    s_add_u32 s17, s61, 0x800000
    s_cmp_eq_u32 s71, 2
    s_cselect_b32 s67, 1, 0
    s_waitcnt lgkmcnt(0)
    v_cmp_ne_u32 vcc, s16, v70
    s_cmp_eq_u64 vcc, 0
    s_cselect_b32 s67, s67, 0
    v_add_f32 v68, v68, v68 quad_perm:[1,0,3,2] row_mask:0xf bank_mask:0xf
    v_add_f32 v69, v69, v69 quad_perm:[1,0,3,2] row_mask:0xf bank_mask:0xf
    s_nop 0
    v_add_f32 v68, v68, v68 quad_perm:[2,3,0,1] row_mask:0xf bank_mask:0xf
    v_add_f32 v69, v69, v69 quad_perm:[2,3,0,1] row_mask:0xf bank_mask:0xf
    v_mul_f32 v68, 0x3b000000, v68
    v_mul_f32 v70, v68, v68
    v_fma_f32 v69, v69, s94, -v70
    v_max_f32 v69, 0, v69
    v_add_f32 v69, 0x3727c5ac, v69
    v_rsq_f32 v69, v69
    v_sub_f32 v52, v192, v68
    v_sub_f32 v53, v193, v68
    v_sub_f32 v54, v194, v68
    v_sub_f32 v55, v195, v68
    v_mul_f32 v52, v52, v69
    v_mul_f32 v53, v53, v69
    v_mul_f32 v54, v54, v69
    v_mul_f32 v55, v55, v69
    v_cvt_pk_bf16_f32 v48, v52, v53
    v_cvt_pk_bf16_f32 v49, v54, v55
    v_mov_b64 v[50:51], v[48:49]
    s_nop 1
    v_permlane16_swap_b32 v48, v50
    v_permlane16_swap_b32 v49, v51
    s_mul_i32 s3, s67, 0xffff
    s_mov_b32 exec_lo, s3
    s_mov_b32 exec_hi, s3
    buffer_store_dwordx4 v[48:51], v13, s[32:35], s17 offen sc1
    s_mov_b64 exec, -1
    s_cmp_eq_u32 s67, 1
    s_cselect_b32 s71, 0, s71
    s_waitcnt lgkmcnt(0)
    s_branch Laq_302
Laq_301:
    s_nop 7
    v_cvt_pk_bf16_f32 v200, v224, v225
    v_cvt_pk_bf16_f32 v201, v226, v227
    v_cvt_pk_bf16_f32 v202, v228, v229
    v_cvt_pk_bf16_f32 v203, v230, v231
    v_cvt_pk_bf16_f32 v204, v232, v233
    v_cvt_pk_bf16_f32 v205, v234, v235
    v_cvt_pk_bf16_f32 v206, v236, v237
    v_cvt_pk_bf16_f32 v207, v238, v239
    v_bfi_b32 v200, 1, s75, v200
    ds_write_b128 v26, v[200:203] offset:0
    v_bfi_b32 v204, 1, s75, v204
    ds_write_b128 v26, v[204:207] offset:16
    v_cvt_pk_bf16_f32 v208, v240, v241
    v_cvt_pk_bf16_f32 v209, v242, v243
    v_cvt_pk_bf16_f32 v210, v244, v245
    v_cvt_pk_bf16_f32 v211, v246, v247
    v_cvt_pk_bf16_f32 v212, v248, v249
    v_cvt_pk_bf16_f32 v213, v250, v251
    v_cvt_pk_bf16_f32 v214, v252, v253
    v_cvt_pk_bf16_f32 v215, v254, v255
    v_bfi_b32 v208, 1, s75, v208
    ds_write_b128 v26, v[208:211] offset:2560
    v_bfi_b32 v212, 1, s75, v212
    ds_write_b128 v26, v[212:215] offset:2576
    ds_read_b128 v[224:227], v27 offset:0
    ds_read_b128 v[228:231], v27 offset:1280
    ds_read_b128 v[232:235], v27 offset:2560
    ds_read_b128 v[236:239], v27 offset:3840
    s_mov_b32 s71, 1
    s_mov_b32 s70, s75
    s_mov_b32 s100, s98
    s_mov_b32 s101, s64
    s_barrier
    s_add_u32 s74, s98, 0x0
    s_waitcnt lgkmcnt(3)
    buffer_store_dwordx4 v[224:227], v28, s[32:35], s74 offen sc1
    s_add_u32 s74, s98, 0x4000
    s_waitcnt lgkmcnt(2)
    buffer_store_dwordx4 v[228:231], v28, s[32:35], s74 offen sc1
    s_add_u32 s74, s98, 0x40000
    s_waitcnt lgkmcnt(1)
    buffer_store_dwordx4 v[232:235], v28, s[32:35], s74 offen sc1
    s_add_u32 s74, s98, 0x44000
    s_waitcnt lgkmcnt(0)
    buffer_store_dwordx4 v[236:239], v28, s[32:35], s74 offen sc1
    s_add_u32 s64, s64, 1
    s_cmp_lt_u32 s64, 32
    s_cbranch_scc1 Laol_268
    s_mov_b32 s62, 0
Laq_306:
    s_cmp_eq_u32 s71, 0
    s_cbranch_scc1 Laq_305
    s_add_u32 s99, s99, 1
    s_cmp_gt_u32 s99, 0x2dc6c0
    s_cbranch_scc0 Lto_307
    s_mov_b32 s3, 22
    s_branch L_abort
Lto_307:
    s_cmp_eq_u32 s71, 2
    s_cbranch_scc1 Laq_304
    s_lshl_b32 s63, s101, 16
    buffer_load_dwordx4 v[64:67], v13, s[44:47], s63 offen sc1
    buffer_load_dwordx4 v[48:51], v12, s[32:35], s100 offen sc1
    s_add_u32 s74, s100, 0x20000
    buffer_load_dwordx4 v[52:55], v12, s[32:35], s74 offen sc1
    s_add_u32 s74, s100, 0x40000
    buffer_load_dwordx4 v[56:59], v12, s[32:35], s74 offen sc1
    s_add_u32 s74, s100, 0x60000
    buffer_load_dwordx4 v[60:63], v12, s[32:35], s74 offen sc1
    s_waitcnt vmcnt(0)
    v_mfma_f32_16x16x32_bf16 v[72:75], v[16:19], v[48:51], 0
    v_mfma_f32_16x16x32_bf16 v[72:75], v[16:19], v[52:55], v[72:75]
    v_mfma_f32_16x16x32_bf16 v[72:75], v[20:23], v[56:59], v[72:75]
    v_mfma_f32_16x16x32_bf16 v[72:75], v[20:23], v[60:63], v[72:75]
    v_xor_b32 v68, s70, v48
    v_xor_b32 v69, s70, v52
    v_xor_b32 v70, s70, v56
    v_xor_b32 v71, s70, v60
    v_or3_b32 v68, v68, v69, v70
    v_or_b32 v68, v68, v71
    v_and_b32 v68, 1, v68
    v_cmp_ne_u32 s[18:19], 0, v68
    v_cmp_eq_u32 vcc, -1, v64
    s_or_b64 s[18:19], s[18:19], vcc
    s_cmp_eq_u64 s[18:19], 0
    s_cselect_b32 s67, s71, 0
    s_and_b32 s67, s67, 1
    v_permlane16_swap_b32 v64, v66
    v_permlane16_swap_b32 v65, v67
    v_lshlrev_b32 v68, 16, v64
    v_and_b32 v69, 0xffff0000, v64
    v_lshlrev_b32 v70, 16, v65
    v_and_b32 v71, 0xffff0000, v65
    v_add_f32 v72, v72, v68
    v_add_f32 v73, v73, v69
    v_add_f32 v74, v74, v70
    v_add_f32 v75, v75, v71
    v_cvt_pk_bf16_f32 v64, v72, v73
    v_cvt_pk_bf16_f32 v65, v74, v75
    v_lshlrev_b32 v72, 16, v64
    v_and_b32 v73, 0xffff0000, v64
    v_lshlrev_b32 v74, 16, v65
    v_and_b32 v75, 0xffff0000, v65
    v_add_f32 v68, v72, v73
    v_add_f32 v69, v74, v75
    v_add_f32 v68, v68, v69
    v_mul_f32 v69, v72, v72
    v_fmac_f32 v69, v73, v73
    v_fmac_f32 v69, v74, v74
    v_fmac_f32 v69, v75, v75
    v_add_f32 v68, v68, v68 row_ror:8 row_mask:0xf bank_mask:0xf
    s_nop 0
    v_add_f32 v69, v69, v69 row_ror:8 row_mask:0xf bank_mask:0xf
    v_add_f32 v68, v68, v68 row_ror:4 row_mask:0xf bank_mask:0xf
    s_nop 0
    v_add_f32 v69, v69, v69 row_ror:4 row_mask:0xf bank_mask:0xf
    v_add_f32 v68, v68, v68 row_ror:2 row_mask:0xf bank_mask:0xf
    s_nop 0
    v_add_f32 v69, v69, v69 row_ror:2 row_mask:0xf bank_mask:0xf
    v_add_f32 v68, v68, v68 row_ror:1 row_mask:0xf bank_mask:0xf
    s_nop 0
    v_add_f32 v69, v69, v69 row_ror:1 row_mask:0xf bank_mask:0xf
    v_mov_b64 v[70:71], v[68:69]
    s_nop 1
    v_permlane16_swap_b32 v68, v70
    v_permlane16_swap_b32 v69, v71
    v_add_f32 v68, v68, v70
    v_add_f32 v69, v69, v71
    s_add_u32 s16, s101, 1
    v_mov_b32 v70, s16
    s_and_b32 s3, s101, 1
    s_lshl_b32 s3, s3, 7
    v_add_u32 v48, s3, v24
    s_mov_b32 exec_lo, s67
    s_mov_b32 exec_hi, s67
    ds_write_b96 v48, v[68:70]
    s_mov_b64 exec, -1
    v_mov_b64 v[66:67], v[64:65]
    s_nop 1
    v_permlane16_swap_b32 v64, v66
    v_permlane16_swap_b32 v65, v67
    s_lshl_b32 s61, s60, 21
    s_lshl_b32 s63, s101, 16
    s_add_u32 s61, s61, s63
    s_add_u32 s61, s61, 0x400000
    s_mul_i32 s3, s67, 0xffff
    s_mov_b32 exec_lo, s3
    s_mov_b32 exec_hi, s3
    buffer_store_dwordx4 v[64:67], v13, s[32:35], s61 offen sc1
    s_sub_u32 s3, 0, s67
    s_mov_b32 exec_lo, s3
    s_mov_b32 exec_hi, s3
    v_mov_b64 v[192:193], v[72:73]
    v_mov_b64 v[194:195], v[74:75]
    s_mov_b64 exec, -1
    s_add_u32 s71, s71, s67
    s_waitcnt lgkmcnt(0)
    s_branch Laq_306
Laq_304:
    s_add_u32 s16, s101, 1
    s_and_b32 s3, s101, 1
    s_lshl_b32 s3, s3, 7
    v_add_u32 v48, s3, v29
    ds_read_b128 v[68:71], v48
    s_lshl_b32 s61, s60, 21
    s_lshl_b32 s63, s101, 16
    s_add_u32 s61, s61, s63
    s_add_u32 s17, s61, 0x800000
    s_cmp_eq_u32 s71, 2
    s_cselect_b32 s67, 1, 0
    s_waitcnt lgkmcnt(0)
    v_cmp_ne_u32 vcc, s16, v70
    s_cmp_eq_u64 vcc, 0
    s_cselect_b32 s67, s67, 0
    v_add_f32 v68, v68, v68 quad_perm:[1,0,3,2] row_mask:0xf bank_mask:0xf
    v_add_f32 v69, v69, v69 quad_perm:[1,0,3,2] row_mask:0xf bank_mask:0xf
    s_nop 0
    v_add_f32 v68, v68, v68 quad_perm:[2,3,0,1] row_mask:0xf bank_mask:0xf
    v_add_f32 v69, v69, v69 quad_perm:[2,3,0,1] row_mask:0xf bank_mask:0xf
    v_mul_f32 v68, 0x3b000000, v68
    v_mul_f32 v70, v68, v68
    v_fma_f32 v69, v69, s94, -v70
    v_max_f32 v69, 0, v69
    v_add_f32 v69, 0x3727c5ac, v69
    v_rsq_f32 v69, v69
    v_sub_f32 v52, v192, v68
    v_sub_f32 v53, v193, v68
    v_sub_f32 v54, v194, v68
    v_sub_f32 v55, v195, v68
    v_mul_f32 v52, v52, v69
    v_mul_f32 v53, v53, v69
    v_mul_f32 v54, v54, v69
    v_mul_f32 v55, v55, v69
    v_cvt_pk_bf16_f32 v48, v52, v53
    v_cvt_pk_bf16_f32 v49, v54, v55
    v_mov_b64 v[50:51], v[48:49]
    s_nop 1
    v_permlane16_swap_b32 v48, v50
    v_permlane16_swap_b32 v49, v51
    s_mul_i32 s3, s67, 0xffff
    s_mov_b32 exec_lo, s3
    s_mov_b32 exec_hi, s3
    buffer_store_dwordx4 v[48:51], v13, s[32:35], s17 offen sc1
    s_mov_b64 exec, -1
    s_cmp_eq_u32 s67, 1
    s_cselect_b32 s71, 0, s71
    s_waitcnt lgkmcnt(0)
    s_branch Laq_306
Laq_305:
    s_branch L_exit
    s_branch L_exit
L_role_ch:
    s_mov_b32 s71, 0x05040100
    s_mov_b32 s72, 0x07060302
    s_mov_b32 s40, s8
    s_and_b32 s41, s9, 0xffff
    s_mov_b32 s42, 0x400000
    s_mov_b32 s43, 0x20000
    s_mov_b32 s44, s10
    s_and_b32 s45, s11, 0xffff
    s_mov_b32 s46, 0x400000
    s_mov_b32 s47, 0x20000
    s_mov_b32 s48, s12
    s_and_b32 s49, s13, 0xffff
    s_mov_b32 s50, 0x400000
    s_mov_b32 s51, 0x20000
    s_mov_b32 s52, s14
    s_and_b32 s53, s15, 0xffff
    s_mov_b32 s54, 0x400000
    s_mov_b32 s55, 0x20000
    v_and_b32 v20, 15, v1
    v_lshrrev_b32 v21, 4, v1
    v_lshrrev_b32 v22, 1, v21
    v_lshlrev_b32 v22, 17, v22
    v_and_b32 v23, 1, v21
    v_lshlrev_b32 v23, 15, v23
    v_add_u32 v22, v22, v23
    v_lshlrev_b32 v23, 2, v20
    v_add_u32 v22, v22, v23
    s_lshl_b32 s61, s58, 8
    s_lshl_b32 s62, s56, 6
    s_add_u32 s61, s61, s62
    v_add_u32 v22, s61, v22
    v_lshlrev_b32 v23, 13, v21
    v_lshlrev_b32 v24, 4, v20
    v_add_u32 v23, v23, v24
    s_lshl_b32 s61, s58, 17
    s_lshl_b32 s62, s56, 8
    s_add_u32 s61, s61, s62
    v_add_u32 v23, s61, v23
    v_lshlrev_b32 v3, 4, v1
    s_lshl_b32 s61, s56, 15
    v_add_u32 v3, s61, v3
    s_cmp_eq_u32 s56, 1
    s_cbranch_scc1 Lcwv_309
    s_cmp_eq_u32 s56, 2
    s_cbranch_scc1 Lcwv_310
    s_cmp_eq_u32 s56, 3
    s_cbranch_scc1 Lcwv_311
Lcwv_308:
    s_mov_b32 s3, 0x0
    buffer_load_dword v32, v22, s[40:43], s3 offen
    s_mov_b32 s3, 0x2000
    buffer_load_dword v33, v22, s[40:43], s3 offen
    s_mov_b32 s3, 0x10000
    buffer_load_dword v34, v22, s[40:43], s3 offen
    s_mov_b32 s3, 0x12000
    buffer_load_dword v35, v22, s[40:43], s3 offen
    s_mov_b32 s3, 0x4000
    buffer_load_dword v36, v22, s[40:43], s3 offen
    s_mov_b32 s3, 0x6000
    buffer_load_dword v37, v22, s[40:43], s3 offen
    s_mov_b32 s3, 0x14000
    buffer_load_dword v38, v22, s[40:43], s3 offen
    s_mov_b32 s3, 0x16000
    buffer_load_dword v39, v22, s[40:43], s3 offen
    s_mov_b32 s3, 0x40000
    buffer_load_dword v40, v22, s[40:43], s3 offen
    s_mov_b32 s3, 0x42000
    buffer_load_dword v41, v22, s[40:43], s3 offen
    s_mov_b32 s3, 0x50000
    buffer_load_dword v42, v22, s[40:43], s3 offen
    s_mov_b32 s3, 0x52000
    buffer_load_dword v43, v22, s[40:43], s3 offen
    s_mov_b32 s3, 0x44000
    buffer_load_dword v44, v22, s[40:43], s3 offen
    s_mov_b32 s3, 0x46000
    buffer_load_dword v45, v22, s[40:43], s3 offen
    s_mov_b32 s3, 0x54000
    buffer_load_dword v46, v22, s[40:43], s3 offen
    s_mov_b32 s3, 0x56000
    buffer_load_dword v47, v22, s[40:43], s3 offen
    s_mov_b32 s3, 0x0
    buffer_load_dword v48, v22, s[44:47], s3 offen
    s_mov_b32 s3, 0x2000
    buffer_load_dword v49, v22, s[44:47], s3 offen
    s_mov_b32 s3, 0x10000
    buffer_load_dword v50, v22, s[44:47], s3 offen
    s_mov_b32 s3, 0x12000
    buffer_load_dword v51, v22, s[44:47], s3 offen
    s_mov_b32 s3, 0x4000
    buffer_load_dword v52, v22, s[44:47], s3 offen
    s_mov_b32 s3, 0x6000
    buffer_load_dword v53, v22, s[44:47], s3 offen
    s_mov_b32 s3, 0x14000
    buffer_load_dword v54, v22, s[44:47], s3 offen
    s_mov_b32 s3, 0x16000
    buffer_load_dword v55, v22, s[44:47], s3 offen
    s_mov_b32 s3, 0x40000
    buffer_load_dword v56, v22, s[44:47], s3 offen
    s_mov_b32 s3, 0x42000
    buffer_load_dword v57, v22, s[44:47], s3 offen
    s_mov_b32 s3, 0x50000
    buffer_load_dword v58, v22, s[44:47], s3 offen
    s_mov_b32 s3, 0x52000
    buffer_load_dword v59, v22, s[44:47], s3 offen
    s_mov_b32 s3, 0x44000
    buffer_load_dword v60, v22, s[44:47], s3 offen
    s_mov_b32 s3, 0x46000
    buffer_load_dword v61, v22, s[44:47], s3 offen
    s_mov_b32 s3, 0x54000
    buffer_load_dword v62, v22, s[44:47], s3 offen
    s_mov_b32 s3, 0x56000
    buffer_load_dword v63, v22, s[44:47], s3 offen
    s_mov_b32 s3, 0x0
    buffer_load_dword v64, v22, s[48:51], s3 offen
    s_mov_b32 s3, 0x2000
    buffer_load_dword v65, v22, s[48:51], s3 offen
    s_mov_b32 s3, 0x10000
    buffer_load_dword v66, v22, s[48:51], s3 offen
    s_mov_b32 s3, 0x12000
    buffer_load_dword v67, v22, s[48:51], s3 offen
    s_mov_b32 s3, 0x4000
    buffer_load_dword v68, v22, s[48:51], s3 offen
    s_mov_b32 s3, 0x6000
    buffer_load_dword v69, v22, s[48:51], s3 offen
    s_mov_b32 s3, 0x14000
    buffer_load_dword v70, v22, s[48:51], s3 offen
    s_mov_b32 s3, 0x16000
    buffer_load_dword v71, v22, s[48:51], s3 offen
    s_mov_b32 s3, 0x40000
    buffer_load_dword v72, v22, s[48:51], s3 offen
    s_mov_b32 s3, 0x42000
    buffer_load_dword v73, v22, s[48:51], s3 offen
    s_mov_b32 s3, 0x50000
    buffer_load_dword v74, v22, s[48:51], s3 offen
    s_mov_b32 s3, 0x52000
    buffer_load_dword v75, v22, s[48:51], s3 offen
    s_mov_b32 s3, 0x44000
    buffer_load_dword v76, v22, s[48:51], s3 offen
    s_mov_b32 s3, 0x46000
    buffer_load_dword v77, v22, s[48:51], s3 offen
    s_mov_b32 s3, 0x54000
    buffer_load_dword v78, v22, s[48:51], s3 offen
    s_mov_b32 s3, 0x56000
    buffer_load_dword v79, v22, s[48:51], s3 offen
    s_mov_b32 s3, 0x80000
    buffer_load_dword v80, v22, s[40:43], s3 offen
    s_mov_b32 s3, 0x82000
    buffer_load_dword v81, v22, s[40:43], s3 offen
    s_mov_b32 s3, 0x90000
    buffer_load_dword v82, v22, s[40:43], s3 offen
    s_mov_b32 s3, 0x92000
    buffer_load_dword v83, v22, s[40:43], s3 offen
    s_mov_b32 s3, 0x84000
    buffer_load_dword v84, v22, s[40:43], s3 offen
    s_mov_b32 s3, 0x86000
    buffer_load_dword v85, v22, s[40:43], s3 offen
    s_mov_b32 s3, 0x94000
    buffer_load_dword v86, v22, s[40:43], s3 offen
    s_mov_b32 s3, 0x96000
    buffer_load_dword v87, v22, s[40:43], s3 offen
    s_waitcnt vmcnt(48)
    v_perm_b32 v88, v33, v32, s71
    v_accvgpr_write_b32 a0, v88
    v_perm_b32 v89, v35, v34, s71
    v_accvgpr_write_b32 a1, v89
    v_perm_b32 v90, v37, v36, s71
    v_accvgpr_write_b32 a2, v90
    v_perm_b32 v91, v39, v38, s71
    v_accvgpr_write_b32 a3, v91
    v_perm_b32 v92, v33, v32, s72
    v_accvgpr_write_b32 a8, v92
    v_perm_b32 v93, v35, v34, s72
    v_accvgpr_write_b32 a9, v93
    v_perm_b32 v94, v37, v36, s72
    v_accvgpr_write_b32 a10, v94
    v_perm_b32 v95, v39, v38, s72
    v_accvgpr_write_b32 a11, v95
    s_mov_b32 s3, 0xc0000
    buffer_load_dword v32, v22, s[40:43], s3 offen
    s_mov_b32 s3, 0xc2000
    buffer_load_dword v33, v22, s[40:43], s3 offen
    s_mov_b32 s3, 0xd0000
    buffer_load_dword v34, v22, s[40:43], s3 offen
    s_mov_b32 s3, 0xd2000
    buffer_load_dword v35, v22, s[40:43], s3 offen
    s_mov_b32 s3, 0xc4000
    buffer_load_dword v36, v22, s[40:43], s3 offen
    s_mov_b32 s3, 0xc6000
    buffer_load_dword v37, v22, s[40:43], s3 offen
    s_mov_b32 s3, 0xd4000
    buffer_load_dword v38, v22, s[40:43], s3 offen
    s_mov_b32 s3, 0xd6000
    buffer_load_dword v39, v22, s[40:43], s3 offen
    s_waitcnt vmcnt(48)
    v_perm_b32 v88, v41, v40, s71
    v_accvgpr_write_b32 a4, v88
    v_perm_b32 v89, v43, v42, s71
    v_accvgpr_write_b32 a5, v89
    v_perm_b32 v90, v45, v44, s71
    v_accvgpr_write_b32 a6, v90
    v_perm_b32 v91, v47, v46, s71
    v_accvgpr_write_b32 a7, v91
    v_perm_b32 v92, v41, v40, s72
    v_accvgpr_write_b32 a12, v92
    v_perm_b32 v93, v43, v42, s72
    v_accvgpr_write_b32 a13, v93
    v_perm_b32 v94, v45, v44, s72
    v_accvgpr_write_b32 a14, v94
    v_perm_b32 v95, v47, v46, s72
    v_accvgpr_write_b32 a15, v95
    s_mov_b32 s3, 0x80000
    buffer_load_dword v40, v22, s[44:47], s3 offen
    s_mov_b32 s3, 0x82000
    buffer_load_dword v41, v22, s[44:47], s3 offen
    s_mov_b32 s3, 0x90000
    buffer_load_dword v42, v22, s[44:47], s3 offen
    s_mov_b32 s3, 0x92000
    buffer_load_dword v43, v22, s[44:47], s3 offen
    s_mov_b32 s3, 0x84000
    buffer_load_dword v44, v22, s[44:47], s3 offen
    s_mov_b32 s3, 0x86000
    buffer_load_dword v45, v22, s[44:47], s3 offen
    s_mov_b32 s3, 0x94000
    buffer_load_dword v46, v22, s[44:47], s3 offen
    s_mov_b32 s3, 0x96000
    buffer_load_dword v47, v22, s[44:47], s3 offen
    s_waitcnt vmcnt(48)
    v_perm_b32 v88, v49, v48, s71
    v_accvgpr_write_b32 a16, v88
    v_perm_b32 v89, v51, v50, s71
    v_accvgpr_write_b32 a17, v89
    v_perm_b32 v90, v53, v52, s71
    v_accvgpr_write_b32 a18, v90
    v_perm_b32 v91, v55, v54, s71
    v_accvgpr_write_b32 a19, v91
    v_perm_b32 v92, v49, v48, s72
    v_perm_b32 v93, v51, v50, s72
    v_perm_b32 v94, v53, v52, s72
    v_perm_b32 v95, v55, v54, s72
    ds_write_b128 v3, v[92:95] offset:0
    s_mov_b32 s3, 0xc0000
    buffer_load_dword v48, v22, s[44:47], s3 offen
    s_mov_b32 s3, 0xc2000
    buffer_load_dword v49, v22, s[44:47], s3 offen
    s_mov_b32 s3, 0xd0000
    buffer_load_dword v50, v22, s[44:47], s3 offen
    s_mov_b32 s3, 0xd2000
    buffer_load_dword v51, v22, s[44:47], s3 offen
    s_mov_b32 s3, 0xc4000
    buffer_load_dword v52, v22, s[44:47], s3 offen
    s_mov_b32 s3, 0xc6000
    buffer_load_dword v53, v22, s[44:47], s3 offen
    s_mov_b32 s3, 0xd4000
    buffer_load_dword v54, v22, s[44:47], s3 offen
    s_mov_b32 s3, 0xd6000
    buffer_load_dword v55, v22, s[44:47], s3 offen
    s_waitcnt vmcnt(48)
    v_perm_b32 v88, v57, v56, s71
    v_accvgpr_write_b32 a20, v88
    v_perm_b32 v89, v59, v58, s71
    v_accvgpr_write_b32 a21, v89
    v_perm_b32 v90, v61, v60, s71
    v_accvgpr_write_b32 a22, v90
    v_perm_b32 v91, v63, v62, s71
    v_accvgpr_write_b32 a23, v91
    v_perm_b32 v92, v57, v56, s72
    v_perm_b32 v93, v59, v58, s72
    v_perm_b32 v94, v61, v60, s72
    v_perm_b32 v95, v63, v62, s72
    ds_write_b128 v3, v[92:95] offset:1024
    s_mov_b32 s3, 0x80000
    buffer_load_dword v56, v22, s[48:51], s3 offen
    s_mov_b32 s3, 0x82000
    buffer_load_dword v57, v22, s[48:51], s3 offen
    s_mov_b32 s3, 0x90000
    buffer_load_dword v58, v22, s[48:51], s3 offen
    s_mov_b32 s3, 0x92000
    buffer_load_dword v59, v22, s[48:51], s3 offen
    s_mov_b32 s3, 0x84000
    buffer_load_dword v60, v22, s[48:51], s3 offen
    s_mov_b32 s3, 0x86000
    buffer_load_dword v61, v22, s[48:51], s3 offen
    s_mov_b32 s3, 0x94000
    buffer_load_dword v62, v22, s[48:51], s3 offen
    s_mov_b32 s3, 0x96000
    buffer_load_dword v63, v22, s[48:51], s3 offen
    s_waitcnt vmcnt(48)
    v_perm_b32 v88, v65, v64, s71
    v_accvgpr_write_b32 a192, v88
    v_perm_b32 v89, v67, v66, s71
    v_accvgpr_write_b32 a193, v89
    v_perm_b32 v90, v69, v68, s71
    v_accvgpr_write_b32 a194, v90
    v_perm_b32 v91, v71, v70, s71
    v_accvgpr_write_b32 a195, v91
    v_perm_b32 v92, v65, v64, s72
    v_accvgpr_write_b32 a200, v92
    v_perm_b32 v93, v67, v66, s72
    v_accvgpr_write_b32 a201, v93
    v_perm_b32 v94, v69, v68, s72
    v_accvgpr_write_b32 a202, v94
    v_perm_b32 v95, v71, v70, s72
    v_accvgpr_write_b32 a203, v95
    s_mov_b32 s3, 0xc0000
    buffer_load_dword v64, v22, s[48:51], s3 offen
    s_mov_b32 s3, 0xc2000
    buffer_load_dword v65, v22, s[48:51], s3 offen
    s_mov_b32 s3, 0xd0000
    buffer_load_dword v66, v22, s[48:51], s3 offen
    s_mov_b32 s3, 0xd2000
    buffer_load_dword v67, v22, s[48:51], s3 offen
    s_mov_b32 s3, 0xc4000
    buffer_load_dword v68, v22, s[48:51], s3 offen
    s_mov_b32 s3, 0xc6000
    buffer_load_dword v69, v22, s[48:51], s3 offen
    s_mov_b32 s3, 0xd4000
    buffer_load_dword v70, v22, s[48:51], s3 offen
    s_mov_b32 s3, 0xd6000
    buffer_load_dword v71, v22, s[48:51], s3 offen
    s_waitcnt vmcnt(48)
    v_perm_b32 v88, v73, v72, s71
    v_accvgpr_write_b32 a196, v88
    v_perm_b32 v89, v75, v74, s71
    v_accvgpr_write_b32 a197, v89
    v_perm_b32 v90, v77, v76, s71
    v_accvgpr_write_b32 a198, v90
    v_perm_b32 v91, v79, v78, s71
    v_accvgpr_write_b32 a199, v91
    v_perm_b32 v92, v73, v72, s72
    v_accvgpr_write_b32 a204, v92
    v_perm_b32 v93, v75, v74, s72
    v_accvgpr_write_b32 a205, v93
    v_perm_b32 v94, v77, v76, s72
    v_accvgpr_write_b32 a206, v94
    v_perm_b32 v95, v79, v78, s72
    v_accvgpr_write_b32 a207, v95
    s_mov_b32 s3, 0x100000
    buffer_load_dword v72, v22, s[40:43], s3 offen
    s_mov_b32 s3, 0x102000
    buffer_load_dword v73, v22, s[40:43], s3 offen
    s_mov_b32 s3, 0x110000
    buffer_load_dword v74, v22, s[40:43], s3 offen
    s_mov_b32 s3, 0x112000
    buffer_load_dword v75, v22, s[40:43], s3 offen
    s_mov_b32 s3, 0x104000
    buffer_load_dword v76, v22, s[40:43], s3 offen
    s_mov_b32 s3, 0x106000
    buffer_load_dword v77, v22, s[40:43], s3 offen
    s_mov_b32 s3, 0x114000
    buffer_load_dword v78, v22, s[40:43], s3 offen
    s_mov_b32 s3, 0x116000
    buffer_load_dword v79, v22, s[40:43], s3 offen
    s_waitcnt vmcnt(48)
    v_perm_b32 v88, v81, v80, s71
    v_accvgpr_write_b32 a24, v88
    v_perm_b32 v89, v83, v82, s71
    v_accvgpr_write_b32 a25, v89
    v_perm_b32 v90, v85, v84, s71
    v_accvgpr_write_b32 a26, v90
    v_perm_b32 v91, v87, v86, s71
    v_accvgpr_write_b32 a27, v91
    v_perm_b32 v92, v81, v80, s72
    v_accvgpr_write_b32 a32, v92
    v_perm_b32 v93, v83, v82, s72
    v_accvgpr_write_b32 a33, v93
    v_perm_b32 v94, v85, v84, s72
    v_accvgpr_write_b32 a34, v94
    v_perm_b32 v95, v87, v86, s72
    v_accvgpr_write_b32 a35, v95
    s_mov_b32 s3, 0x140000
    buffer_load_dword v80, v22, s[40:43], s3 offen
    s_mov_b32 s3, 0x142000
    buffer_load_dword v81, v22, s[40:43], s3 offen
    s_mov_b32 s3, 0x150000
    buffer_load_dword v82, v22, s[40:43], s3 offen
    s_mov_b32 s3, 0x152000
    buffer_load_dword v83, v22, s[40:43], s3 offen
    s_mov_b32 s3, 0x144000
    buffer_load_dword v84, v22, s[40:43], s3 offen
    s_mov_b32 s3, 0x146000
    buffer_load_dword v85, v22, s[40:43], s3 offen
    s_mov_b32 s3, 0x154000
    buffer_load_dword v86, v22, s[40:43], s3 offen
    s_mov_b32 s3, 0x156000
    buffer_load_dword v87, v22, s[40:43], s3 offen
    s_waitcnt vmcnt(48)
    v_perm_b32 v88, v33, v32, s71
    v_accvgpr_write_b32 a28, v88
    v_perm_b32 v89, v35, v34, s71
    v_accvgpr_write_b32 a29, v89
    v_perm_b32 v90, v37, v36, s71
    v_accvgpr_write_b32 a30, v90
    v_perm_b32 v91, v39, v38, s71
    v_accvgpr_write_b32 a31, v91
    v_perm_b32 v92, v33, v32, s72
    v_accvgpr_write_b32 a36, v92
    v_perm_b32 v93, v35, v34, s72
    v_accvgpr_write_b32 a37, v93
    v_perm_b32 v94, v37, v36, s72
    v_accvgpr_write_b32 a38, v94
    v_perm_b32 v95, v39, v38, s72
    v_accvgpr_write_b32 a39, v95
    s_mov_b32 s3, 0x100000
    buffer_load_dword v32, v22, s[44:47], s3 offen
    s_mov_b32 s3, 0x102000
    buffer_load_dword v33, v22, s[44:47], s3 offen
    s_mov_b32 s3, 0x110000
    buffer_load_dword v34, v22, s[44:47], s3 offen
    s_mov_b32 s3, 0x112000
    buffer_load_dword v35, v22, s[44:47], s3 offen
    s_mov_b32 s3, 0x104000
    buffer_load_dword v36, v22, s[44:47], s3 offen
    s_mov_b32 s3, 0x106000
    buffer_load_dword v37, v22, s[44:47], s3 offen
    s_mov_b32 s3, 0x114000
    buffer_load_dword v38, v22, s[44:47], s3 offen
    s_mov_b32 s3, 0x116000
    buffer_load_dword v39, v22, s[44:47], s3 offen
    s_waitcnt vmcnt(48)
    v_perm_b32 v88, v41, v40, s71
    v_accvgpr_write_b32 a40, v88
    v_perm_b32 v89, v43, v42, s71
    v_accvgpr_write_b32 a41, v89
    v_perm_b32 v90, v45, v44, s71
    v_accvgpr_write_b32 a42, v90
    v_perm_b32 v91, v47, v46, s71
    v_accvgpr_write_b32 a43, v91
    v_perm_b32 v92, v41, v40, s72
    v_perm_b32 v93, v43, v42, s72
    v_perm_b32 v94, v45, v44, s72
    v_perm_b32 v95, v47, v46, s72
    ds_write_b128 v3, v[92:95] offset:2048
    s_mov_b32 s3, 0x140000
    buffer_load_dword v40, v22, s[44:47], s3 offen
    s_mov_b32 s3, 0x142000
    buffer_load_dword v41, v22, s[44:47], s3 offen
    s_mov_b32 s3, 0x150000
    buffer_load_dword v42, v22, s[44:47], s3 offen
    s_mov_b32 s3, 0x152000
    buffer_load_dword v43, v22, s[44:47], s3 offen
    s_mov_b32 s3, 0x144000
    buffer_load_dword v44, v22, s[44:47], s3 offen
    s_mov_b32 s3, 0x146000
    buffer_load_dword v45, v22, s[44:47], s3 offen
    s_mov_b32 s3, 0x154000
    buffer_load_dword v46, v22, s[44:47], s3 offen
    s_mov_b32 s3, 0x156000
    buffer_load_dword v47, v22, s[44:47], s3 offen
    s_waitcnt vmcnt(48)
    v_perm_b32 v88, v49, v48, s71
    v_accvgpr_write_b32 a44, v88
    v_perm_b32 v89, v51, v50, s71
    v_accvgpr_write_b32 a45, v89
    v_perm_b32 v90, v53, v52, s71
    v_accvgpr_write_b32 a46, v90
    v_perm_b32 v91, v55, v54, s71
    v_accvgpr_write_b32 a47, v91
    v_perm_b32 v92, v49, v48, s72
    v_perm_b32 v93, v51, v50, s72
    v_perm_b32 v94, v53, v52, s72
    v_perm_b32 v95, v55, v54, s72
    ds_write_b128 v3, v[92:95] offset:3072
    s_mov_b32 s3, 0x100000
    buffer_load_dword v48, v22, s[48:51], s3 offen
    s_mov_b32 s3, 0x102000
    buffer_load_dword v49, v22, s[48:51], s3 offen
    s_mov_b32 s3, 0x110000
    buffer_load_dword v50, v22, s[48:51], s3 offen
    s_mov_b32 s3, 0x112000
    buffer_load_dword v51, v22, s[48:51], s3 offen
    s_mov_b32 s3, 0x104000
    buffer_load_dword v52, v22, s[48:51], s3 offen
    s_mov_b32 s3, 0x106000
    buffer_load_dword v53, v22, s[48:51], s3 offen
    s_mov_b32 s3, 0x114000
    buffer_load_dword v54, v22, s[48:51], s3 offen
    s_mov_b32 s3, 0x116000
    buffer_load_dword v55, v22, s[48:51], s3 offen
    s_waitcnt vmcnt(48)
    v_perm_b32 v88, v57, v56, s71
    v_accvgpr_write_b32 a208, v88
    v_perm_b32 v89, v59, v58, s71
    v_accvgpr_write_b32 a209, v89
    v_perm_b32 v90, v61, v60, s71
    v_accvgpr_write_b32 a210, v90
    v_perm_b32 v91, v63, v62, s71
    v_accvgpr_write_b32 a211, v91
    v_perm_b32 v92, v57, v56, s72
    v_accvgpr_write_b32 a216, v92
    v_perm_b32 v93, v59, v58, s72
    v_accvgpr_write_b32 a217, v93
    v_perm_b32 v94, v61, v60, s72
    v_accvgpr_write_b32 a218, v94
    v_perm_b32 v95, v63, v62, s72
    v_accvgpr_write_b32 a219, v95
    s_mov_b32 s3, 0x140000
    buffer_load_dword v56, v22, s[48:51], s3 offen
    s_mov_b32 s3, 0x142000
    buffer_load_dword v57, v22, s[48:51], s3 offen
    s_mov_b32 s3, 0x150000
    buffer_load_dword v58, v22, s[48:51], s3 offen
    s_mov_b32 s3, 0x152000
    buffer_load_dword v59, v22, s[48:51], s3 offen
    s_mov_b32 s3, 0x144000
    buffer_load_dword v60, v22, s[48:51], s3 offen
    s_mov_b32 s3, 0x146000
    buffer_load_dword v61, v22, s[48:51], s3 offen
    s_mov_b32 s3, 0x154000
    buffer_load_dword v62, v22, s[48:51], s3 offen
    s_mov_b32 s3, 0x156000
    buffer_load_dword v63, v22, s[48:51], s3 offen
    s_waitcnt vmcnt(48)
    v_perm_b32 v88, v65, v64, s71
    v_accvgpr_write_b32 a212, v88
    v_perm_b32 v89, v67, v66, s71
    v_accvgpr_write_b32 a213, v89
    v_perm_b32 v90, v69, v68, s71
    v_accvgpr_write_b32 a214, v90
    v_perm_b32 v91, v71, v70, s71
    v_accvgpr_write_b32 a215, v91
    v_perm_b32 v92, v65, v64, s72
    v_accvgpr_write_b32 a220, v92
    v_perm_b32 v93, v67, v66, s72
    v_accvgpr_write_b32 a221, v93
    v_perm_b32 v94, v69, v68, s72
    v_accvgpr_write_b32 a222, v94
    v_perm_b32 v95, v71, v70, s72
    v_accvgpr_write_b32 a223, v95
    s_mov_b32 s3, 0x180000
    buffer_load_dword v64, v22, s[40:43], s3 offen
    s_mov_b32 s3, 0x182000
    buffer_load_dword v65, v22, s[40:43], s3 offen
    s_mov_b32 s3, 0x190000
    buffer_load_dword v66, v22, s[40:43], s3 offen
    s_mov_b32 s3, 0x192000
    buffer_load_dword v67, v22, s[40:43], s3 offen
    s_mov_b32 s3, 0x184000
    buffer_load_dword v68, v22, s[40:43], s3 offen
    s_mov_b32 s3, 0x186000
    buffer_load_dword v69, v22, s[40:43], s3 offen
    s_mov_b32 s3, 0x194000
    buffer_load_dword v70, v22, s[40:43], s3 offen
    s_mov_b32 s3, 0x196000
    buffer_load_dword v71, v22, s[40:43], s3 offen
    s_waitcnt vmcnt(48)
    v_perm_b32 v88, v73, v72, s71
    v_accvgpr_write_b32 a48, v88
    v_perm_b32 v89, v75, v74, s71
    v_accvgpr_write_b32 a49, v89
    v_perm_b32 v90, v77, v76, s71
    v_accvgpr_write_b32 a50, v90
    v_perm_b32 v91, v79, v78, s71
    v_accvgpr_write_b32 a51, v91
    v_perm_b32 v92, v73, v72, s72
    v_accvgpr_write_b32 a56, v92
    v_perm_b32 v93, v75, v74, s72
    v_accvgpr_write_b32 a57, v93
    v_perm_b32 v94, v77, v76, s72
    v_accvgpr_write_b32 a58, v94
    v_perm_b32 v95, v79, v78, s72
    v_accvgpr_write_b32 a59, v95
    s_mov_b32 s3, 0x1c0000
    buffer_load_dword v72, v22, s[40:43], s3 offen
    s_mov_b32 s3, 0x1c2000
    buffer_load_dword v73, v22, s[40:43], s3 offen
    s_mov_b32 s3, 0x1d0000
    buffer_load_dword v74, v22, s[40:43], s3 offen
    s_mov_b32 s3, 0x1d2000
    buffer_load_dword v75, v22, s[40:43], s3 offen
    s_mov_b32 s3, 0x1c4000
    buffer_load_dword v76, v22, s[40:43], s3 offen
    s_mov_b32 s3, 0x1c6000
    buffer_load_dword v77, v22, s[40:43], s3 offen
    s_mov_b32 s3, 0x1d4000
    buffer_load_dword v78, v22, s[40:43], s3 offen
    s_mov_b32 s3, 0x1d6000
    buffer_load_dword v79, v22, s[40:43], s3 offen
    s_waitcnt vmcnt(48)
    v_perm_b32 v88, v81, v80, s71
    v_accvgpr_write_b32 a52, v88
    v_perm_b32 v89, v83, v82, s71
    v_accvgpr_write_b32 a53, v89
    v_perm_b32 v90, v85, v84, s71
    v_accvgpr_write_b32 a54, v90
    v_perm_b32 v91, v87, v86, s71
    v_accvgpr_write_b32 a55, v91
    v_perm_b32 v92, v81, v80, s72
    v_accvgpr_write_b32 a60, v92
    v_perm_b32 v93, v83, v82, s72
    v_accvgpr_write_b32 a61, v93
    v_perm_b32 v94, v85, v84, s72
    v_accvgpr_write_b32 a62, v94
    v_perm_b32 v95, v87, v86, s72
    v_accvgpr_write_b32 a63, v95
    s_mov_b32 s3, 0x180000
    buffer_load_dword v80, v22, s[44:47], s3 offen
    s_mov_b32 s3, 0x182000
    buffer_load_dword v81, v22, s[44:47], s3 offen
    s_mov_b32 s3, 0x190000
    buffer_load_dword v82, v22, s[44:47], s3 offen
    s_mov_b32 s3, 0x192000
    buffer_load_dword v83, v22, s[44:47], s3 offen
    s_mov_b32 s3, 0x184000
    buffer_load_dword v84, v22, s[44:47], s3 offen
    s_mov_b32 s3, 0x186000
    buffer_load_dword v85, v22, s[44:47], s3 offen
    s_mov_b32 s3, 0x194000
    buffer_load_dword v86, v22, s[44:47], s3 offen
    s_mov_b32 s3, 0x196000
    buffer_load_dword v87, v22, s[44:47], s3 offen
    s_waitcnt vmcnt(48)
    v_perm_b32 v88, v33, v32, s71
    v_accvgpr_write_b32 a64, v88
    v_perm_b32 v89, v35, v34, s71
    v_accvgpr_write_b32 a65, v89
    v_perm_b32 v90, v37, v36, s71
    v_accvgpr_write_b32 a66, v90
    v_perm_b32 v91, v39, v38, s71
    v_accvgpr_write_b32 a67, v91
    v_perm_b32 v92, v33, v32, s72
    v_perm_b32 v93, v35, v34, s72
    v_perm_b32 v94, v37, v36, s72
    v_perm_b32 v95, v39, v38, s72
    ds_write_b128 v3, v[92:95] offset:4096
    s_mov_b32 s3, 0x1c0000
    buffer_load_dword v32, v22, s[44:47], s3 offen
    s_mov_b32 s3, 0x1c2000
    buffer_load_dword v33, v22, s[44:47], s3 offen
    s_mov_b32 s3, 0x1d0000
    buffer_load_dword v34, v22, s[44:47], s3 offen
    s_mov_b32 s3, 0x1d2000
    buffer_load_dword v35, v22, s[44:47], s3 offen
    s_mov_b32 s3, 0x1c4000
    buffer_load_dword v36, v22, s[44:47], s3 offen
    s_mov_b32 s3, 0x1c6000
    buffer_load_dword v37, v22, s[44:47], s3 offen
    s_mov_b32 s3, 0x1d4000
    buffer_load_dword v38, v22, s[44:47], s3 offen
    s_mov_b32 s3, 0x1d6000
    buffer_load_dword v39, v22, s[44:47], s3 offen
    s_waitcnt vmcnt(48)
    v_perm_b32 v88, v41, v40, s71
    v_accvgpr_write_b32 a68, v88
    v_perm_b32 v89, v43, v42, s71
    v_accvgpr_write_b32 a69, v89
    v_perm_b32 v90, v45, v44, s71
    v_accvgpr_write_b32 a70, v90
    v_perm_b32 v91, v47, v46, s71
    v_accvgpr_write_b32 a71, v91
    v_perm_b32 v92, v41, v40, s72
    v_perm_b32 v93, v43, v42, s72
    v_perm_b32 v94, v45, v44, s72
    v_perm_b32 v95, v47, v46, s72
    ds_write_b128 v3, v[92:95] offset:5120
    s_mov_b32 s3, 0x180000
    buffer_load_dword v40, v22, s[48:51], s3 offen
    s_mov_b32 s3, 0x182000
    buffer_load_dword v41, v22, s[48:51], s3 offen
    s_mov_b32 s3, 0x190000
    buffer_load_dword v42, v22, s[48:51], s3 offen
    s_mov_b32 s3, 0x192000
    buffer_load_dword v43, v22, s[48:51], s3 offen
    s_mov_b32 s3, 0x184000
    buffer_load_dword v44, v22, s[48:51], s3 offen
    s_mov_b32 s3, 0x186000
    buffer_load_dword v45, v22, s[48:51], s3 offen
    s_mov_b32 s3, 0x194000
    buffer_load_dword v46, v22, s[48:51], s3 offen
    s_mov_b32 s3, 0x196000
    buffer_load_dword v47, v22, s[48:51], s3 offen
    s_waitcnt vmcnt(48)
    v_perm_b32 v88, v49, v48, s71
    v_accvgpr_write_b32 a224, v88
    v_perm_b32 v89, v51, v50, s71
    v_accvgpr_write_b32 a225, v89
    v_perm_b32 v90, v53, v52, s71
    v_accvgpr_write_b32 a226, v90
    v_perm_b32 v91, v55, v54, s71
    v_accvgpr_write_b32 a227, v91
    v_perm_b32 v92, v49, v48, s72
    v_accvgpr_write_b32 a232, v92
    v_perm_b32 v93, v51, v50, s72
    v_accvgpr_write_b32 a233, v93
    v_perm_b32 v94, v53, v52, s72
    v_accvgpr_write_b32 a234, v94
    v_perm_b32 v95, v55, v54, s72
    v_accvgpr_write_b32 a235, v95
    s_mov_b32 s3, 0x1c0000
    buffer_load_dword v48, v22, s[48:51], s3 offen
    s_mov_b32 s3, 0x1c2000
    buffer_load_dword v49, v22, s[48:51], s3 offen
    s_mov_b32 s3, 0x1d0000
    buffer_load_dword v50, v22, s[48:51], s3 offen
    s_mov_b32 s3, 0x1d2000
    buffer_load_dword v51, v22, s[48:51], s3 offen
    s_mov_b32 s3, 0x1c4000
    buffer_load_dword v52, v22, s[48:51], s3 offen
    s_mov_b32 s3, 0x1c6000
    buffer_load_dword v53, v22, s[48:51], s3 offen
    s_mov_b32 s3, 0x1d4000
    buffer_load_dword v54, v22, s[48:51], s3 offen
    s_mov_b32 s3, 0x1d6000
    buffer_load_dword v55, v22, s[48:51], s3 offen
    s_waitcnt vmcnt(48)
    v_perm_b32 v88, v57, v56, s71
    v_accvgpr_write_b32 a228, v88
    v_perm_b32 v89, v59, v58, s71
    v_accvgpr_write_b32 a229, v89
    v_perm_b32 v90, v61, v60, s71
    v_accvgpr_write_b32 a230, v90
    v_perm_b32 v91, v63, v62, s71
    v_accvgpr_write_b32 a231, v91
    v_perm_b32 v92, v57, v56, s72
    v_accvgpr_write_b32 a236, v92
    v_perm_b32 v93, v59, v58, s72
    v_accvgpr_write_b32 a237, v93
    v_perm_b32 v94, v61, v60, s72
    v_accvgpr_write_b32 a238, v94
    v_perm_b32 v95, v63, v62, s72
    v_accvgpr_write_b32 a239, v95
    s_mov_b32 s3, 0x200000
    buffer_load_dword v56, v22, s[40:43], s3 offen
    s_mov_b32 s3, 0x202000
    buffer_load_dword v57, v22, s[40:43], s3 offen
    s_mov_b32 s3, 0x210000
    buffer_load_dword v58, v22, s[40:43], s3 offen
    s_mov_b32 s3, 0x212000
    buffer_load_dword v59, v22, s[40:43], s3 offen
    s_mov_b32 s3, 0x204000
    buffer_load_dword v60, v22, s[40:43], s3 offen
    s_mov_b32 s3, 0x206000
    buffer_load_dword v61, v22, s[40:43], s3 offen
    s_mov_b32 s3, 0x214000
    buffer_load_dword v62, v22, s[40:43], s3 offen
    s_mov_b32 s3, 0x216000
    buffer_load_dword v63, v22, s[40:43], s3 offen
    s_waitcnt vmcnt(48)
    v_perm_b32 v88, v65, v64, s71
    v_accvgpr_write_b32 a72, v88
    v_perm_b32 v89, v67, v66, s71
    v_accvgpr_write_b32 a73, v89
    v_perm_b32 v90, v69, v68, s71
    v_accvgpr_write_b32 a74, v90
    v_perm_b32 v91, v71, v70, s71
    v_accvgpr_write_b32 a75, v91
    v_perm_b32 v92, v65, v64, s72
    v_accvgpr_write_b32 a80, v92
    v_perm_b32 v93, v67, v66, s72
    v_accvgpr_write_b32 a81, v93
    v_perm_b32 v94, v69, v68, s72
    v_accvgpr_write_b32 a82, v94
    v_perm_b32 v95, v71, v70, s72
    v_accvgpr_write_b32 a83, v95
    s_mov_b32 s3, 0x240000
    buffer_load_dword v64, v22, s[40:43], s3 offen
    s_mov_b32 s3, 0x242000
    buffer_load_dword v65, v22, s[40:43], s3 offen
    s_mov_b32 s3, 0x250000
    buffer_load_dword v66, v22, s[40:43], s3 offen
    s_mov_b32 s3, 0x252000
    buffer_load_dword v67, v22, s[40:43], s3 offen
    s_mov_b32 s3, 0x244000
    buffer_load_dword v68, v22, s[40:43], s3 offen
    s_mov_b32 s3, 0x246000
    buffer_load_dword v69, v22, s[40:43], s3 offen
    s_mov_b32 s3, 0x254000
    buffer_load_dword v70, v22, s[40:43], s3 offen
    s_mov_b32 s3, 0x256000
    buffer_load_dword v71, v22, s[40:43], s3 offen
    s_waitcnt vmcnt(48)
    v_perm_b32 v88, v73, v72, s71
    v_accvgpr_write_b32 a76, v88
    v_perm_b32 v89, v75, v74, s71
    v_accvgpr_write_b32 a77, v89
    v_perm_b32 v90, v77, v76, s71
    v_accvgpr_write_b32 a78, v90
    v_perm_b32 v91, v79, v78, s71
    v_accvgpr_write_b32 a79, v91
    v_perm_b32 v92, v73, v72, s72
    v_accvgpr_write_b32 a84, v92
    v_perm_b32 v93, v75, v74, s72
    v_accvgpr_write_b32 a85, v93
    v_perm_b32 v94, v77, v76, s72
    v_accvgpr_write_b32 a86, v94
    v_perm_b32 v95, v79, v78, s72
    v_accvgpr_write_b32 a87, v95
    s_mov_b32 s3, 0x200000
    buffer_load_dword v72, v22, s[44:47], s3 offen
    s_mov_b32 s3, 0x202000
    buffer_load_dword v73, v22, s[44:47], s3 offen
    s_mov_b32 s3, 0x210000
    buffer_load_dword v74, v22, s[44:47], s3 offen
    s_mov_b32 s3, 0x212000
    buffer_load_dword v75, v22, s[44:47], s3 offen
    s_mov_b32 s3, 0x204000
    buffer_load_dword v76, v22, s[44:47], s3 offen
    s_mov_b32 s3, 0x206000
    buffer_load_dword v77, v22, s[44:47], s3 offen
    s_mov_b32 s3, 0x214000
    buffer_load_dword v78, v22, s[44:47], s3 offen
    s_mov_b32 s3, 0x216000
    buffer_load_dword v79, v22, s[44:47], s3 offen
    s_waitcnt vmcnt(48)
    v_perm_b32 v88, v81, v80, s71
    v_accvgpr_write_b32 a88, v88
    v_perm_b32 v89, v83, v82, s71
    v_accvgpr_write_b32 a89, v89
    v_perm_b32 v90, v85, v84, s71
    v_accvgpr_write_b32 a90, v90
    v_perm_b32 v91, v87, v86, s71
    v_accvgpr_write_b32 a91, v91
    v_perm_b32 v92, v81, v80, s72
    v_perm_b32 v93, v83, v82, s72
    v_perm_b32 v94, v85, v84, s72
    v_perm_b32 v95, v87, v86, s72
    ds_write_b128 v3, v[92:95] offset:6144
    s_mov_b32 s3, 0x240000
    buffer_load_dword v80, v22, s[44:47], s3 offen
    s_mov_b32 s3, 0x242000
    buffer_load_dword v81, v22, s[44:47], s3 offen
    s_mov_b32 s3, 0x250000
    buffer_load_dword v82, v22, s[44:47], s3 offen
    s_mov_b32 s3, 0x252000
    buffer_load_dword v83, v22, s[44:47], s3 offen
    s_mov_b32 s3, 0x244000
    buffer_load_dword v84, v22, s[44:47], s3 offen
    s_mov_b32 s3, 0x246000
    buffer_load_dword v85, v22, s[44:47], s3 offen
    s_mov_b32 s3, 0x254000
    buffer_load_dword v86, v22, s[44:47], s3 offen
    s_mov_b32 s3, 0x256000
    buffer_load_dword v87, v22, s[44:47], s3 offen
    s_waitcnt vmcnt(48)
    v_perm_b32 v88, v33, v32, s71
    v_accvgpr_write_b32 a92, v88
    v_perm_b32 v89, v35, v34, s71
    v_accvgpr_write_b32 a93, v89
    v_perm_b32 v90, v37, v36, s71
    v_accvgpr_write_b32 a94, v90
    v_perm_b32 v91, v39, v38, s71
    v_accvgpr_write_b32 a95, v91
    v_perm_b32 v92, v33, v32, s72
    v_perm_b32 v93, v35, v34, s72
    v_perm_b32 v94, v37, v36, s72
    v_perm_b32 v95, v39, v38, s72
    ds_write_b128 v3, v[92:95] offset:7168
    s_mov_b32 s3, 0x200000
    buffer_load_dword v32, v22, s[48:51], s3 offen
    s_mov_b32 s3, 0x202000
    buffer_load_dword v33, v22, s[48:51], s3 offen
    s_mov_b32 s3, 0x210000
    buffer_load_dword v34, v22, s[48:51], s3 offen
    s_mov_b32 s3, 0x212000
    buffer_load_dword v35, v22, s[48:51], s3 offen
    s_mov_b32 s3, 0x204000
    buffer_load_dword v36, v22, s[48:51], s3 offen
    s_mov_b32 s3, 0x206000
    buffer_load_dword v37, v22, s[48:51], s3 offen
    s_mov_b32 s3, 0x214000
    buffer_load_dword v38, v22, s[48:51], s3 offen
    s_mov_b32 s3, 0x216000
    buffer_load_dword v39, v22, s[48:51], s3 offen
    s_waitcnt vmcnt(48)
    v_perm_b32 v88, v41, v40, s71
    v_accvgpr_write_b32 a240, v88
    v_perm_b32 v89, v43, v42, s71
    v_accvgpr_write_b32 a241, v89
    v_perm_b32 v90, v45, v44, s71
    v_accvgpr_write_b32 a242, v90
    v_perm_b32 v91, v47, v46, s71
    v_accvgpr_write_b32 a243, v91
    v_perm_b32 v92, v41, v40, s72
    v_accvgpr_write_b32 a248, v92
    v_perm_b32 v93, v43, v42, s72
    v_accvgpr_write_b32 a249, v93
    v_perm_b32 v94, v45, v44, s72
    v_accvgpr_write_b32 a250, v94
    v_perm_b32 v95, v47, v46, s72
    v_accvgpr_write_b32 a251, v95
    s_mov_b32 s3, 0x240000
    buffer_load_dword v40, v22, s[48:51], s3 offen
    s_mov_b32 s3, 0x242000
    buffer_load_dword v41, v22, s[48:51], s3 offen
    s_mov_b32 s3, 0x250000
    buffer_load_dword v42, v22, s[48:51], s3 offen
    s_mov_b32 s3, 0x252000
    buffer_load_dword v43, v22, s[48:51], s3 offen
    s_mov_b32 s3, 0x244000
    buffer_load_dword v44, v22, s[48:51], s3 offen
    s_mov_b32 s3, 0x246000
    buffer_load_dword v45, v22, s[48:51], s3 offen
    s_mov_b32 s3, 0x254000
    buffer_load_dword v46, v22, s[48:51], s3 offen
    s_mov_b32 s3, 0x256000
    buffer_load_dword v47, v22, s[48:51], s3 offen
    s_waitcnt vmcnt(48)
    v_perm_b32 v88, v49, v48, s71
    v_accvgpr_write_b32 a244, v88
    v_perm_b32 v89, v51, v50, s71
    v_accvgpr_write_b32 a245, v89
    v_perm_b32 v90, v53, v52, s71
    v_accvgpr_write_b32 a246, v90
    v_perm_b32 v91, v55, v54, s71
    v_accvgpr_write_b32 a247, v91
    v_perm_b32 v92, v49, v48, s72
    v_accvgpr_write_b32 a252, v92
    v_perm_b32 v93, v51, v50, s72
    v_accvgpr_write_b32 a253, v93
    v_perm_b32 v94, v53, v52, s72
    v_accvgpr_write_b32 a254, v94
    v_perm_b32 v95, v55, v54, s72
    v_accvgpr_write_b32 a255, v95
    s_mov_b32 s3, 0x280000
    buffer_load_dword v48, v22, s[40:43], s3 offen
    s_mov_b32 s3, 0x282000
    buffer_load_dword v49, v22, s[40:43], s3 offen
    s_mov_b32 s3, 0x290000
    buffer_load_dword v50, v22, s[40:43], s3 offen
    s_mov_b32 s3, 0x292000
    buffer_load_dword v51, v22, s[40:43], s3 offen
    s_mov_b32 s3, 0x284000
    buffer_load_dword v52, v22, s[40:43], s3 offen
    s_mov_b32 s3, 0x286000
    buffer_load_dword v53, v22, s[40:43], s3 offen
    s_mov_b32 s3, 0x294000
    buffer_load_dword v54, v22, s[40:43], s3 offen
    s_mov_b32 s3, 0x296000
    buffer_load_dword v55, v22, s[40:43], s3 offen
    s_waitcnt vmcnt(48)
    v_perm_b32 v88, v57, v56, s71
    v_accvgpr_write_b32 a96, v88
    v_perm_b32 v89, v59, v58, s71
    v_accvgpr_write_b32 a97, v89
    v_perm_b32 v90, v61, v60, s71
    v_accvgpr_write_b32 a98, v90
    v_perm_b32 v91, v63, v62, s71
    v_accvgpr_write_b32 a99, v91
    v_perm_b32 v92, v57, v56, s72
    v_accvgpr_write_b32 a104, v92
    v_perm_b32 v93, v59, v58, s72
    v_accvgpr_write_b32 a105, v93
    v_perm_b32 v94, v61, v60, s72
    v_accvgpr_write_b32 a106, v94
    v_perm_b32 v95, v63, v62, s72
    v_accvgpr_write_b32 a107, v95
    s_mov_b32 s3, 0x2c0000
    buffer_load_dword v56, v22, s[40:43], s3 offen
    s_mov_b32 s3, 0x2c2000
    buffer_load_dword v57, v22, s[40:43], s3 offen
    s_mov_b32 s3, 0x2d0000
    buffer_load_dword v58, v22, s[40:43], s3 offen
    s_mov_b32 s3, 0x2d2000
    buffer_load_dword v59, v22, s[40:43], s3 offen
    s_mov_b32 s3, 0x2c4000
    buffer_load_dword v60, v22, s[40:43], s3 offen
    s_mov_b32 s3, 0x2c6000
    buffer_load_dword v61, v22, s[40:43], s3 offen
    s_mov_b32 s3, 0x2d4000
    buffer_load_dword v62, v22, s[40:43], s3 offen
    s_mov_b32 s3, 0x2d6000
    buffer_load_dword v63, v22, s[40:43], s3 offen
    s_waitcnt vmcnt(48)
    v_perm_b32 v88, v65, v64, s71
    v_accvgpr_write_b32 a100, v88
    v_perm_b32 v89, v67, v66, s71
    v_accvgpr_write_b32 a101, v89
    v_perm_b32 v90, v69, v68, s71
    v_accvgpr_write_b32 a102, v90
    v_perm_b32 v91, v71, v70, s71
    v_accvgpr_write_b32 a103, v91
    v_perm_b32 v92, v65, v64, s72
    v_accvgpr_write_b32 a108, v92
    v_perm_b32 v93, v67, v66, s72
    v_accvgpr_write_b32 a109, v93
    v_perm_b32 v94, v69, v68, s72
    v_accvgpr_write_b32 a110, v94
    v_perm_b32 v95, v71, v70, s72
    v_accvgpr_write_b32 a111, v95
    s_mov_b32 s3, 0x280000
    buffer_load_dword v64, v22, s[44:47], s3 offen
    s_mov_b32 s3, 0x282000
    buffer_load_dword v65, v22, s[44:47], s3 offen
    s_mov_b32 s3, 0x290000
    buffer_load_dword v66, v22, s[44:47], s3 offen
    s_mov_b32 s3, 0x292000
    buffer_load_dword v67, v22, s[44:47], s3 offen
    s_mov_b32 s3, 0x284000
    buffer_load_dword v68, v22, s[44:47], s3 offen
    s_mov_b32 s3, 0x286000
    buffer_load_dword v69, v22, s[44:47], s3 offen
    s_mov_b32 s3, 0x294000
    buffer_load_dword v70, v22, s[44:47], s3 offen
    s_mov_b32 s3, 0x296000
    buffer_load_dword v71, v22, s[44:47], s3 offen
    s_waitcnt vmcnt(48)
    v_perm_b32 v88, v73, v72, s71
    v_accvgpr_write_b32 a112, v88
    v_perm_b32 v89, v75, v74, s71
    v_accvgpr_write_b32 a113, v89
    v_perm_b32 v90, v77, v76, s71
    v_accvgpr_write_b32 a114, v90
    v_perm_b32 v91, v79, v78, s71
    v_accvgpr_write_b32 a115, v91
    v_perm_b32 v92, v73, v72, s72
    v_perm_b32 v93, v75, v74, s72
    v_perm_b32 v94, v77, v76, s72
    v_perm_b32 v95, v79, v78, s72
    ds_write_b128 v3, v[92:95] offset:8192
    s_mov_b32 s3, 0x2c0000
    buffer_load_dword v72, v22, s[44:47], s3 offen
    s_mov_b32 s3, 0x2c2000
    buffer_load_dword v73, v22, s[44:47], s3 offen
    s_mov_b32 s3, 0x2d0000
    buffer_load_dword v74, v22, s[44:47], s3 offen
    s_mov_b32 s3, 0x2d2000
    buffer_load_dword v75, v22, s[44:47], s3 offen
    s_mov_b32 s3, 0x2c4000
    buffer_load_dword v76, v22, s[44:47], s3 offen
    s_mov_b32 s3, 0x2c6000
    buffer_load_dword v77, v22, s[44:47], s3 offen
    s_mov_b32 s3, 0x2d4000
    buffer_load_dword v78, v22, s[44:47], s3 offen
    s_mov_b32 s3, 0x2d6000
    buffer_load_dword v79, v22, s[44:47], s3 offen
    s_waitcnt vmcnt(48)
    v_perm_b32 v88, v81, v80, s71
    v_accvgpr_write_b32 a116, v88
    v_perm_b32 v89, v83, v82, s71
    v_accvgpr_write_b32 a117, v89
    v_perm_b32 v90, v85, v84, s71
    v_accvgpr_write_b32 a118, v90
    v_perm_b32 v91, v87, v86, s71
    v_accvgpr_write_b32 a119, v91
    v_perm_b32 v92, v81, v80, s72
    v_perm_b32 v93, v83, v82, s72
    v_perm_b32 v94, v85, v84, s72
    v_perm_b32 v95, v87, v86, s72
    ds_write_b128 v3, v[92:95] offset:9216
    s_mov_b32 s3, 0x280000
    buffer_load_dword v80, v22, s[48:51], s3 offen
    s_mov_b32 s3, 0x282000
    buffer_load_dword v81, v22, s[48:51], s3 offen
    s_mov_b32 s3, 0x290000
    buffer_load_dword v82, v22, s[48:51], s3 offen
    s_mov_b32 s3, 0x292000
    buffer_load_dword v83, v22, s[48:51], s3 offen
    s_mov_b32 s3, 0x284000
    buffer_load_dword v84, v22, s[48:51], s3 offen
    s_mov_b32 s3, 0x286000
    buffer_load_dword v85, v22, s[48:51], s3 offen
    s_mov_b32 s3, 0x294000
    buffer_load_dword v86, v22, s[48:51], s3 offen
    s_mov_b32 s3, 0x296000
    buffer_load_dword v87, v22, s[48:51], s3 offen
    s_waitcnt vmcnt(48)
    v_perm_b32 v88, v33, v32, s71
    v_perm_b32 v89, v35, v34, s71
    v_perm_b32 v90, v37, v36, s71
    v_perm_b32 v91, v39, v38, s71
    ds_write_b128 v3, v[88:91] offset:16384
    v_perm_b32 v92, v33, v32, s72
    v_perm_b32 v93, v35, v34, s72
    v_perm_b32 v94, v37, v36, s72
    v_perm_b32 v95, v39, v38, s72
    ds_write_b128 v3, v[92:95] offset:18432
    s_mov_b32 s3, 0x2c0000
    buffer_load_dword v32, v22, s[48:51], s3 offen
    s_mov_b32 s3, 0x2c2000
    buffer_load_dword v33, v22, s[48:51], s3 offen
    s_mov_b32 s3, 0x2d0000
    buffer_load_dword v34, v22, s[48:51], s3 offen
    s_mov_b32 s3, 0x2d2000
    buffer_load_dword v35, v22, s[48:51], s3 offen
    s_mov_b32 s3, 0x2c4000
    buffer_load_dword v36, v22, s[48:51], s3 offen
    s_mov_b32 s3, 0x2c6000
    buffer_load_dword v37, v22, s[48:51], s3 offen
    s_mov_b32 s3, 0x2d4000
    buffer_load_dword v38, v22, s[48:51], s3 offen
    s_mov_b32 s3, 0x2d6000
    buffer_load_dword v39, v22, s[48:51], s3 offen
    s_waitcnt vmcnt(48)
    v_perm_b32 v88, v41, v40, s71
    v_perm_b32 v89, v43, v42, s71
    v_perm_b32 v90, v45, v44, s71
    v_perm_b32 v91, v47, v46, s71
    ds_write_b128 v3, v[88:91] offset:17408
    v_perm_b32 v92, v41, v40, s72
    v_perm_b32 v93, v43, v42, s72
    v_perm_b32 v94, v45, v44, s72
    v_perm_b32 v95, v47, v46, s72
    ds_write_b128 v3, v[92:95] offset:19456
    s_mov_b32 s3, 0x300000
    buffer_load_dword v40, v22, s[40:43], s3 offen
    s_mov_b32 s3, 0x302000
    buffer_load_dword v41, v22, s[40:43], s3 offen
    s_mov_b32 s3, 0x310000
    buffer_load_dword v42, v22, s[40:43], s3 offen
    s_mov_b32 s3, 0x312000
    buffer_load_dword v43, v22, s[40:43], s3 offen
    s_mov_b32 s3, 0x304000
    buffer_load_dword v44, v22, s[40:43], s3 offen
    s_mov_b32 s3, 0x306000
    buffer_load_dword v45, v22, s[40:43], s3 offen
    s_mov_b32 s3, 0x314000
    buffer_load_dword v46, v22, s[40:43], s3 offen
    s_mov_b32 s3, 0x316000
    buffer_load_dword v47, v22, s[40:43], s3 offen
    s_waitcnt vmcnt(48)
    v_perm_b32 v88, v49, v48, s71
    v_accvgpr_write_b32 a120, v88
    v_perm_b32 v89, v51, v50, s71
    v_accvgpr_write_b32 a121, v89
    v_perm_b32 v90, v53, v52, s71
    v_accvgpr_write_b32 a122, v90
    v_perm_b32 v91, v55, v54, s71
    v_accvgpr_write_b32 a123, v91
    v_perm_b32 v92, v49, v48, s72
    v_accvgpr_write_b32 a128, v92
    v_perm_b32 v93, v51, v50, s72
    v_accvgpr_write_b32 a129, v93
    v_perm_b32 v94, v53, v52, s72
    v_accvgpr_write_b32 a130, v94
    v_perm_b32 v95, v55, v54, s72
    v_accvgpr_write_b32 a131, v95
    s_mov_b32 s3, 0x340000
    buffer_load_dword v48, v22, s[40:43], s3 offen
    s_mov_b32 s3, 0x342000
    buffer_load_dword v49, v22, s[40:43], s3 offen
    s_mov_b32 s3, 0x350000
    buffer_load_dword v50, v22, s[40:43], s3 offen
    s_mov_b32 s3, 0x352000
    buffer_load_dword v51, v22, s[40:43], s3 offen
    s_mov_b32 s3, 0x344000
    buffer_load_dword v52, v22, s[40:43], s3 offen
    s_mov_b32 s3, 0x346000
    buffer_load_dword v53, v22, s[40:43], s3 offen
    s_mov_b32 s3, 0x354000
    buffer_load_dword v54, v22, s[40:43], s3 offen
    s_mov_b32 s3, 0x356000
    buffer_load_dword v55, v22, s[40:43], s3 offen
    s_waitcnt vmcnt(48)
    v_perm_b32 v88, v57, v56, s71
    v_accvgpr_write_b32 a124, v88
    v_perm_b32 v89, v59, v58, s71
    v_accvgpr_write_b32 a125, v89
    v_perm_b32 v90, v61, v60, s71
    v_accvgpr_write_b32 a126, v90
    v_perm_b32 v91, v63, v62, s71
    v_accvgpr_write_b32 a127, v91
    v_perm_b32 v92, v57, v56, s72
    v_accvgpr_write_b32 a132, v92
    v_perm_b32 v93, v59, v58, s72
    v_accvgpr_write_b32 a133, v93
    v_perm_b32 v94, v61, v60, s72
    v_accvgpr_write_b32 a134, v94
    v_perm_b32 v95, v63, v62, s72
    v_accvgpr_write_b32 a135, v95
    s_mov_b32 s3, 0x300000
    buffer_load_dword v56, v22, s[44:47], s3 offen
    s_mov_b32 s3, 0x302000
    buffer_load_dword v57, v22, s[44:47], s3 offen
    s_mov_b32 s3, 0x310000
    buffer_load_dword v58, v22, s[44:47], s3 offen
    s_mov_b32 s3, 0x312000
    buffer_load_dword v59, v22, s[44:47], s3 offen
    s_mov_b32 s3, 0x304000
    buffer_load_dword v60, v22, s[44:47], s3 offen
    s_mov_b32 s3, 0x306000
    buffer_load_dword v61, v22, s[44:47], s3 offen
    s_mov_b32 s3, 0x314000
    buffer_load_dword v62, v22, s[44:47], s3 offen
    s_mov_b32 s3, 0x316000
    buffer_load_dword v63, v22, s[44:47], s3 offen
    s_waitcnt vmcnt(48)
    v_perm_b32 v88, v65, v64, s71
    v_accvgpr_write_b32 a136, v88
    v_perm_b32 v89, v67, v66, s71
    v_accvgpr_write_b32 a137, v89
    v_perm_b32 v90, v69, v68, s71
    v_accvgpr_write_b32 a138, v90
    v_perm_b32 v91, v71, v70, s71
    v_accvgpr_write_b32 a139, v91
    v_perm_b32 v92, v65, v64, s72
    v_perm_b32 v93, v67, v66, s72
    v_perm_b32 v94, v69, v68, s72
    v_perm_b32 v95, v71, v70, s72
    ds_write_b128 v3, v[92:95] offset:10240
    s_mov_b32 s3, 0x340000
    buffer_load_dword v64, v22, s[44:47], s3 offen
    s_mov_b32 s3, 0x342000
    buffer_load_dword v65, v22, s[44:47], s3 offen
    s_mov_b32 s3, 0x350000
    buffer_load_dword v66, v22, s[44:47], s3 offen
    s_mov_b32 s3, 0x352000
    buffer_load_dword v67, v22, s[44:47], s3 offen
    s_mov_b32 s3, 0x344000
    buffer_load_dword v68, v22, s[44:47], s3 offen
    s_mov_b32 s3, 0x346000
    buffer_load_dword v69, v22, s[44:47], s3 offen
    s_mov_b32 s3, 0x354000
    buffer_load_dword v70, v22, s[44:47], s3 offen
    s_mov_b32 s3, 0x356000
    buffer_load_dword v71, v22, s[44:47], s3 offen
    s_waitcnt vmcnt(48)
    v_perm_b32 v88, v73, v72, s71
    v_accvgpr_write_b32 a140, v88
    v_perm_b32 v89, v75, v74, s71
    v_accvgpr_write_b32 a141, v89
    v_perm_b32 v90, v77, v76, s71
    v_accvgpr_write_b32 a142, v90
    v_perm_b32 v91, v79, v78, s71
    v_accvgpr_write_b32 a143, v91
    v_perm_b32 v92, v73, v72, s72
    v_perm_b32 v93, v75, v74, s72
    v_perm_b32 v94, v77, v76, s72
    v_perm_b32 v95, v79, v78, s72
    ds_write_b128 v3, v[92:95] offset:11264
    s_mov_b32 s3, 0x300000
    buffer_load_dword v72, v22, s[48:51], s3 offen
    s_mov_b32 s3, 0x302000
    buffer_load_dword v73, v22, s[48:51], s3 offen
    s_mov_b32 s3, 0x310000
    buffer_load_dword v74, v22, s[48:51], s3 offen
    s_mov_b32 s3, 0x312000
    buffer_load_dword v75, v22, s[48:51], s3 offen
    s_mov_b32 s3, 0x304000
    buffer_load_dword v76, v22, s[48:51], s3 offen
    s_mov_b32 s3, 0x306000
    buffer_load_dword v77, v22, s[48:51], s3 offen
    s_mov_b32 s3, 0x314000
    buffer_load_dword v78, v22, s[48:51], s3 offen
    s_mov_b32 s3, 0x316000
    buffer_load_dword v79, v22, s[48:51], s3 offen
    s_waitcnt vmcnt(48)
    v_perm_b32 v88, v81, v80, s71
    v_perm_b32 v89, v83, v82, s71
    v_perm_b32 v90, v85, v84, s71
    v_perm_b32 v91, v87, v86, s71
    ds_write_b128 v3, v[88:91] offset:20480
    v_perm_b32 v92, v81, v80, s72
    v_perm_b32 v93, v83, v82, s72
    v_perm_b32 v94, v85, v84, s72
    v_perm_b32 v95, v87, v86, s72
    ds_write_b128 v3, v[92:95] offset:22528
    s_mov_b32 s3, 0x340000
    buffer_load_dword v80, v22, s[48:51], s3 offen
    s_mov_b32 s3, 0x342000
    buffer_load_dword v81, v22, s[48:51], s3 offen
    s_mov_b32 s3, 0x350000
    buffer_load_dword v82, v22, s[48:51], s3 offen
    s_mov_b32 s3, 0x352000
    buffer_load_dword v83, v22, s[48:51], s3 offen
    s_mov_b32 s3, 0x344000
    buffer_load_dword v84, v22, s[48:51], s3 offen
    s_mov_b32 s3, 0x346000
    buffer_load_dword v85, v22, s[48:51], s3 offen
    s_mov_b32 s3, 0x354000
    buffer_load_dword v86, v22, s[48:51], s3 offen
    s_mov_b32 s3, 0x356000
    buffer_load_dword v87, v22, s[48:51], s3 offen
    s_waitcnt vmcnt(48)
    v_perm_b32 v88, v33, v32, s71
    v_perm_b32 v89, v35, v34, s71
    v_perm_b32 v90, v37, v36, s71
    v_perm_b32 v91, v39, v38, s71
    ds_write_b128 v3, v[88:91] offset:21504
    v_perm_b32 v92, v33, v32, s72
    v_perm_b32 v93, v35, v34, s72
    v_perm_b32 v94, v37, v36, s72
    v_perm_b32 v95, v39, v38, s72
    ds_write_b128 v3, v[92:95] offset:23552
    s_mov_b32 s3, 0x380000
    buffer_load_dword v32, v22, s[40:43], s3 offen
    s_mov_b32 s3, 0x382000
    buffer_load_dword v33, v22, s[40:43], s3 offen
    s_mov_b32 s3, 0x390000
    buffer_load_dword v34, v22, s[40:43], s3 offen
    s_mov_b32 s3, 0x392000
    buffer_load_dword v35, v22, s[40:43], s3 offen
    s_mov_b32 s3, 0x384000
    buffer_load_dword v36, v22, s[40:43], s3 offen
    s_mov_b32 s3, 0x386000
    buffer_load_dword v37, v22, s[40:43], s3 offen
    s_mov_b32 s3, 0x394000
    buffer_load_dword v38, v22, s[40:43], s3 offen
    s_mov_b32 s3, 0x396000
    buffer_load_dword v39, v22, s[40:43], s3 offen
    s_waitcnt vmcnt(48)
    v_perm_b32 v88, v41, v40, s71
    v_accvgpr_write_b32 a144, v88
    v_perm_b32 v89, v43, v42, s71
    v_accvgpr_write_b32 a145, v89
    v_perm_b32 v90, v45, v44, s71
    v_accvgpr_write_b32 a146, v90
    v_perm_b32 v91, v47, v46, s71
    v_accvgpr_write_b32 a147, v91
    v_perm_b32 v92, v41, v40, s72
    v_accvgpr_write_b32 a152, v92
    v_perm_b32 v93, v43, v42, s72
    v_accvgpr_write_b32 a153, v93
    v_perm_b32 v94, v45, v44, s72
    v_accvgpr_write_b32 a154, v94
    v_perm_b32 v95, v47, v46, s72
    v_accvgpr_write_b32 a155, v95
    s_mov_b32 s3, 0x3c0000
    buffer_load_dword v40, v22, s[40:43], s3 offen
    s_mov_b32 s3, 0x3c2000
    buffer_load_dword v41, v22, s[40:43], s3 offen
    s_mov_b32 s3, 0x3d0000
    buffer_load_dword v42, v22, s[40:43], s3 offen
    s_mov_b32 s3, 0x3d2000
    buffer_load_dword v43, v22, s[40:43], s3 offen
    s_mov_b32 s3, 0x3c4000
    buffer_load_dword v44, v22, s[40:43], s3 offen
    s_mov_b32 s3, 0x3c6000
    buffer_load_dword v45, v22, s[40:43], s3 offen
    s_mov_b32 s3, 0x3d4000
    buffer_load_dword v46, v22, s[40:43], s3 offen
    s_mov_b32 s3, 0x3d6000
    buffer_load_dword v47, v22, s[40:43], s3 offen
    s_waitcnt vmcnt(48)
    v_perm_b32 v88, v49, v48, s71
    v_accvgpr_write_b32 a148, v88
    v_perm_b32 v89, v51, v50, s71
    v_accvgpr_write_b32 a149, v89
    v_perm_b32 v90, v53, v52, s71
    v_accvgpr_write_b32 a150, v90
    v_perm_b32 v91, v55, v54, s71
    v_accvgpr_write_b32 a151, v91
    v_perm_b32 v92, v49, v48, s72
    v_accvgpr_write_b32 a156, v92
    v_perm_b32 v93, v51, v50, s72
    v_accvgpr_write_b32 a157, v93
    v_perm_b32 v94, v53, v52, s72
    v_accvgpr_write_b32 a158, v94
    v_perm_b32 v95, v55, v54, s72
    v_accvgpr_write_b32 a159, v95
    s_mov_b32 s3, 0x380000
    buffer_load_dword v48, v22, s[44:47], s3 offen
    s_mov_b32 s3, 0x382000
    buffer_load_dword v49, v22, s[44:47], s3 offen
    s_mov_b32 s3, 0x390000
    buffer_load_dword v50, v22, s[44:47], s3 offen
    s_mov_b32 s3, 0x392000
    buffer_load_dword v51, v22, s[44:47], s3 offen
    s_mov_b32 s3, 0x384000
    buffer_load_dword v52, v22, s[44:47], s3 offen
    s_mov_b32 s3, 0x386000
    buffer_load_dword v53, v22, s[44:47], s3 offen
    s_mov_b32 s3, 0x394000
    buffer_load_dword v54, v22, s[44:47], s3 offen
    s_mov_b32 s3, 0x396000
    buffer_load_dword v55, v22, s[44:47], s3 offen
    s_waitcnt vmcnt(48)
    v_perm_b32 v88, v57, v56, s71
    v_accvgpr_write_b32 a160, v88
    v_perm_b32 v89, v59, v58, s71
    v_accvgpr_write_b32 a161, v89
    v_perm_b32 v90, v61, v60, s71
    v_accvgpr_write_b32 a162, v90
    v_perm_b32 v91, v63, v62, s71
    v_accvgpr_write_b32 a163, v91
    v_perm_b32 v92, v57, v56, s72
    v_perm_b32 v93, v59, v58, s72
    v_perm_b32 v94, v61, v60, s72
    v_perm_b32 v95, v63, v62, s72
    ds_write_b128 v3, v[92:95] offset:12288
    s_mov_b32 s3, 0x3c0000
    buffer_load_dword v56, v22, s[44:47], s3 offen
    s_mov_b32 s3, 0x3c2000
    buffer_load_dword v57, v22, s[44:47], s3 offen
    s_mov_b32 s3, 0x3d0000
    buffer_load_dword v58, v22, s[44:47], s3 offen
    s_mov_b32 s3, 0x3d2000
    buffer_load_dword v59, v22, s[44:47], s3 offen
    s_mov_b32 s3, 0x3c4000
    buffer_load_dword v60, v22, s[44:47], s3 offen
    s_mov_b32 s3, 0x3c6000
    buffer_load_dword v61, v22, s[44:47], s3 offen
    s_mov_b32 s3, 0x3d4000
    buffer_load_dword v62, v22, s[44:47], s3 offen
    s_mov_b32 s3, 0x3d6000
    buffer_load_dword v63, v22, s[44:47], s3 offen
    s_waitcnt vmcnt(48)
    v_perm_b32 v88, v65, v64, s71
    v_accvgpr_write_b32 a164, v88
    v_perm_b32 v89, v67, v66, s71
    v_accvgpr_write_b32 a165, v89
    v_perm_b32 v90, v69, v68, s71
    v_accvgpr_write_b32 a166, v90
    v_perm_b32 v91, v71, v70, s71
    v_accvgpr_write_b32 a167, v91
    v_perm_b32 v92, v65, v64, s72
    v_perm_b32 v93, v67, v66, s72
    v_perm_b32 v94, v69, v68, s72
    v_perm_b32 v95, v71, v70, s72
    ds_write_b128 v3, v[92:95] offset:13312
    s_mov_b32 s3, 0x380000
    buffer_load_dword v64, v22, s[48:51], s3 offen
    s_mov_b32 s3, 0x382000
    buffer_load_dword v65, v22, s[48:51], s3 offen
    s_mov_b32 s3, 0x390000
    buffer_load_dword v66, v22, s[48:51], s3 offen
    s_mov_b32 s3, 0x392000
    buffer_load_dword v67, v22, s[48:51], s3 offen
    s_mov_b32 s3, 0x384000
    buffer_load_dword v68, v22, s[48:51], s3 offen
    s_mov_b32 s3, 0x386000
    buffer_load_dword v69, v22, s[48:51], s3 offen
    s_mov_b32 s3, 0x394000
    buffer_load_dword v70, v22, s[48:51], s3 offen
    s_mov_b32 s3, 0x396000
    buffer_load_dword v71, v22, s[48:51], s3 offen
    s_waitcnt vmcnt(48)
    v_perm_b32 v88, v73, v72, s71
    v_perm_b32 v89, v75, v74, s71
    v_perm_b32 v90, v77, v76, s71
    v_perm_b32 v91, v79, v78, s71
    ds_write_b128 v3, v[88:91] offset:24576
    v_perm_b32 v92, v73, v72, s72
    v_perm_b32 v93, v75, v74, s72
    v_perm_b32 v94, v77, v76, s72
    v_perm_b32 v95, v79, v78, s72
    ds_write_b128 v3, v[92:95] offset:26624
    s_mov_b32 s3, 0x3c0000
    buffer_load_dword v72, v22, s[48:51], s3 offen
    s_mov_b32 s3, 0x3c2000
    buffer_load_dword v73, v22, s[48:51], s3 offen
    s_mov_b32 s3, 0x3d0000
    buffer_load_dword v74, v22, s[48:51], s3 offen
    s_mov_b32 s3, 0x3d2000
    buffer_load_dword v75, v22, s[48:51], s3 offen
    s_mov_b32 s3, 0x3c4000
    buffer_load_dword v76, v22, s[48:51], s3 offen
    s_mov_b32 s3, 0x3c6000
    buffer_load_dword v77, v22, s[48:51], s3 offen
    s_mov_b32 s3, 0x3d4000
    buffer_load_dword v78, v22, s[48:51], s3 offen
    s_mov_b32 s3, 0x3d6000
    buffer_load_dword v79, v22, s[48:51], s3 offen
    s_waitcnt vmcnt(48)
    v_perm_b32 v88, v81, v80, s71
    v_perm_b32 v89, v83, v82, s71
    v_perm_b32 v90, v85, v84, s71
    v_perm_b32 v91, v87, v86, s71
    ds_write_b128 v3, v[88:91] offset:25600
    v_perm_b32 v92, v81, v80, s72
    v_perm_b32 v93, v83, v82, s72
    v_perm_b32 v94, v85, v84, s72
    v_perm_b32 v95, v87, v86, s72
    ds_write_b128 v3, v[92:95] offset:27648
    s_waitcnt vmcnt(40)
    v_perm_b32 v88, v33, v32, s71
    v_accvgpr_write_b32 a168, v88
    v_perm_b32 v89, v35, v34, s71
    v_accvgpr_write_b32 a169, v89
    v_perm_b32 v90, v37, v36, s71
    v_accvgpr_write_b32 a170, v90
    v_perm_b32 v91, v39, v38, s71
    v_accvgpr_write_b32 a171, v91
    v_perm_b32 v92, v33, v32, s72
    v_accvgpr_write_b32 a176, v92
    v_perm_b32 v93, v35, v34, s72
    v_accvgpr_write_b32 a177, v93
    v_perm_b32 v94, v37, v36, s72
    v_accvgpr_write_b32 a178, v94
    v_perm_b32 v95, v39, v38, s72
    v_accvgpr_write_b32 a179, v95
    s_waitcnt vmcnt(32)
    v_perm_b32 v88, v41, v40, s71
    v_accvgpr_write_b32 a172, v88
    v_perm_b32 v89, v43, v42, s71
    v_accvgpr_write_b32 a173, v89
    v_perm_b32 v90, v45, v44, s71
    v_accvgpr_write_b32 a174, v90
    v_perm_b32 v91, v47, v46, s71
    v_accvgpr_write_b32 a175, v91
    v_perm_b32 v92, v41, v40, s72
    v_accvgpr_write_b32 a180, v92
    v_perm_b32 v93, v43, v42, s72
    v_accvgpr_write_b32 a181, v93
    v_perm_b32 v94, v45, v44, s72
    v_accvgpr_write_b32 a182, v94
    v_perm_b32 v95, v47, v46, s72
    v_accvgpr_write_b32 a183, v95
    s_waitcnt vmcnt(24)
    v_perm_b32 v88, v49, v48, s71
    v_accvgpr_write_b32 a184, v88
    v_perm_b32 v89, v51, v50, s71
    v_accvgpr_write_b32 a185, v89
    v_perm_b32 v90, v53, v52, s71
    v_accvgpr_write_b32 a186, v90
    v_perm_b32 v91, v55, v54, s71
    v_accvgpr_write_b32 a187, v91
    v_perm_b32 v92, v49, v48, s72
    v_perm_b32 v93, v51, v50, s72
    v_perm_b32 v94, v53, v52, s72
    v_perm_b32 v95, v55, v54, s72
    ds_write_b128 v3, v[92:95] offset:14336
    s_waitcnt vmcnt(16)
    v_perm_b32 v88, v57, v56, s71
    v_accvgpr_write_b32 a188, v88
    v_perm_b32 v89, v59, v58, s71
    v_accvgpr_write_b32 a189, v89
    v_perm_b32 v90, v61, v60, s71
    v_accvgpr_write_b32 a190, v90
    v_perm_b32 v91, v63, v62, s71
    v_accvgpr_write_b32 a191, v91
    v_perm_b32 v92, v57, v56, s72
    v_perm_b32 v93, v59, v58, s72
    v_perm_b32 v94, v61, v60, s72
    v_perm_b32 v95, v63, v62, s72
    ds_write_b128 v3, v[92:95] offset:15360
    s_waitcnt vmcnt(8)
    v_perm_b32 v88, v65, v64, s71
    v_perm_b32 v89, v67, v66, s71
    v_perm_b32 v90, v69, v68, s71
    v_perm_b32 v91, v71, v70, s71
    ds_write_b128 v3, v[88:91] offset:28672
    v_perm_b32 v92, v65, v64, s72
    v_perm_b32 v93, v67, v66, s72
    v_perm_b32 v94, v69, v68, s72
    v_perm_b32 v95, v71, v70, s72
    ds_write_b128 v3, v[92:95] offset:30720
    s_waitcnt vmcnt(0)
    v_perm_b32 v88, v73, v72, s71
    v_perm_b32 v89, v75, v74, s71
    v_perm_b32 v90, v77, v76, s71
    v_perm_b32 v91, v79, v78, s71
    ds_write_b128 v3, v[88:91] offset:29696
    v_perm_b32 v92, v73, v72, s72
    v_perm_b32 v93, v75, v74, s72
    v_perm_b32 v94, v77, v76, s72
    v_perm_b32 v95, v79, v78, s72
    ds_write_b128 v3, v[92:95] offset:31744
    s_branch Lcwe_312
Lcwv_309:
    s_mov_b32 s3, 0x0
    buffer_load_dword v32, v22, s[40:43], s3 offen
    s_mov_b32 s3, 0x2000
    buffer_load_dword v33, v22, s[40:43], s3 offen
    s_mov_b32 s3, 0x10000
    buffer_load_dword v34, v22, s[40:43], s3 offen
    s_mov_b32 s3, 0x12000
    buffer_load_dword v35, v22, s[40:43], s3 offen
    s_mov_b32 s3, 0x4000
    buffer_load_dword v36, v22, s[40:43], s3 offen
    s_mov_b32 s3, 0x6000
    buffer_load_dword v37, v22, s[40:43], s3 offen
    s_mov_b32 s3, 0x14000
    buffer_load_dword v38, v22, s[40:43], s3 offen
    s_mov_b32 s3, 0x16000
    buffer_load_dword v39, v22, s[40:43], s3 offen
    s_mov_b32 s3, 0x40000
    buffer_load_dword v40, v22, s[40:43], s3 offen
    s_mov_b32 s3, 0x42000
    buffer_load_dword v41, v22, s[40:43], s3 offen
    s_mov_b32 s3, 0x50000
    buffer_load_dword v42, v22, s[40:43], s3 offen
    s_mov_b32 s3, 0x52000
    buffer_load_dword v43, v22, s[40:43], s3 offen
    s_mov_b32 s3, 0x44000
    buffer_load_dword v44, v22, s[40:43], s3 offen
    s_mov_b32 s3, 0x46000
    buffer_load_dword v45, v22, s[40:43], s3 offen
    s_mov_b32 s3, 0x54000
    buffer_load_dword v46, v22, s[40:43], s3 offen
    s_mov_b32 s3, 0x56000
    buffer_load_dword v47, v22, s[40:43], s3 offen
    s_mov_b32 s3, 0x0
    buffer_load_dword v48, v22, s[44:47], s3 offen
    s_mov_b32 s3, 0x2000
    buffer_load_dword v49, v22, s[44:47], s3 offen
    s_mov_b32 s3, 0x10000
    buffer_load_dword v50, v22, s[44:47], s3 offen
    s_mov_b32 s3, 0x12000
    buffer_load_dword v51, v22, s[44:47], s3 offen
    s_mov_b32 s3, 0x4000
    buffer_load_dword v52, v22, s[44:47], s3 offen
    s_mov_b32 s3, 0x6000
    buffer_load_dword v53, v22, s[44:47], s3 offen
    s_mov_b32 s3, 0x14000
    buffer_load_dword v54, v22, s[44:47], s3 offen
    s_mov_b32 s3, 0x16000
    buffer_load_dword v55, v22, s[44:47], s3 offen
    s_mov_b32 s3, 0x40000
    buffer_load_dword v56, v22, s[44:47], s3 offen
    s_mov_b32 s3, 0x42000
    buffer_load_dword v57, v22, s[44:47], s3 offen
    s_mov_b32 s3, 0x50000
    buffer_load_dword v58, v22, s[44:47], s3 offen
    s_mov_b32 s3, 0x52000
    buffer_load_dword v59, v22, s[44:47], s3 offen
    s_mov_b32 s3, 0x44000
    buffer_load_dword v60, v22, s[44:47], s3 offen
    s_mov_b32 s3, 0x46000
    buffer_load_dword v61, v22, s[44:47], s3 offen
    s_mov_b32 s3, 0x54000
    buffer_load_dword v62, v22, s[44:47], s3 offen
    s_mov_b32 s3, 0x56000
    buffer_load_dword v63, v22, s[44:47], s3 offen
    s_mov_b32 s3, 0x0
    buffer_load_dword v64, v22, s[48:51], s3 offen
    s_mov_b32 s3, 0x2000
    buffer_load_dword v65, v22, s[48:51], s3 offen
    s_mov_b32 s3, 0x10000
    buffer_load_dword v66, v22, s[48:51], s3 offen
    s_mov_b32 s3, 0x12000
    buffer_load_dword v67, v22, s[48:51], s3 offen
    s_mov_b32 s3, 0x4000
    buffer_load_dword v68, v22, s[48:51], s3 offen
    s_mov_b32 s3, 0x6000
    buffer_load_dword v69, v22, s[48:51], s3 offen
    s_mov_b32 s3, 0x14000
    buffer_load_dword v70, v22, s[48:51], s3 offen
    s_mov_b32 s3, 0x16000
    buffer_load_dword v71, v22, s[48:51], s3 offen
    s_mov_b32 s3, 0x40000
    buffer_load_dword v72, v22, s[48:51], s3 offen
    s_mov_b32 s3, 0x42000
    buffer_load_dword v73, v22, s[48:51], s3 offen
    s_mov_b32 s3, 0x50000
    buffer_load_dword v74, v22, s[48:51], s3 offen
    s_mov_b32 s3, 0x52000
    buffer_load_dword v75, v22, s[48:51], s3 offen
    s_mov_b32 s3, 0x44000
    buffer_load_dword v76, v22, s[48:51], s3 offen
    s_mov_b32 s3, 0x46000
    buffer_load_dword v77, v22, s[48:51], s3 offen
    s_mov_b32 s3, 0x54000
    buffer_load_dword v78, v22, s[48:51], s3 offen
    s_mov_b32 s3, 0x56000
    buffer_load_dword v79, v22, s[48:51], s3 offen
    s_mov_b32 s3, 0x80000
    buffer_load_dword v80, v22, s[40:43], s3 offen
    s_mov_b32 s3, 0x82000
    buffer_load_dword v81, v22, s[40:43], s3 offen
    s_mov_b32 s3, 0x90000
    buffer_load_dword v82, v22, s[40:43], s3 offen
    s_mov_b32 s3, 0x92000
    buffer_load_dword v83, v22, s[40:43], s3 offen
    s_mov_b32 s3, 0x84000
    buffer_load_dword v84, v22, s[40:43], s3 offen
    s_mov_b32 s3, 0x86000
    buffer_load_dword v85, v22, s[40:43], s3 offen
    s_mov_b32 s3, 0x94000
    buffer_load_dword v86, v22, s[40:43], s3 offen
    s_mov_b32 s3, 0x96000
    buffer_load_dword v87, v22, s[40:43], s3 offen
    s_waitcnt vmcnt(48)
    v_perm_b32 v88, v33, v32, s71
    v_accvgpr_write_b32 a144, v88
    v_perm_b32 v89, v35, v34, s71
    v_accvgpr_write_b32 a145, v89
    v_perm_b32 v90, v37, v36, s71
    v_accvgpr_write_b32 a146, v90
    v_perm_b32 v91, v39, v38, s71
    v_accvgpr_write_b32 a147, v91
    v_perm_b32 v92, v33, v32, s72
    v_accvgpr_write_b32 a152, v92
    v_perm_b32 v93, v35, v34, s72
    v_accvgpr_write_b32 a153, v93
    v_perm_b32 v94, v37, v36, s72
    v_accvgpr_write_b32 a154, v94
    v_perm_b32 v95, v39, v38, s72
    v_accvgpr_write_b32 a155, v95
    s_mov_b32 s3, 0xc0000
    buffer_load_dword v32, v22, s[40:43], s3 offen
    s_mov_b32 s3, 0xc2000
    buffer_load_dword v33, v22, s[40:43], s3 offen
    s_mov_b32 s3, 0xd0000
    buffer_load_dword v34, v22, s[40:43], s3 offen
    s_mov_b32 s3, 0xd2000
    buffer_load_dword v35, v22, s[40:43], s3 offen
    s_mov_b32 s3, 0xc4000
    buffer_load_dword v36, v22, s[40:43], s3 offen
    s_mov_b32 s3, 0xc6000
    buffer_load_dword v37, v22, s[40:43], s3 offen
    s_mov_b32 s3, 0xd4000
    buffer_load_dword v38, v22, s[40:43], s3 offen
    s_mov_b32 s3, 0xd6000
    buffer_load_dword v39, v22, s[40:43], s3 offen
    s_waitcnt vmcnt(48)
    v_perm_b32 v88, v41, v40, s71
    v_accvgpr_write_b32 a148, v88
    v_perm_b32 v89, v43, v42, s71
    v_accvgpr_write_b32 a149, v89
    v_perm_b32 v90, v45, v44, s71
    v_accvgpr_write_b32 a150, v90
    v_perm_b32 v91, v47, v46, s71
    v_accvgpr_write_b32 a151, v91
    v_perm_b32 v92, v41, v40, s72
    v_accvgpr_write_b32 a156, v92
    v_perm_b32 v93, v43, v42, s72
    v_accvgpr_write_b32 a157, v93
    v_perm_b32 v94, v45, v44, s72
    v_accvgpr_write_b32 a158, v94
    v_perm_b32 v95, v47, v46, s72
    v_accvgpr_write_b32 a159, v95
    s_mov_b32 s3, 0x80000
    buffer_load_dword v40, v22, s[44:47], s3 offen
    s_mov_b32 s3, 0x82000
    buffer_load_dword v41, v22, s[44:47], s3 offen
    s_mov_b32 s3, 0x90000
    buffer_load_dword v42, v22, s[44:47], s3 offen
    s_mov_b32 s3, 0x92000
    buffer_load_dword v43, v22, s[44:47], s3 offen
    s_mov_b32 s3, 0x84000
    buffer_load_dword v44, v22, s[44:47], s3 offen
    s_mov_b32 s3, 0x86000
    buffer_load_dword v45, v22, s[44:47], s3 offen
    s_mov_b32 s3, 0x94000
    buffer_load_dword v46, v22, s[44:47], s3 offen
    s_mov_b32 s3, 0x96000
    buffer_load_dword v47, v22, s[44:47], s3 offen
    s_waitcnt vmcnt(48)
    v_perm_b32 v88, v49, v48, s71
    v_accvgpr_write_b32 a160, v88
    v_perm_b32 v89, v51, v50, s71
    v_accvgpr_write_b32 a161, v89
    v_perm_b32 v90, v53, v52, s71
    v_accvgpr_write_b32 a162, v90
    v_perm_b32 v91, v55, v54, s71
    v_accvgpr_write_b32 a163, v91
    v_perm_b32 v92, v49, v48, s72
    v_perm_b32 v93, v51, v50, s72
    v_perm_b32 v94, v53, v52, s72
    v_perm_b32 v95, v55, v54, s72
    ds_write_b128 v3, v[92:95] offset:12288
    s_mov_b32 s3, 0xc0000
    buffer_load_dword v48, v22, s[44:47], s3 offen
    s_mov_b32 s3, 0xc2000
    buffer_load_dword v49, v22, s[44:47], s3 offen
    s_mov_b32 s3, 0xd0000
    buffer_load_dword v50, v22, s[44:47], s3 offen
    s_mov_b32 s3, 0xd2000
    buffer_load_dword v51, v22, s[44:47], s3 offen
    s_mov_b32 s3, 0xc4000
    buffer_load_dword v52, v22, s[44:47], s3 offen
    s_mov_b32 s3, 0xc6000
    buffer_load_dword v53, v22, s[44:47], s3 offen
    s_mov_b32 s3, 0xd4000
    buffer_load_dword v54, v22, s[44:47], s3 offen
    s_mov_b32 s3, 0xd6000
    buffer_load_dword v55, v22, s[44:47], s3 offen
    s_waitcnt vmcnt(48)
    v_perm_b32 v88, v57, v56, s71
    v_accvgpr_write_b32 a164, v88
    v_perm_b32 v89, v59, v58, s71
    v_accvgpr_write_b32 a165, v89
    v_perm_b32 v90, v61, v60, s71
    v_accvgpr_write_b32 a166, v90
    v_perm_b32 v91, v63, v62, s71
    v_accvgpr_write_b32 a167, v91
    v_perm_b32 v92, v57, v56, s72
    v_perm_b32 v93, v59, v58, s72
    v_perm_b32 v94, v61, v60, s72
    v_perm_b32 v95, v63, v62, s72
    ds_write_b128 v3, v[92:95] offset:13312
    s_mov_b32 s3, 0x80000
    buffer_load_dword v56, v22, s[48:51], s3 offen
    s_mov_b32 s3, 0x82000
    buffer_load_dword v57, v22, s[48:51], s3 offen
    s_mov_b32 s3, 0x90000
    buffer_load_dword v58, v22, s[48:51], s3 offen
    s_mov_b32 s3, 0x92000
    buffer_load_dword v59, v22, s[48:51], s3 offen
    s_mov_b32 s3, 0x84000
    buffer_load_dword v60, v22, s[48:51], s3 offen
    s_mov_b32 s3, 0x86000
    buffer_load_dword v61, v22, s[48:51], s3 offen
    s_mov_b32 s3, 0x94000
    buffer_load_dword v62, v22, s[48:51], s3 offen
    s_mov_b32 s3, 0x96000
    buffer_load_dword v63, v22, s[48:51], s3 offen
    s_waitcnt vmcnt(48)
    v_perm_b32 v88, v65, v64, s71
    v_perm_b32 v89, v67, v66, s71
    v_perm_b32 v90, v69, v68, s71
    v_perm_b32 v91, v71, v70, s71
    ds_write_b128 v3, v[88:91] offset:24576
    v_perm_b32 v92, v65, v64, s72
    v_perm_b32 v93, v67, v66, s72
    v_perm_b32 v94, v69, v68, s72
    v_perm_b32 v95, v71, v70, s72
    ds_write_b128 v3, v[92:95] offset:26624
    s_mov_b32 s3, 0xc0000
    buffer_load_dword v64, v22, s[48:51], s3 offen
    s_mov_b32 s3, 0xc2000
    buffer_load_dword v65, v22, s[48:51], s3 offen
    s_mov_b32 s3, 0xd0000
    buffer_load_dword v66, v22, s[48:51], s3 offen
    s_mov_b32 s3, 0xd2000
    buffer_load_dword v67, v22, s[48:51], s3 offen
    s_mov_b32 s3, 0xc4000
    buffer_load_dword v68, v22, s[48:51], s3 offen
    s_mov_b32 s3, 0xc6000
    buffer_load_dword v69, v22, s[48:51], s3 offen
    s_mov_b32 s3, 0xd4000
    buffer_load_dword v70, v22, s[48:51], s3 offen
    s_mov_b32 s3, 0xd6000
    buffer_load_dword v71, v22, s[48:51], s3 offen
    s_waitcnt vmcnt(48)
    v_perm_b32 v88, v73, v72, s71
    v_perm_b32 v89, v75, v74, s71
    v_perm_b32 v90, v77, v76, s71
    v_perm_b32 v91, v79, v78, s71
    ds_write_b128 v3, v[88:91] offset:25600
    v_perm_b32 v92, v73, v72, s72
    v_perm_b32 v93, v75, v74, s72
    v_perm_b32 v94, v77, v76, s72
    v_perm_b32 v95, v79, v78, s72
    ds_write_b128 v3, v[92:95] offset:27648
    s_mov_b32 s3, 0x100000
    buffer_load_dword v72, v22, s[40:43], s3 offen
    s_mov_b32 s3, 0x102000
    buffer_load_dword v73, v22, s[40:43], s3 offen
    s_mov_b32 s3, 0x110000
    buffer_load_dword v74, v22, s[40:43], s3 offen
    s_mov_b32 s3, 0x112000
    buffer_load_dword v75, v22, s[40:43], s3 offen
    s_mov_b32 s3, 0x104000
    buffer_load_dword v76, v22, s[40:43], s3 offen
    s_mov_b32 s3, 0x106000
    buffer_load_dword v77, v22, s[40:43], s3 offen
    s_mov_b32 s3, 0x114000
    buffer_load_dword v78, v22, s[40:43], s3 offen
    s_mov_b32 s3, 0x116000
    buffer_load_dword v79, v22, s[40:43], s3 offen
    s_waitcnt vmcnt(48)
    v_perm_b32 v88, v81, v80, s71
    v_accvgpr_write_b32 a168, v88
    v_perm_b32 v89, v83, v82, s71
    v_accvgpr_write_b32 a169, v89
    v_perm_b32 v90, v85, v84, s71
    v_accvgpr_write_b32 a170, v90
    v_perm_b32 v91, v87, v86, s71
    v_accvgpr_write_b32 a171, v91
    v_perm_b32 v92, v81, v80, s72
    v_accvgpr_write_b32 a176, v92
    v_perm_b32 v93, v83, v82, s72
    v_accvgpr_write_b32 a177, v93
    v_perm_b32 v94, v85, v84, s72
    v_accvgpr_write_b32 a178, v94
    v_perm_b32 v95, v87, v86, s72
    v_accvgpr_write_b32 a179, v95
    s_mov_b32 s3, 0x140000
    buffer_load_dword v80, v22, s[40:43], s3 offen
    s_mov_b32 s3, 0x142000
    buffer_load_dword v81, v22, s[40:43], s3 offen
    s_mov_b32 s3, 0x150000
    buffer_load_dword v82, v22, s[40:43], s3 offen
    s_mov_b32 s3, 0x152000
    buffer_load_dword v83, v22, s[40:43], s3 offen
    s_mov_b32 s3, 0x144000
    buffer_load_dword v84, v22, s[40:43], s3 offen
    s_mov_b32 s3, 0x146000
    buffer_load_dword v85, v22, s[40:43], s3 offen
    s_mov_b32 s3, 0x154000
    buffer_load_dword v86, v22, s[40:43], s3 offen
    s_mov_b32 s3, 0x156000
    buffer_load_dword v87, v22, s[40:43], s3 offen
    s_waitcnt vmcnt(48)
    v_perm_b32 v88, v33, v32, s71
    v_accvgpr_write_b32 a172, v88
    v_perm_b32 v89, v35, v34, s71
    v_accvgpr_write_b32 a173, v89
    v_perm_b32 v90, v37, v36, s71
    v_accvgpr_write_b32 a174, v90
    v_perm_b32 v91, v39, v38, s71
    v_accvgpr_write_b32 a175, v91
    v_perm_b32 v92, v33, v32, s72
    v_accvgpr_write_b32 a180, v92
    v_perm_b32 v93, v35, v34, s72
    v_accvgpr_write_b32 a181, v93
    v_perm_b32 v94, v37, v36, s72
    v_accvgpr_write_b32 a182, v94
    v_perm_b32 v95, v39, v38, s72
    v_accvgpr_write_b32 a183, v95
    s_mov_b32 s3, 0x100000
    buffer_load_dword v32, v22, s[44:47], s3 offen
    s_mov_b32 s3, 0x102000
    buffer_load_dword v33, v22, s[44:47], s3 offen
    s_mov_b32 s3, 0x110000
    buffer_load_dword v34, v22, s[44:47], s3 offen
    s_mov_b32 s3, 0x112000
    buffer_load_dword v35, v22, s[44:47], s3 offen
    s_mov_b32 s3, 0x104000
    buffer_load_dword v36, v22, s[44:47], s3 offen
    s_mov_b32 s3, 0x106000
    buffer_load_dword v37, v22, s[44:47], s3 offen
    s_mov_b32 s3, 0x114000
    buffer_load_dword v38, v22, s[44:47], s3 offen
    s_mov_b32 s3, 0x116000
    buffer_load_dword v39, v22, s[44:47], s3 offen
    s_waitcnt vmcnt(48)
    v_perm_b32 v88, v41, v40, s71
    v_accvgpr_write_b32 a184, v88
    v_perm_b32 v89, v43, v42, s71
    v_accvgpr_write_b32 a185, v89
    v_perm_b32 v90, v45, v44, s71
    v_accvgpr_write_b32 a186, v90
    v_perm_b32 v91, v47, v46, s71
    v_accvgpr_write_b32 a187, v91
    v_perm_b32 v92, v41, v40, s72
    v_perm_b32 v93, v43, v42, s72
    v_perm_b32 v94, v45, v44, s72
    v_perm_b32 v95, v47, v46, s72
    ds_write_b128 v3, v[92:95] offset:14336
    s_mov_b32 s3, 0x140000
    buffer_load_dword v40, v22, s[44:47], s3 offen
    s_mov_b32 s3, 0x142000
    buffer_load_dword v41, v22, s[44:47], s3 offen
    s_mov_b32 s3, 0x150000
    buffer_load_dword v42, v22, s[44:47], s3 offen
    s_mov_b32 s3, 0x152000
    buffer_load_dword v43, v22, s[44:47], s3 offen
    s_mov_b32 s3, 0x144000
    buffer_load_dword v44, v22, s[44:47], s3 offen
    s_mov_b32 s3, 0x146000
    buffer_load_dword v45, v22, s[44:47], s3 offen
    s_mov_b32 s3, 0x154000
    buffer_load_dword v46, v22, s[44:47], s3 offen
    s_mov_b32 s3, 0x156000
    buffer_load_dword v47, v22, s[44:47], s3 offen
    s_waitcnt vmcnt(48)
    v_perm_b32 v88, v49, v48, s71
    v_accvgpr_write_b32 a188, v88
    v_perm_b32 v89, v51, v50, s71
    v_accvgpr_write_b32 a189, v89
    v_perm_b32 v90, v53, v52, s71
    v_accvgpr_write_b32 a190, v90
    v_perm_b32 v91, v55, v54, s71
    v_accvgpr_write_b32 a191, v91
    v_perm_b32 v92, v49, v48, s72
    v_perm_b32 v93, v51, v50, s72
    v_perm_b32 v94, v53, v52, s72
    v_perm_b32 v95, v55, v54, s72
    ds_write_b128 v3, v[92:95] offset:15360
    s_mov_b32 s3, 0x100000
    buffer_load_dword v48, v22, s[48:51], s3 offen
    s_mov_b32 s3, 0x102000
    buffer_load_dword v49, v22, s[48:51], s3 offen
    s_mov_b32 s3, 0x110000
    buffer_load_dword v50, v22, s[48:51], s3 offen
    s_mov_b32 s3, 0x112000
    buffer_load_dword v51, v22, s[48:51], s3 offen
    s_mov_b32 s3, 0x104000
    buffer_load_dword v52, v22, s[48:51], s3 offen
    s_mov_b32 s3, 0x106000
    buffer_load_dword v53, v22, s[48:51], s3 offen
    s_mov_b32 s3, 0x114000
    buffer_load_dword v54, v22, s[48:51], s3 offen
    s_mov_b32 s3, 0x116000
    buffer_load_dword v55, v22, s[48:51], s3 offen
    s_waitcnt vmcnt(48)
    v_perm_b32 v88, v57, v56, s71
    v_perm_b32 v89, v59, v58, s71
    v_perm_b32 v90, v61, v60, s71
    v_perm_b32 v91, v63, v62, s71
    ds_write_b128 v3, v[88:91] offset:28672
    v_perm_b32 v92, v57, v56, s72
    v_perm_b32 v93, v59, v58, s72
    v_perm_b32 v94, v61, v60, s72
    v_perm_b32 v95, v63, v62, s72
    ds_write_b128 v3, v[92:95] offset:30720
    s_mov_b32 s3, 0x140000
    buffer_load_dword v56, v22, s[48:51], s3 offen
    s_mov_b32 s3, 0x142000
    buffer_load_dword v57, v22, s[48:51], s3 offen
    s_mov_b32 s3, 0x150000
    buffer_load_dword v58, v22, s[48:51], s3 offen
    s_mov_b32 s3, 0x152000
    buffer_load_dword v59, v22, s[48:51], s3 offen
    s_mov_b32 s3, 0x144000
    buffer_load_dword v60, v22, s[48:51], s3 offen
    s_mov_b32 s3, 0x146000
    buffer_load_dword v61, v22, s[48:51], s3 offen
    s_mov_b32 s3, 0x154000
    buffer_load_dword v62, v22, s[48:51], s3 offen
    s_mov_b32 s3, 0x156000
    buffer_load_dword v63, v22, s[48:51], s3 offen
    s_waitcnt vmcnt(48)
    v_perm_b32 v88, v65, v64, s71
    v_perm_b32 v89, v67, v66, s71
    v_perm_b32 v90, v69, v68, s71
    v_perm_b32 v91, v71, v70, s71
    ds_write_b128 v3, v[88:91] offset:29696
    v_perm_b32 v92, v65, v64, s72
    v_perm_b32 v93, v67, v66, s72
    v_perm_b32 v94, v69, v68, s72
    v_perm_b32 v95, v71, v70, s72
    ds_write_b128 v3, v[92:95] offset:31744
    s_mov_b32 s3, 0x180000
    buffer_load_dword v64, v22, s[40:43], s3 offen
    s_mov_b32 s3, 0x182000
    buffer_load_dword v65, v22, s[40:43], s3 offen
    s_mov_b32 s3, 0x190000
    buffer_load_dword v66, v22, s[40:43], s3 offen
    s_mov_b32 s3, 0x192000
    buffer_load_dword v67, v22, s[40:43], s3 offen
    s_mov_b32 s3, 0x184000
    buffer_load_dword v68, v22, s[40:43], s3 offen
    s_mov_b32 s3, 0x186000
    buffer_load_dword v69, v22, s[40:43], s3 offen
    s_mov_b32 s3, 0x194000
    buffer_load_dword v70, v22, s[40:43], s3 offen
    s_mov_b32 s3, 0x196000
    buffer_load_dword v71, v22, s[40:43], s3 offen
    s_waitcnt vmcnt(48)
    v_perm_b32 v88, v73, v72, s71
    v_accvgpr_write_b32 a0, v88
    v_perm_b32 v89, v75, v74, s71
    v_accvgpr_write_b32 a1, v89
    v_perm_b32 v90, v77, v76, s71
    v_accvgpr_write_b32 a2, v90
    v_perm_b32 v91, v79, v78, s71
    v_accvgpr_write_b32 a3, v91
    v_perm_b32 v92, v73, v72, s72
    v_accvgpr_write_b32 a8, v92
    v_perm_b32 v93, v75, v74, s72
    v_accvgpr_write_b32 a9, v93
    v_perm_b32 v94, v77, v76, s72
    v_accvgpr_write_b32 a10, v94
    v_perm_b32 v95, v79, v78, s72
    v_accvgpr_write_b32 a11, v95
    s_mov_b32 s3, 0x1c0000
    buffer_load_dword v72, v22, s[40:43], s3 offen
    s_mov_b32 s3, 0x1c2000
    buffer_load_dword v73, v22, s[40:43], s3 offen
    s_mov_b32 s3, 0x1d0000
    buffer_load_dword v74, v22, s[40:43], s3 offen
    s_mov_b32 s3, 0x1d2000
    buffer_load_dword v75, v22, s[40:43], s3 offen
    s_mov_b32 s3, 0x1c4000
    buffer_load_dword v76, v22, s[40:43], s3 offen
    s_mov_b32 s3, 0x1c6000
    buffer_load_dword v77, v22, s[40:43], s3 offen
    s_mov_b32 s3, 0x1d4000
    buffer_load_dword v78, v22, s[40:43], s3 offen
    s_mov_b32 s3, 0x1d6000
    buffer_load_dword v79, v22, s[40:43], s3 offen
    s_waitcnt vmcnt(48)
    v_perm_b32 v88, v81, v80, s71
    v_accvgpr_write_b32 a4, v88
    v_perm_b32 v89, v83, v82, s71
    v_accvgpr_write_b32 a5, v89
    v_perm_b32 v90, v85, v84, s71
    v_accvgpr_write_b32 a6, v90
    v_perm_b32 v91, v87, v86, s71
    v_accvgpr_write_b32 a7, v91
    v_perm_b32 v92, v81, v80, s72
    v_accvgpr_write_b32 a12, v92
    v_perm_b32 v93, v83, v82, s72
    v_accvgpr_write_b32 a13, v93
    v_perm_b32 v94, v85, v84, s72
    v_accvgpr_write_b32 a14, v94
    v_perm_b32 v95, v87, v86, s72
    v_accvgpr_write_b32 a15, v95
    s_mov_b32 s3, 0x180000
    buffer_load_dword v80, v22, s[44:47], s3 offen
    s_mov_b32 s3, 0x182000
    buffer_load_dword v81, v22, s[44:47], s3 offen
    s_mov_b32 s3, 0x190000
    buffer_load_dword v82, v22, s[44:47], s3 offen
    s_mov_b32 s3, 0x192000
    buffer_load_dword v83, v22, s[44:47], s3 offen
    s_mov_b32 s3, 0x184000
    buffer_load_dword v84, v22, s[44:47], s3 offen
    s_mov_b32 s3, 0x186000
    buffer_load_dword v85, v22, s[44:47], s3 offen
    s_mov_b32 s3, 0x194000
    buffer_load_dword v86, v22, s[44:47], s3 offen
    s_mov_b32 s3, 0x196000
    buffer_load_dword v87, v22, s[44:47], s3 offen
    s_waitcnt vmcnt(48)
    v_perm_b32 v88, v33, v32, s71
    v_accvgpr_write_b32 a16, v88
    v_perm_b32 v89, v35, v34, s71
    v_accvgpr_write_b32 a17, v89
    v_perm_b32 v90, v37, v36, s71
    v_accvgpr_write_b32 a18, v90
    v_perm_b32 v91, v39, v38, s71
    v_accvgpr_write_b32 a19, v91
    v_perm_b32 v92, v33, v32, s72
    v_perm_b32 v93, v35, v34, s72
    v_perm_b32 v94, v37, v36, s72
    v_perm_b32 v95, v39, v38, s72
    ds_write_b128 v3, v[92:95] offset:0
    s_mov_b32 s3, 0x1c0000
    buffer_load_dword v32, v22, s[44:47], s3 offen
    s_mov_b32 s3, 0x1c2000
    buffer_load_dword v33, v22, s[44:47], s3 offen
    s_mov_b32 s3, 0x1d0000
    buffer_load_dword v34, v22, s[44:47], s3 offen
    s_mov_b32 s3, 0x1d2000
    buffer_load_dword v35, v22, s[44:47], s3 offen
    s_mov_b32 s3, 0x1c4000
    buffer_load_dword v36, v22, s[44:47], s3 offen
    s_mov_b32 s3, 0x1c6000
    buffer_load_dword v37, v22, s[44:47], s3 offen
    s_mov_b32 s3, 0x1d4000
    buffer_load_dword v38, v22, s[44:47], s3 offen
    s_mov_b32 s3, 0x1d6000
    buffer_load_dword v39, v22, s[44:47], s3 offen
    s_waitcnt vmcnt(48)
    v_perm_b32 v88, v41, v40, s71
    v_accvgpr_write_b32 a20, v88
    v_perm_b32 v89, v43, v42, s71
    v_accvgpr_write_b32 a21, v89
    v_perm_b32 v90, v45, v44, s71
    v_accvgpr_write_b32 a22, v90
    v_perm_b32 v91, v47, v46, s71
    v_accvgpr_write_b32 a23, v91
    v_perm_b32 v92, v41, v40, s72
    v_perm_b32 v93, v43, v42, s72
    v_perm_b32 v94, v45, v44, s72
    v_perm_b32 v95, v47, v46, s72
    ds_write_b128 v3, v[92:95] offset:1024
    s_mov_b32 s3, 0x180000
    buffer_load_dword v40, v22, s[48:51], s3 offen
    s_mov_b32 s3, 0x182000
    buffer_load_dword v41, v22, s[48:51], s3 offen
    s_mov_b32 s3, 0x190000
    buffer_load_dword v42, v22, s[48:51], s3 offen
    s_mov_b32 s3, 0x192000
    buffer_load_dword v43, v22, s[48:51], s3 offen
    s_mov_b32 s3, 0x184000
    buffer_load_dword v44, v22, s[48:51], s3 offen
    s_mov_b32 s3, 0x186000
    buffer_load_dword v45, v22, s[48:51], s3 offen
    s_mov_b32 s3, 0x194000
    buffer_load_dword v46, v22, s[48:51], s3 offen
    s_mov_b32 s3, 0x196000
    buffer_load_dword v47, v22, s[48:51], s3 offen
    s_waitcnt vmcnt(48)
    v_perm_b32 v88, v49, v48, s71
    v_accvgpr_write_b32 a192, v88
    v_perm_b32 v89, v51, v50, s71
    v_accvgpr_write_b32 a193, v89
    v_perm_b32 v90, v53, v52, s71
    v_accvgpr_write_b32 a194, v90
    v_perm_b32 v91, v55, v54, s71
    v_accvgpr_write_b32 a195, v91
    v_perm_b32 v92, v49, v48, s72
    v_accvgpr_write_b32 a200, v92
    v_perm_b32 v93, v51, v50, s72
    v_accvgpr_write_b32 a201, v93
    v_perm_b32 v94, v53, v52, s72
    v_accvgpr_write_b32 a202, v94
    v_perm_b32 v95, v55, v54, s72
    v_accvgpr_write_b32 a203, v95
    s_mov_b32 s3, 0x1c0000
    buffer_load_dword v48, v22, s[48:51], s3 offen
    s_mov_b32 s3, 0x1c2000
    buffer_load_dword v49, v22, s[48:51], s3 offen
    s_mov_b32 s3, 0x1d0000
    buffer_load_dword v50, v22, s[48:51], s3 offen
    s_mov_b32 s3, 0x1d2000
    buffer_load_dword v51, v22, s[48:51], s3 offen
    s_mov_b32 s3, 0x1c4000
    buffer_load_dword v52, v22, s[48:51], s3 offen
    s_mov_b32 s3, 0x1c6000
    buffer_load_dword v53, v22, s[48:51], s3 offen
    s_mov_b32 s3, 0x1d4000
    buffer_load_dword v54, v22, s[48:51], s3 offen
    s_mov_b32 s3, 0x1d6000
    buffer_load_dword v55, v22, s[48:51], s3 offen
    s_waitcnt vmcnt(48)
    v_perm_b32 v88, v57, v56, s71
    v_accvgpr_write_b32 a196, v88
    v_perm_b32 v89, v59, v58, s71
    v_accvgpr_write_b32 a197, v89
    v_perm_b32 v90, v61, v60, s71
    v_accvgpr_write_b32 a198, v90
    v_perm_b32 v91, v63, v62, s71
    v_accvgpr_write_b32 a199, v91
    v_perm_b32 v92, v57, v56, s72
    v_accvgpr_write_b32 a204, v92
    v_perm_b32 v93, v59, v58, s72
    v_accvgpr_write_b32 a205, v93
    v_perm_b32 v94, v61, v60, s72
    v_accvgpr_write_b32 a206, v94
    v_perm_b32 v95, v63, v62, s72
    v_accvgpr_write_b32 a207, v95
    s_mov_b32 s3, 0x200000
    buffer_load_dword v56, v22, s[40:43], s3 offen
    s_mov_b32 s3, 0x202000
    buffer_load_dword v57, v22, s[40:43], s3 offen
    s_mov_b32 s3, 0x210000
    buffer_load_dword v58, v22, s[40:43], s3 offen
    s_mov_b32 s3, 0x212000
    buffer_load_dword v59, v22, s[40:43], s3 offen
    s_mov_b32 s3, 0x204000
    buffer_load_dword v60, v22, s[40:43], s3 offen
    s_mov_b32 s3, 0x206000
    buffer_load_dword v61, v22, s[40:43], s3 offen
    s_mov_b32 s3, 0x214000
    buffer_load_dword v62, v22, s[40:43], s3 offen
    s_mov_b32 s3, 0x216000
    buffer_load_dword v63, v22, s[40:43], s3 offen
    s_waitcnt vmcnt(48)
    v_perm_b32 v88, v65, v64, s71
    v_accvgpr_write_b32 a24, v88
    v_perm_b32 v89, v67, v66, s71
    v_accvgpr_write_b32 a25, v89
    v_perm_b32 v90, v69, v68, s71
    v_accvgpr_write_b32 a26, v90
    v_perm_b32 v91, v71, v70, s71
    v_accvgpr_write_b32 a27, v91
    v_perm_b32 v92, v65, v64, s72
    v_accvgpr_write_b32 a32, v92
    v_perm_b32 v93, v67, v66, s72
    v_accvgpr_write_b32 a33, v93
    v_perm_b32 v94, v69, v68, s72
    v_accvgpr_write_b32 a34, v94
    v_perm_b32 v95, v71, v70, s72
    v_accvgpr_write_b32 a35, v95
    s_mov_b32 s3, 0x240000
    buffer_load_dword v64, v22, s[40:43], s3 offen
    s_mov_b32 s3, 0x242000
    buffer_load_dword v65, v22, s[40:43], s3 offen
    s_mov_b32 s3, 0x250000
    buffer_load_dword v66, v22, s[40:43], s3 offen
    s_mov_b32 s3, 0x252000
    buffer_load_dword v67, v22, s[40:43], s3 offen
    s_mov_b32 s3, 0x244000
    buffer_load_dword v68, v22, s[40:43], s3 offen
    s_mov_b32 s3, 0x246000
    buffer_load_dword v69, v22, s[40:43], s3 offen
    s_mov_b32 s3, 0x254000
    buffer_load_dword v70, v22, s[40:43], s3 offen
    s_mov_b32 s3, 0x256000
    buffer_load_dword v71, v22, s[40:43], s3 offen
    s_waitcnt vmcnt(48)
    v_perm_b32 v88, v73, v72, s71
    v_accvgpr_write_b32 a28, v88
    v_perm_b32 v89, v75, v74, s71
    v_accvgpr_write_b32 a29, v89
    v_perm_b32 v90, v77, v76, s71
    v_accvgpr_write_b32 a30, v90
    v_perm_b32 v91, v79, v78, s71
    v_accvgpr_write_b32 a31, v91
    v_perm_b32 v92, v73, v72, s72
    v_accvgpr_write_b32 a36, v92
    v_perm_b32 v93, v75, v74, s72
    v_accvgpr_write_b32 a37, v93
    v_perm_b32 v94, v77, v76, s72
    v_accvgpr_write_b32 a38, v94
    v_perm_b32 v95, v79, v78, s72
    v_accvgpr_write_b32 a39, v95
    s_mov_b32 s3, 0x200000
    buffer_load_dword v72, v22, s[44:47], s3 offen
    s_mov_b32 s3, 0x202000
    buffer_load_dword v73, v22, s[44:47], s3 offen
    s_mov_b32 s3, 0x210000
    buffer_load_dword v74, v22, s[44:47], s3 offen
    s_mov_b32 s3, 0x212000
    buffer_load_dword v75, v22, s[44:47], s3 offen
    s_mov_b32 s3, 0x204000
    buffer_load_dword v76, v22, s[44:47], s3 offen
    s_mov_b32 s3, 0x206000
    buffer_load_dword v77, v22, s[44:47], s3 offen
    s_mov_b32 s3, 0x214000
    buffer_load_dword v78, v22, s[44:47], s3 offen
    s_mov_b32 s3, 0x216000
    buffer_load_dword v79, v22, s[44:47], s3 offen
    s_waitcnt vmcnt(48)
    v_perm_b32 v88, v81, v80, s71
    v_accvgpr_write_b32 a40, v88
    v_perm_b32 v89, v83, v82, s71
    v_accvgpr_write_b32 a41, v89
    v_perm_b32 v90, v85, v84, s71
    v_accvgpr_write_b32 a42, v90
    v_perm_b32 v91, v87, v86, s71
    v_accvgpr_write_b32 a43, v91
    v_perm_b32 v92, v81, v80, s72
    v_perm_b32 v93, v83, v82, s72
    v_perm_b32 v94, v85, v84, s72
    v_perm_b32 v95, v87, v86, s72
    ds_write_b128 v3, v[92:95] offset:2048
    s_mov_b32 s3, 0x240000
    buffer_load_dword v80, v22, s[44:47], s3 offen
    s_mov_b32 s3, 0x242000
    buffer_load_dword v81, v22, s[44:47], s3 offen
    s_mov_b32 s3, 0x250000
    buffer_load_dword v82, v22, s[44:47], s3 offen
    s_mov_b32 s3, 0x252000
    buffer_load_dword v83, v22, s[44:47], s3 offen
    s_mov_b32 s3, 0x244000
    buffer_load_dword v84, v22, s[44:47], s3 offen
    s_mov_b32 s3, 0x246000
    buffer_load_dword v85, v22, s[44:47], s3 offen
    s_mov_b32 s3, 0x254000
    buffer_load_dword v86, v22, s[44:47], s3 offen
    s_mov_b32 s3, 0x256000
    buffer_load_dword v87, v22, s[44:47], s3 offen
    s_waitcnt vmcnt(48)
    v_perm_b32 v88, v33, v32, s71
    v_accvgpr_write_b32 a44, v88
    v_perm_b32 v89, v35, v34, s71
    v_accvgpr_write_b32 a45, v89
    v_perm_b32 v90, v37, v36, s71
    v_accvgpr_write_b32 a46, v90
    v_perm_b32 v91, v39, v38, s71
    v_accvgpr_write_b32 a47, v91
    v_perm_b32 v92, v33, v32, s72
    v_perm_b32 v93, v35, v34, s72
    v_perm_b32 v94, v37, v36, s72
    v_perm_b32 v95, v39, v38, s72
    ds_write_b128 v3, v[92:95] offset:3072
    s_mov_b32 s3, 0x200000
    buffer_load_dword v32, v22, s[48:51], s3 offen
    s_mov_b32 s3, 0x202000
    buffer_load_dword v33, v22, s[48:51], s3 offen
    s_mov_b32 s3, 0x210000
    buffer_load_dword v34, v22, s[48:51], s3 offen
    s_mov_b32 s3, 0x212000
    buffer_load_dword v35, v22, s[48:51], s3 offen
    s_mov_b32 s3, 0x204000
    buffer_load_dword v36, v22, s[48:51], s3 offen
    s_mov_b32 s3, 0x206000
    buffer_load_dword v37, v22, s[48:51], s3 offen
    s_mov_b32 s3, 0x214000
    buffer_load_dword v38, v22, s[48:51], s3 offen
    s_mov_b32 s3, 0x216000
    buffer_load_dword v39, v22, s[48:51], s3 offen
    s_waitcnt vmcnt(48)
    v_perm_b32 v88, v41, v40, s71
    v_accvgpr_write_b32 a208, v88
    v_perm_b32 v89, v43, v42, s71
    v_accvgpr_write_b32 a209, v89
    v_perm_b32 v90, v45, v44, s71
    v_accvgpr_write_b32 a210, v90
    v_perm_b32 v91, v47, v46, s71
    v_accvgpr_write_b32 a211, v91
    v_perm_b32 v92, v41, v40, s72
    v_accvgpr_write_b32 a216, v92
    v_perm_b32 v93, v43, v42, s72
    v_accvgpr_write_b32 a217, v93
    v_perm_b32 v94, v45, v44, s72
    v_accvgpr_write_b32 a218, v94
    v_perm_b32 v95, v47, v46, s72
    v_accvgpr_write_b32 a219, v95
    s_mov_b32 s3, 0x240000
    buffer_load_dword v40, v22, s[48:51], s3 offen
    s_mov_b32 s3, 0x242000
    buffer_load_dword v41, v22, s[48:51], s3 offen
    s_mov_b32 s3, 0x250000
    buffer_load_dword v42, v22, s[48:51], s3 offen
    s_mov_b32 s3, 0x252000
    buffer_load_dword v43, v22, s[48:51], s3 offen
    s_mov_b32 s3, 0x244000
    buffer_load_dword v44, v22, s[48:51], s3 offen
    s_mov_b32 s3, 0x246000
    buffer_load_dword v45, v22, s[48:51], s3 offen
    s_mov_b32 s3, 0x254000
    buffer_load_dword v46, v22, s[48:51], s3 offen
    s_mov_b32 s3, 0x256000
    buffer_load_dword v47, v22, s[48:51], s3 offen
    s_waitcnt vmcnt(48)
    v_perm_b32 v88, v49, v48, s71
    v_accvgpr_write_b32 a212, v88
    v_perm_b32 v89, v51, v50, s71
    v_accvgpr_write_b32 a213, v89
    v_perm_b32 v90, v53, v52, s71
    v_accvgpr_write_b32 a214, v90
    v_perm_b32 v91, v55, v54, s71
    v_accvgpr_write_b32 a215, v91
    v_perm_b32 v92, v49, v48, s72
    v_accvgpr_write_b32 a220, v92
    v_perm_b32 v93, v51, v50, s72
    v_accvgpr_write_b32 a221, v93
    v_perm_b32 v94, v53, v52, s72
    v_accvgpr_write_b32 a222, v94
    v_perm_b32 v95, v55, v54, s72
    v_accvgpr_write_b32 a223, v95
    s_mov_b32 s3, 0x280000
    buffer_load_dword v48, v22, s[40:43], s3 offen
    s_mov_b32 s3, 0x282000
    buffer_load_dword v49, v22, s[40:43], s3 offen
    s_mov_b32 s3, 0x290000
    buffer_load_dword v50, v22, s[40:43], s3 offen
    s_mov_b32 s3, 0x292000
    buffer_load_dword v51, v22, s[40:43], s3 offen
    s_mov_b32 s3, 0x284000
    buffer_load_dword v52, v22, s[40:43], s3 offen
    s_mov_b32 s3, 0x286000
    buffer_load_dword v53, v22, s[40:43], s3 offen
    s_mov_b32 s3, 0x294000
    buffer_load_dword v54, v22, s[40:43], s3 offen
    s_mov_b32 s3, 0x296000
    buffer_load_dword v55, v22, s[40:43], s3 offen
    s_waitcnt vmcnt(48)
    v_perm_b32 v88, v57, v56, s71
    v_accvgpr_write_b32 a48, v88
    v_perm_b32 v89, v59, v58, s71
    v_accvgpr_write_b32 a49, v89
    v_perm_b32 v90, v61, v60, s71
    v_accvgpr_write_b32 a50, v90
    v_perm_b32 v91, v63, v62, s71
    v_accvgpr_write_b32 a51, v91
    v_perm_b32 v92, v57, v56, s72
    v_accvgpr_write_b32 a56, v92
    v_perm_b32 v93, v59, v58, s72
    v_accvgpr_write_b32 a57, v93
    v_perm_b32 v94, v61, v60, s72
    v_accvgpr_write_b32 a58, v94
    v_perm_b32 v95, v63, v62, s72
    v_accvgpr_write_b32 a59, v95
    s_mov_b32 s3, 0x2c0000
    buffer_load_dword v56, v22, s[40:43], s3 offen
    s_mov_b32 s3, 0x2c2000
    buffer_load_dword v57, v22, s[40:43], s3 offen
    s_mov_b32 s3, 0x2d0000
    buffer_load_dword v58, v22, s[40:43], s3 offen
    s_mov_b32 s3, 0x2d2000
    buffer_load_dword v59, v22, s[40:43], s3 offen
    s_mov_b32 s3, 0x2c4000
    buffer_load_dword v60, v22, s[40:43], s3 offen
    s_mov_b32 s3, 0x2c6000
    buffer_load_dword v61, v22, s[40:43], s3 offen
    s_mov_b32 s3, 0x2d4000
    buffer_load_dword v62, v22, s[40:43], s3 offen
    s_mov_b32 s3, 0x2d6000
    buffer_load_dword v63, v22, s[40:43], s3 offen
    s_waitcnt vmcnt(48)
    v_perm_b32 v88, v65, v64, s71
    v_accvgpr_write_b32 a52, v88
    v_perm_b32 v89, v67, v66, s71
    v_accvgpr_write_b32 a53, v89
    v_perm_b32 v90, v69, v68, s71
    v_accvgpr_write_b32 a54, v90
    v_perm_b32 v91, v71, v70, s71
    v_accvgpr_write_b32 a55, v91
    v_perm_b32 v92, v65, v64, s72
    v_accvgpr_write_b32 a60, v92
    v_perm_b32 v93, v67, v66, s72
    v_accvgpr_write_b32 a61, v93
    v_perm_b32 v94, v69, v68, s72
    v_accvgpr_write_b32 a62, v94
    v_perm_b32 v95, v71, v70, s72
    v_accvgpr_write_b32 a63, v95
    s_mov_b32 s3, 0x280000
    buffer_load_dword v64, v22, s[44:47], s3 offen
    s_mov_b32 s3, 0x282000
    buffer_load_dword v65, v22, s[44:47], s3 offen
    s_mov_b32 s3, 0x290000
    buffer_load_dword v66, v22, s[44:47], s3 offen
    s_mov_b32 s3, 0x292000
    buffer_load_dword v67, v22, s[44:47], s3 offen
    s_mov_b32 s3, 0x284000
    buffer_load_dword v68, v22, s[44:47], s3 offen
    s_mov_b32 s3, 0x286000
    buffer_load_dword v69, v22, s[44:47], s3 offen
    s_mov_b32 s3, 0x294000
    buffer_load_dword v70, v22, s[44:47], s3 offen
    s_mov_b32 s3, 0x296000
    buffer_load_dword v71, v22, s[44:47], s3 offen
    s_waitcnt vmcnt(48)
    v_perm_b32 v88, v73, v72, s71
    v_accvgpr_write_b32 a64, v88
    v_perm_b32 v89, v75, v74, s71
    v_accvgpr_write_b32 a65, v89
    v_perm_b32 v90, v77, v76, s71
    v_accvgpr_write_b32 a66, v90
    v_perm_b32 v91, v79, v78, s71
    v_accvgpr_write_b32 a67, v91
    v_perm_b32 v92, v73, v72, s72
    v_perm_b32 v93, v75, v74, s72
    v_perm_b32 v94, v77, v76, s72
    v_perm_b32 v95, v79, v78, s72
    ds_write_b128 v3, v[92:95] offset:4096
    s_mov_b32 s3, 0x2c0000
    buffer_load_dword v72, v22, s[44:47], s3 offen
    s_mov_b32 s3, 0x2c2000
    buffer_load_dword v73, v22, s[44:47], s3 offen
    s_mov_b32 s3, 0x2d0000
    buffer_load_dword v74, v22, s[44:47], s3 offen
    s_mov_b32 s3, 0x2d2000
    buffer_load_dword v75, v22, s[44:47], s3 offen
    s_mov_b32 s3, 0x2c4000
    buffer_load_dword v76, v22, s[44:47], s3 offen
    s_mov_b32 s3, 0x2c6000
    buffer_load_dword v77, v22, s[44:47], s3 offen
    s_mov_b32 s3, 0x2d4000
    buffer_load_dword v78, v22, s[44:47], s3 offen
    s_mov_b32 s3, 0x2d6000
    buffer_load_dword v79, v22, s[44:47], s3 offen
    s_waitcnt vmcnt(48)
    v_perm_b32 v88, v81, v80, s71
    v_accvgpr_write_b32 a68, v88
    v_perm_b32 v89, v83, v82, s71
    v_accvgpr_write_b32 a69, v89
    v_perm_b32 v90, v85, v84, s71
    v_accvgpr_write_b32 a70, v90
    v_perm_b32 v91, v87, v86, s71
    v_accvgpr_write_b32 a71, v91
    v_perm_b32 v92, v81, v80, s72
    v_perm_b32 v93, v83, v82, s72
    v_perm_b32 v94, v85, v84, s72
    v_perm_b32 v95, v87, v86, s72
    ds_write_b128 v3, v[92:95] offset:5120
    s_mov_b32 s3, 0x280000
    buffer_load_dword v80, v22, s[48:51], s3 offen
    s_mov_b32 s3, 0x282000
    buffer_load_dword v81, v22, s[48:51], s3 offen
    s_mov_b32 s3, 0x290000
    buffer_load_dword v82, v22, s[48:51], s3 offen
    s_mov_b32 s3, 0x292000
    buffer_load_dword v83, v22, s[48:51], s3 offen
    s_mov_b32 s3, 0x284000
    buffer_load_dword v84, v22, s[48:51], s3 offen
    s_mov_b32 s3, 0x286000
    buffer_load_dword v85, v22, s[48:51], s3 offen
    s_mov_b32 s3, 0x294000
    buffer_load_dword v86, v22, s[48:51], s3 offen
    s_mov_b32 s3, 0x296000
    buffer_load_dword v87, v22, s[48:51], s3 offen
    s_waitcnt vmcnt(48)
    v_perm_b32 v88, v33, v32, s71
    v_accvgpr_write_b32 a224, v88
    v_perm_b32 v89, v35, v34, s71
    v_accvgpr_write_b32 a225, v89
    v_perm_b32 v90, v37, v36, s71
    v_accvgpr_write_b32 a226, v90
    v_perm_b32 v91, v39, v38, s71
    v_accvgpr_write_b32 a227, v91
    v_perm_b32 v92, v33, v32, s72
    v_accvgpr_write_b32 a232, v92
    v_perm_b32 v93, v35, v34, s72
    v_accvgpr_write_b32 a233, v93
    v_perm_b32 v94, v37, v36, s72
    v_accvgpr_write_b32 a234, v94
    v_perm_b32 v95, v39, v38, s72
    v_accvgpr_write_b32 a235, v95
    s_mov_b32 s3, 0x2c0000
    buffer_load_dword v32, v22, s[48:51], s3 offen
    s_mov_b32 s3, 0x2c2000
    buffer_load_dword v33, v22, s[48:51], s3 offen
    s_mov_b32 s3, 0x2d0000
    buffer_load_dword v34, v22, s[48:51], s3 offen
    s_mov_b32 s3, 0x2d2000
    buffer_load_dword v35, v22, s[48:51], s3 offen
    s_mov_b32 s3, 0x2c4000
    buffer_load_dword v36, v22, s[48:51], s3 offen
    s_mov_b32 s3, 0x2c6000
    buffer_load_dword v37, v22, s[48:51], s3 offen
    s_mov_b32 s3, 0x2d4000
    buffer_load_dword v38, v22, s[48:51], s3 offen
    s_mov_b32 s3, 0x2d6000
    buffer_load_dword v39, v22, s[48:51], s3 offen
    s_waitcnt vmcnt(48)
    v_perm_b32 v88, v41, v40, s71
    v_accvgpr_write_b32 a228, v88
    v_perm_b32 v89, v43, v42, s71
    v_accvgpr_write_b32 a229, v89
    v_perm_b32 v90, v45, v44, s71
    v_accvgpr_write_b32 a230, v90
    v_perm_b32 v91, v47, v46, s71
    v_accvgpr_write_b32 a231, v91
    v_perm_b32 v92, v41, v40, s72
    v_accvgpr_write_b32 a236, v92
    v_perm_b32 v93, v43, v42, s72
    v_accvgpr_write_b32 a237, v93
    v_perm_b32 v94, v45, v44, s72
    v_accvgpr_write_b32 a238, v94
    v_perm_b32 v95, v47, v46, s72
    v_accvgpr_write_b32 a239, v95
    s_mov_b32 s3, 0x300000
    buffer_load_dword v40, v22, s[40:43], s3 offen
    s_mov_b32 s3, 0x302000
    buffer_load_dword v41, v22, s[40:43], s3 offen
    s_mov_b32 s3, 0x310000
    buffer_load_dword v42, v22, s[40:43], s3 offen
    s_mov_b32 s3, 0x312000
    buffer_load_dword v43, v22, s[40:43], s3 offen
    s_mov_b32 s3, 0x304000
    buffer_load_dword v44, v22, s[40:43], s3 offen
    s_mov_b32 s3, 0x306000
    buffer_load_dword v45, v22, s[40:43], s3 offen
    s_mov_b32 s3, 0x314000
    buffer_load_dword v46, v22, s[40:43], s3 offen
    s_mov_b32 s3, 0x316000
    buffer_load_dword v47, v22, s[40:43], s3 offen
    s_waitcnt vmcnt(48)
    v_perm_b32 v88, v49, v48, s71
    v_accvgpr_write_b32 a72, v88
    v_perm_b32 v89, v51, v50, s71
    v_accvgpr_write_b32 a73, v89
    v_perm_b32 v90, v53, v52, s71
    v_accvgpr_write_b32 a74, v90
    v_perm_b32 v91, v55, v54, s71
    v_accvgpr_write_b32 a75, v91
    v_perm_b32 v92, v49, v48, s72
    v_accvgpr_write_b32 a80, v92
    v_perm_b32 v93, v51, v50, s72
    v_accvgpr_write_b32 a81, v93
    v_perm_b32 v94, v53, v52, s72
    v_accvgpr_write_b32 a82, v94
    v_perm_b32 v95, v55, v54, s72
    v_accvgpr_write_b32 a83, v95
    s_mov_b32 s3, 0x340000
    buffer_load_dword v48, v22, s[40:43], s3 offen
    s_mov_b32 s3, 0x342000
    buffer_load_dword v49, v22, s[40:43], s3 offen
    s_mov_b32 s3, 0x350000
    buffer_load_dword v50, v22, s[40:43], s3 offen
    s_mov_b32 s3, 0x352000
    buffer_load_dword v51, v22, s[40:43], s3 offen
    s_mov_b32 s3, 0x344000
    buffer_load_dword v52, v22, s[40:43], s3 offen
    s_mov_b32 s3, 0x346000
    buffer_load_dword v53, v22, s[40:43], s3 offen
    s_mov_b32 s3, 0x354000
    buffer_load_dword v54, v22, s[40:43], s3 offen
    s_mov_b32 s3, 0x356000
    buffer_load_dword v55, v22, s[40:43], s3 offen
    s_waitcnt vmcnt(48)
    v_perm_b32 v88, v57, v56, s71
    v_accvgpr_write_b32 a76, v88
    v_perm_b32 v89, v59, v58, s71
    v_accvgpr_write_b32 a77, v89
    v_perm_b32 v90, v61, v60, s71
    v_accvgpr_write_b32 a78, v90
    v_perm_b32 v91, v63, v62, s71
    v_accvgpr_write_b32 a79, v91
    v_perm_b32 v92, v57, v56, s72
    v_accvgpr_write_b32 a84, v92
    v_perm_b32 v93, v59, v58, s72
    v_accvgpr_write_b32 a85, v93
    v_perm_b32 v94, v61, v60, s72
    v_accvgpr_write_b32 a86, v94
    v_perm_b32 v95, v63, v62, s72
    v_accvgpr_write_b32 a87, v95
    s_mov_b32 s3, 0x300000
    buffer_load_dword v56, v22, s[44:47], s3 offen
    s_mov_b32 s3, 0x302000
    buffer_load_dword v57, v22, s[44:47], s3 offen
    s_mov_b32 s3, 0x310000
    buffer_load_dword v58, v22, s[44:47], s3 offen
    s_mov_b32 s3, 0x312000
    buffer_load_dword v59, v22, s[44:47], s3 offen
    s_mov_b32 s3, 0x304000
    buffer_load_dword v60, v22, s[44:47], s3 offen
    s_mov_b32 s3, 0x306000
    buffer_load_dword v61, v22, s[44:47], s3 offen
    s_mov_b32 s3, 0x314000
    buffer_load_dword v62, v22, s[44:47], s3 offen
    s_mov_b32 s3, 0x316000
    buffer_load_dword v63, v22, s[44:47], s3 offen
    s_waitcnt vmcnt(48)
    v_perm_b32 v88, v65, v64, s71
    v_accvgpr_write_b32 a88, v88
    v_perm_b32 v89, v67, v66, s71
    v_accvgpr_write_b32 a89, v89
    v_perm_b32 v90, v69, v68, s71
    v_accvgpr_write_b32 a90, v90
    v_perm_b32 v91, v71, v70, s71
    v_accvgpr_write_b32 a91, v91
    v_perm_b32 v92, v65, v64, s72
    v_perm_b32 v93, v67, v66, s72
    v_perm_b32 v94, v69, v68, s72
    v_perm_b32 v95, v71, v70, s72
    ds_write_b128 v3, v[92:95] offset:6144
    s_mov_b32 s3, 0x340000
    buffer_load_dword v64, v22, s[44:47], s3 offen
    s_mov_b32 s3, 0x342000
    buffer_load_dword v65, v22, s[44:47], s3 offen
    s_mov_b32 s3, 0x350000
    buffer_load_dword v66, v22, s[44:47], s3 offen
    s_mov_b32 s3, 0x352000
    buffer_load_dword v67, v22, s[44:47], s3 offen
    s_mov_b32 s3, 0x344000
    buffer_load_dword v68, v22, s[44:47], s3 offen
    s_mov_b32 s3, 0x346000
    buffer_load_dword v69, v22, s[44:47], s3 offen
    s_mov_b32 s3, 0x354000
    buffer_load_dword v70, v22, s[44:47], s3 offen
    s_mov_b32 s3, 0x356000
    buffer_load_dword v71, v22, s[44:47], s3 offen
    s_waitcnt vmcnt(48)
    v_perm_b32 v88, v73, v72, s71
    v_accvgpr_write_b32 a92, v88
    v_perm_b32 v89, v75, v74, s71
    v_accvgpr_write_b32 a93, v89
    v_perm_b32 v90, v77, v76, s71
    v_accvgpr_write_b32 a94, v90
    v_perm_b32 v91, v79, v78, s71
    v_accvgpr_write_b32 a95, v91
    v_perm_b32 v92, v73, v72, s72
    v_perm_b32 v93, v75, v74, s72
    v_perm_b32 v94, v77, v76, s72
    v_perm_b32 v95, v79, v78, s72
    ds_write_b128 v3, v[92:95] offset:7168
    s_mov_b32 s3, 0x300000
    buffer_load_dword v72, v22, s[48:51], s3 offen
    s_mov_b32 s3, 0x302000
    buffer_load_dword v73, v22, s[48:51], s3 offen
    s_mov_b32 s3, 0x310000
    buffer_load_dword v74, v22, s[48:51], s3 offen
    s_mov_b32 s3, 0x312000
    buffer_load_dword v75, v22, s[48:51], s3 offen
    s_mov_b32 s3, 0x304000
    buffer_load_dword v76, v22, s[48:51], s3 offen
    s_mov_b32 s3, 0x306000
    buffer_load_dword v77, v22, s[48:51], s3 offen
    s_mov_b32 s3, 0x314000
    buffer_load_dword v78, v22, s[48:51], s3 offen
    s_mov_b32 s3, 0x316000
    buffer_load_dword v79, v22, s[48:51], s3 offen
    s_waitcnt vmcnt(48)
    v_perm_b32 v88, v81, v80, s71
    v_accvgpr_write_b32 a240, v88
    v_perm_b32 v89, v83, v82, s71
    v_accvgpr_write_b32 a241, v89
    v_perm_b32 v90, v85, v84, s71
    v_accvgpr_write_b32 a242, v90
    v_perm_b32 v91, v87, v86, s71
    v_accvgpr_write_b32 a243, v91
    v_perm_b32 v92, v81, v80, s72
    v_accvgpr_write_b32 a248, v92
    v_perm_b32 v93, v83, v82, s72
    v_accvgpr_write_b32 a249, v93
    v_perm_b32 v94, v85, v84, s72
    v_accvgpr_write_b32 a250, v94
    v_perm_b32 v95, v87, v86, s72
    v_accvgpr_write_b32 a251, v95
    s_mov_b32 s3, 0x340000
    buffer_load_dword v80, v22, s[48:51], s3 offen
    s_mov_b32 s3, 0x342000
    buffer_load_dword v81, v22, s[48:51], s3 offen
    s_mov_b32 s3, 0x350000
    buffer_load_dword v82, v22, s[48:51], s3 offen
    s_mov_b32 s3, 0x352000
    buffer_load_dword v83, v22, s[48:51], s3 offen
    s_mov_b32 s3, 0x344000
    buffer_load_dword v84, v22, s[48:51], s3 offen
    s_mov_b32 s3, 0x346000
    buffer_load_dword v85, v22, s[48:51], s3 offen
    s_mov_b32 s3, 0x354000
    buffer_load_dword v86, v22, s[48:51], s3 offen
    s_mov_b32 s3, 0x356000
    buffer_load_dword v87, v22, s[48:51], s3 offen
    s_waitcnt vmcnt(48)
    v_perm_b32 v88, v33, v32, s71
    v_accvgpr_write_b32 a244, v88
    v_perm_b32 v89, v35, v34, s71
    v_accvgpr_write_b32 a245, v89
    v_perm_b32 v90, v37, v36, s71
    v_accvgpr_write_b32 a246, v90
    v_perm_b32 v91, v39, v38, s71
    v_accvgpr_write_b32 a247, v91
    v_perm_b32 v92, v33, v32, s72
    v_accvgpr_write_b32 a252, v92
    v_perm_b32 v93, v35, v34, s72
    v_accvgpr_write_b32 a253, v93
    v_perm_b32 v94, v37, v36, s72
    v_accvgpr_write_b32 a254, v94
    v_perm_b32 v95, v39, v38, s72
    v_accvgpr_write_b32 a255, v95
    s_mov_b32 s3, 0x380000
    buffer_load_dword v32, v22, s[40:43], s3 offen
    s_mov_b32 s3, 0x382000
    buffer_load_dword v33, v22, s[40:43], s3 offen
    s_mov_b32 s3, 0x390000
    buffer_load_dword v34, v22, s[40:43], s3 offen
    s_mov_b32 s3, 0x392000
    buffer_load_dword v35, v22, s[40:43], s3 offen
    s_mov_b32 s3, 0x384000
    buffer_load_dword v36, v22, s[40:43], s3 offen
    s_mov_b32 s3, 0x386000
    buffer_load_dword v37, v22, s[40:43], s3 offen
    s_mov_b32 s3, 0x394000
    buffer_load_dword v38, v22, s[40:43], s3 offen
    s_mov_b32 s3, 0x396000
    buffer_load_dword v39, v22, s[40:43], s3 offen
    s_waitcnt vmcnt(48)
    v_perm_b32 v88, v41, v40, s71
    v_accvgpr_write_b32 a96, v88
    v_perm_b32 v89, v43, v42, s71
    v_accvgpr_write_b32 a97, v89
    v_perm_b32 v90, v45, v44, s71
    v_accvgpr_write_b32 a98, v90
    v_perm_b32 v91, v47, v46, s71
    v_accvgpr_write_b32 a99, v91
    v_perm_b32 v92, v41, v40, s72
    v_accvgpr_write_b32 a104, v92
    v_perm_b32 v93, v43, v42, s72
    v_accvgpr_write_b32 a105, v93
    v_perm_b32 v94, v45, v44, s72
    v_accvgpr_write_b32 a106, v94
    v_perm_b32 v95, v47, v46, s72
    v_accvgpr_write_b32 a107, v95
    s_mov_b32 s3, 0x3c0000
    buffer_load_dword v40, v22, s[40:43], s3 offen
    s_mov_b32 s3, 0x3c2000
    buffer_load_dword v41, v22, s[40:43], s3 offen
    s_mov_b32 s3, 0x3d0000
    buffer_load_dword v42, v22, s[40:43], s3 offen
    s_mov_b32 s3, 0x3d2000
    buffer_load_dword v43, v22, s[40:43], s3 offen
    s_mov_b32 s3, 0x3c4000
    buffer_load_dword v44, v22, s[40:43], s3 offen
    s_mov_b32 s3, 0x3c6000
    buffer_load_dword v45, v22, s[40:43], s3 offen
    s_mov_b32 s3, 0x3d4000
    buffer_load_dword v46, v22, s[40:43], s3 offen
    s_mov_b32 s3, 0x3d6000
    buffer_load_dword v47, v22, s[40:43], s3 offen
    s_waitcnt vmcnt(48)
    v_perm_b32 v88, v49, v48, s71
    v_accvgpr_write_b32 a100, v88
    v_perm_b32 v89, v51, v50, s71
    v_accvgpr_write_b32 a101, v89
    v_perm_b32 v90, v53, v52, s71
    v_accvgpr_write_b32 a102, v90
    v_perm_b32 v91, v55, v54, s71
    v_accvgpr_write_b32 a103, v91
    v_perm_b32 v92, v49, v48, s72
    v_accvgpr_write_b32 a108, v92
    v_perm_b32 v93, v51, v50, s72
    v_accvgpr_write_b32 a109, v93
    v_perm_b32 v94, v53, v52, s72
    v_accvgpr_write_b32 a110, v94
    v_perm_b32 v95, v55, v54, s72
    v_accvgpr_write_b32 a111, v95
    s_mov_b32 s3, 0x380000
    buffer_load_dword v48, v22, s[44:47], s3 offen
    s_mov_b32 s3, 0x382000
    buffer_load_dword v49, v22, s[44:47], s3 offen
    s_mov_b32 s3, 0x390000
    buffer_load_dword v50, v22, s[44:47], s3 offen
    s_mov_b32 s3, 0x392000
    buffer_load_dword v51, v22, s[44:47], s3 offen
    s_mov_b32 s3, 0x384000
    buffer_load_dword v52, v22, s[44:47], s3 offen
    s_mov_b32 s3, 0x386000
    buffer_load_dword v53, v22, s[44:47], s3 offen
    s_mov_b32 s3, 0x394000
    buffer_load_dword v54, v22, s[44:47], s3 offen
    s_mov_b32 s3, 0x396000
    buffer_load_dword v55, v22, s[44:47], s3 offen
    s_waitcnt vmcnt(48)
    v_perm_b32 v88, v57, v56, s71
    v_accvgpr_write_b32 a112, v88
    v_perm_b32 v89, v59, v58, s71
    v_accvgpr_write_b32 a113, v89
    v_perm_b32 v90, v61, v60, s71
    v_accvgpr_write_b32 a114, v90
    v_perm_b32 v91, v63, v62, s71
    v_accvgpr_write_b32 a115, v91
    v_perm_b32 v92, v57, v56, s72
    v_perm_b32 v93, v59, v58, s72
    v_perm_b32 v94, v61, v60, s72
    v_perm_b32 v95, v63, v62, s72
    ds_write_b128 v3, v[92:95] offset:8192
    s_mov_b32 s3, 0x3c0000
    buffer_load_dword v56, v22, s[44:47], s3 offen
    s_mov_b32 s3, 0x3c2000
    buffer_load_dword v57, v22, s[44:47], s3 offen
    s_mov_b32 s3, 0x3d0000
    buffer_load_dword v58, v22, s[44:47], s3 offen
    s_mov_b32 s3, 0x3d2000
    buffer_load_dword v59, v22, s[44:47], s3 offen
    s_mov_b32 s3, 0x3c4000
    buffer_load_dword v60, v22, s[44:47], s3 offen
    s_mov_b32 s3, 0x3c6000
    buffer_load_dword v61, v22, s[44:47], s3 offen
    s_mov_b32 s3, 0x3d4000
    buffer_load_dword v62, v22, s[44:47], s3 offen
    s_mov_b32 s3, 0x3d6000
    buffer_load_dword v63, v22, s[44:47], s3 offen
    s_waitcnt vmcnt(48)
    v_perm_b32 v88, v65, v64, s71
    v_accvgpr_write_b32 a116, v88
    v_perm_b32 v89, v67, v66, s71
    v_accvgpr_write_b32 a117, v89
    v_perm_b32 v90, v69, v68, s71
    v_accvgpr_write_b32 a118, v90
    v_perm_b32 v91, v71, v70, s71
    v_accvgpr_write_b32 a119, v91
    v_perm_b32 v92, v65, v64, s72
    v_perm_b32 v93, v67, v66, s72
    v_perm_b32 v94, v69, v68, s72
    v_perm_b32 v95, v71, v70, s72
    ds_write_b128 v3, v[92:95] offset:9216
    s_mov_b32 s3, 0x380000
    buffer_load_dword v64, v22, s[48:51], s3 offen
    s_mov_b32 s3, 0x382000
    buffer_load_dword v65, v22, s[48:51], s3 offen
    s_mov_b32 s3, 0x390000
    buffer_load_dword v66, v22, s[48:51], s3 offen
    s_mov_b32 s3, 0x392000
    buffer_load_dword v67, v22, s[48:51], s3 offen
    s_mov_b32 s3, 0x384000
    buffer_load_dword v68, v22, s[48:51], s3 offen
    s_mov_b32 s3, 0x386000
    buffer_load_dword v69, v22, s[48:51], s3 offen
    s_mov_b32 s3, 0x394000
    buffer_load_dword v70, v22, s[48:51], s3 offen
    s_mov_b32 s3, 0x396000
    buffer_load_dword v71, v22, s[48:51], s3 offen
    s_waitcnt vmcnt(48)
    v_perm_b32 v88, v73, v72, s71
    v_perm_b32 v89, v75, v74, s71
    v_perm_b32 v90, v77, v76, s71
    v_perm_b32 v91, v79, v78, s71
    ds_write_b128 v3, v[88:91] offset:16384
    v_perm_b32 v92, v73, v72, s72
    v_perm_b32 v93, v75, v74, s72
    v_perm_b32 v94, v77, v76, s72
    v_perm_b32 v95, v79, v78, s72
    ds_write_b128 v3, v[92:95] offset:18432
    s_mov_b32 s3, 0x3c0000
    buffer_load_dword v72, v22, s[48:51], s3 offen
    s_mov_b32 s3, 0x3c2000
    buffer_load_dword v73, v22, s[48:51], s3 offen
    s_mov_b32 s3, 0x3d0000
    buffer_load_dword v74, v22, s[48:51], s3 offen
    s_mov_b32 s3, 0x3d2000
    buffer_load_dword v75, v22, s[48:51], s3 offen
    s_mov_b32 s3, 0x3c4000
    buffer_load_dword v76, v22, s[48:51], s3 offen
    s_mov_b32 s3, 0x3c6000
    buffer_load_dword v77, v22, s[48:51], s3 offen
    s_mov_b32 s3, 0x3d4000
    buffer_load_dword v78, v22, s[48:51], s3 offen
    s_mov_b32 s3, 0x3d6000
    buffer_load_dword v79, v22, s[48:51], s3 offen
    s_waitcnt vmcnt(48)
    v_perm_b32 v88, v81, v80, s71
    v_perm_b32 v89, v83, v82, s71
    v_perm_b32 v90, v85, v84, s71
    v_perm_b32 v91, v87, v86, s71
    ds_write_b128 v3, v[88:91] offset:17408
    v_perm_b32 v92, v81, v80, s72
    v_perm_b32 v93, v83, v82, s72
    v_perm_b32 v94, v85, v84, s72
    v_perm_b32 v95, v87, v86, s72
    ds_write_b128 v3, v[92:95] offset:19456
    s_waitcnt vmcnt(40)
    v_perm_b32 v88, v33, v32, s71
    v_accvgpr_write_b32 a120, v88
    v_perm_b32 v89, v35, v34, s71
    v_accvgpr_write_b32 a121, v89
    v_perm_b32 v90, v37, v36, s71
    v_accvgpr_write_b32 a122, v90
    v_perm_b32 v91, v39, v38, s71
    v_accvgpr_write_b32 a123, v91
    v_perm_b32 v92, v33, v32, s72
    v_accvgpr_write_b32 a128, v92
    v_perm_b32 v93, v35, v34, s72
    v_accvgpr_write_b32 a129, v93
    v_perm_b32 v94, v37, v36, s72
    v_accvgpr_write_b32 a130, v94
    v_perm_b32 v95, v39, v38, s72
    v_accvgpr_write_b32 a131, v95
    s_waitcnt vmcnt(32)
    v_perm_b32 v88, v41, v40, s71
    v_accvgpr_write_b32 a124, v88
    v_perm_b32 v89, v43, v42, s71
    v_accvgpr_write_b32 a125, v89
    v_perm_b32 v90, v45, v44, s71
    v_accvgpr_write_b32 a126, v90
    v_perm_b32 v91, v47, v46, s71
    v_accvgpr_write_b32 a127, v91
    v_perm_b32 v92, v41, v40, s72
    v_accvgpr_write_b32 a132, v92
    v_perm_b32 v93, v43, v42, s72
    v_accvgpr_write_b32 a133, v93
    v_perm_b32 v94, v45, v44, s72
    v_accvgpr_write_b32 a134, v94
    v_perm_b32 v95, v47, v46, s72
    v_accvgpr_write_b32 a135, v95
    s_waitcnt vmcnt(24)
    v_perm_b32 v88, v49, v48, s71
    v_accvgpr_write_b32 a136, v88
    v_perm_b32 v89, v51, v50, s71
    v_accvgpr_write_b32 a137, v89
    v_perm_b32 v90, v53, v52, s71
    v_accvgpr_write_b32 a138, v90
    v_perm_b32 v91, v55, v54, s71
    v_accvgpr_write_b32 a139, v91
    v_perm_b32 v92, v49, v48, s72
    v_perm_b32 v93, v51, v50, s72
    v_perm_b32 v94, v53, v52, s72
    v_perm_b32 v95, v55, v54, s72
    ds_write_b128 v3, v[92:95] offset:10240
    s_waitcnt vmcnt(16)
    v_perm_b32 v88, v57, v56, s71
    v_accvgpr_write_b32 a140, v88
    v_perm_b32 v89, v59, v58, s71
    v_accvgpr_write_b32 a141, v89
    v_perm_b32 v90, v61, v60, s71
    v_accvgpr_write_b32 a142, v90
    v_perm_b32 v91, v63, v62, s71
    v_accvgpr_write_b32 a143, v91
    v_perm_b32 v92, v57, v56, s72
    v_perm_b32 v93, v59, v58, s72
    v_perm_b32 v94, v61, v60, s72
    v_perm_b32 v95, v63, v62, s72
    ds_write_b128 v3, v[92:95] offset:11264
    s_waitcnt vmcnt(8)
    v_perm_b32 v88, v65, v64, s71
    v_perm_b32 v89, v67, v66, s71
    v_perm_b32 v90, v69, v68, s71
    v_perm_b32 v91, v71, v70, s71
    ds_write_b128 v3, v[88:91] offset:20480
    v_perm_b32 v92, v65, v64, s72
    v_perm_b32 v93, v67, v66, s72
    v_perm_b32 v94, v69, v68, s72
    v_perm_b32 v95, v71, v70, s72
    ds_write_b128 v3, v[92:95] offset:22528
    s_waitcnt vmcnt(0)
    v_perm_b32 v88, v73, v72, s71
    v_perm_b32 v89, v75, v74, s71
    v_perm_b32 v90, v77, v76, s71
    v_perm_b32 v91, v79, v78, s71
    ds_write_b128 v3, v[88:91] offset:21504
    v_perm_b32 v92, v73, v72, s72
    v_perm_b32 v93, v75, v74, s72
    v_perm_b32 v94, v77, v76, s72
    v_perm_b32 v95, v79, v78, s72
    ds_write_b128 v3, v[92:95] offset:23552
    s_branch Lcwe_312
Lcwv_310:
    s_mov_b32 s3, 0x0
    buffer_load_dword v32, v22, s[40:43], s3 offen
    s_mov_b32 s3, 0x2000
    buffer_load_dword v33, v22, s[40:43], s3 offen
    s_mov_b32 s3, 0x10000
    buffer_load_dword v34, v22, s[40:43], s3 offen
    s_mov_b32 s3, 0x12000
    buffer_load_dword v35, v22, s[40:43], s3 offen
    s_mov_b32 s3, 0x4000
    buffer_load_dword v36, v22, s[40:43], s3 offen
    s_mov_b32 s3, 0x6000
    buffer_load_dword v37, v22, s[40:43], s3 offen
    s_mov_b32 s3, 0x14000
    buffer_load_dword v38, v22, s[40:43], s3 offen
    s_mov_b32 s3, 0x16000
    buffer_load_dword v39, v22, s[40:43], s3 offen
    s_mov_b32 s3, 0x40000
    buffer_load_dword v40, v22, s[40:43], s3 offen
    s_mov_b32 s3, 0x42000
    buffer_load_dword v41, v22, s[40:43], s3 offen
    s_mov_b32 s3, 0x50000
    buffer_load_dword v42, v22, s[40:43], s3 offen
    s_mov_b32 s3, 0x52000
    buffer_load_dword v43, v22, s[40:43], s3 offen
    s_mov_b32 s3, 0x44000
    buffer_load_dword v44, v22, s[40:43], s3 offen
    s_mov_b32 s3, 0x46000
    buffer_load_dword v45, v22, s[40:43], s3 offen
    s_mov_b32 s3, 0x54000
    buffer_load_dword v46, v22, s[40:43], s3 offen
    s_mov_b32 s3, 0x56000
    buffer_load_dword v47, v22, s[40:43], s3 offen
    s_mov_b32 s3, 0x0
    buffer_load_dword v48, v22, s[44:47], s3 offen
    s_mov_b32 s3, 0x2000
    buffer_load_dword v49, v22, s[44:47], s3 offen
    s_mov_b32 s3, 0x10000
    buffer_load_dword v50, v22, s[44:47], s3 offen
    s_mov_b32 s3, 0x12000
    buffer_load_dword v51, v22, s[44:47], s3 offen
    s_mov_b32 s3, 0x4000
    buffer_load_dword v52, v22, s[44:47], s3 offen
    s_mov_b32 s3, 0x6000
    buffer_load_dword v53, v22, s[44:47], s3 offen
    s_mov_b32 s3, 0x14000
    buffer_load_dword v54, v22, s[44:47], s3 offen
    s_mov_b32 s3, 0x16000
    buffer_load_dword v55, v22, s[44:47], s3 offen
    s_mov_b32 s3, 0x40000
    buffer_load_dword v56, v22, s[44:47], s3 offen
    s_mov_b32 s3, 0x42000
    buffer_load_dword v57, v22, s[44:47], s3 offen
    s_mov_b32 s3, 0x50000
    buffer_load_dword v58, v22, s[44:47], s3 offen
    s_mov_b32 s3, 0x52000
    buffer_load_dword v59, v22, s[44:47], s3 offen
    s_mov_b32 s3, 0x44000
    buffer_load_dword v60, v22, s[44:47], s3 offen
    s_mov_b32 s3, 0x46000
    buffer_load_dword v61, v22, s[44:47], s3 offen
    s_mov_b32 s3, 0x54000
    buffer_load_dword v62, v22, s[44:47], s3 offen
    s_mov_b32 s3, 0x56000
    buffer_load_dword v63, v22, s[44:47], s3 offen
    s_mov_b32 s3, 0x0
    buffer_load_dword v64, v22, s[48:51], s3 offen
    s_mov_b32 s3, 0x2000
    buffer_load_dword v65, v22, s[48:51], s3 offen
    s_mov_b32 s3, 0x10000
    buffer_load_dword v66, v22, s[48:51], s3 offen
    s_mov_b32 s3, 0x12000
    buffer_load_dword v67, v22, s[48:51], s3 offen
    s_mov_b32 s3, 0x4000
    buffer_load_dword v68, v22, s[48:51], s3 offen
    s_mov_b32 s3, 0x6000
    buffer_load_dword v69, v22, s[48:51], s3 offen
    s_mov_b32 s3, 0x14000
    buffer_load_dword v70, v22, s[48:51], s3 offen
    s_mov_b32 s3, 0x16000
    buffer_load_dword v71, v22, s[48:51], s3 offen
    s_mov_b32 s3, 0x40000
    buffer_load_dword v72, v22, s[48:51], s3 offen
    s_mov_b32 s3, 0x42000
    buffer_load_dword v73, v22, s[48:51], s3 offen
    s_mov_b32 s3, 0x50000
    buffer_load_dword v74, v22, s[48:51], s3 offen
    s_mov_b32 s3, 0x52000
    buffer_load_dword v75, v22, s[48:51], s3 offen
    s_mov_b32 s3, 0x44000
    buffer_load_dword v76, v22, s[48:51], s3 offen
    s_mov_b32 s3, 0x46000
    buffer_load_dword v77, v22, s[48:51], s3 offen
    s_mov_b32 s3, 0x54000
    buffer_load_dword v78, v22, s[48:51], s3 offen
    s_mov_b32 s3, 0x56000
    buffer_load_dword v79, v22, s[48:51], s3 offen
    s_mov_b32 s3, 0x80000
    buffer_load_dword v80, v22, s[40:43], s3 offen
    s_mov_b32 s3, 0x82000
    buffer_load_dword v81, v22, s[40:43], s3 offen
    s_mov_b32 s3, 0x90000
    buffer_load_dword v82, v22, s[40:43], s3 offen
    s_mov_b32 s3, 0x92000
    buffer_load_dword v83, v22, s[40:43], s3 offen
    s_mov_b32 s3, 0x84000
    buffer_load_dword v84, v22, s[40:43], s3 offen
    s_mov_b32 s3, 0x86000
    buffer_load_dword v85, v22, s[40:43], s3 offen
    s_mov_b32 s3, 0x94000
    buffer_load_dword v86, v22, s[40:43], s3 offen
    s_mov_b32 s3, 0x96000
    buffer_load_dword v87, v22, s[40:43], s3 offen
    s_waitcnt vmcnt(48)
    v_perm_b32 v88, v33, v32, s71
    v_accvgpr_write_b32 a96, v88
    v_perm_b32 v89, v35, v34, s71
    v_accvgpr_write_b32 a97, v89
    v_perm_b32 v90, v37, v36, s71
    v_accvgpr_write_b32 a98, v90
    v_perm_b32 v91, v39, v38, s71
    v_accvgpr_write_b32 a99, v91
    v_perm_b32 v92, v33, v32, s72
    v_accvgpr_write_b32 a104, v92
    v_perm_b32 v93, v35, v34, s72
    v_accvgpr_write_b32 a105, v93
    v_perm_b32 v94, v37, v36, s72
    v_accvgpr_write_b32 a106, v94
    v_perm_b32 v95, v39, v38, s72
    v_accvgpr_write_b32 a107, v95
    s_mov_b32 s3, 0xc0000
    buffer_load_dword v32, v22, s[40:43], s3 offen
    s_mov_b32 s3, 0xc2000
    buffer_load_dword v33, v22, s[40:43], s3 offen
    s_mov_b32 s3, 0xd0000
    buffer_load_dword v34, v22, s[40:43], s3 offen
    s_mov_b32 s3, 0xd2000
    buffer_load_dword v35, v22, s[40:43], s3 offen
    s_mov_b32 s3, 0xc4000
    buffer_load_dword v36, v22, s[40:43], s3 offen
    s_mov_b32 s3, 0xc6000
    buffer_load_dword v37, v22, s[40:43], s3 offen
    s_mov_b32 s3, 0xd4000
    buffer_load_dword v38, v22, s[40:43], s3 offen
    s_mov_b32 s3, 0xd6000
    buffer_load_dword v39, v22, s[40:43], s3 offen
    s_waitcnt vmcnt(48)
    v_perm_b32 v88, v41, v40, s71
    v_accvgpr_write_b32 a100, v88
    v_perm_b32 v89, v43, v42, s71
    v_accvgpr_write_b32 a101, v89
    v_perm_b32 v90, v45, v44, s71
    v_accvgpr_write_b32 a102, v90
    v_perm_b32 v91, v47, v46, s71
    v_accvgpr_write_b32 a103, v91
    v_perm_b32 v92, v41, v40, s72
    v_accvgpr_write_b32 a108, v92
    v_perm_b32 v93, v43, v42, s72
    v_accvgpr_write_b32 a109, v93
    v_perm_b32 v94, v45, v44, s72
    v_accvgpr_write_b32 a110, v94
    v_perm_b32 v95, v47, v46, s72
    v_accvgpr_write_b32 a111, v95
    s_mov_b32 s3, 0x80000
    buffer_load_dword v40, v22, s[44:47], s3 offen
    s_mov_b32 s3, 0x82000
    buffer_load_dword v41, v22, s[44:47], s3 offen
    s_mov_b32 s3, 0x90000
    buffer_load_dword v42, v22, s[44:47], s3 offen
    s_mov_b32 s3, 0x92000
    buffer_load_dword v43, v22, s[44:47], s3 offen
    s_mov_b32 s3, 0x84000
    buffer_load_dword v44, v22, s[44:47], s3 offen
    s_mov_b32 s3, 0x86000
    buffer_load_dword v45, v22, s[44:47], s3 offen
    s_mov_b32 s3, 0x94000
    buffer_load_dword v46, v22, s[44:47], s3 offen
    s_mov_b32 s3, 0x96000
    buffer_load_dword v47, v22, s[44:47], s3 offen
    s_waitcnt vmcnt(48)
    v_perm_b32 v88, v49, v48, s71
    v_accvgpr_write_b32 a112, v88
    v_perm_b32 v89, v51, v50, s71
    v_accvgpr_write_b32 a113, v89
    v_perm_b32 v90, v53, v52, s71
    v_accvgpr_write_b32 a114, v90
    v_perm_b32 v91, v55, v54, s71
    v_accvgpr_write_b32 a115, v91
    v_perm_b32 v92, v49, v48, s72
    v_perm_b32 v93, v51, v50, s72
    v_perm_b32 v94, v53, v52, s72
    v_perm_b32 v95, v55, v54, s72
    ds_write_b128 v3, v[92:95] offset:8192
    s_mov_b32 s3, 0xc0000
    buffer_load_dword v48, v22, s[44:47], s3 offen
    s_mov_b32 s3, 0xc2000
    buffer_load_dword v49, v22, s[44:47], s3 offen
    s_mov_b32 s3, 0xd0000
    buffer_load_dword v50, v22, s[44:47], s3 offen
    s_mov_b32 s3, 0xd2000
    buffer_load_dword v51, v22, s[44:47], s3 offen
    s_mov_b32 s3, 0xc4000
    buffer_load_dword v52, v22, s[44:47], s3 offen
    s_mov_b32 s3, 0xc6000
    buffer_load_dword v53, v22, s[44:47], s3 offen
    s_mov_b32 s3, 0xd4000
    buffer_load_dword v54, v22, s[44:47], s3 offen
    s_mov_b32 s3, 0xd6000
    buffer_load_dword v55, v22, s[44:47], s3 offen
    s_waitcnt vmcnt(48)
    v_perm_b32 v88, v57, v56, s71
    v_accvgpr_write_b32 a116, v88
    v_perm_b32 v89, v59, v58, s71
    v_accvgpr_write_b32 a117, v89
    v_perm_b32 v90, v61, v60, s71
    v_accvgpr_write_b32 a118, v90
    v_perm_b32 v91, v63, v62, s71
    v_accvgpr_write_b32 a119, v91
    v_perm_b32 v92, v57, v56, s72
    v_perm_b32 v93, v59, v58, s72
    v_perm_b32 v94, v61, v60, s72
    v_perm_b32 v95, v63, v62, s72
    ds_write_b128 v3, v[92:95] offset:9216
    s_mov_b32 s3, 0x80000
    buffer_load_dword v56, v22, s[48:51], s3 offen
    s_mov_b32 s3, 0x82000
    buffer_load_dword v57, v22, s[48:51], s3 offen
    s_mov_b32 s3, 0x90000
    buffer_load_dword v58, v22, s[48:51], s3 offen
    s_mov_b32 s3, 0x92000
    buffer_load_dword v59, v22, s[48:51], s3 offen
    s_mov_b32 s3, 0x84000
    buffer_load_dword v60, v22, s[48:51], s3 offen
    s_mov_b32 s3, 0x86000
    buffer_load_dword v61, v22, s[48:51], s3 offen
    s_mov_b32 s3, 0x94000
    buffer_load_dword v62, v22, s[48:51], s3 offen
    s_mov_b32 s3, 0x96000
    buffer_load_dword v63, v22, s[48:51], s3 offen
    s_waitcnt vmcnt(48)
    v_perm_b32 v88, v65, v64, s71
    v_perm_b32 v89, v67, v66, s71
    v_perm_b32 v90, v69, v68, s71
    v_perm_b32 v91, v71, v70, s71
    ds_write_b128 v3, v[88:91] offset:16384
    v_perm_b32 v92, v65, v64, s72
    v_perm_b32 v93, v67, v66, s72
    v_perm_b32 v94, v69, v68, s72
    v_perm_b32 v95, v71, v70, s72
    ds_write_b128 v3, v[92:95] offset:18432
    s_mov_b32 s3, 0xc0000
    buffer_load_dword v64, v22, s[48:51], s3 offen
    s_mov_b32 s3, 0xc2000
    buffer_load_dword v65, v22, s[48:51], s3 offen
    s_mov_b32 s3, 0xd0000
    buffer_load_dword v66, v22, s[48:51], s3 offen
    s_mov_b32 s3, 0xd2000
    buffer_load_dword v67, v22, s[48:51], s3 offen
    s_mov_b32 s3, 0xc4000
    buffer_load_dword v68, v22, s[48:51], s3 offen
    s_mov_b32 s3, 0xc6000
    buffer_load_dword v69, v22, s[48:51], s3 offen
    s_mov_b32 s3, 0xd4000
    buffer_load_dword v70, v22, s[48:51], s3 offen
    s_mov_b32 s3, 0xd6000
    buffer_load_dword v71, v22, s[48:51], s3 offen
    s_waitcnt vmcnt(48)
    v_perm_b32 v88, v73, v72, s71
    v_perm_b32 v89, v75, v74, s71
    v_perm_b32 v90, v77, v76, s71
    v_perm_b32 v91, v79, v78, s71
    ds_write_b128 v3, v[88:91] offset:17408
    v_perm_b32 v92, v73, v72, s72
    v_perm_b32 v93, v75, v74, s72
    v_perm_b32 v94, v77, v76, s72
    v_perm_b32 v95, v79, v78, s72
    ds_write_b128 v3, v[92:95] offset:19456
    s_mov_b32 s3, 0x100000
    buffer_load_dword v72, v22, s[40:43], s3 offen
    s_mov_b32 s3, 0x102000
    buffer_load_dword v73, v22, s[40:43], s3 offen
    s_mov_b32 s3, 0x110000
    buffer_load_dword v74, v22, s[40:43], s3 offen
    s_mov_b32 s3, 0x112000
    buffer_load_dword v75, v22, s[40:43], s3 offen
    s_mov_b32 s3, 0x104000
    buffer_load_dword v76, v22, s[40:43], s3 offen
    s_mov_b32 s3, 0x106000
    buffer_load_dword v77, v22, s[40:43], s3 offen
    s_mov_b32 s3, 0x114000
    buffer_load_dword v78, v22, s[40:43], s3 offen
    s_mov_b32 s3, 0x116000
    buffer_load_dword v79, v22, s[40:43], s3 offen
    s_waitcnt vmcnt(48)
    v_perm_b32 v88, v81, v80, s71
    v_accvgpr_write_b32 a120, v88
    v_perm_b32 v89, v83, v82, s71
    v_accvgpr_write_b32 a121, v89
    v_perm_b32 v90, v85, v84, s71
    v_accvgpr_write_b32 a122, v90
    v_perm_b32 v91, v87, v86, s71
    v_accvgpr_write_b32 a123, v91
    v_perm_b32 v92, v81, v80, s72
    v_accvgpr_write_b32 a128, v92
    v_perm_b32 v93, v83, v82, s72
    v_accvgpr_write_b32 a129, v93
    v_perm_b32 v94, v85, v84, s72
    v_accvgpr_write_b32 a130, v94
    v_perm_b32 v95, v87, v86, s72
    v_accvgpr_write_b32 a131, v95
    s_mov_b32 s3, 0x140000
    buffer_load_dword v80, v22, s[40:43], s3 offen
    s_mov_b32 s3, 0x142000
    buffer_load_dword v81, v22, s[40:43], s3 offen
    s_mov_b32 s3, 0x150000
    buffer_load_dword v82, v22, s[40:43], s3 offen
    s_mov_b32 s3, 0x152000
    buffer_load_dword v83, v22, s[40:43], s3 offen
    s_mov_b32 s3, 0x144000
    buffer_load_dword v84, v22, s[40:43], s3 offen
    s_mov_b32 s3, 0x146000
    buffer_load_dword v85, v22, s[40:43], s3 offen
    s_mov_b32 s3, 0x154000
    buffer_load_dword v86, v22, s[40:43], s3 offen
    s_mov_b32 s3, 0x156000
    buffer_load_dword v87, v22, s[40:43], s3 offen
    s_waitcnt vmcnt(48)
    v_perm_b32 v88, v33, v32, s71
    v_accvgpr_write_b32 a124, v88
    v_perm_b32 v89, v35, v34, s71
    v_accvgpr_write_b32 a125, v89
    v_perm_b32 v90, v37, v36, s71
    v_accvgpr_write_b32 a126, v90
    v_perm_b32 v91, v39, v38, s71
    v_accvgpr_write_b32 a127, v91
    v_perm_b32 v92, v33, v32, s72
    v_accvgpr_write_b32 a132, v92
    v_perm_b32 v93, v35, v34, s72
    v_accvgpr_write_b32 a133, v93
    v_perm_b32 v94, v37, v36, s72
    v_accvgpr_write_b32 a134, v94
    v_perm_b32 v95, v39, v38, s72
    v_accvgpr_write_b32 a135, v95
    s_mov_b32 s3, 0x100000
    buffer_load_dword v32, v22, s[44:47], s3 offen
    s_mov_b32 s3, 0x102000
    buffer_load_dword v33, v22, s[44:47], s3 offen
    s_mov_b32 s3, 0x110000
    buffer_load_dword v34, v22, s[44:47], s3 offen
    s_mov_b32 s3, 0x112000
    buffer_load_dword v35, v22, s[44:47], s3 offen
    s_mov_b32 s3, 0x104000
    buffer_load_dword v36, v22, s[44:47], s3 offen
    s_mov_b32 s3, 0x106000
    buffer_load_dword v37, v22, s[44:47], s3 offen
    s_mov_b32 s3, 0x114000
    buffer_load_dword v38, v22, s[44:47], s3 offen
    s_mov_b32 s3, 0x116000
    buffer_load_dword v39, v22, s[44:47], s3 offen
    s_waitcnt vmcnt(48)
    v_perm_b32 v88, v41, v40, s71
    v_accvgpr_write_b32 a136, v88
    v_perm_b32 v89, v43, v42, s71
    v_accvgpr_write_b32 a137, v89
    v_perm_b32 v90, v45, v44, s71
    v_accvgpr_write_b32 a138, v90
    v_perm_b32 v91, v47, v46, s71
    v_accvgpr_write_b32 a139, v91
    v_perm_b32 v92, v41, v40, s72
    v_perm_b32 v93, v43, v42, s72
    v_perm_b32 v94, v45, v44, s72
    v_perm_b32 v95, v47, v46, s72
    ds_write_b128 v3, v[92:95] offset:10240
    s_mov_b32 s3, 0x140000
    buffer_load_dword v40, v22, s[44:47], s3 offen
    s_mov_b32 s3, 0x142000
    buffer_load_dword v41, v22, s[44:47], s3 offen
    s_mov_b32 s3, 0x150000
    buffer_load_dword v42, v22, s[44:47], s3 offen
    s_mov_b32 s3, 0x152000
    buffer_load_dword v43, v22, s[44:47], s3 offen
    s_mov_b32 s3, 0x144000
    buffer_load_dword v44, v22, s[44:47], s3 offen
    s_mov_b32 s3, 0x146000
    buffer_load_dword v45, v22, s[44:47], s3 offen
    s_mov_b32 s3, 0x154000
    buffer_load_dword v46, v22, s[44:47], s3 offen
    s_mov_b32 s3, 0x156000
    buffer_load_dword v47, v22, s[44:47], s3 offen
    s_waitcnt vmcnt(48)
    v_perm_b32 v88, v49, v48, s71
    v_accvgpr_write_b32 a140, v88
    v_perm_b32 v89, v51, v50, s71
    v_accvgpr_write_b32 a141, v89
    v_perm_b32 v90, v53, v52, s71
    v_accvgpr_write_b32 a142, v90
    v_perm_b32 v91, v55, v54, s71
    v_accvgpr_write_b32 a143, v91
    v_perm_b32 v92, v49, v48, s72
    v_perm_b32 v93, v51, v50, s72
    v_perm_b32 v94, v53, v52, s72
    v_perm_b32 v95, v55, v54, s72
    ds_write_b128 v3, v[92:95] offset:11264
    s_mov_b32 s3, 0x100000
    buffer_load_dword v48, v22, s[48:51], s3 offen
    s_mov_b32 s3, 0x102000
    buffer_load_dword v49, v22, s[48:51], s3 offen
    s_mov_b32 s3, 0x110000
    buffer_load_dword v50, v22, s[48:51], s3 offen
    s_mov_b32 s3, 0x112000
    buffer_load_dword v51, v22, s[48:51], s3 offen
    s_mov_b32 s3, 0x104000
    buffer_load_dword v52, v22, s[48:51], s3 offen
    s_mov_b32 s3, 0x106000
    buffer_load_dword v53, v22, s[48:51], s3 offen
    s_mov_b32 s3, 0x114000
    buffer_load_dword v54, v22, s[48:51], s3 offen
    s_mov_b32 s3, 0x116000
    buffer_load_dword v55, v22, s[48:51], s3 offen
    s_waitcnt vmcnt(48)
    v_perm_b32 v88, v57, v56, s71
    v_perm_b32 v89, v59, v58, s71
    v_perm_b32 v90, v61, v60, s71
    v_perm_b32 v91, v63, v62, s71
    ds_write_b128 v3, v[88:91] offset:20480
    v_perm_b32 v92, v57, v56, s72
    v_perm_b32 v93, v59, v58, s72
    v_perm_b32 v94, v61, v60, s72
    v_perm_b32 v95, v63, v62, s72
    ds_write_b128 v3, v[92:95] offset:22528
    s_mov_b32 s3, 0x140000
    buffer_load_dword v56, v22, s[48:51], s3 offen
    s_mov_b32 s3, 0x142000
    buffer_load_dword v57, v22, s[48:51], s3 offen
    s_mov_b32 s3, 0x150000
    buffer_load_dword v58, v22, s[48:51], s3 offen
    s_mov_b32 s3, 0x152000
    buffer_load_dword v59, v22, s[48:51], s3 offen
    s_mov_b32 s3, 0x144000
    buffer_load_dword v60, v22, s[48:51], s3 offen
    s_mov_b32 s3, 0x146000
    buffer_load_dword v61, v22, s[48:51], s3 offen
    s_mov_b32 s3, 0x154000
    buffer_load_dword v62, v22, s[48:51], s3 offen
    s_mov_b32 s3, 0x156000
    buffer_load_dword v63, v22, s[48:51], s3 offen
    s_waitcnt vmcnt(48)
    v_perm_b32 v88, v65, v64, s71
    v_perm_b32 v89, v67, v66, s71
    v_perm_b32 v90, v69, v68, s71
    v_perm_b32 v91, v71, v70, s71
    ds_write_b128 v3, v[88:91] offset:21504
    v_perm_b32 v92, v65, v64, s72
    v_perm_b32 v93, v67, v66, s72
    v_perm_b32 v94, v69, v68, s72
    v_perm_b32 v95, v71, v70, s72
    ds_write_b128 v3, v[92:95] offset:23552
    s_mov_b32 s3, 0x180000
    buffer_load_dword v64, v22, s[40:43], s3 offen
    s_mov_b32 s3, 0x182000
    buffer_load_dword v65, v22, s[40:43], s3 offen
    s_mov_b32 s3, 0x190000
    buffer_load_dword v66, v22, s[40:43], s3 offen
    s_mov_b32 s3, 0x192000
    buffer_load_dword v67, v22, s[40:43], s3 offen
    s_mov_b32 s3, 0x184000
    buffer_load_dword v68, v22, s[40:43], s3 offen
    s_mov_b32 s3, 0x186000
    buffer_load_dword v69, v22, s[40:43], s3 offen
    s_mov_b32 s3, 0x194000
    buffer_load_dword v70, v22, s[40:43], s3 offen
    s_mov_b32 s3, 0x196000
    buffer_load_dword v71, v22, s[40:43], s3 offen
    s_waitcnt vmcnt(48)
    v_perm_b32 v88, v73, v72, s71
    v_accvgpr_write_b32 a144, v88
    v_perm_b32 v89, v75, v74, s71
    v_accvgpr_write_b32 a145, v89
    v_perm_b32 v90, v77, v76, s71
    v_accvgpr_write_b32 a146, v90
    v_perm_b32 v91, v79, v78, s71
    v_accvgpr_write_b32 a147, v91
    v_perm_b32 v92, v73, v72, s72
    v_accvgpr_write_b32 a152, v92
    v_perm_b32 v93, v75, v74, s72
    v_accvgpr_write_b32 a153, v93
    v_perm_b32 v94, v77, v76, s72
    v_accvgpr_write_b32 a154, v94
    v_perm_b32 v95, v79, v78, s72
    v_accvgpr_write_b32 a155, v95
    s_mov_b32 s3, 0x1c0000
    buffer_load_dword v72, v22, s[40:43], s3 offen
    s_mov_b32 s3, 0x1c2000
    buffer_load_dword v73, v22, s[40:43], s3 offen
    s_mov_b32 s3, 0x1d0000
    buffer_load_dword v74, v22, s[40:43], s3 offen
    s_mov_b32 s3, 0x1d2000
    buffer_load_dword v75, v22, s[40:43], s3 offen
    s_mov_b32 s3, 0x1c4000
    buffer_load_dword v76, v22, s[40:43], s3 offen
    s_mov_b32 s3, 0x1c6000
    buffer_load_dword v77, v22, s[40:43], s3 offen
    s_mov_b32 s3, 0x1d4000
    buffer_load_dword v78, v22, s[40:43], s3 offen
    s_mov_b32 s3, 0x1d6000
    buffer_load_dword v79, v22, s[40:43], s3 offen
    s_waitcnt vmcnt(48)
    v_perm_b32 v88, v81, v80, s71
    v_accvgpr_write_b32 a148, v88
    v_perm_b32 v89, v83, v82, s71
    v_accvgpr_write_b32 a149, v89
    v_perm_b32 v90, v85, v84, s71
    v_accvgpr_write_b32 a150, v90
    v_perm_b32 v91, v87, v86, s71
    v_accvgpr_write_b32 a151, v91
    v_perm_b32 v92, v81, v80, s72
    v_accvgpr_write_b32 a156, v92
    v_perm_b32 v93, v83, v82, s72
    v_accvgpr_write_b32 a157, v93
    v_perm_b32 v94, v85, v84, s72
    v_accvgpr_write_b32 a158, v94
    v_perm_b32 v95, v87, v86, s72
    v_accvgpr_write_b32 a159, v95
    s_mov_b32 s3, 0x180000
    buffer_load_dword v80, v22, s[44:47], s3 offen
    s_mov_b32 s3, 0x182000
    buffer_load_dword v81, v22, s[44:47], s3 offen
    s_mov_b32 s3, 0x190000
    buffer_load_dword v82, v22, s[44:47], s3 offen
    s_mov_b32 s3, 0x192000
    buffer_load_dword v83, v22, s[44:47], s3 offen
    s_mov_b32 s3, 0x184000
    buffer_load_dword v84, v22, s[44:47], s3 offen
    s_mov_b32 s3, 0x186000
    buffer_load_dword v85, v22, s[44:47], s3 offen
    s_mov_b32 s3, 0x194000
    buffer_load_dword v86, v22, s[44:47], s3 offen
    s_mov_b32 s3, 0x196000
    buffer_load_dword v87, v22, s[44:47], s3 offen
    s_waitcnt vmcnt(48)
    v_perm_b32 v88, v33, v32, s71
    v_accvgpr_write_b32 a160, v88
    v_perm_b32 v89, v35, v34, s71
    v_accvgpr_write_b32 a161, v89
    v_perm_b32 v90, v37, v36, s71
    v_accvgpr_write_b32 a162, v90
    v_perm_b32 v91, v39, v38, s71
    v_accvgpr_write_b32 a163, v91
    v_perm_b32 v92, v33, v32, s72
    v_perm_b32 v93, v35, v34, s72
    v_perm_b32 v94, v37, v36, s72
    v_perm_b32 v95, v39, v38, s72
    ds_write_b128 v3, v[92:95] offset:12288
    s_mov_b32 s3, 0x1c0000
    buffer_load_dword v32, v22, s[44:47], s3 offen
    s_mov_b32 s3, 0x1c2000
    buffer_load_dword v33, v22, s[44:47], s3 offen
    s_mov_b32 s3, 0x1d0000
    buffer_load_dword v34, v22, s[44:47], s3 offen
    s_mov_b32 s3, 0x1d2000
    buffer_load_dword v35, v22, s[44:47], s3 offen
    s_mov_b32 s3, 0x1c4000
    buffer_load_dword v36, v22, s[44:47], s3 offen
    s_mov_b32 s3, 0x1c6000
    buffer_load_dword v37, v22, s[44:47], s3 offen
    s_mov_b32 s3, 0x1d4000
    buffer_load_dword v38, v22, s[44:47], s3 offen
    s_mov_b32 s3, 0x1d6000
    buffer_load_dword v39, v22, s[44:47], s3 offen
    s_waitcnt vmcnt(48)
    v_perm_b32 v88, v41, v40, s71
    v_accvgpr_write_b32 a164, v88
    v_perm_b32 v89, v43, v42, s71
    v_accvgpr_write_b32 a165, v89
    v_perm_b32 v90, v45, v44, s71
    v_accvgpr_write_b32 a166, v90
    v_perm_b32 v91, v47, v46, s71
    v_accvgpr_write_b32 a167, v91
    v_perm_b32 v92, v41, v40, s72
    v_perm_b32 v93, v43, v42, s72
    v_perm_b32 v94, v45, v44, s72
    v_perm_b32 v95, v47, v46, s72
    ds_write_b128 v3, v[92:95] offset:13312
    s_mov_b32 s3, 0x180000
    buffer_load_dword v40, v22, s[48:51], s3 offen
    s_mov_b32 s3, 0x182000
    buffer_load_dword v41, v22, s[48:51], s3 offen
    s_mov_b32 s3, 0x190000
    buffer_load_dword v42, v22, s[48:51], s3 offen
    s_mov_b32 s3, 0x192000
    buffer_load_dword v43, v22, s[48:51], s3 offen
    s_mov_b32 s3, 0x184000
    buffer_load_dword v44, v22, s[48:51], s3 offen
    s_mov_b32 s3, 0x186000
    buffer_load_dword v45, v22, s[48:51], s3 offen
    s_mov_b32 s3, 0x194000
    buffer_load_dword v46, v22, s[48:51], s3 offen
    s_mov_b32 s3, 0x196000
    buffer_load_dword v47, v22, s[48:51], s3 offen
    s_waitcnt vmcnt(48)
    v_perm_b32 v88, v49, v48, s71
    v_perm_b32 v89, v51, v50, s71
    v_perm_b32 v90, v53, v52, s71
    v_perm_b32 v91, v55, v54, s71
    ds_write_b128 v3, v[88:91] offset:24576
    v_perm_b32 v92, v49, v48, s72
    v_perm_b32 v93, v51, v50, s72
    v_perm_b32 v94, v53, v52, s72
    v_perm_b32 v95, v55, v54, s72
    ds_write_b128 v3, v[92:95] offset:26624
    s_mov_b32 s3, 0x1c0000
    buffer_load_dword v48, v22, s[48:51], s3 offen
    s_mov_b32 s3, 0x1c2000
    buffer_load_dword v49, v22, s[48:51], s3 offen
    s_mov_b32 s3, 0x1d0000
    buffer_load_dword v50, v22, s[48:51], s3 offen
    s_mov_b32 s3, 0x1d2000
    buffer_load_dword v51, v22, s[48:51], s3 offen
    s_mov_b32 s3, 0x1c4000
    buffer_load_dword v52, v22, s[48:51], s3 offen
    s_mov_b32 s3, 0x1c6000
    buffer_load_dword v53, v22, s[48:51], s3 offen
    s_mov_b32 s3, 0x1d4000
    buffer_load_dword v54, v22, s[48:51], s3 offen
    s_mov_b32 s3, 0x1d6000
    buffer_load_dword v55, v22, s[48:51], s3 offen
    s_waitcnt vmcnt(48)
    v_perm_b32 v88, v57, v56, s71
    v_perm_b32 v89, v59, v58, s71
    v_perm_b32 v90, v61, v60, s71
    v_perm_b32 v91, v63, v62, s71
    ds_write_b128 v3, v[88:91] offset:25600
    v_perm_b32 v92, v57, v56, s72
    v_perm_b32 v93, v59, v58, s72
    v_perm_b32 v94, v61, v60, s72
    v_perm_b32 v95, v63, v62, s72
    ds_write_b128 v3, v[92:95] offset:27648
    s_mov_b32 s3, 0x200000
    buffer_load_dword v56, v22, s[40:43], s3 offen
    s_mov_b32 s3, 0x202000
    buffer_load_dword v57, v22, s[40:43], s3 offen
    s_mov_b32 s3, 0x210000
    buffer_load_dword v58, v22, s[40:43], s3 offen
    s_mov_b32 s3, 0x212000
    buffer_load_dword v59, v22, s[40:43], s3 offen
    s_mov_b32 s3, 0x204000
    buffer_load_dword v60, v22, s[40:43], s3 offen
    s_mov_b32 s3, 0x206000
    buffer_load_dword v61, v22, s[40:43], s3 offen
    s_mov_b32 s3, 0x214000
    buffer_load_dword v62, v22, s[40:43], s3 offen
    s_mov_b32 s3, 0x216000
    buffer_load_dword v63, v22, s[40:43], s3 offen
    s_waitcnt vmcnt(48)
    v_perm_b32 v88, v65, v64, s71
    v_accvgpr_write_b32 a168, v88
    v_perm_b32 v89, v67, v66, s71
    v_accvgpr_write_b32 a169, v89
    v_perm_b32 v90, v69, v68, s71
    v_accvgpr_write_b32 a170, v90
    v_perm_b32 v91, v71, v70, s71
    v_accvgpr_write_b32 a171, v91
    v_perm_b32 v92, v65, v64, s72
    v_accvgpr_write_b32 a176, v92
    v_perm_b32 v93, v67, v66, s72
    v_accvgpr_write_b32 a177, v93
    v_perm_b32 v94, v69, v68, s72
    v_accvgpr_write_b32 a178, v94
    v_perm_b32 v95, v71, v70, s72
    v_accvgpr_write_b32 a179, v95
    s_mov_b32 s3, 0x240000
    buffer_load_dword v64, v22, s[40:43], s3 offen
    s_mov_b32 s3, 0x242000
    buffer_load_dword v65, v22, s[40:43], s3 offen
    s_mov_b32 s3, 0x250000
    buffer_load_dword v66, v22, s[40:43], s3 offen
    s_mov_b32 s3, 0x252000
    buffer_load_dword v67, v22, s[40:43], s3 offen
    s_mov_b32 s3, 0x244000
    buffer_load_dword v68, v22, s[40:43], s3 offen
    s_mov_b32 s3, 0x246000
    buffer_load_dword v69, v22, s[40:43], s3 offen
    s_mov_b32 s3, 0x254000
    buffer_load_dword v70, v22, s[40:43], s3 offen
    s_mov_b32 s3, 0x256000
    buffer_load_dword v71, v22, s[40:43], s3 offen
    s_waitcnt vmcnt(48)
    v_perm_b32 v88, v73, v72, s71
    v_accvgpr_write_b32 a172, v88
    v_perm_b32 v89, v75, v74, s71
    v_accvgpr_write_b32 a173, v89
    v_perm_b32 v90, v77, v76, s71
    v_accvgpr_write_b32 a174, v90
    v_perm_b32 v91, v79, v78, s71
    v_accvgpr_write_b32 a175, v91
    v_perm_b32 v92, v73, v72, s72
    v_accvgpr_write_b32 a180, v92
    v_perm_b32 v93, v75, v74, s72
    v_accvgpr_write_b32 a181, v93
    v_perm_b32 v94, v77, v76, s72
    v_accvgpr_write_b32 a182, v94
    v_perm_b32 v95, v79, v78, s72
    v_accvgpr_write_b32 a183, v95
    s_mov_b32 s3, 0x200000
    buffer_load_dword v72, v22, s[44:47], s3 offen
    s_mov_b32 s3, 0x202000
    buffer_load_dword v73, v22, s[44:47], s3 offen
    s_mov_b32 s3, 0x210000
    buffer_load_dword v74, v22, s[44:47], s3 offen
    s_mov_b32 s3, 0x212000
    buffer_load_dword v75, v22, s[44:47], s3 offen
    s_mov_b32 s3, 0x204000
    buffer_load_dword v76, v22, s[44:47], s3 offen
    s_mov_b32 s3, 0x206000
    buffer_load_dword v77, v22, s[44:47], s3 offen
    s_mov_b32 s3, 0x214000
    buffer_load_dword v78, v22, s[44:47], s3 offen
    s_mov_b32 s3, 0x216000
    buffer_load_dword v79, v22, s[44:47], s3 offen
    s_waitcnt vmcnt(48)
    v_perm_b32 v88, v81, v80, s71
    v_accvgpr_write_b32 a184, v88
    v_perm_b32 v89, v83, v82, s71
    v_accvgpr_write_b32 a185, v89
    v_perm_b32 v90, v85, v84, s71
    v_accvgpr_write_b32 a186, v90
    v_perm_b32 v91, v87, v86, s71
    v_accvgpr_write_b32 a187, v91
    v_perm_b32 v92, v81, v80, s72
    v_perm_b32 v93, v83, v82, s72
    v_perm_b32 v94, v85, v84, s72
    v_perm_b32 v95, v87, v86, s72
    ds_write_b128 v3, v[92:95] offset:14336
    s_mov_b32 s3, 0x240000
    buffer_load_dword v80, v22, s[44:47], s3 offen
    s_mov_b32 s3, 0x242000
    buffer_load_dword v81, v22, s[44:47], s3 offen
    s_mov_b32 s3, 0x250000
    buffer_load_dword v82, v22, s[44:47], s3 offen
    s_mov_b32 s3, 0x252000
    buffer_load_dword v83, v22, s[44:47], s3 offen
    s_mov_b32 s3, 0x244000
    buffer_load_dword v84, v22, s[44:47], s3 offen
    s_mov_b32 s3, 0x246000
    buffer_load_dword v85, v22, s[44:47], s3 offen
    s_mov_b32 s3, 0x254000
    buffer_load_dword v86, v22, s[44:47], s3 offen
    s_mov_b32 s3, 0x256000
    buffer_load_dword v87, v22, s[44:47], s3 offen
    s_waitcnt vmcnt(48)
    v_perm_b32 v88, v33, v32, s71
    v_accvgpr_write_b32 a188, v88
    v_perm_b32 v89, v35, v34, s71
    v_accvgpr_write_b32 a189, v89
    v_perm_b32 v90, v37, v36, s71
    v_accvgpr_write_b32 a190, v90
    v_perm_b32 v91, v39, v38, s71
    v_accvgpr_write_b32 a191, v91
    v_perm_b32 v92, v33, v32, s72
    v_perm_b32 v93, v35, v34, s72
    v_perm_b32 v94, v37, v36, s72
    v_perm_b32 v95, v39, v38, s72
    ds_write_b128 v3, v[92:95] offset:15360
    s_mov_b32 s3, 0x200000
    buffer_load_dword v32, v22, s[48:51], s3 offen
    s_mov_b32 s3, 0x202000
    buffer_load_dword v33, v22, s[48:51], s3 offen
    s_mov_b32 s3, 0x210000
    buffer_load_dword v34, v22, s[48:51], s3 offen
    s_mov_b32 s3, 0x212000
    buffer_load_dword v35, v22, s[48:51], s3 offen
    s_mov_b32 s3, 0x204000
    buffer_load_dword v36, v22, s[48:51], s3 offen
    s_mov_b32 s3, 0x206000
    buffer_load_dword v37, v22, s[48:51], s3 offen
    s_mov_b32 s3, 0x214000
    buffer_load_dword v38, v22, s[48:51], s3 offen
    s_mov_b32 s3, 0x216000
    buffer_load_dword v39, v22, s[48:51], s3 offen
    s_waitcnt vmcnt(48)
    v_perm_b32 v88, v41, v40, s71
    v_perm_b32 v89, v43, v42, s71
    v_perm_b32 v90, v45, v44, s71
    v_perm_b32 v91, v47, v46, s71
    ds_write_b128 v3, v[88:91] offset:28672
    v_perm_b32 v92, v41, v40, s72
    v_perm_b32 v93, v43, v42, s72
    v_perm_b32 v94, v45, v44, s72
    v_perm_b32 v95, v47, v46, s72
    ds_write_b128 v3, v[92:95] offset:30720
    s_mov_b32 s3, 0x240000
    buffer_load_dword v40, v22, s[48:51], s3 offen
    s_mov_b32 s3, 0x242000
    buffer_load_dword v41, v22, s[48:51], s3 offen
    s_mov_b32 s3, 0x250000
    buffer_load_dword v42, v22, s[48:51], s3 offen
    s_mov_b32 s3, 0x252000
    buffer_load_dword v43, v22, s[48:51], s3 offen
    s_mov_b32 s3, 0x244000
    buffer_load_dword v44, v22, s[48:51], s3 offen
    s_mov_b32 s3, 0x246000
    buffer_load_dword v45, v22, s[48:51], s3 offen
    s_mov_b32 s3, 0x254000
    buffer_load_dword v46, v22, s[48:51], s3 offen
    s_mov_b32 s3, 0x256000
    buffer_load_dword v47, v22, s[48:51], s3 offen
    s_waitcnt vmcnt(48)
    v_perm_b32 v88, v49, v48, s71
    v_perm_b32 v89, v51, v50, s71
    v_perm_b32 v90, v53, v52, s71
    v_perm_b32 v91, v55, v54, s71
    ds_write_b128 v3, v[88:91] offset:29696
    v_perm_b32 v92, v49, v48, s72
    v_perm_b32 v93, v51, v50, s72
    v_perm_b32 v94, v53, v52, s72
    v_perm_b32 v95, v55, v54, s72
    ds_write_b128 v3, v[92:95] offset:31744
    s_mov_b32 s3, 0x280000
    buffer_load_dword v48, v22, s[40:43], s3 offen
    s_mov_b32 s3, 0x282000
    buffer_load_dword v49, v22, s[40:43], s3 offen
    s_mov_b32 s3, 0x290000
    buffer_load_dword v50, v22, s[40:43], s3 offen
    s_mov_b32 s3, 0x292000
    buffer_load_dword v51, v22, s[40:43], s3 offen
    s_mov_b32 s3, 0x284000
    buffer_load_dword v52, v22, s[40:43], s3 offen
    s_mov_b32 s3, 0x286000
    buffer_load_dword v53, v22, s[40:43], s3 offen
    s_mov_b32 s3, 0x294000
    buffer_load_dword v54, v22, s[40:43], s3 offen
    s_mov_b32 s3, 0x296000
    buffer_load_dword v55, v22, s[40:43], s3 offen
    s_waitcnt vmcnt(48)
    v_perm_b32 v88, v57, v56, s71
    v_accvgpr_write_b32 a0, v88
    v_perm_b32 v89, v59, v58, s71
    v_accvgpr_write_b32 a1, v89
    v_perm_b32 v90, v61, v60, s71
    v_accvgpr_write_b32 a2, v90
    v_perm_b32 v91, v63, v62, s71
    v_accvgpr_write_b32 a3, v91
    v_perm_b32 v92, v57, v56, s72
    v_accvgpr_write_b32 a8, v92
    v_perm_b32 v93, v59, v58, s72
    v_accvgpr_write_b32 a9, v93
    v_perm_b32 v94, v61, v60, s72
    v_accvgpr_write_b32 a10, v94
    v_perm_b32 v95, v63, v62, s72
    v_accvgpr_write_b32 a11, v95
    s_mov_b32 s3, 0x2c0000
    buffer_load_dword v56, v22, s[40:43], s3 offen
    s_mov_b32 s3, 0x2c2000
    buffer_load_dword v57, v22, s[40:43], s3 offen
    s_mov_b32 s3, 0x2d0000
    buffer_load_dword v58, v22, s[40:43], s3 offen
    s_mov_b32 s3, 0x2d2000
    buffer_load_dword v59, v22, s[40:43], s3 offen
    s_mov_b32 s3, 0x2c4000
    buffer_load_dword v60, v22, s[40:43], s3 offen
    s_mov_b32 s3, 0x2c6000
    buffer_load_dword v61, v22, s[40:43], s3 offen
    s_mov_b32 s3, 0x2d4000
    buffer_load_dword v62, v22, s[40:43], s3 offen
    s_mov_b32 s3, 0x2d6000
    buffer_load_dword v63, v22, s[40:43], s3 offen
    s_waitcnt vmcnt(48)
    v_perm_b32 v88, v65, v64, s71
    v_accvgpr_write_b32 a4, v88
    v_perm_b32 v89, v67, v66, s71
    v_accvgpr_write_b32 a5, v89
    v_perm_b32 v90, v69, v68, s71
    v_accvgpr_write_b32 a6, v90
    v_perm_b32 v91, v71, v70, s71
    v_accvgpr_write_b32 a7, v91
    v_perm_b32 v92, v65, v64, s72
    v_accvgpr_write_b32 a12, v92
    v_perm_b32 v93, v67, v66, s72
    v_accvgpr_write_b32 a13, v93
    v_perm_b32 v94, v69, v68, s72
    v_accvgpr_write_b32 a14, v94
    v_perm_b32 v95, v71, v70, s72
    v_accvgpr_write_b32 a15, v95
    s_mov_b32 s3, 0x280000
    buffer_load_dword v64, v22, s[44:47], s3 offen
    s_mov_b32 s3, 0x282000
    buffer_load_dword v65, v22, s[44:47], s3 offen
    s_mov_b32 s3, 0x290000
    buffer_load_dword v66, v22, s[44:47], s3 offen
    s_mov_b32 s3, 0x292000
    buffer_load_dword v67, v22, s[44:47], s3 offen
    s_mov_b32 s3, 0x284000
    buffer_load_dword v68, v22, s[44:47], s3 offen
    s_mov_b32 s3, 0x286000
    buffer_load_dword v69, v22, s[44:47], s3 offen
    s_mov_b32 s3, 0x294000
    buffer_load_dword v70, v22, s[44:47], s3 offen
    s_mov_b32 s3, 0x296000
    buffer_load_dword v71, v22, s[44:47], s3 offen
    s_waitcnt vmcnt(48)
    v_perm_b32 v88, v73, v72, s71
    v_accvgpr_write_b32 a16, v88
    v_perm_b32 v89, v75, v74, s71
    v_accvgpr_write_b32 a17, v89
    v_perm_b32 v90, v77, v76, s71
    v_accvgpr_write_b32 a18, v90
    v_perm_b32 v91, v79, v78, s71
    v_accvgpr_write_b32 a19, v91
    v_perm_b32 v92, v73, v72, s72
    v_perm_b32 v93, v75, v74, s72
    v_perm_b32 v94, v77, v76, s72
    v_perm_b32 v95, v79, v78, s72
    ds_write_b128 v3, v[92:95] offset:0
    s_mov_b32 s3, 0x2c0000
    buffer_load_dword v72, v22, s[44:47], s3 offen
    s_mov_b32 s3, 0x2c2000
    buffer_load_dword v73, v22, s[44:47], s3 offen
    s_mov_b32 s3, 0x2d0000
    buffer_load_dword v74, v22, s[44:47], s3 offen
    s_mov_b32 s3, 0x2d2000
    buffer_load_dword v75, v22, s[44:47], s3 offen
    s_mov_b32 s3, 0x2c4000
    buffer_load_dword v76, v22, s[44:47], s3 offen
    s_mov_b32 s3, 0x2c6000
    buffer_load_dword v77, v22, s[44:47], s3 offen
    s_mov_b32 s3, 0x2d4000
    buffer_load_dword v78, v22, s[44:47], s3 offen
    s_mov_b32 s3, 0x2d6000
    buffer_load_dword v79, v22, s[44:47], s3 offen
    s_waitcnt vmcnt(48)
    v_perm_b32 v88, v81, v80, s71
    v_accvgpr_write_b32 a20, v88
    v_perm_b32 v89, v83, v82, s71
    v_accvgpr_write_b32 a21, v89
    v_perm_b32 v90, v85, v84, s71
    v_accvgpr_write_b32 a22, v90
    v_perm_b32 v91, v87, v86, s71
    v_accvgpr_write_b32 a23, v91
    v_perm_b32 v92, v81, v80, s72
    v_perm_b32 v93, v83, v82, s72
    v_perm_b32 v94, v85, v84, s72
    v_perm_b32 v95, v87, v86, s72
    ds_write_b128 v3, v[92:95] offset:1024
    s_mov_b32 s3, 0x280000
    buffer_load_dword v80, v22, s[48:51], s3 offen
    s_mov_b32 s3, 0x282000
    buffer_load_dword v81, v22, s[48:51], s3 offen
    s_mov_b32 s3, 0x290000
    buffer_load_dword v82, v22, s[48:51], s3 offen
    s_mov_b32 s3, 0x292000
    buffer_load_dword v83, v22, s[48:51], s3 offen
    s_mov_b32 s3, 0x284000
    buffer_load_dword v84, v22, s[48:51], s3 offen
    s_mov_b32 s3, 0x286000
    buffer_load_dword v85, v22, s[48:51], s3 offen
    s_mov_b32 s3, 0x294000
    buffer_load_dword v86, v22, s[48:51], s3 offen
    s_mov_b32 s3, 0x296000
    buffer_load_dword v87, v22, s[48:51], s3 offen
    s_waitcnt vmcnt(48)
    v_perm_b32 v88, v33, v32, s71
    v_accvgpr_write_b32 a192, v88
    v_perm_b32 v89, v35, v34, s71
    v_accvgpr_write_b32 a193, v89
    v_perm_b32 v90, v37, v36, s71
    v_accvgpr_write_b32 a194, v90
    v_perm_b32 v91, v39, v38, s71
    v_accvgpr_write_b32 a195, v91
    v_perm_b32 v92, v33, v32, s72
    v_accvgpr_write_b32 a200, v92
    v_perm_b32 v93, v35, v34, s72
    v_accvgpr_write_b32 a201, v93
    v_perm_b32 v94, v37, v36, s72
    v_accvgpr_write_b32 a202, v94
    v_perm_b32 v95, v39, v38, s72
    v_accvgpr_write_b32 a203, v95
    s_mov_b32 s3, 0x2c0000
    buffer_load_dword v32, v22, s[48:51], s3 offen
    s_mov_b32 s3, 0x2c2000
    buffer_load_dword v33, v22, s[48:51], s3 offen
    s_mov_b32 s3, 0x2d0000
    buffer_load_dword v34, v22, s[48:51], s3 offen
    s_mov_b32 s3, 0x2d2000
    buffer_load_dword v35, v22, s[48:51], s3 offen
    s_mov_b32 s3, 0x2c4000
    buffer_load_dword v36, v22, s[48:51], s3 offen
    s_mov_b32 s3, 0x2c6000
    buffer_load_dword v37, v22, s[48:51], s3 offen
    s_mov_b32 s3, 0x2d4000
    buffer_load_dword v38, v22, s[48:51], s3 offen
    s_mov_b32 s3, 0x2d6000
    buffer_load_dword v39, v22, s[48:51], s3 offen
    s_waitcnt vmcnt(48)
    v_perm_b32 v88, v41, v40, s71
    v_accvgpr_write_b32 a196, v88
    v_perm_b32 v89, v43, v42, s71
    v_accvgpr_write_b32 a197, v89
    v_perm_b32 v90, v45, v44, s71
    v_accvgpr_write_b32 a198, v90
    v_perm_b32 v91, v47, v46, s71
    v_accvgpr_write_b32 a199, v91
    v_perm_b32 v92, v41, v40, s72
    v_accvgpr_write_b32 a204, v92
    v_perm_b32 v93, v43, v42, s72
    v_accvgpr_write_b32 a205, v93
    v_perm_b32 v94, v45, v44, s72
    v_accvgpr_write_b32 a206, v94
    v_perm_b32 v95, v47, v46, s72
    v_accvgpr_write_b32 a207, v95
    s_mov_b32 s3, 0x300000
    buffer_load_dword v40, v22, s[40:43], s3 offen
    s_mov_b32 s3, 0x302000
    buffer_load_dword v41, v22, s[40:43], s3 offen
    s_mov_b32 s3, 0x310000
    buffer_load_dword v42, v22, s[40:43], s3 offen
    s_mov_b32 s3, 0x312000
    buffer_load_dword v43, v22, s[40:43], s3 offen
    s_mov_b32 s3, 0x304000
    buffer_load_dword v44, v22, s[40:43], s3 offen
    s_mov_b32 s3, 0x306000
    buffer_load_dword v45, v22, s[40:43], s3 offen
    s_mov_b32 s3, 0x314000
    buffer_load_dword v46, v22, s[40:43], s3 offen
    s_mov_b32 s3, 0x316000
    buffer_load_dword v47, v22, s[40:43], s3 offen
    s_waitcnt vmcnt(48)
    v_perm_b32 v88, v49, v48, s71
    v_accvgpr_write_b32 a24, v88
    v_perm_b32 v89, v51, v50, s71
    v_accvgpr_write_b32 a25, v89
    v_perm_b32 v90, v53, v52, s71
    v_accvgpr_write_b32 a26, v90
    v_perm_b32 v91, v55, v54, s71
    v_accvgpr_write_b32 a27, v91
    v_perm_b32 v92, v49, v48, s72
    v_accvgpr_write_b32 a32, v92
    v_perm_b32 v93, v51, v50, s72
    v_accvgpr_write_b32 a33, v93
    v_perm_b32 v94, v53, v52, s72
    v_accvgpr_write_b32 a34, v94
    v_perm_b32 v95, v55, v54, s72
    v_accvgpr_write_b32 a35, v95
    s_mov_b32 s3, 0x340000
    buffer_load_dword v48, v22, s[40:43], s3 offen
    s_mov_b32 s3, 0x342000
    buffer_load_dword v49, v22, s[40:43], s3 offen
    s_mov_b32 s3, 0x350000
    buffer_load_dword v50, v22, s[40:43], s3 offen
    s_mov_b32 s3, 0x352000
    buffer_load_dword v51, v22, s[40:43], s3 offen
    s_mov_b32 s3, 0x344000
    buffer_load_dword v52, v22, s[40:43], s3 offen
    s_mov_b32 s3, 0x346000
    buffer_load_dword v53, v22, s[40:43], s3 offen
    s_mov_b32 s3, 0x354000
    buffer_load_dword v54, v22, s[40:43], s3 offen
    s_mov_b32 s3, 0x356000
    buffer_load_dword v55, v22, s[40:43], s3 offen
    s_waitcnt vmcnt(48)
    v_perm_b32 v88, v57, v56, s71
    v_accvgpr_write_b32 a28, v88
    v_perm_b32 v89, v59, v58, s71
    v_accvgpr_write_b32 a29, v89
    v_perm_b32 v90, v61, v60, s71
    v_accvgpr_write_b32 a30, v90
    v_perm_b32 v91, v63, v62, s71
    v_accvgpr_write_b32 a31, v91
    v_perm_b32 v92, v57, v56, s72
    v_accvgpr_write_b32 a36, v92
    v_perm_b32 v93, v59, v58, s72
    v_accvgpr_write_b32 a37, v93
    v_perm_b32 v94, v61, v60, s72
    v_accvgpr_write_b32 a38, v94
    v_perm_b32 v95, v63, v62, s72
    v_accvgpr_write_b32 a39, v95
    s_mov_b32 s3, 0x300000
    buffer_load_dword v56, v22, s[44:47], s3 offen
    s_mov_b32 s3, 0x302000
    buffer_load_dword v57, v22, s[44:47], s3 offen
    s_mov_b32 s3, 0x310000
    buffer_load_dword v58, v22, s[44:47], s3 offen
    s_mov_b32 s3, 0x312000
    buffer_load_dword v59, v22, s[44:47], s3 offen
    s_mov_b32 s3, 0x304000
    buffer_load_dword v60, v22, s[44:47], s3 offen
    s_mov_b32 s3, 0x306000
    buffer_load_dword v61, v22, s[44:47], s3 offen
    s_mov_b32 s3, 0x314000
    buffer_load_dword v62, v22, s[44:47], s3 offen
    s_mov_b32 s3, 0x316000
    buffer_load_dword v63, v22, s[44:47], s3 offen
    s_waitcnt vmcnt(48)
    v_perm_b32 v88, v65, v64, s71
    v_accvgpr_write_b32 a40, v88
    v_perm_b32 v89, v67, v66, s71
    v_accvgpr_write_b32 a41, v89
    v_perm_b32 v90, v69, v68, s71
    v_accvgpr_write_b32 a42, v90
    v_perm_b32 v91, v71, v70, s71
    v_accvgpr_write_b32 a43, v91
    v_perm_b32 v92, v65, v64, s72
    v_perm_b32 v93, v67, v66, s72
    v_perm_b32 v94, v69, v68, s72
    v_perm_b32 v95, v71, v70, s72
    ds_write_b128 v3, v[92:95] offset:2048
    s_mov_b32 s3, 0x340000
    buffer_load_dword v64, v22, s[44:47], s3 offen
    s_mov_b32 s3, 0x342000
    buffer_load_dword v65, v22, s[44:47], s3 offen
    s_mov_b32 s3, 0x350000
    buffer_load_dword v66, v22, s[44:47], s3 offen
    s_mov_b32 s3, 0x352000
    buffer_load_dword v67, v22, s[44:47], s3 offen
    s_mov_b32 s3, 0x344000
    buffer_load_dword v68, v22, s[44:47], s3 offen
    s_mov_b32 s3, 0x346000
    buffer_load_dword v69, v22, s[44:47], s3 offen
    s_mov_b32 s3, 0x354000
    buffer_load_dword v70, v22, s[44:47], s3 offen
    s_mov_b32 s3, 0x356000
    buffer_load_dword v71, v22, s[44:47], s3 offen
    s_waitcnt vmcnt(48)
    v_perm_b32 v88, v73, v72, s71
    v_accvgpr_write_b32 a44, v88
    v_perm_b32 v89, v75, v74, s71
    v_accvgpr_write_b32 a45, v89
    v_perm_b32 v90, v77, v76, s71
    v_accvgpr_write_b32 a46, v90
    v_perm_b32 v91, v79, v78, s71
    v_accvgpr_write_b32 a47, v91
    v_perm_b32 v92, v73, v72, s72
    v_perm_b32 v93, v75, v74, s72
    v_perm_b32 v94, v77, v76, s72
    v_perm_b32 v95, v79, v78, s72
    ds_write_b128 v3, v[92:95] offset:3072
    s_mov_b32 s3, 0x300000
    buffer_load_dword v72, v22, s[48:51], s3 offen
    s_mov_b32 s3, 0x302000
    buffer_load_dword v73, v22, s[48:51], s3 offen
    s_mov_b32 s3, 0x310000
    buffer_load_dword v74, v22, s[48:51], s3 offen
    s_mov_b32 s3, 0x312000
    buffer_load_dword v75, v22, s[48:51], s3 offen
    s_mov_b32 s3, 0x304000
    buffer_load_dword v76, v22, s[48:51], s3 offen
    s_mov_b32 s3, 0x306000
    buffer_load_dword v77, v22, s[48:51], s3 offen
    s_mov_b32 s3, 0x314000
    buffer_load_dword v78, v22, s[48:51], s3 offen
    s_mov_b32 s3, 0x316000
    buffer_load_dword v79, v22, s[48:51], s3 offen
    s_waitcnt vmcnt(48)
    v_perm_b32 v88, v81, v80, s71
    v_accvgpr_write_b32 a208, v88
    v_perm_b32 v89, v83, v82, s71
    v_accvgpr_write_b32 a209, v89
    v_perm_b32 v90, v85, v84, s71
    v_accvgpr_write_b32 a210, v90
    v_perm_b32 v91, v87, v86, s71
    v_accvgpr_write_b32 a211, v91
    v_perm_b32 v92, v81, v80, s72
    v_accvgpr_write_b32 a216, v92
    v_perm_b32 v93, v83, v82, s72
    v_accvgpr_write_b32 a217, v93
    v_perm_b32 v94, v85, v84, s72
    v_accvgpr_write_b32 a218, v94
    v_perm_b32 v95, v87, v86, s72
    v_accvgpr_write_b32 a219, v95
    s_mov_b32 s3, 0x340000
    buffer_load_dword v80, v22, s[48:51], s3 offen
    s_mov_b32 s3, 0x342000
    buffer_load_dword v81, v22, s[48:51], s3 offen
    s_mov_b32 s3, 0x350000
    buffer_load_dword v82, v22, s[48:51], s3 offen
    s_mov_b32 s3, 0x352000
    buffer_load_dword v83, v22, s[48:51], s3 offen
    s_mov_b32 s3, 0x344000
    buffer_load_dword v84, v22, s[48:51], s3 offen
    s_mov_b32 s3, 0x346000
    buffer_load_dword v85, v22, s[48:51], s3 offen
    s_mov_b32 s3, 0x354000
    buffer_load_dword v86, v22, s[48:51], s3 offen
    s_mov_b32 s3, 0x356000
    buffer_load_dword v87, v22, s[48:51], s3 offen
    s_waitcnt vmcnt(48)
    v_perm_b32 v88, v33, v32, s71
    v_accvgpr_write_b32 a212, v88
    v_perm_b32 v89, v35, v34, s71
    v_accvgpr_write_b32 a213, v89
    v_perm_b32 v90, v37, v36, s71
    v_accvgpr_write_b32 a214, v90
    v_perm_b32 v91, v39, v38, s71
    v_accvgpr_write_b32 a215, v91
    v_perm_b32 v92, v33, v32, s72
    v_accvgpr_write_b32 a220, v92
    v_perm_b32 v93, v35, v34, s72
    v_accvgpr_write_b32 a221, v93
    v_perm_b32 v94, v37, v36, s72
    v_accvgpr_write_b32 a222, v94
    v_perm_b32 v95, v39, v38, s72
    v_accvgpr_write_b32 a223, v95
    s_mov_b32 s3, 0x380000
    buffer_load_dword v32, v22, s[40:43], s3 offen
    s_mov_b32 s3, 0x382000
    buffer_load_dword v33, v22, s[40:43], s3 offen
    s_mov_b32 s3, 0x390000
    buffer_load_dword v34, v22, s[40:43], s3 offen
    s_mov_b32 s3, 0x392000
    buffer_load_dword v35, v22, s[40:43], s3 offen
    s_mov_b32 s3, 0x384000
    buffer_load_dword v36, v22, s[40:43], s3 offen
    s_mov_b32 s3, 0x386000
    buffer_load_dword v37, v22, s[40:43], s3 offen
    s_mov_b32 s3, 0x394000
    buffer_load_dword v38, v22, s[40:43], s3 offen
    s_mov_b32 s3, 0x396000
    buffer_load_dword v39, v22, s[40:43], s3 offen
    s_waitcnt vmcnt(48)
    v_perm_b32 v88, v41, v40, s71
    v_accvgpr_write_b32 a48, v88
    v_perm_b32 v89, v43, v42, s71
    v_accvgpr_write_b32 a49, v89
    v_perm_b32 v90, v45, v44, s71
    v_accvgpr_write_b32 a50, v90
    v_perm_b32 v91, v47, v46, s71
    v_accvgpr_write_b32 a51, v91
    v_perm_b32 v92, v41, v40, s72
    v_accvgpr_write_b32 a56, v92
    v_perm_b32 v93, v43, v42, s72
    v_accvgpr_write_b32 a57, v93
    v_perm_b32 v94, v45, v44, s72
    v_accvgpr_write_b32 a58, v94
    v_perm_b32 v95, v47, v46, s72
    v_accvgpr_write_b32 a59, v95
    s_mov_b32 s3, 0x3c0000
    buffer_load_dword v40, v22, s[40:43], s3 offen
    s_mov_b32 s3, 0x3c2000
    buffer_load_dword v41, v22, s[40:43], s3 offen
    s_mov_b32 s3, 0x3d0000
    buffer_load_dword v42, v22, s[40:43], s3 offen
    s_mov_b32 s3, 0x3d2000
    buffer_load_dword v43, v22, s[40:43], s3 offen
    s_mov_b32 s3, 0x3c4000
    buffer_load_dword v44, v22, s[40:43], s3 offen
    s_mov_b32 s3, 0x3c6000
    buffer_load_dword v45, v22, s[40:43], s3 offen
    s_mov_b32 s3, 0x3d4000
    buffer_load_dword v46, v22, s[40:43], s3 offen
    s_mov_b32 s3, 0x3d6000
    buffer_load_dword v47, v22, s[40:43], s3 offen
    s_waitcnt vmcnt(48)
    v_perm_b32 v88, v49, v48, s71
    v_accvgpr_write_b32 a52, v88
    v_perm_b32 v89, v51, v50, s71
    v_accvgpr_write_b32 a53, v89
    v_perm_b32 v90, v53, v52, s71
    v_accvgpr_write_b32 a54, v90
    v_perm_b32 v91, v55, v54, s71
    v_accvgpr_write_b32 a55, v91
    v_perm_b32 v92, v49, v48, s72
    v_accvgpr_write_b32 a60, v92
    v_perm_b32 v93, v51, v50, s72
    v_accvgpr_write_b32 a61, v93
    v_perm_b32 v94, v53, v52, s72
    v_accvgpr_write_b32 a62, v94
    v_perm_b32 v95, v55, v54, s72
    v_accvgpr_write_b32 a63, v95
    s_mov_b32 s3, 0x380000
    buffer_load_dword v48, v22, s[44:47], s3 offen
    s_mov_b32 s3, 0x382000
    buffer_load_dword v49, v22, s[44:47], s3 offen
    s_mov_b32 s3, 0x390000
    buffer_load_dword v50, v22, s[44:47], s3 offen
    s_mov_b32 s3, 0x392000
    buffer_load_dword v51, v22, s[44:47], s3 offen
    s_mov_b32 s3, 0x384000
    buffer_load_dword v52, v22, s[44:47], s3 offen
    s_mov_b32 s3, 0x386000
    buffer_load_dword v53, v22, s[44:47], s3 offen
    s_mov_b32 s3, 0x394000
    buffer_load_dword v54, v22, s[44:47], s3 offen
    s_mov_b32 s3, 0x396000
    buffer_load_dword v55, v22, s[44:47], s3 offen
    s_waitcnt vmcnt(48)
    v_perm_b32 v88, v57, v56, s71
    v_accvgpr_write_b32 a64, v88
    v_perm_b32 v89, v59, v58, s71
    v_accvgpr_write_b32 a65, v89
    v_perm_b32 v90, v61, v60, s71
    v_accvgpr_write_b32 a66, v90
    v_perm_b32 v91, v63, v62, s71
    v_accvgpr_write_b32 a67, v91
    v_perm_b32 v92, v57, v56, s72
    v_perm_b32 v93, v59, v58, s72
    v_perm_b32 v94, v61, v60, s72
    v_perm_b32 v95, v63, v62, s72
    ds_write_b128 v3, v[92:95] offset:4096
    s_mov_b32 s3, 0x3c0000
    buffer_load_dword v56, v22, s[44:47], s3 offen
    s_mov_b32 s3, 0x3c2000
    buffer_load_dword v57, v22, s[44:47], s3 offen
    s_mov_b32 s3, 0x3d0000
    buffer_load_dword v58, v22, s[44:47], s3 offen
    s_mov_b32 s3, 0x3d2000
    buffer_load_dword v59, v22, s[44:47], s3 offen
    s_mov_b32 s3, 0x3c4000
    buffer_load_dword v60, v22, s[44:47], s3 offen
    s_mov_b32 s3, 0x3c6000
    buffer_load_dword v61, v22, s[44:47], s3 offen
    s_mov_b32 s3, 0x3d4000
    buffer_load_dword v62, v22, s[44:47], s3 offen
    s_mov_b32 s3, 0x3d6000
    buffer_load_dword v63, v22, s[44:47], s3 offen
    s_waitcnt vmcnt(48)
    v_perm_b32 v88, v65, v64, s71
    v_accvgpr_write_b32 a68, v88
    v_perm_b32 v89, v67, v66, s71
    v_accvgpr_write_b32 a69, v89
    v_perm_b32 v90, v69, v68, s71
    v_accvgpr_write_b32 a70, v90
    v_perm_b32 v91, v71, v70, s71
    v_accvgpr_write_b32 a71, v91
    v_perm_b32 v92, v65, v64, s72
    v_perm_b32 v93, v67, v66, s72
    v_perm_b32 v94, v69, v68, s72
    v_perm_b32 v95, v71, v70, s72
    ds_write_b128 v3, v[92:95] offset:5120
    s_mov_b32 s3, 0x380000
    buffer_load_dword v64, v22, s[48:51], s3 offen
    s_mov_b32 s3, 0x382000
    buffer_load_dword v65, v22, s[48:51], s3 offen
    s_mov_b32 s3, 0x390000
    buffer_load_dword v66, v22, s[48:51], s3 offen
    s_mov_b32 s3, 0x392000
    buffer_load_dword v67, v22, s[48:51], s3 offen
    s_mov_b32 s3, 0x384000
    buffer_load_dword v68, v22, s[48:51], s3 offen
    s_mov_b32 s3, 0x386000
    buffer_load_dword v69, v22, s[48:51], s3 offen
    s_mov_b32 s3, 0x394000
    buffer_load_dword v70, v22, s[48:51], s3 offen
    s_mov_b32 s3, 0x396000
    buffer_load_dword v71, v22, s[48:51], s3 offen
    s_waitcnt vmcnt(48)
    v_perm_b32 v88, v73, v72, s71
    v_accvgpr_write_b32 a224, v88
    v_perm_b32 v89, v75, v74, s71
    v_accvgpr_write_b32 a225, v89
    v_perm_b32 v90, v77, v76, s71
    v_accvgpr_write_b32 a226, v90
    v_perm_b32 v91, v79, v78, s71
    v_accvgpr_write_b32 a227, v91
    v_perm_b32 v92, v73, v72, s72
    v_accvgpr_write_b32 a232, v92
    v_perm_b32 v93, v75, v74, s72
    v_accvgpr_write_b32 a233, v93
    v_perm_b32 v94, v77, v76, s72
    v_accvgpr_write_b32 a234, v94
    v_perm_b32 v95, v79, v78, s72
    v_accvgpr_write_b32 a235, v95
    s_mov_b32 s3, 0x3c0000
    buffer_load_dword v72, v22, s[48:51], s3 offen
    s_mov_b32 s3, 0x3c2000
    buffer_load_dword v73, v22, s[48:51], s3 offen
    s_mov_b32 s3, 0x3d0000
    buffer_load_dword v74, v22, s[48:51], s3 offen
    s_mov_b32 s3, 0x3d2000
    buffer_load_dword v75, v22, s[48:51], s3 offen
    s_mov_b32 s3, 0x3c4000
    buffer_load_dword v76, v22, s[48:51], s3 offen
    s_mov_b32 s3, 0x3c6000
    buffer_load_dword v77, v22, s[48:51], s3 offen
    s_mov_b32 s3, 0x3d4000
    buffer_load_dword v78, v22, s[48:51], s3 offen
    s_mov_b32 s3, 0x3d6000
    buffer_load_dword v79, v22, s[48:51], s3 offen
    s_waitcnt vmcnt(48)
    v_perm_b32 v88, v81, v80, s71
    v_accvgpr_write_b32 a228, v88
    v_perm_b32 v89, v83, v82, s71
    v_accvgpr_write_b32 a229, v89
    v_perm_b32 v90, v85, v84, s71
    v_accvgpr_write_b32 a230, v90
    v_perm_b32 v91, v87, v86, s71
    v_accvgpr_write_b32 a231, v91
    v_perm_b32 v92, v81, v80, s72
    v_accvgpr_write_b32 a236, v92
    v_perm_b32 v93, v83, v82, s72
    v_accvgpr_write_b32 a237, v93
    v_perm_b32 v94, v85, v84, s72
    v_accvgpr_write_b32 a238, v94
    v_perm_b32 v95, v87, v86, s72
    v_accvgpr_write_b32 a239, v95
    s_waitcnt vmcnt(40)
    v_perm_b32 v88, v33, v32, s71
    v_accvgpr_write_b32 a72, v88
    v_perm_b32 v89, v35, v34, s71
    v_accvgpr_write_b32 a73, v89
    v_perm_b32 v90, v37, v36, s71
    v_accvgpr_write_b32 a74, v90
    v_perm_b32 v91, v39, v38, s71
    v_accvgpr_write_b32 a75, v91
    v_perm_b32 v92, v33, v32, s72
    v_accvgpr_write_b32 a80, v92
    v_perm_b32 v93, v35, v34, s72
    v_accvgpr_write_b32 a81, v93
    v_perm_b32 v94, v37, v36, s72
    v_accvgpr_write_b32 a82, v94
    v_perm_b32 v95, v39, v38, s72
    v_accvgpr_write_b32 a83, v95
    s_waitcnt vmcnt(32)
    v_perm_b32 v88, v41, v40, s71
    v_accvgpr_write_b32 a76, v88
    v_perm_b32 v89, v43, v42, s71
    v_accvgpr_write_b32 a77, v89
    v_perm_b32 v90, v45, v44, s71
    v_accvgpr_write_b32 a78, v90
    v_perm_b32 v91, v47, v46, s71
    v_accvgpr_write_b32 a79, v91
    v_perm_b32 v92, v41, v40, s72
    v_accvgpr_write_b32 a84, v92
    v_perm_b32 v93, v43, v42, s72
    v_accvgpr_write_b32 a85, v93
    v_perm_b32 v94, v45, v44, s72
    v_accvgpr_write_b32 a86, v94
    v_perm_b32 v95, v47, v46, s72
    v_accvgpr_write_b32 a87, v95
    s_waitcnt vmcnt(24)
    v_perm_b32 v88, v49, v48, s71
    v_accvgpr_write_b32 a88, v88
    v_perm_b32 v89, v51, v50, s71
    v_accvgpr_write_b32 a89, v89
    v_perm_b32 v90, v53, v52, s71
    v_accvgpr_write_b32 a90, v90
    v_perm_b32 v91, v55, v54, s71
    v_accvgpr_write_b32 a91, v91
    v_perm_b32 v92, v49, v48, s72
    v_perm_b32 v93, v51, v50, s72
    v_perm_b32 v94, v53, v52, s72
    v_perm_b32 v95, v55, v54, s72
    ds_write_b128 v3, v[92:95] offset:6144
    s_waitcnt vmcnt(16)
    v_perm_b32 v88, v57, v56, s71
    v_accvgpr_write_b32 a92, v88
    v_perm_b32 v89, v59, v58, s71
    v_accvgpr_write_b32 a93, v89
    v_perm_b32 v90, v61, v60, s71
    v_accvgpr_write_b32 a94, v90
    v_perm_b32 v91, v63, v62, s71
    v_accvgpr_write_b32 a95, v91
    v_perm_b32 v92, v57, v56, s72
    v_perm_b32 v93, v59, v58, s72
    v_perm_b32 v94, v61, v60, s72
    v_perm_b32 v95, v63, v62, s72
    ds_write_b128 v3, v[92:95] offset:7168
    s_waitcnt vmcnt(8)
    v_perm_b32 v88, v65, v64, s71
    v_accvgpr_write_b32 a240, v88
    v_perm_b32 v89, v67, v66, s71
    v_accvgpr_write_b32 a241, v89
    v_perm_b32 v90, v69, v68, s71
    v_accvgpr_write_b32 a242, v90
    v_perm_b32 v91, v71, v70, s71
    v_accvgpr_write_b32 a243, v91
    v_perm_b32 v92, v65, v64, s72
    v_accvgpr_write_b32 a248, v92
    v_perm_b32 v93, v67, v66, s72
    v_accvgpr_write_b32 a249, v93
    v_perm_b32 v94, v69, v68, s72
    v_accvgpr_write_b32 a250, v94
    v_perm_b32 v95, v71, v70, s72
    v_accvgpr_write_b32 a251, v95
    s_waitcnt vmcnt(0)
    v_perm_b32 v88, v73, v72, s71
    v_accvgpr_write_b32 a244, v88
    v_perm_b32 v89, v75, v74, s71
    v_accvgpr_write_b32 a245, v89
    v_perm_b32 v90, v77, v76, s71
    v_accvgpr_write_b32 a246, v90
    v_perm_b32 v91, v79, v78, s71
    v_accvgpr_write_b32 a247, v91
    v_perm_b32 v92, v73, v72, s72
    v_accvgpr_write_b32 a252, v92
    v_perm_b32 v93, v75, v74, s72
    v_accvgpr_write_b32 a253, v93
    v_perm_b32 v94, v77, v76, s72
    v_accvgpr_write_b32 a254, v94
    v_perm_b32 v95, v79, v78, s72
    v_accvgpr_write_b32 a255, v95
    s_branch Lcwe_312
Lcwv_311:
    s_mov_b32 s3, 0x0
    buffer_load_dword v32, v22, s[40:43], s3 offen
    s_mov_b32 s3, 0x2000
    buffer_load_dword v33, v22, s[40:43], s3 offen
    s_mov_b32 s3, 0x10000
    buffer_load_dword v34, v22, s[40:43], s3 offen
    s_mov_b32 s3, 0x12000
    buffer_load_dword v35, v22, s[40:43], s3 offen
    s_mov_b32 s3, 0x4000
    buffer_load_dword v36, v22, s[40:43], s3 offen
    s_mov_b32 s3, 0x6000
    buffer_load_dword v37, v22, s[40:43], s3 offen
    s_mov_b32 s3, 0x14000
    buffer_load_dword v38, v22, s[40:43], s3 offen
    s_mov_b32 s3, 0x16000
    buffer_load_dword v39, v22, s[40:43], s3 offen
    s_mov_b32 s3, 0x40000
    buffer_load_dword v40, v22, s[40:43], s3 offen
    s_mov_b32 s3, 0x42000
    buffer_load_dword v41, v22, s[40:43], s3 offen
    s_mov_b32 s3, 0x50000
    buffer_load_dword v42, v22, s[40:43], s3 offen
    s_mov_b32 s3, 0x52000
    buffer_load_dword v43, v22, s[40:43], s3 offen
    s_mov_b32 s3, 0x44000
    buffer_load_dword v44, v22, s[40:43], s3 offen
    s_mov_b32 s3, 0x46000
    buffer_load_dword v45, v22, s[40:43], s3 offen
    s_mov_b32 s3, 0x54000
    buffer_load_dword v46, v22, s[40:43], s3 offen
    s_mov_b32 s3, 0x56000
    buffer_load_dword v47, v22, s[40:43], s3 offen
    s_mov_b32 s3, 0x0
    buffer_load_dword v48, v22, s[44:47], s3 offen
    s_mov_b32 s3, 0x2000
    buffer_load_dword v49, v22, s[44:47], s3 offen
    s_mov_b32 s3, 0x10000
    buffer_load_dword v50, v22, s[44:47], s3 offen
    s_mov_b32 s3, 0x12000
    buffer_load_dword v51, v22, s[44:47], s3 offen
    s_mov_b32 s3, 0x4000
    buffer_load_dword v52, v22, s[44:47], s3 offen
    s_mov_b32 s3, 0x6000
    buffer_load_dword v53, v22, s[44:47], s3 offen
    s_mov_b32 s3, 0x14000
    buffer_load_dword v54, v22, s[44:47], s3 offen
    s_mov_b32 s3, 0x16000
    buffer_load_dword v55, v22, s[44:47], s3 offen
    s_mov_b32 s3, 0x40000
    buffer_load_dword v56, v22, s[44:47], s3 offen
    s_mov_b32 s3, 0x42000
    buffer_load_dword v57, v22, s[44:47], s3 offen
    s_mov_b32 s3, 0x50000
    buffer_load_dword v58, v22, s[44:47], s3 offen
    s_mov_b32 s3, 0x52000
    buffer_load_dword v59, v22, s[44:47], s3 offen
    s_mov_b32 s3, 0x44000
    buffer_load_dword v60, v22, s[44:47], s3 offen
    s_mov_b32 s3, 0x46000
    buffer_load_dword v61, v22, s[44:47], s3 offen
    s_mov_b32 s3, 0x54000
    buffer_load_dword v62, v22, s[44:47], s3 offen
    s_mov_b32 s3, 0x56000
    buffer_load_dword v63, v22, s[44:47], s3 offen
    s_mov_b32 s3, 0x0
    buffer_load_dword v64, v22, s[48:51], s3 offen
    s_mov_b32 s3, 0x2000
    buffer_load_dword v65, v22, s[48:51], s3 offen
    s_mov_b32 s3, 0x10000
    buffer_load_dword v66, v22, s[48:51], s3 offen
    s_mov_b32 s3, 0x12000
    buffer_load_dword v67, v22, s[48:51], s3 offen
    s_mov_b32 s3, 0x4000
    buffer_load_dword v68, v22, s[48:51], s3 offen
    s_mov_b32 s3, 0x6000
    buffer_load_dword v69, v22, s[48:51], s3 offen
    s_mov_b32 s3, 0x14000
    buffer_load_dword v70, v22, s[48:51], s3 offen
    s_mov_b32 s3, 0x16000
    buffer_load_dword v71, v22, s[48:51], s3 offen
    s_mov_b32 s3, 0x40000
    buffer_load_dword v72, v22, s[48:51], s3 offen
    s_mov_b32 s3, 0x42000
    buffer_load_dword v73, v22, s[48:51], s3 offen
    s_mov_b32 s3, 0x50000
    buffer_load_dword v74, v22, s[48:51], s3 offen
    s_mov_b32 s3, 0x52000
    buffer_load_dword v75, v22, s[48:51], s3 offen
    s_mov_b32 s3, 0x44000
    buffer_load_dword v76, v22, s[48:51], s3 offen
    s_mov_b32 s3, 0x46000
    buffer_load_dword v77, v22, s[48:51], s3 offen
    s_mov_b32 s3, 0x54000
    buffer_load_dword v78, v22, s[48:51], s3 offen
    s_mov_b32 s3, 0x56000
    buffer_load_dword v79, v22, s[48:51], s3 offen
    s_mov_b32 s3, 0x80000
    buffer_load_dword v80, v22, s[40:43], s3 offen
    s_mov_b32 s3, 0x82000
    buffer_load_dword v81, v22, s[40:43], s3 offen
    s_mov_b32 s3, 0x90000
    buffer_load_dword v82, v22, s[40:43], s3 offen
    s_mov_b32 s3, 0x92000
    buffer_load_dword v83, v22, s[40:43], s3 offen
    s_mov_b32 s3, 0x84000
    buffer_load_dword v84, v22, s[40:43], s3 offen
    s_mov_b32 s3, 0x86000
    buffer_load_dword v85, v22, s[40:43], s3 offen
    s_mov_b32 s3, 0x94000
    buffer_load_dword v86, v22, s[40:43], s3 offen
    s_mov_b32 s3, 0x96000
    buffer_load_dword v87, v22, s[40:43], s3 offen
    s_waitcnt vmcnt(48)
    v_perm_b32 v88, v33, v32, s71
    v_accvgpr_write_b32 a48, v88
    v_perm_b32 v89, v35, v34, s71
    v_accvgpr_write_b32 a49, v89
    v_perm_b32 v90, v37, v36, s71
    v_accvgpr_write_b32 a50, v90
    v_perm_b32 v91, v39, v38, s71
    v_accvgpr_write_b32 a51, v91
    v_perm_b32 v92, v33, v32, s72
    v_accvgpr_write_b32 a56, v92
    v_perm_b32 v93, v35, v34, s72
    v_accvgpr_write_b32 a57, v93
    v_perm_b32 v94, v37, v36, s72
    v_accvgpr_write_b32 a58, v94
    v_perm_b32 v95, v39, v38, s72
    v_accvgpr_write_b32 a59, v95
    s_mov_b32 s3, 0xc0000
    buffer_load_dword v32, v22, s[40:43], s3 offen
    s_mov_b32 s3, 0xc2000
    buffer_load_dword v33, v22, s[40:43], s3 offen
    s_mov_b32 s3, 0xd0000
    buffer_load_dword v34, v22, s[40:43], s3 offen
    s_mov_b32 s3, 0xd2000
    buffer_load_dword v35, v22, s[40:43], s3 offen
    s_mov_b32 s3, 0xc4000
    buffer_load_dword v36, v22, s[40:43], s3 offen
    s_mov_b32 s3, 0xc6000
    buffer_load_dword v37, v22, s[40:43], s3 offen
    s_mov_b32 s3, 0xd4000
    buffer_load_dword v38, v22, s[40:43], s3 offen
    s_mov_b32 s3, 0xd6000
    buffer_load_dword v39, v22, s[40:43], s3 offen
    s_waitcnt vmcnt(48)
    v_perm_b32 v88, v41, v40, s71
    v_accvgpr_write_b32 a52, v88
    v_perm_b32 v89, v43, v42, s71
    v_accvgpr_write_b32 a53, v89
    v_perm_b32 v90, v45, v44, s71
    v_accvgpr_write_b32 a54, v90
    v_perm_b32 v91, v47, v46, s71
    v_accvgpr_write_b32 a55, v91
    v_perm_b32 v92, v41, v40, s72
    v_accvgpr_write_b32 a60, v92
    v_perm_b32 v93, v43, v42, s72
    v_accvgpr_write_b32 a61, v93
    v_perm_b32 v94, v45, v44, s72
    v_accvgpr_write_b32 a62, v94
    v_perm_b32 v95, v47, v46, s72
    v_accvgpr_write_b32 a63, v95
    s_mov_b32 s3, 0x80000
    buffer_load_dword v40, v22, s[44:47], s3 offen
    s_mov_b32 s3, 0x82000
    buffer_load_dword v41, v22, s[44:47], s3 offen
    s_mov_b32 s3, 0x90000
    buffer_load_dword v42, v22, s[44:47], s3 offen
    s_mov_b32 s3, 0x92000
    buffer_load_dword v43, v22, s[44:47], s3 offen
    s_mov_b32 s3, 0x84000
    buffer_load_dword v44, v22, s[44:47], s3 offen
    s_mov_b32 s3, 0x86000
    buffer_load_dword v45, v22, s[44:47], s3 offen
    s_mov_b32 s3, 0x94000
    buffer_load_dword v46, v22, s[44:47], s3 offen
    s_mov_b32 s3, 0x96000
    buffer_load_dword v47, v22, s[44:47], s3 offen
    s_waitcnt vmcnt(48)
    v_perm_b32 v88, v49, v48, s71
    v_accvgpr_write_b32 a64, v88
    v_perm_b32 v89, v51, v50, s71
    v_accvgpr_write_b32 a65, v89
    v_perm_b32 v90, v53, v52, s71
    v_accvgpr_write_b32 a66, v90
    v_perm_b32 v91, v55, v54, s71
    v_accvgpr_write_b32 a67, v91
    v_perm_b32 v92, v49, v48, s72
    v_perm_b32 v93, v51, v50, s72
    v_perm_b32 v94, v53, v52, s72
    v_perm_b32 v95, v55, v54, s72
    ds_write_b128 v3, v[92:95] offset:4096
    s_mov_b32 s3, 0xc0000
    buffer_load_dword v48, v22, s[44:47], s3 offen
    s_mov_b32 s3, 0xc2000
    buffer_load_dword v49, v22, s[44:47], s3 offen
    s_mov_b32 s3, 0xd0000
    buffer_load_dword v50, v22, s[44:47], s3 offen
    s_mov_b32 s3, 0xd2000
    buffer_load_dword v51, v22, s[44:47], s3 offen
    s_mov_b32 s3, 0xc4000
    buffer_load_dword v52, v22, s[44:47], s3 offen
    s_mov_b32 s3, 0xc6000
    buffer_load_dword v53, v22, s[44:47], s3 offen
    s_mov_b32 s3, 0xd4000
    buffer_load_dword v54, v22, s[44:47], s3 offen
    s_mov_b32 s3, 0xd6000
    buffer_load_dword v55, v22, s[44:47], s3 offen
    s_waitcnt vmcnt(48)
    v_perm_b32 v88, v57, v56, s71
    v_accvgpr_write_b32 a68, v88
    v_perm_b32 v89, v59, v58, s71
    v_accvgpr_write_b32 a69, v89
    v_perm_b32 v90, v61, v60, s71
    v_accvgpr_write_b32 a70, v90
    v_perm_b32 v91, v63, v62, s71
    v_accvgpr_write_b32 a71, v91
    v_perm_b32 v92, v57, v56, s72
    v_perm_b32 v93, v59, v58, s72
    v_perm_b32 v94, v61, v60, s72
    v_perm_b32 v95, v63, v62, s72
    ds_write_b128 v3, v[92:95] offset:5120
    s_mov_b32 s3, 0x80000
    buffer_load_dword v56, v22, s[48:51], s3 offen
    s_mov_b32 s3, 0x82000
    buffer_load_dword v57, v22, s[48:51], s3 offen
    s_mov_b32 s3, 0x90000
    buffer_load_dword v58, v22, s[48:51], s3 offen
    s_mov_b32 s3, 0x92000
    buffer_load_dword v59, v22, s[48:51], s3 offen
    s_mov_b32 s3, 0x84000
    buffer_load_dword v60, v22, s[48:51], s3 offen
    s_mov_b32 s3, 0x86000
    buffer_load_dword v61, v22, s[48:51], s3 offen
    s_mov_b32 s3, 0x94000
    buffer_load_dword v62, v22, s[48:51], s3 offen
    s_mov_b32 s3, 0x96000
    buffer_load_dword v63, v22, s[48:51], s3 offen
    s_waitcnt vmcnt(48)
    v_perm_b32 v88, v65, v64, s71
    v_accvgpr_write_b32 a224, v88
    v_perm_b32 v89, v67, v66, s71
    v_accvgpr_write_b32 a225, v89
    v_perm_b32 v90, v69, v68, s71
    v_accvgpr_write_b32 a226, v90
    v_perm_b32 v91, v71, v70, s71
    v_accvgpr_write_b32 a227, v91
    v_perm_b32 v92, v65, v64, s72
    v_accvgpr_write_b32 a232, v92
    v_perm_b32 v93, v67, v66, s72
    v_accvgpr_write_b32 a233, v93
    v_perm_b32 v94, v69, v68, s72
    v_accvgpr_write_b32 a234, v94
    v_perm_b32 v95, v71, v70, s72
    v_accvgpr_write_b32 a235, v95
    s_mov_b32 s3, 0xc0000
    buffer_load_dword v64, v22, s[48:51], s3 offen
    s_mov_b32 s3, 0xc2000
    buffer_load_dword v65, v22, s[48:51], s3 offen
    s_mov_b32 s3, 0xd0000
    buffer_load_dword v66, v22, s[48:51], s3 offen
    s_mov_b32 s3, 0xd2000
    buffer_load_dword v67, v22, s[48:51], s3 offen
    s_mov_b32 s3, 0xc4000
    buffer_load_dword v68, v22, s[48:51], s3 offen
    s_mov_b32 s3, 0xc6000
    buffer_load_dword v69, v22, s[48:51], s3 offen
    s_mov_b32 s3, 0xd4000
    buffer_load_dword v70, v22, s[48:51], s3 offen
    s_mov_b32 s3, 0xd6000
    buffer_load_dword v71, v22, s[48:51], s3 offen
    s_waitcnt vmcnt(48)
    v_perm_b32 v88, v73, v72, s71
    v_accvgpr_write_b32 a228, v88
    v_perm_b32 v89, v75, v74, s71
    v_accvgpr_write_b32 a229, v89
    v_perm_b32 v90, v77, v76, s71
    v_accvgpr_write_b32 a230, v90
    v_perm_b32 v91, v79, v78, s71
    v_accvgpr_write_b32 a231, v91
    v_perm_b32 v92, v73, v72, s72
    v_accvgpr_write_b32 a236, v92
    v_perm_b32 v93, v75, v74, s72
    v_accvgpr_write_b32 a237, v93
    v_perm_b32 v94, v77, v76, s72
    v_accvgpr_write_b32 a238, v94
    v_perm_b32 v95, v79, v78, s72
    v_accvgpr_write_b32 a239, v95
    s_mov_b32 s3, 0x100000
    buffer_load_dword v72, v22, s[40:43], s3 offen
    s_mov_b32 s3, 0x102000
    buffer_load_dword v73, v22, s[40:43], s3 offen
    s_mov_b32 s3, 0x110000
    buffer_load_dword v74, v22, s[40:43], s3 offen
    s_mov_b32 s3, 0x112000
    buffer_load_dword v75, v22, s[40:43], s3 offen
    s_mov_b32 s3, 0x104000
    buffer_load_dword v76, v22, s[40:43], s3 offen
    s_mov_b32 s3, 0x106000
    buffer_load_dword v77, v22, s[40:43], s3 offen
    s_mov_b32 s3, 0x114000
    buffer_load_dword v78, v22, s[40:43], s3 offen
    s_mov_b32 s3, 0x116000
    buffer_load_dword v79, v22, s[40:43], s3 offen
    s_waitcnt vmcnt(48)
    v_perm_b32 v88, v81, v80, s71
    v_accvgpr_write_b32 a72, v88
    v_perm_b32 v89, v83, v82, s71
    v_accvgpr_write_b32 a73, v89
    v_perm_b32 v90, v85, v84, s71
    v_accvgpr_write_b32 a74, v90
    v_perm_b32 v91, v87, v86, s71
    v_accvgpr_write_b32 a75, v91
    v_perm_b32 v92, v81, v80, s72
    v_accvgpr_write_b32 a80, v92
    v_perm_b32 v93, v83, v82, s72
    v_accvgpr_write_b32 a81, v93
    v_perm_b32 v94, v85, v84, s72
    v_accvgpr_write_b32 a82, v94
    v_perm_b32 v95, v87, v86, s72
    v_accvgpr_write_b32 a83, v95
    s_mov_b32 s3, 0x140000
    buffer_load_dword v80, v22, s[40:43], s3 offen
    s_mov_b32 s3, 0x142000
    buffer_load_dword v81, v22, s[40:43], s3 offen
    s_mov_b32 s3, 0x150000
    buffer_load_dword v82, v22, s[40:43], s3 offen
    s_mov_b32 s3, 0x152000
    buffer_load_dword v83, v22, s[40:43], s3 offen
    s_mov_b32 s3, 0x144000
    buffer_load_dword v84, v22, s[40:43], s3 offen
    s_mov_b32 s3, 0x146000
    buffer_load_dword v85, v22, s[40:43], s3 offen
    s_mov_b32 s3, 0x154000
    buffer_load_dword v86, v22, s[40:43], s3 offen
    s_mov_b32 s3, 0x156000
    buffer_load_dword v87, v22, s[40:43], s3 offen
    s_waitcnt vmcnt(48)
    v_perm_b32 v88, v33, v32, s71
    v_accvgpr_write_b32 a76, v88
    v_perm_b32 v89, v35, v34, s71
    v_accvgpr_write_b32 a77, v89
    v_perm_b32 v90, v37, v36, s71
    v_accvgpr_write_b32 a78, v90
    v_perm_b32 v91, v39, v38, s71
    v_accvgpr_write_b32 a79, v91
    v_perm_b32 v92, v33, v32, s72
    v_accvgpr_write_b32 a84, v92
    v_perm_b32 v93, v35, v34, s72
    v_accvgpr_write_b32 a85, v93
    v_perm_b32 v94, v37, v36, s72
    v_accvgpr_write_b32 a86, v94
    v_perm_b32 v95, v39, v38, s72
    v_accvgpr_write_b32 a87, v95
    s_mov_b32 s3, 0x100000
    buffer_load_dword v32, v22, s[44:47], s3 offen
    s_mov_b32 s3, 0x102000
    buffer_load_dword v33, v22, s[44:47], s3 offen
    s_mov_b32 s3, 0x110000
    buffer_load_dword v34, v22, s[44:47], s3 offen
    s_mov_b32 s3, 0x112000
    buffer_load_dword v35, v22, s[44:47], s3 offen
    s_mov_b32 s3, 0x104000
    buffer_load_dword v36, v22, s[44:47], s3 offen
    s_mov_b32 s3, 0x106000
    buffer_load_dword v37, v22, s[44:47], s3 offen
    s_mov_b32 s3, 0x114000
    buffer_load_dword v38, v22, s[44:47], s3 offen
    s_mov_b32 s3, 0x116000
    buffer_load_dword v39, v22, s[44:47], s3 offen
    s_waitcnt vmcnt(48)
    v_perm_b32 v88, v41, v40, s71
    v_accvgpr_write_b32 a88, v88
    v_perm_b32 v89, v43, v42, s71
    v_accvgpr_write_b32 a89, v89
    v_perm_b32 v90, v45, v44, s71
    v_accvgpr_write_b32 a90, v90
    v_perm_b32 v91, v47, v46, s71
    v_accvgpr_write_b32 a91, v91
    v_perm_b32 v92, v41, v40, s72
    v_perm_b32 v93, v43, v42, s72
    v_perm_b32 v94, v45, v44, s72
    v_perm_b32 v95, v47, v46, s72
    ds_write_b128 v3, v[92:95] offset:6144
    s_mov_b32 s3, 0x140000
    buffer_load_dword v40, v22, s[44:47], s3 offen
    s_mov_b32 s3, 0x142000
    buffer_load_dword v41, v22, s[44:47], s3 offen
    s_mov_b32 s3, 0x150000
    buffer_load_dword v42, v22, s[44:47], s3 offen
    s_mov_b32 s3, 0x152000
    buffer_load_dword v43, v22, s[44:47], s3 offen
    s_mov_b32 s3, 0x144000
    buffer_load_dword v44, v22, s[44:47], s3 offen
    s_mov_b32 s3, 0x146000
    buffer_load_dword v45, v22, s[44:47], s3 offen
    s_mov_b32 s3, 0x154000
    buffer_load_dword v46, v22, s[44:47], s3 offen
    s_mov_b32 s3, 0x156000
    buffer_load_dword v47, v22, s[44:47], s3 offen
    s_waitcnt vmcnt(48)
    v_perm_b32 v88, v49, v48, s71
    v_accvgpr_write_b32 a92, v88
    v_perm_b32 v89, v51, v50, s71
    v_accvgpr_write_b32 a93, v89
    v_perm_b32 v90, v53, v52, s71
    v_accvgpr_write_b32 a94, v90
    v_perm_b32 v91, v55, v54, s71
    v_accvgpr_write_b32 a95, v91
    v_perm_b32 v92, v49, v48, s72
    v_perm_b32 v93, v51, v50, s72
    v_perm_b32 v94, v53, v52, s72
    v_perm_b32 v95, v55, v54, s72
    ds_write_b128 v3, v[92:95] offset:7168
    s_mov_b32 s3, 0x100000
    buffer_load_dword v48, v22, s[48:51], s3 offen
    s_mov_b32 s3, 0x102000
    buffer_load_dword v49, v22, s[48:51], s3 offen
    s_mov_b32 s3, 0x110000
    buffer_load_dword v50, v22, s[48:51], s3 offen
    s_mov_b32 s3, 0x112000
    buffer_load_dword v51, v22, s[48:51], s3 offen
    s_mov_b32 s3, 0x104000
    buffer_load_dword v52, v22, s[48:51], s3 offen
    s_mov_b32 s3, 0x106000
    buffer_load_dword v53, v22, s[48:51], s3 offen
    s_mov_b32 s3, 0x114000
    buffer_load_dword v54, v22, s[48:51], s3 offen
    s_mov_b32 s3, 0x116000
    buffer_load_dword v55, v22, s[48:51], s3 offen
    s_waitcnt vmcnt(48)
    v_perm_b32 v88, v57, v56, s71
    v_accvgpr_write_b32 a240, v88
    v_perm_b32 v89, v59, v58, s71
    v_accvgpr_write_b32 a241, v89
    v_perm_b32 v90, v61, v60, s71
    v_accvgpr_write_b32 a242, v90
    v_perm_b32 v91, v63, v62, s71
    v_accvgpr_write_b32 a243, v91
    v_perm_b32 v92, v57, v56, s72
    v_accvgpr_write_b32 a248, v92
    v_perm_b32 v93, v59, v58, s72
    v_accvgpr_write_b32 a249, v93
    v_perm_b32 v94, v61, v60, s72
    v_accvgpr_write_b32 a250, v94
    v_perm_b32 v95, v63, v62, s72
    v_accvgpr_write_b32 a251, v95
    s_mov_b32 s3, 0x140000
    buffer_load_dword v56, v22, s[48:51], s3 offen
    s_mov_b32 s3, 0x142000
    buffer_load_dword v57, v22, s[48:51], s3 offen
    s_mov_b32 s3, 0x150000
    buffer_load_dword v58, v22, s[48:51], s3 offen
    s_mov_b32 s3, 0x152000
    buffer_load_dword v59, v22, s[48:51], s3 offen
    s_mov_b32 s3, 0x144000
    buffer_load_dword v60, v22, s[48:51], s3 offen
    s_mov_b32 s3, 0x146000
    buffer_load_dword v61, v22, s[48:51], s3 offen
    s_mov_b32 s3, 0x154000
    buffer_load_dword v62, v22, s[48:51], s3 offen
    s_mov_b32 s3, 0x156000
    buffer_load_dword v63, v22, s[48:51], s3 offen
    s_waitcnt vmcnt(48)
    v_perm_b32 v88, v65, v64, s71
    v_accvgpr_write_b32 a244, v88
    v_perm_b32 v89, v67, v66, s71
    v_accvgpr_write_b32 a245, v89
    v_perm_b32 v90, v69, v68, s71
    v_accvgpr_write_b32 a246, v90
    v_perm_b32 v91, v71, v70, s71
    v_accvgpr_write_b32 a247, v91
    v_perm_b32 v92, v65, v64, s72
    v_accvgpr_write_b32 a252, v92
    v_perm_b32 v93, v67, v66, s72
    v_accvgpr_write_b32 a253, v93
    v_perm_b32 v94, v69, v68, s72
    v_accvgpr_write_b32 a254, v94
    v_perm_b32 v95, v71, v70, s72
    v_accvgpr_write_b32 a255, v95
    s_mov_b32 s3, 0x180000
    buffer_load_dword v64, v22, s[40:43], s3 offen
    s_mov_b32 s3, 0x182000
    buffer_load_dword v65, v22, s[40:43], s3 offen
    s_mov_b32 s3, 0x190000
    buffer_load_dword v66, v22, s[40:43], s3 offen
    s_mov_b32 s3, 0x192000
    buffer_load_dword v67, v22, s[40:43], s3 offen
    s_mov_b32 s3, 0x184000
    buffer_load_dword v68, v22, s[40:43], s3 offen
    s_mov_b32 s3, 0x186000
    buffer_load_dword v69, v22, s[40:43], s3 offen
    s_mov_b32 s3, 0x194000
    buffer_load_dword v70, v22, s[40:43], s3 offen
    s_mov_b32 s3, 0x196000
    buffer_load_dword v71, v22, s[40:43], s3 offen
    s_waitcnt vmcnt(48)
    v_perm_b32 v88, v73, v72, s71
    v_accvgpr_write_b32 a96, v88
    v_perm_b32 v89, v75, v74, s71
    v_accvgpr_write_b32 a97, v89
    v_perm_b32 v90, v77, v76, s71
    v_accvgpr_write_b32 a98, v90
    v_perm_b32 v91, v79, v78, s71
    v_accvgpr_write_b32 a99, v91
    v_perm_b32 v92, v73, v72, s72
    v_accvgpr_write_b32 a104, v92
    v_perm_b32 v93, v75, v74, s72
    v_accvgpr_write_b32 a105, v93
    v_perm_b32 v94, v77, v76, s72
    v_accvgpr_write_b32 a106, v94
    v_perm_b32 v95, v79, v78, s72
    v_accvgpr_write_b32 a107, v95
    s_mov_b32 s3, 0x1c0000
    buffer_load_dword v72, v22, s[40:43], s3 offen
    s_mov_b32 s3, 0x1c2000
    buffer_load_dword v73, v22, s[40:43], s3 offen
    s_mov_b32 s3, 0x1d0000
    buffer_load_dword v74, v22, s[40:43], s3 offen
    s_mov_b32 s3, 0x1d2000
    buffer_load_dword v75, v22, s[40:43], s3 offen
    s_mov_b32 s3, 0x1c4000
    buffer_load_dword v76, v22, s[40:43], s3 offen
    s_mov_b32 s3, 0x1c6000
    buffer_load_dword v77, v22, s[40:43], s3 offen
    s_mov_b32 s3, 0x1d4000
    buffer_load_dword v78, v22, s[40:43], s3 offen
    s_mov_b32 s3, 0x1d6000
    buffer_load_dword v79, v22, s[40:43], s3 offen
    s_waitcnt vmcnt(48)
    v_perm_b32 v88, v81, v80, s71
    v_accvgpr_write_b32 a100, v88
    v_perm_b32 v89, v83, v82, s71
    v_accvgpr_write_b32 a101, v89
    v_perm_b32 v90, v85, v84, s71
    v_accvgpr_write_b32 a102, v90
    v_perm_b32 v91, v87, v86, s71
    v_accvgpr_write_b32 a103, v91
    v_perm_b32 v92, v81, v80, s72
    v_accvgpr_write_b32 a108, v92
    v_perm_b32 v93, v83, v82, s72
    v_accvgpr_write_b32 a109, v93
    v_perm_b32 v94, v85, v84, s72
    v_accvgpr_write_b32 a110, v94
    v_perm_b32 v95, v87, v86, s72
    v_accvgpr_write_b32 a111, v95
    s_mov_b32 s3, 0x180000
    buffer_load_dword v80, v22, s[44:47], s3 offen
    s_mov_b32 s3, 0x182000
    buffer_load_dword v81, v22, s[44:47], s3 offen
    s_mov_b32 s3, 0x190000
    buffer_load_dword v82, v22, s[44:47], s3 offen
    s_mov_b32 s3, 0x192000
    buffer_load_dword v83, v22, s[44:47], s3 offen
    s_mov_b32 s3, 0x184000
    buffer_load_dword v84, v22, s[44:47], s3 offen
    s_mov_b32 s3, 0x186000
    buffer_load_dword v85, v22, s[44:47], s3 offen
    s_mov_b32 s3, 0x194000
    buffer_load_dword v86, v22, s[44:47], s3 offen
    s_mov_b32 s3, 0x196000
    buffer_load_dword v87, v22, s[44:47], s3 offen
    s_waitcnt vmcnt(48)
    v_perm_b32 v88, v33, v32, s71
    v_accvgpr_write_b32 a112, v88
    v_perm_b32 v89, v35, v34, s71
    v_accvgpr_write_b32 a113, v89
    v_perm_b32 v90, v37, v36, s71
    v_accvgpr_write_b32 a114, v90
    v_perm_b32 v91, v39, v38, s71
    v_accvgpr_write_b32 a115, v91
    v_perm_b32 v92, v33, v32, s72
    v_perm_b32 v93, v35, v34, s72
    v_perm_b32 v94, v37, v36, s72
    v_perm_b32 v95, v39, v38, s72
    ds_write_b128 v3, v[92:95] offset:8192
    s_mov_b32 s3, 0x1c0000
    buffer_load_dword v32, v22, s[44:47], s3 offen
    s_mov_b32 s3, 0x1c2000
    buffer_load_dword v33, v22, s[44:47], s3 offen
    s_mov_b32 s3, 0x1d0000
    buffer_load_dword v34, v22, s[44:47], s3 offen
    s_mov_b32 s3, 0x1d2000
    buffer_load_dword v35, v22, s[44:47], s3 offen
    s_mov_b32 s3, 0x1c4000
    buffer_load_dword v36, v22, s[44:47], s3 offen
    s_mov_b32 s3, 0x1c6000
    buffer_load_dword v37, v22, s[44:47], s3 offen
    s_mov_b32 s3, 0x1d4000
    buffer_load_dword v38, v22, s[44:47], s3 offen
    s_mov_b32 s3, 0x1d6000
    buffer_load_dword v39, v22, s[44:47], s3 offen
    s_waitcnt vmcnt(48)
    v_perm_b32 v88, v41, v40, s71
    v_accvgpr_write_b32 a116, v88
    v_perm_b32 v89, v43, v42, s71
    v_accvgpr_write_b32 a117, v89
    v_perm_b32 v90, v45, v44, s71
    v_accvgpr_write_b32 a118, v90
    v_perm_b32 v91, v47, v46, s71
    v_accvgpr_write_b32 a119, v91
    v_perm_b32 v92, v41, v40, s72
    v_perm_b32 v93, v43, v42, s72
    v_perm_b32 v94, v45, v44, s72
    v_perm_b32 v95, v47, v46, s72
    ds_write_b128 v3, v[92:95] offset:9216
    s_mov_b32 s3, 0x180000
    buffer_load_dword v40, v22, s[48:51], s3 offen
    s_mov_b32 s3, 0x182000
    buffer_load_dword v41, v22, s[48:51], s3 offen
    s_mov_b32 s3, 0x190000
    buffer_load_dword v42, v22, s[48:51], s3 offen
    s_mov_b32 s3, 0x192000
    buffer_load_dword v43, v22, s[48:51], s3 offen
    s_mov_b32 s3, 0x184000
    buffer_load_dword v44, v22, s[48:51], s3 offen
    s_mov_b32 s3, 0x186000
    buffer_load_dword v45, v22, s[48:51], s3 offen
    s_mov_b32 s3, 0x194000
    buffer_load_dword v46, v22, s[48:51], s3 offen
    s_mov_b32 s3, 0x196000
    buffer_load_dword v47, v22, s[48:51], s3 offen
    s_waitcnt vmcnt(48)
    v_perm_b32 v88, v49, v48, s71
    v_perm_b32 v89, v51, v50, s71
    v_perm_b32 v90, v53, v52, s71
    v_perm_b32 v91, v55, v54, s71
    ds_write_b128 v3, v[88:91] offset:16384
    v_perm_b32 v92, v49, v48, s72
    v_perm_b32 v93, v51, v50, s72
    v_perm_b32 v94, v53, v52, s72
    v_perm_b32 v95, v55, v54, s72
    ds_write_b128 v3, v[92:95] offset:18432
    s_mov_b32 s3, 0x1c0000
    buffer_load_dword v48, v22, s[48:51], s3 offen
    s_mov_b32 s3, 0x1c2000
    buffer_load_dword v49, v22, s[48:51], s3 offen
    s_mov_b32 s3, 0x1d0000
    buffer_load_dword v50, v22, s[48:51], s3 offen
    s_mov_b32 s3, 0x1d2000
    buffer_load_dword v51, v22, s[48:51], s3 offen
    s_mov_b32 s3, 0x1c4000
    buffer_load_dword v52, v22, s[48:51], s3 offen
    s_mov_b32 s3, 0x1c6000
    buffer_load_dword v53, v22, s[48:51], s3 offen
    s_mov_b32 s3, 0x1d4000
    buffer_load_dword v54, v22, s[48:51], s3 offen
    s_mov_b32 s3, 0x1d6000
    buffer_load_dword v55, v22, s[48:51], s3 offen
    s_waitcnt vmcnt(48)
    v_perm_b32 v88, v57, v56, s71
    v_perm_b32 v89, v59, v58, s71
    v_perm_b32 v90, v61, v60, s71
    v_perm_b32 v91, v63, v62, s71
    ds_write_b128 v3, v[88:91] offset:17408
    v_perm_b32 v92, v57, v56, s72
    v_perm_b32 v93, v59, v58, s72
    v_perm_b32 v94, v61, v60, s72
    v_perm_b32 v95, v63, v62, s72
    ds_write_b128 v3, v[92:95] offset:19456
    s_mov_b32 s3, 0x200000
    buffer_load_dword v56, v22, s[40:43], s3 offen
    s_mov_b32 s3, 0x202000
    buffer_load_dword v57, v22, s[40:43], s3 offen
    s_mov_b32 s3, 0x210000
    buffer_load_dword v58, v22, s[40:43], s3 offen
    s_mov_b32 s3, 0x212000
    buffer_load_dword v59, v22, s[40:43], s3 offen
    s_mov_b32 s3, 0x204000
    buffer_load_dword v60, v22, s[40:43], s3 offen
    s_mov_b32 s3, 0x206000
    buffer_load_dword v61, v22, s[40:43], s3 offen
    s_mov_b32 s3, 0x214000
    buffer_load_dword v62, v22, s[40:43], s3 offen
    s_mov_b32 s3, 0x216000
    buffer_load_dword v63, v22, s[40:43], s3 offen
    s_waitcnt vmcnt(48)
    v_perm_b32 v88, v65, v64, s71
    v_accvgpr_write_b32 a120, v88
    v_perm_b32 v89, v67, v66, s71
    v_accvgpr_write_b32 a121, v89
    v_perm_b32 v90, v69, v68, s71
    v_accvgpr_write_b32 a122, v90
    v_perm_b32 v91, v71, v70, s71
    v_accvgpr_write_b32 a123, v91
    v_perm_b32 v92, v65, v64, s72
    v_accvgpr_write_b32 a128, v92
    v_perm_b32 v93, v67, v66, s72
    v_accvgpr_write_b32 a129, v93
    v_perm_b32 v94, v69, v68, s72
    v_accvgpr_write_b32 a130, v94
    v_perm_b32 v95, v71, v70, s72
    v_accvgpr_write_b32 a131, v95
    s_mov_b32 s3, 0x240000
    buffer_load_dword v64, v22, s[40:43], s3 offen
    s_mov_b32 s3, 0x242000
    buffer_load_dword v65, v22, s[40:43], s3 offen
    s_mov_b32 s3, 0x250000
    buffer_load_dword v66, v22, s[40:43], s3 offen
    s_mov_b32 s3, 0x252000
    buffer_load_dword v67, v22, s[40:43], s3 offen
    s_mov_b32 s3, 0x244000
    buffer_load_dword v68, v22, s[40:43], s3 offen
    s_mov_b32 s3, 0x246000
    buffer_load_dword v69, v22, s[40:43], s3 offen
    s_mov_b32 s3, 0x254000
    buffer_load_dword v70, v22, s[40:43], s3 offen
    s_mov_b32 s3, 0x256000
    buffer_load_dword v71, v22, s[40:43], s3 offen
    s_waitcnt vmcnt(48)
    v_perm_b32 v88, v73, v72, s71
    v_accvgpr_write_b32 a124, v88
    v_perm_b32 v89, v75, v74, s71
    v_accvgpr_write_b32 a125, v89
    v_perm_b32 v90, v77, v76, s71
    v_accvgpr_write_b32 a126, v90
    v_perm_b32 v91, v79, v78, s71
    v_accvgpr_write_b32 a127, v91
    v_perm_b32 v92, v73, v72, s72
    v_accvgpr_write_b32 a132, v92
    v_perm_b32 v93, v75, v74, s72
    v_accvgpr_write_b32 a133, v93
    v_perm_b32 v94, v77, v76, s72
    v_accvgpr_write_b32 a134, v94
    v_perm_b32 v95, v79, v78, s72
    v_accvgpr_write_b32 a135, v95
    s_mov_b32 s3, 0x200000
    buffer_load_dword v72, v22, s[44:47], s3 offen
    s_mov_b32 s3, 0x202000
    buffer_load_dword v73, v22, s[44:47], s3 offen
    s_mov_b32 s3, 0x210000
    buffer_load_dword v74, v22, s[44:47], s3 offen
    s_mov_b32 s3, 0x212000
    buffer_load_dword v75, v22, s[44:47], s3 offen
    s_mov_b32 s3, 0x204000
    buffer_load_dword v76, v22, s[44:47], s3 offen
    s_mov_b32 s3, 0x206000
    buffer_load_dword v77, v22, s[44:47], s3 offen
    s_mov_b32 s3, 0x214000
    buffer_load_dword v78, v22, s[44:47], s3 offen
    s_mov_b32 s3, 0x216000
    buffer_load_dword v79, v22, s[44:47], s3 offen
    s_waitcnt vmcnt(48)
    v_perm_b32 v88, v81, v80, s71
    v_accvgpr_write_b32 a136, v88
    v_perm_b32 v89, v83, v82, s71
    v_accvgpr_write_b32 a137, v89
    v_perm_b32 v90, v85, v84, s71
    v_accvgpr_write_b32 a138, v90
    v_perm_b32 v91, v87, v86, s71
    v_accvgpr_write_b32 a139, v91
    v_perm_b32 v92, v81, v80, s72
    v_perm_b32 v93, v83, v82, s72
    v_perm_b32 v94, v85, v84, s72
    v_perm_b32 v95, v87, v86, s72
    ds_write_b128 v3, v[92:95] offset:10240
    s_mov_b32 s3, 0x240000
    buffer_load_dword v80, v22, s[44:47], s3 offen
    s_mov_b32 s3, 0x242000
    buffer_load_dword v81, v22, s[44:47], s3 offen
    s_mov_b32 s3, 0x250000
    buffer_load_dword v82, v22, s[44:47], s3 offen
    s_mov_b32 s3, 0x252000
    buffer_load_dword v83, v22, s[44:47], s3 offen
    s_mov_b32 s3, 0x244000
    buffer_load_dword v84, v22, s[44:47], s3 offen
    s_mov_b32 s3, 0x246000
    buffer_load_dword v85, v22, s[44:47], s3 offen
    s_mov_b32 s3, 0x254000
    buffer_load_dword v86, v22, s[44:47], s3 offen
    s_mov_b32 s3, 0x256000
    buffer_load_dword v87, v22, s[44:47], s3 offen
    s_waitcnt vmcnt(48)
    v_perm_b32 v88, v33, v32, s71
    v_accvgpr_write_b32 a140, v88
    v_perm_b32 v89, v35, v34, s71
    v_accvgpr_write_b32 a141, v89
    v_perm_b32 v90, v37, v36, s71
    v_accvgpr_write_b32 a142, v90
    v_perm_b32 v91, v39, v38, s71
    v_accvgpr_write_b32 a143, v91
    v_perm_b32 v92, v33, v32, s72
    v_perm_b32 v93, v35, v34, s72
    v_perm_b32 v94, v37, v36, s72
    v_perm_b32 v95, v39, v38, s72
    ds_write_b128 v3, v[92:95] offset:11264
    s_mov_b32 s3, 0x200000
    buffer_load_dword v32, v22, s[48:51], s3 offen
    s_mov_b32 s3, 0x202000
    buffer_load_dword v33, v22, s[48:51], s3 offen
    s_mov_b32 s3, 0x210000
    buffer_load_dword v34, v22, s[48:51], s3 offen
    s_mov_b32 s3, 0x212000
    buffer_load_dword v35, v22, s[48:51], s3 offen
    s_mov_b32 s3, 0x204000
    buffer_load_dword v36, v22, s[48:51], s3 offen
    s_mov_b32 s3, 0x206000
    buffer_load_dword v37, v22, s[48:51], s3 offen
    s_mov_b32 s3, 0x214000
    buffer_load_dword v38, v22, s[48:51], s3 offen
    s_mov_b32 s3, 0x216000
    buffer_load_dword v39, v22, s[48:51], s3 offen
    s_waitcnt vmcnt(48)
    v_perm_b32 v88, v41, v40, s71
    v_perm_b32 v89, v43, v42, s71
    v_perm_b32 v90, v45, v44, s71
    v_perm_b32 v91, v47, v46, s71
    ds_write_b128 v3, v[88:91] offset:20480
    v_perm_b32 v92, v41, v40, s72
    v_perm_b32 v93, v43, v42, s72
    v_perm_b32 v94, v45, v44, s72
    v_perm_b32 v95, v47, v46, s72
    ds_write_b128 v3, v[92:95] offset:22528
    s_mov_b32 s3, 0x240000
    buffer_load_dword v40, v22, s[48:51], s3 offen
    s_mov_b32 s3, 0x242000
    buffer_load_dword v41, v22, s[48:51], s3 offen
    s_mov_b32 s3, 0x250000
    buffer_load_dword v42, v22, s[48:51], s3 offen
    s_mov_b32 s3, 0x252000
    buffer_load_dword v43, v22, s[48:51], s3 offen
    s_mov_b32 s3, 0x244000
    buffer_load_dword v44, v22, s[48:51], s3 offen
    s_mov_b32 s3, 0x246000
    buffer_load_dword v45, v22, s[48:51], s3 offen
    s_mov_b32 s3, 0x254000
    buffer_load_dword v46, v22, s[48:51], s3 offen
    s_mov_b32 s3, 0x256000
    buffer_load_dword v47, v22, s[48:51], s3 offen
    s_waitcnt vmcnt(48)
    v_perm_b32 v88, v49, v48, s71
    v_perm_b32 v89, v51, v50, s71
    v_perm_b32 v90, v53, v52, s71
    v_perm_b32 v91, v55, v54, s71
    ds_write_b128 v3, v[88:91] offset:21504
    v_perm_b32 v92, v49, v48, s72
    v_perm_b32 v93, v51, v50, s72
    v_perm_b32 v94, v53, v52, s72
    v_perm_b32 v95, v55, v54, s72
    ds_write_b128 v3, v[92:95] offset:23552
    s_mov_b32 s3, 0x280000
    buffer_load_dword v48, v22, s[40:43], s3 offen
    s_mov_b32 s3, 0x282000
    buffer_load_dword v49, v22, s[40:43], s3 offen
    s_mov_b32 s3, 0x290000
    buffer_load_dword v50, v22, s[40:43], s3 offen
    s_mov_b32 s3, 0x292000
    buffer_load_dword v51, v22, s[40:43], s3 offen
    s_mov_b32 s3, 0x284000
    buffer_load_dword v52, v22, s[40:43], s3 offen
    s_mov_b32 s3, 0x286000
    buffer_load_dword v53, v22, s[40:43], s3 offen
    s_mov_b32 s3, 0x294000
    buffer_load_dword v54, v22, s[40:43], s3 offen
    s_mov_b32 s3, 0x296000
    buffer_load_dword v55, v22, s[40:43], s3 offen
    s_waitcnt vmcnt(48)
    v_perm_b32 v88, v57, v56, s71
    v_accvgpr_write_b32 a144, v88
    v_perm_b32 v89, v59, v58, s71
    v_accvgpr_write_b32 a145, v89
    v_perm_b32 v90, v61, v60, s71
    v_accvgpr_write_b32 a146, v90
    v_perm_b32 v91, v63, v62, s71
    v_accvgpr_write_b32 a147, v91
    v_perm_b32 v92, v57, v56, s72
    v_accvgpr_write_b32 a152, v92
    v_perm_b32 v93, v59, v58, s72
    v_accvgpr_write_b32 a153, v93
    v_perm_b32 v94, v61, v60, s72
    v_accvgpr_write_b32 a154, v94
    v_perm_b32 v95, v63, v62, s72
    v_accvgpr_write_b32 a155, v95
    s_mov_b32 s3, 0x2c0000
    buffer_load_dword v56, v22, s[40:43], s3 offen
    s_mov_b32 s3, 0x2c2000
    buffer_load_dword v57, v22, s[40:43], s3 offen
    s_mov_b32 s3, 0x2d0000
    buffer_load_dword v58, v22, s[40:43], s3 offen
    s_mov_b32 s3, 0x2d2000
    buffer_load_dword v59, v22, s[40:43], s3 offen
    s_mov_b32 s3, 0x2c4000
    buffer_load_dword v60, v22, s[40:43], s3 offen
    s_mov_b32 s3, 0x2c6000
    buffer_load_dword v61, v22, s[40:43], s3 offen
    s_mov_b32 s3, 0x2d4000
    buffer_load_dword v62, v22, s[40:43], s3 offen
    s_mov_b32 s3, 0x2d6000
    buffer_load_dword v63, v22, s[40:43], s3 offen
    s_waitcnt vmcnt(48)
    v_perm_b32 v88, v65, v64, s71
    v_accvgpr_write_b32 a148, v88
    v_perm_b32 v89, v67, v66, s71
    v_accvgpr_write_b32 a149, v89
    v_perm_b32 v90, v69, v68, s71
    v_accvgpr_write_b32 a150, v90
    v_perm_b32 v91, v71, v70, s71
    v_accvgpr_write_b32 a151, v91
    v_perm_b32 v92, v65, v64, s72
    v_accvgpr_write_b32 a156, v92
    v_perm_b32 v93, v67, v66, s72
    v_accvgpr_write_b32 a157, v93
    v_perm_b32 v94, v69, v68, s72
    v_accvgpr_write_b32 a158, v94
    v_perm_b32 v95, v71, v70, s72
    v_accvgpr_write_b32 a159, v95
    s_mov_b32 s3, 0x280000
    buffer_load_dword v64, v22, s[44:47], s3 offen
    s_mov_b32 s3, 0x282000
    buffer_load_dword v65, v22, s[44:47], s3 offen
    s_mov_b32 s3, 0x290000
    buffer_load_dword v66, v22, s[44:47], s3 offen
    s_mov_b32 s3, 0x292000
    buffer_load_dword v67, v22, s[44:47], s3 offen
    s_mov_b32 s3, 0x284000
    buffer_load_dword v68, v22, s[44:47], s3 offen
    s_mov_b32 s3, 0x286000
    buffer_load_dword v69, v22, s[44:47], s3 offen
    s_mov_b32 s3, 0x294000
    buffer_load_dword v70, v22, s[44:47], s3 offen
    s_mov_b32 s3, 0x296000
    buffer_load_dword v71, v22, s[44:47], s3 offen
    s_waitcnt vmcnt(48)
    v_perm_b32 v88, v73, v72, s71
    v_accvgpr_write_b32 a160, v88
    v_perm_b32 v89, v75, v74, s71
    v_accvgpr_write_b32 a161, v89
    v_perm_b32 v90, v77, v76, s71
    v_accvgpr_write_b32 a162, v90
    v_perm_b32 v91, v79, v78, s71
    v_accvgpr_write_b32 a163, v91
    v_perm_b32 v92, v73, v72, s72
    v_perm_b32 v93, v75, v74, s72
    v_perm_b32 v94, v77, v76, s72
    v_perm_b32 v95, v79, v78, s72
    ds_write_b128 v3, v[92:95] offset:12288
    s_mov_b32 s3, 0x2c0000
    buffer_load_dword v72, v22, s[44:47], s3 offen
    s_mov_b32 s3, 0x2c2000
    buffer_load_dword v73, v22, s[44:47], s3 offen
    s_mov_b32 s3, 0x2d0000
    buffer_load_dword v74, v22, s[44:47], s3 offen
    s_mov_b32 s3, 0x2d2000
    buffer_load_dword v75, v22, s[44:47], s3 offen
    s_mov_b32 s3, 0x2c4000
    buffer_load_dword v76, v22, s[44:47], s3 offen
    s_mov_b32 s3, 0x2c6000
    buffer_load_dword v77, v22, s[44:47], s3 offen
    s_mov_b32 s3, 0x2d4000
    buffer_load_dword v78, v22, s[44:47], s3 offen
    s_mov_b32 s3, 0x2d6000
    buffer_load_dword v79, v22, s[44:47], s3 offen
    s_waitcnt vmcnt(48)
    v_perm_b32 v88, v81, v80, s71
    v_accvgpr_write_b32 a164, v88
    v_perm_b32 v89, v83, v82, s71
    v_accvgpr_write_b32 a165, v89
    v_perm_b32 v90, v85, v84, s71
    v_accvgpr_write_b32 a166, v90
    v_perm_b32 v91, v87, v86, s71
    v_accvgpr_write_b32 a167, v91
    v_perm_b32 v92, v81, v80, s72
    v_perm_b32 v93, v83, v82, s72
    v_perm_b32 v94, v85, v84, s72
    v_perm_b32 v95, v87, v86, s72
    ds_write_b128 v3, v[92:95] offset:13312
    s_mov_b32 s3, 0x280000
    buffer_load_dword v80, v22, s[48:51], s3 offen
    s_mov_b32 s3, 0x282000
    buffer_load_dword v81, v22, s[48:51], s3 offen
    s_mov_b32 s3, 0x290000
    buffer_load_dword v82, v22, s[48:51], s3 offen
    s_mov_b32 s3, 0x292000
    buffer_load_dword v83, v22, s[48:51], s3 offen
    s_mov_b32 s3, 0x284000
    buffer_load_dword v84, v22, s[48:51], s3 offen
    s_mov_b32 s3, 0x286000
    buffer_load_dword v85, v22, s[48:51], s3 offen
    s_mov_b32 s3, 0x294000
    buffer_load_dword v86, v22, s[48:51], s3 offen
    s_mov_b32 s3, 0x296000
    buffer_load_dword v87, v22, s[48:51], s3 offen
    s_waitcnt vmcnt(48)
    v_perm_b32 v88, v33, v32, s71
    v_perm_b32 v89, v35, v34, s71
    v_perm_b32 v90, v37, v36, s71
    v_perm_b32 v91, v39, v38, s71
    ds_write_b128 v3, v[88:91] offset:24576
    v_perm_b32 v92, v33, v32, s72
    v_perm_b32 v93, v35, v34, s72
    v_perm_b32 v94, v37, v36, s72
    v_perm_b32 v95, v39, v38, s72
    ds_write_b128 v3, v[92:95] offset:26624
    s_mov_b32 s3, 0x2c0000
    buffer_load_dword v32, v22, s[48:51], s3 offen
    s_mov_b32 s3, 0x2c2000
    buffer_load_dword v33, v22, s[48:51], s3 offen
    s_mov_b32 s3, 0x2d0000
    buffer_load_dword v34, v22, s[48:51], s3 offen
    s_mov_b32 s3, 0x2d2000
    buffer_load_dword v35, v22, s[48:51], s3 offen
    s_mov_b32 s3, 0x2c4000
    buffer_load_dword v36, v22, s[48:51], s3 offen
    s_mov_b32 s3, 0x2c6000
    buffer_load_dword v37, v22, s[48:51], s3 offen
    s_mov_b32 s3, 0x2d4000
    buffer_load_dword v38, v22, s[48:51], s3 offen
    s_mov_b32 s3, 0x2d6000
    buffer_load_dword v39, v22, s[48:51], s3 offen
    s_waitcnt vmcnt(48)
    v_perm_b32 v88, v41, v40, s71
    v_perm_b32 v89, v43, v42, s71
    v_perm_b32 v90, v45, v44, s71
    v_perm_b32 v91, v47, v46, s71
    ds_write_b128 v3, v[88:91] offset:25600
    v_perm_b32 v92, v41, v40, s72
    v_perm_b32 v93, v43, v42, s72
    v_perm_b32 v94, v45, v44, s72
    v_perm_b32 v95, v47, v46, s72
    ds_write_b128 v3, v[92:95] offset:27648
    s_mov_b32 s3, 0x300000
    buffer_load_dword v40, v22, s[40:43], s3 offen
    s_mov_b32 s3, 0x302000
    buffer_load_dword v41, v22, s[40:43], s3 offen
    s_mov_b32 s3, 0x310000
    buffer_load_dword v42, v22, s[40:43], s3 offen
    s_mov_b32 s3, 0x312000
    buffer_load_dword v43, v22, s[40:43], s3 offen
    s_mov_b32 s3, 0x304000
    buffer_load_dword v44, v22, s[40:43], s3 offen
    s_mov_b32 s3, 0x306000
    buffer_load_dword v45, v22, s[40:43], s3 offen
    s_mov_b32 s3, 0x314000
    buffer_load_dword v46, v22, s[40:43], s3 offen
    s_mov_b32 s3, 0x316000
    buffer_load_dword v47, v22, s[40:43], s3 offen
    s_waitcnt vmcnt(48)
    v_perm_b32 v88, v49, v48, s71
    v_accvgpr_write_b32 a168, v88
    v_perm_b32 v89, v51, v50, s71
    v_accvgpr_write_b32 a169, v89
    v_perm_b32 v90, v53, v52, s71
    v_accvgpr_write_b32 a170, v90
    v_perm_b32 v91, v55, v54, s71
    v_accvgpr_write_b32 a171, v91
    v_perm_b32 v92, v49, v48, s72
    v_accvgpr_write_b32 a176, v92
    v_perm_b32 v93, v51, v50, s72
    v_accvgpr_write_b32 a177, v93
    v_perm_b32 v94, v53, v52, s72
    v_accvgpr_write_b32 a178, v94
    v_perm_b32 v95, v55, v54, s72
    v_accvgpr_write_b32 a179, v95
    s_mov_b32 s3, 0x340000
    buffer_load_dword v48, v22, s[40:43], s3 offen
    s_mov_b32 s3, 0x342000
    buffer_load_dword v49, v22, s[40:43], s3 offen
    s_mov_b32 s3, 0x350000
    buffer_load_dword v50, v22, s[40:43], s3 offen
    s_mov_b32 s3, 0x352000
    buffer_load_dword v51, v22, s[40:43], s3 offen
    s_mov_b32 s3, 0x344000
    buffer_load_dword v52, v22, s[40:43], s3 offen
    s_mov_b32 s3, 0x346000
    buffer_load_dword v53, v22, s[40:43], s3 offen
    s_mov_b32 s3, 0x354000
    buffer_load_dword v54, v22, s[40:43], s3 offen
    s_mov_b32 s3, 0x356000
    buffer_load_dword v55, v22, s[40:43], s3 offen
    s_waitcnt vmcnt(48)
    v_perm_b32 v88, v57, v56, s71
    v_accvgpr_write_b32 a172, v88
    v_perm_b32 v89, v59, v58, s71
    v_accvgpr_write_b32 a173, v89
    v_perm_b32 v90, v61, v60, s71
    v_accvgpr_write_b32 a174, v90
    v_perm_b32 v91, v63, v62, s71
    v_accvgpr_write_b32 a175, v91
    v_perm_b32 v92, v57, v56, s72
    v_accvgpr_write_b32 a180, v92
    v_perm_b32 v93, v59, v58, s72
    v_accvgpr_write_b32 a181, v93
    v_perm_b32 v94, v61, v60, s72
    v_accvgpr_write_b32 a182, v94
    v_perm_b32 v95, v63, v62, s72
    v_accvgpr_write_b32 a183, v95
    s_mov_b32 s3, 0x300000
    buffer_load_dword v56, v22, s[44:47], s3 offen
    s_mov_b32 s3, 0x302000
    buffer_load_dword v57, v22, s[44:47], s3 offen
    s_mov_b32 s3, 0x310000
    buffer_load_dword v58, v22, s[44:47], s3 offen
    s_mov_b32 s3, 0x312000
    buffer_load_dword v59, v22, s[44:47], s3 offen
    s_mov_b32 s3, 0x304000
    buffer_load_dword v60, v22, s[44:47], s3 offen
    s_mov_b32 s3, 0x306000
    buffer_load_dword v61, v22, s[44:47], s3 offen
    s_mov_b32 s3, 0x314000
    buffer_load_dword v62, v22, s[44:47], s3 offen
    s_mov_b32 s3, 0x316000
    buffer_load_dword v63, v22, s[44:47], s3 offen
    s_waitcnt vmcnt(48)
    v_perm_b32 v88, v65, v64, s71
    v_accvgpr_write_b32 a184, v88
    v_perm_b32 v89, v67, v66, s71
    v_accvgpr_write_b32 a185, v89
    v_perm_b32 v90, v69, v68, s71
    v_accvgpr_write_b32 a186, v90
    v_perm_b32 v91, v71, v70, s71
    v_accvgpr_write_b32 a187, v91
    v_perm_b32 v92, v65, v64, s72
    v_perm_b32 v93, v67, v66, s72
    v_perm_b32 v94, v69, v68, s72
    v_perm_b32 v95, v71, v70, s72
    ds_write_b128 v3, v[92:95] offset:14336
    s_mov_b32 s3, 0x340000
    buffer_load_dword v64, v22, s[44:47], s3 offen
    s_mov_b32 s3, 0x342000
    buffer_load_dword v65, v22, s[44:47], s3 offen
    s_mov_b32 s3, 0x350000
    buffer_load_dword v66, v22, s[44:47], s3 offen
    s_mov_b32 s3, 0x352000
    buffer_load_dword v67, v22, s[44:47], s3 offen
    s_mov_b32 s3, 0x344000
    buffer_load_dword v68, v22, s[44:47], s3 offen
    s_mov_b32 s3, 0x346000
    buffer_load_dword v69, v22, s[44:47], s3 offen
    s_mov_b32 s3, 0x354000
    buffer_load_dword v70, v22, s[44:47], s3 offen
    s_mov_b32 s3, 0x356000
    buffer_load_dword v71, v22, s[44:47], s3 offen
    s_waitcnt vmcnt(48)
    v_perm_b32 v88, v73, v72, s71
    v_accvgpr_write_b32 a188, v88
    v_perm_b32 v89, v75, v74, s71
    v_accvgpr_write_b32 a189, v89
    v_perm_b32 v90, v77, v76, s71
    v_accvgpr_write_b32 a190, v90
    v_perm_b32 v91, v79, v78, s71
    v_accvgpr_write_b32 a191, v91
    v_perm_b32 v92, v73, v72, s72
    v_perm_b32 v93, v75, v74, s72
    v_perm_b32 v94, v77, v76, s72
    v_perm_b32 v95, v79, v78, s72
    ds_write_b128 v3, v[92:95] offset:15360
    s_mov_b32 s3, 0x300000
    buffer_load_dword v72, v22, s[48:51], s3 offen
    s_mov_b32 s3, 0x302000
    buffer_load_dword v73, v22, s[48:51], s3 offen
    s_mov_b32 s3, 0x310000
    buffer_load_dword v74, v22, s[48:51], s3 offen
    s_mov_b32 s3, 0x312000
    buffer_load_dword v75, v22, s[48:51], s3 offen
    s_mov_b32 s3, 0x304000
    buffer_load_dword v76, v22, s[48:51], s3 offen
    s_mov_b32 s3, 0x306000
    buffer_load_dword v77, v22, s[48:51], s3 offen
    s_mov_b32 s3, 0x314000
    buffer_load_dword v78, v22, s[48:51], s3 offen
    s_mov_b32 s3, 0x316000
    buffer_load_dword v79, v22, s[48:51], s3 offen
    s_waitcnt vmcnt(48)
    v_perm_b32 v88, v81, v80, s71
    v_perm_b32 v89, v83, v82, s71
    v_perm_b32 v90, v85, v84, s71
    v_perm_b32 v91, v87, v86, s71
    ds_write_b128 v3, v[88:91] offset:28672
    v_perm_b32 v92, v81, v80, s72
    v_perm_b32 v93, v83, v82, s72
    v_perm_b32 v94, v85, v84, s72
    v_perm_b32 v95, v87, v86, s72
    ds_write_b128 v3, v[92:95] offset:30720
    s_mov_b32 s3, 0x340000
    buffer_load_dword v80, v22, s[48:51], s3 offen
    s_mov_b32 s3, 0x342000
    buffer_load_dword v81, v22, s[48:51], s3 offen
    s_mov_b32 s3, 0x350000
    buffer_load_dword v82, v22, s[48:51], s3 offen
    s_mov_b32 s3, 0x352000
    buffer_load_dword v83, v22, s[48:51], s3 offen
    s_mov_b32 s3, 0x344000
    buffer_load_dword v84, v22, s[48:51], s3 offen
    s_mov_b32 s3, 0x346000
    buffer_load_dword v85, v22, s[48:51], s3 offen
    s_mov_b32 s3, 0x354000
    buffer_load_dword v86, v22, s[48:51], s3 offen
    s_mov_b32 s3, 0x356000
    buffer_load_dword v87, v22, s[48:51], s3 offen
    s_waitcnt vmcnt(48)
    v_perm_b32 v88, v33, v32, s71
    v_perm_b32 v89, v35, v34, s71
    v_perm_b32 v90, v37, v36, s71
    v_perm_b32 v91, v39, v38, s71
    ds_write_b128 v3, v[88:91] offset:29696
    v_perm_b32 v92, v33, v32, s72
    v_perm_b32 v93, v35, v34, s72
    v_perm_b32 v94, v37, v36, s72
    v_perm_b32 v95, v39, v38, s72
    ds_write_b128 v3, v[92:95] offset:31744
    s_mov_b32 s3, 0x380000
    buffer_load_dword v32, v22, s[40:43], s3 offen
    s_mov_b32 s3, 0x382000
    buffer_load_dword v33, v22, s[40:43], s3 offen
    s_mov_b32 s3, 0x390000
    buffer_load_dword v34, v22, s[40:43], s3 offen
    s_mov_b32 s3, 0x392000
    buffer_load_dword v35, v22, s[40:43], s3 offen
    s_mov_b32 s3, 0x384000
    buffer_load_dword v36, v22, s[40:43], s3 offen
    s_mov_b32 s3, 0x386000
    buffer_load_dword v37, v22, s[40:43], s3 offen
    s_mov_b32 s3, 0x394000
    buffer_load_dword v38, v22, s[40:43], s3 offen
    s_mov_b32 s3, 0x396000
    buffer_load_dword v39, v22, s[40:43], s3 offen
    s_waitcnt vmcnt(48)
    v_perm_b32 v88, v41, v40, s71
    v_accvgpr_write_b32 a0, v88
    v_perm_b32 v89, v43, v42, s71
    v_accvgpr_write_b32 a1, v89
    v_perm_b32 v90, v45, v44, s71
    v_accvgpr_write_b32 a2, v90
    v_perm_b32 v91, v47, v46, s71
    v_accvgpr_write_b32 a3, v91
    v_perm_b32 v92, v41, v40, s72
    v_accvgpr_write_b32 a8, v92
    v_perm_b32 v93, v43, v42, s72
    v_accvgpr_write_b32 a9, v93
    v_perm_b32 v94, v45, v44, s72
    v_accvgpr_write_b32 a10, v94
    v_perm_b32 v95, v47, v46, s72
    v_accvgpr_write_b32 a11, v95
    s_mov_b32 s3, 0x3c0000
    buffer_load_dword v40, v22, s[40:43], s3 offen
    s_mov_b32 s3, 0x3c2000
    buffer_load_dword v41, v22, s[40:43], s3 offen
    s_mov_b32 s3, 0x3d0000
    buffer_load_dword v42, v22, s[40:43], s3 offen
    s_mov_b32 s3, 0x3d2000
    buffer_load_dword v43, v22, s[40:43], s3 offen
    s_mov_b32 s3, 0x3c4000
    buffer_load_dword v44, v22, s[40:43], s3 offen
    s_mov_b32 s3, 0x3c6000
    buffer_load_dword v45, v22, s[40:43], s3 offen
    s_mov_b32 s3, 0x3d4000
    buffer_load_dword v46, v22, s[40:43], s3 offen
    s_mov_b32 s3, 0x3d6000
    buffer_load_dword v47, v22, s[40:43], s3 offen
    s_waitcnt vmcnt(48)
    v_perm_b32 v88, v49, v48, s71
    v_accvgpr_write_b32 a4, v88
    v_perm_b32 v89, v51, v50, s71
    v_accvgpr_write_b32 a5, v89
    v_perm_b32 v90, v53, v52, s71
    v_accvgpr_write_b32 a6, v90
    v_perm_b32 v91, v55, v54, s71
    v_accvgpr_write_b32 a7, v91
    v_perm_b32 v92, v49, v48, s72
    v_accvgpr_write_b32 a12, v92
    v_perm_b32 v93, v51, v50, s72
    v_accvgpr_write_b32 a13, v93
    v_perm_b32 v94, v53, v52, s72
    v_accvgpr_write_b32 a14, v94
    v_perm_b32 v95, v55, v54, s72
    v_accvgpr_write_b32 a15, v95
    s_mov_b32 s3, 0x380000
    buffer_load_dword v48, v22, s[44:47], s3 offen
    s_mov_b32 s3, 0x382000
    buffer_load_dword v49, v22, s[44:47], s3 offen
    s_mov_b32 s3, 0x390000
    buffer_load_dword v50, v22, s[44:47], s3 offen
    s_mov_b32 s3, 0x392000
    buffer_load_dword v51, v22, s[44:47], s3 offen
    s_mov_b32 s3, 0x384000
    buffer_load_dword v52, v22, s[44:47], s3 offen
    s_mov_b32 s3, 0x386000
    buffer_load_dword v53, v22, s[44:47], s3 offen
    s_mov_b32 s3, 0x394000
    buffer_load_dword v54, v22, s[44:47], s3 offen
    s_mov_b32 s3, 0x396000
    buffer_load_dword v55, v22, s[44:47], s3 offen
    s_waitcnt vmcnt(48)
    v_perm_b32 v88, v57, v56, s71
    v_accvgpr_write_b32 a16, v88
    v_perm_b32 v89, v59, v58, s71
    v_accvgpr_write_b32 a17, v89
    v_perm_b32 v90, v61, v60, s71
    v_accvgpr_write_b32 a18, v90
    v_perm_b32 v91, v63, v62, s71
    v_accvgpr_write_b32 a19, v91
    v_perm_b32 v92, v57, v56, s72
    v_perm_b32 v93, v59, v58, s72
    v_perm_b32 v94, v61, v60, s72
    v_perm_b32 v95, v63, v62, s72
    ds_write_b128 v3, v[92:95] offset:0
    s_mov_b32 s3, 0x3c0000
    buffer_load_dword v56, v22, s[44:47], s3 offen
    s_mov_b32 s3, 0x3c2000
    buffer_load_dword v57, v22, s[44:47], s3 offen
    s_mov_b32 s3, 0x3d0000
    buffer_load_dword v58, v22, s[44:47], s3 offen
    s_mov_b32 s3, 0x3d2000
    buffer_load_dword v59, v22, s[44:47], s3 offen
    s_mov_b32 s3, 0x3c4000
    buffer_load_dword v60, v22, s[44:47], s3 offen
    s_mov_b32 s3, 0x3c6000
    buffer_load_dword v61, v22, s[44:47], s3 offen
    s_mov_b32 s3, 0x3d4000
    buffer_load_dword v62, v22, s[44:47], s3 offen
    s_mov_b32 s3, 0x3d6000
    buffer_load_dword v63, v22, s[44:47], s3 offen
    s_waitcnt vmcnt(48)
    v_perm_b32 v88, v65, v64, s71
    v_accvgpr_write_b32 a20, v88
    v_perm_b32 v89, v67, v66, s71
    v_accvgpr_write_b32 a21, v89
    v_perm_b32 v90, v69, v68, s71
    v_accvgpr_write_b32 a22, v90
    v_perm_b32 v91, v71, v70, s71
    v_accvgpr_write_b32 a23, v91
    v_perm_b32 v92, v65, v64, s72
    v_perm_b32 v93, v67, v66, s72
    v_perm_b32 v94, v69, v68, s72
    v_perm_b32 v95, v71, v70, s72
    ds_write_b128 v3, v[92:95] offset:1024
    s_mov_b32 s3, 0x380000
    buffer_load_dword v64, v22, s[48:51], s3 offen
    s_mov_b32 s3, 0x382000
    buffer_load_dword v65, v22, s[48:51], s3 offen
    s_mov_b32 s3, 0x390000
    buffer_load_dword v66, v22, s[48:51], s3 offen
    s_mov_b32 s3, 0x392000
    buffer_load_dword v67, v22, s[48:51], s3 offen
    s_mov_b32 s3, 0x384000
    buffer_load_dword v68, v22, s[48:51], s3 offen
    s_mov_b32 s3, 0x386000
    buffer_load_dword v69, v22, s[48:51], s3 offen
    s_mov_b32 s3, 0x394000
    buffer_load_dword v70, v22, s[48:51], s3 offen
    s_mov_b32 s3, 0x396000
    buffer_load_dword v71, v22, s[48:51], s3 offen
    s_waitcnt vmcnt(48)
    v_perm_b32 v88, v73, v72, s71
    v_accvgpr_write_b32 a192, v88
    v_perm_b32 v89, v75, v74, s71
    v_accvgpr_write_b32 a193, v89
    v_perm_b32 v90, v77, v76, s71
    v_accvgpr_write_b32 a194, v90
    v_perm_b32 v91, v79, v78, s71
    v_accvgpr_write_b32 a195, v91
    v_perm_b32 v92, v73, v72, s72
    v_accvgpr_write_b32 a200, v92
    v_perm_b32 v93, v75, v74, s72
    v_accvgpr_write_b32 a201, v93
    v_perm_b32 v94, v77, v76, s72
    v_accvgpr_write_b32 a202, v94
    v_perm_b32 v95, v79, v78, s72
    v_accvgpr_write_b32 a203, v95
    s_mov_b32 s3, 0x3c0000
    buffer_load_dword v72, v22, s[48:51], s3 offen
    s_mov_b32 s3, 0x3c2000
    buffer_load_dword v73, v22, s[48:51], s3 offen
    s_mov_b32 s3, 0x3d0000
    buffer_load_dword v74, v22, s[48:51], s3 offen
    s_mov_b32 s3, 0x3d2000
    buffer_load_dword v75, v22, s[48:51], s3 offen
    s_mov_b32 s3, 0x3c4000
    buffer_load_dword v76, v22, s[48:51], s3 offen
    s_mov_b32 s3, 0x3c6000
    buffer_load_dword v77, v22, s[48:51], s3 offen
    s_mov_b32 s3, 0x3d4000
    buffer_load_dword v78, v22, s[48:51], s3 offen
    s_mov_b32 s3, 0x3d6000
    buffer_load_dword v79, v22, s[48:51], s3 offen
    s_waitcnt vmcnt(48)
    v_perm_b32 v88, v81, v80, s71
    v_accvgpr_write_b32 a196, v88
    v_perm_b32 v89, v83, v82, s71
    v_accvgpr_write_b32 a197, v89
    v_perm_b32 v90, v85, v84, s71
    v_accvgpr_write_b32 a198, v90
    v_perm_b32 v91, v87, v86, s71
    v_accvgpr_write_b32 a199, v91
    v_perm_b32 v92, v81, v80, s72
    v_accvgpr_write_b32 a204, v92
    v_perm_b32 v93, v83, v82, s72
    v_accvgpr_write_b32 a205, v93
    v_perm_b32 v94, v85, v84, s72
    v_accvgpr_write_b32 a206, v94
    v_perm_b32 v95, v87, v86, s72
    v_accvgpr_write_b32 a207, v95
    s_waitcnt vmcnt(40)
    v_perm_b32 v88, v33, v32, s71
    v_accvgpr_write_b32 a24, v88
    v_perm_b32 v89, v35, v34, s71
    v_accvgpr_write_b32 a25, v89
    v_perm_b32 v90, v37, v36, s71
    v_accvgpr_write_b32 a26, v90
    v_perm_b32 v91, v39, v38, s71
    v_accvgpr_write_b32 a27, v91
    v_perm_b32 v92, v33, v32, s72
    v_accvgpr_write_b32 a32, v92
    v_perm_b32 v93, v35, v34, s72
    v_accvgpr_write_b32 a33, v93
    v_perm_b32 v94, v37, v36, s72
    v_accvgpr_write_b32 a34, v94
    v_perm_b32 v95, v39, v38, s72
    v_accvgpr_write_b32 a35, v95
    s_waitcnt vmcnt(32)
    v_perm_b32 v88, v41, v40, s71
    v_accvgpr_write_b32 a28, v88
    v_perm_b32 v89, v43, v42, s71
    v_accvgpr_write_b32 a29, v89
    v_perm_b32 v90, v45, v44, s71
    v_accvgpr_write_b32 a30, v90
    v_perm_b32 v91, v47, v46, s71
    v_accvgpr_write_b32 a31, v91
    v_perm_b32 v92, v41, v40, s72
    v_accvgpr_write_b32 a36, v92
    v_perm_b32 v93, v43, v42, s72
    v_accvgpr_write_b32 a37, v93
    v_perm_b32 v94, v45, v44, s72
    v_accvgpr_write_b32 a38, v94
    v_perm_b32 v95, v47, v46, s72
    v_accvgpr_write_b32 a39, v95
    s_waitcnt vmcnt(24)
    v_perm_b32 v88, v49, v48, s71
    v_accvgpr_write_b32 a40, v88
    v_perm_b32 v89, v51, v50, s71
    v_accvgpr_write_b32 a41, v89
    v_perm_b32 v90, v53, v52, s71
    v_accvgpr_write_b32 a42, v90
    v_perm_b32 v91, v55, v54, s71
    v_accvgpr_write_b32 a43, v91
    v_perm_b32 v92, v49, v48, s72
    v_perm_b32 v93, v51, v50, s72
    v_perm_b32 v94, v53, v52, s72
    v_perm_b32 v95, v55, v54, s72
    ds_write_b128 v3, v[92:95] offset:2048
    s_waitcnt vmcnt(16)
    v_perm_b32 v88, v57, v56, s71
    v_accvgpr_write_b32 a44, v88
    v_perm_b32 v89, v59, v58, s71
    v_accvgpr_write_b32 a45, v89
    v_perm_b32 v90, v61, v60, s71
    v_accvgpr_write_b32 a46, v90
    v_perm_b32 v91, v63, v62, s71
    v_accvgpr_write_b32 a47, v91
    v_perm_b32 v92, v57, v56, s72
    v_perm_b32 v93, v59, v58, s72
    v_perm_b32 v94, v61, v60, s72
    v_perm_b32 v95, v63, v62, s72
    ds_write_b128 v3, v[92:95] offset:3072
    s_waitcnt vmcnt(8)
    v_perm_b32 v88, v65, v64, s71
    v_accvgpr_write_b32 a208, v88
    v_perm_b32 v89, v67, v66, s71
    v_accvgpr_write_b32 a209, v89
    v_perm_b32 v90, v69, v68, s71
    v_accvgpr_write_b32 a210, v90
    v_perm_b32 v91, v71, v70, s71
    v_accvgpr_write_b32 a211, v91
    v_perm_b32 v92, v65, v64, s72
    v_accvgpr_write_b32 a216, v92
    v_perm_b32 v93, v67, v66, s72
    v_accvgpr_write_b32 a217, v93
    v_perm_b32 v94, v69, v68, s72
    v_accvgpr_write_b32 a218, v94
    v_perm_b32 v95, v71, v70, s72
    v_accvgpr_write_b32 a219, v95
    s_waitcnt vmcnt(0)
    v_perm_b32 v88, v73, v72, s71
    v_accvgpr_write_b32 a212, v88
    v_perm_b32 v89, v75, v74, s71
    v_accvgpr_write_b32 a213, v89
    v_perm_b32 v90, v77, v76, s71
    v_accvgpr_write_b32 a214, v90
    v_perm_b32 v91, v79, v78, s71
    v_accvgpr_write_b32 a215, v91
    v_perm_b32 v92, v73, v72, s72
    v_accvgpr_write_b32 a220, v92
    v_perm_b32 v93, v75, v74, s72
    v_accvgpr_write_b32 a221, v93
    v_perm_b32 v94, v77, v76, s72
    v_accvgpr_write_b32 a222, v94
    v_perm_b32 v95, v79, v78, s72
    v_accvgpr_write_b32 a223, v95
Lcwe_312:
    s_nop 1
    s_cmp_lg_u32 s57, 0
    s_cbranch_scc1 Lcx_313
    s_cmp_lg_u32 s56, 0
    s_cbranch_scc1 Lda_314
    v_mov_b32 v120, 252
    v_mov_b32 v121, 1
    s_mov_b64 exec, 1
    buffer_atomic_add v121, v120, s[36:39], 0 offen
    s_mov_b64 exec, -1
Lda_314:
Lcx_313:
    s_mov_b32 s3, 0x0
    buffer_load_dwordx4 v[32:35], v23, s[52:55], s3 offen
    buffer_load_dwordx4 v[36:39], v23, s[52:55], s3 offen offset:1024
    s_mov_b32 s3, 0x800
    buffer_load_dwordx4 v[40:43], v23, s[52:55], s3 offen
    buffer_load_dwordx4 v[44:47], v23, s[52:55], s3 offen offset:1024
    s_mov_b32 s3, 0x1000
    buffer_load_dwordx4 v[48:51], v23, s[52:55], s3 offen
    buffer_load_dwordx4 v[52:55], v23, s[52:55], s3 offen offset:1024
    s_mov_b32 s3, 0x1800
    buffer_load_dwordx4 v[56:59], v23, s[52:55], s3 offen
    buffer_load_dwordx4 v[60:63], v23, s[52:55], s3 offen offset:1024
    s_mov_b32 s3, 0x8000
    buffer_load_dwordx4 v[64:67], v23, s[52:55], s3 offen
    buffer_load_dwordx4 v[68:71], v23, s[52:55], s3 offen offset:1024
    s_mov_b32 s3, 0x8800
    buffer_load_dwordx4 v[72:75], v23, s[52:55], s3 offen
    buffer_load_dwordx4 v[76:79], v23, s[52:55], s3 offen offset:1024
    s_mov_b32 s3, 0x9000
    buffer_load_dwordx4 v[80:83], v23, s[52:55], s3 offen
    buffer_load_dwordx4 v[84:87], v23, s[52:55], s3 offen offset:1024
    s_waitcnt vmcnt(12)
    v_perm_b32 v128, v36, v32, s71
    v_perm_b32 v144, v36, v32, s72
    v_perm_b32 v160, v37, v33, s71
    v_perm_b32 v176, v37, v33, s72
    v_perm_b32 v192, v38, v34, s71
    v_perm_b32 v208, v38, v34, s72
    v_perm_b32 v224, v39, v35, s71
    v_perm_b32 v240, v39, v35, s72
    s_mov_b32 s3, 0x9800
    buffer_load_dwordx4 v[32:35], v23, s[52:55], s3 offen
    buffer_load_dwordx4 v[36:39], v23, s[52:55], s3 offen offset:1024
    s_waitcnt vmcnt(12)
    v_perm_b32 v129, v44, v40, s71
    v_perm_b32 v145, v44, v40, s72
    v_perm_b32 v161, v45, v41, s71
    v_perm_b32 v177, v45, v41, s72
    v_perm_b32 v193, v46, v42, s71
    v_perm_b32 v209, v46, v42, s72
    v_perm_b32 v225, v47, v43, s71
    v_perm_b32 v241, v47, v43, s72
    s_mov_b32 s3, 0x10000
    buffer_load_dwordx4 v[40:43], v23, s[52:55], s3 offen
    buffer_load_dwordx4 v[44:47], v23, s[52:55], s3 offen offset:1024
    s_waitcnt vmcnt(12)
    v_perm_b32 v130, v52, v48, s71
    v_perm_b32 v146, v52, v48, s72
    v_perm_b32 v162, v53, v49, s71
    v_perm_b32 v178, v53, v49, s72
    v_perm_b32 v194, v54, v50, s71
    v_perm_b32 v210, v54, v50, s72
    v_perm_b32 v226, v55, v51, s71
    v_perm_b32 v242, v55, v51, s72
    s_mov_b32 s3, 0x10800
    buffer_load_dwordx4 v[48:51], v23, s[52:55], s3 offen
    buffer_load_dwordx4 v[52:55], v23, s[52:55], s3 offen offset:1024
    s_waitcnt vmcnt(12)
    v_perm_b32 v131, v60, v56, s71
    v_perm_b32 v147, v60, v56, s72
    v_perm_b32 v163, v61, v57, s71
    v_perm_b32 v179, v61, v57, s72
    v_perm_b32 v195, v62, v58, s71
    v_perm_b32 v211, v62, v58, s72
    v_perm_b32 v227, v63, v59, s71
    v_perm_b32 v243, v63, v59, s72
    s_mov_b32 s3, 0x11000
    buffer_load_dwordx4 v[56:59], v23, s[52:55], s3 offen
    buffer_load_dwordx4 v[60:63], v23, s[52:55], s3 offen offset:1024
    s_waitcnt vmcnt(12)
    v_perm_b32 v132, v68, v64, s71
    v_perm_b32 v148, v68, v64, s72
    v_perm_b32 v164, v69, v65, s71
    v_perm_b32 v180, v69, v65, s72
    v_perm_b32 v196, v70, v66, s71
    v_perm_b32 v212, v70, v66, s72
    v_perm_b32 v228, v71, v67, s71
    v_perm_b32 v244, v71, v67, s72
    s_mov_b32 s3, 0x11800
    buffer_load_dwordx4 v[64:67], v23, s[52:55], s3 offen
    buffer_load_dwordx4 v[68:71], v23, s[52:55], s3 offen offset:1024
    s_waitcnt vmcnt(12)
    v_perm_b32 v133, v76, v72, s71
    v_perm_b32 v149, v76, v72, s72
    v_perm_b32 v165, v77, v73, s71
    v_perm_b32 v181, v77, v73, s72
    v_perm_b32 v197, v78, v74, s71
    v_perm_b32 v213, v78, v74, s72
    v_perm_b32 v229, v79, v75, s71
    v_perm_b32 v245, v79, v75, s72
    s_mov_b32 s3, 0x18000
    buffer_load_dwordx4 v[72:75], v23, s[52:55], s3 offen
    buffer_load_dwordx4 v[76:79], v23, s[52:55], s3 offen offset:1024
    s_waitcnt vmcnt(12)
    v_perm_b32 v134, v84, v80, s71
    v_perm_b32 v150, v84, v80, s72
    v_perm_b32 v166, v85, v81, s71
    v_perm_b32 v182, v85, v81, s72
    v_perm_b32 v198, v86, v82, s71
    v_perm_b32 v214, v86, v82, s72
    v_perm_b32 v230, v87, v83, s71
    v_perm_b32 v246, v87, v83, s72
    s_mov_b32 s3, 0x18800
    buffer_load_dwordx4 v[80:83], v23, s[52:55], s3 offen
    buffer_load_dwordx4 v[84:87], v23, s[52:55], s3 offen offset:1024
    s_waitcnt vmcnt(12)
    v_perm_b32 v135, v36, v32, s71
    v_perm_b32 v151, v36, v32, s72
    v_perm_b32 v167, v37, v33, s71
    v_perm_b32 v183, v37, v33, s72
    v_perm_b32 v199, v38, v34, s71
    v_perm_b32 v215, v38, v34, s72
    v_perm_b32 v231, v39, v35, s71
    v_perm_b32 v247, v39, v35, s72
    s_mov_b32 s3, 0x19000
    buffer_load_dwordx4 v[32:35], v23, s[52:55], s3 offen
    buffer_load_dwordx4 v[36:39], v23, s[52:55], s3 offen offset:1024
    s_waitcnt vmcnt(12)
    v_perm_b32 v136, v44, v40, s71
    v_perm_b32 v152, v44, v40, s72
    v_perm_b32 v168, v45, v41, s71
    v_perm_b32 v184, v45, v41, s72
    v_perm_b32 v200, v46, v42, s71
    v_perm_b32 v216, v46, v42, s72
    v_perm_b32 v232, v47, v43, s71
    v_perm_b32 v248, v47, v43, s72
    s_mov_b32 s3, 0x19800
    buffer_load_dwordx4 v[40:43], v23, s[52:55], s3 offen
    buffer_load_dwordx4 v[44:47], v23, s[52:55], s3 offen offset:1024
    s_waitcnt vmcnt(12)
    v_perm_b32 v137, v52, v48, s71
    v_perm_b32 v153, v52, v48, s72
    v_perm_b32 v169, v53, v49, s71
    v_perm_b32 v185, v53, v49, s72
    v_perm_b32 v201, v54, v50, s71
    v_perm_b32 v217, v54, v50, s72
    v_perm_b32 v233, v55, v51, s71
    v_perm_b32 v249, v55, v51, s72
    s_waitcnt vmcnt(10)
    v_perm_b32 v138, v60, v56, s71
    v_perm_b32 v154, v60, v56, s72
    v_perm_b32 v170, v61, v57, s71
    v_perm_b32 v186, v61, v57, s72
    v_perm_b32 v202, v62, v58, s71
    v_perm_b32 v218, v62, v58, s72
    v_perm_b32 v234, v63, v59, s71
    v_perm_b32 v250, v63, v59, s72
    s_waitcnt vmcnt(8)
    v_perm_b32 v139, v68, v64, s71
    v_perm_b32 v155, v68, v64, s72
    v_perm_b32 v171, v69, v65, s71
    v_perm_b32 v187, v69, v65, s72
    v_perm_b32 v203, v70, v66, s71
    v_perm_b32 v219, v70, v66, s72
    v_perm_b32 v235, v71, v67, s71
    v_perm_b32 v251, v71, v67, s72
    s_waitcnt vmcnt(6)
    v_perm_b32 v140, v76, v72, s71
    v_perm_b32 v156, v76, v72, s72
    v_perm_b32 v172, v77, v73, s71
    v_perm_b32 v188, v77, v73, s72
    v_perm_b32 v204, v78, v74, s71
    v_perm_b32 v220, v78, v74, s72
    v_perm_b32 v236, v79, v75, s71
    v_perm_b32 v252, v79, v75, s72
    s_waitcnt vmcnt(4)
    v_perm_b32 v141, v84, v80, s71
    v_perm_b32 v157, v84, v80, s72
    v_perm_b32 v173, v85, v81, s71
    v_perm_b32 v189, v85, v81, s72
    v_perm_b32 v205, v86, v82, s71
    v_perm_b32 v221, v86, v82, s72
    v_perm_b32 v237, v87, v83, s71
    v_perm_b32 v253, v87, v83, s72
    s_waitcnt vmcnt(2)
    v_perm_b32 v142, v36, v32, s71
    v_perm_b32 v158, v36, v32, s72
    v_perm_b32 v174, v37, v33, s71
    v_perm_b32 v190, v37, v33, s72
    v_perm_b32 v206, v38, v34, s71
    v_perm_b32 v222, v38, v34, s72
    v_perm_b32 v238, v39, v35, s71
    v_perm_b32 v254, v39, v35, s72
    s_waitcnt vmcnt(0)
    v_perm_b32 v143, v44, v40, s71
    v_perm_b32 v159, v44, v40, s72
    v_perm_b32 v175, v45, v41, s71
    v_perm_b32 v191, v45, v41, s72
    v_perm_b32 v207, v46, v42, s71
    v_perm_b32 v223, v46, v42, s72
    v_perm_b32 v239, v47, v43, s71
    v_perm_b32 v255, v47, v43, s72
    s_cmp_lg_u32 s57, 0
    s_cbranch_scc1 Lcx_315
    s_cmp_lg_u32 s56, 0
    s_cbranch_scc1 Lda_316
    v_mov_b32 v120, 44
    v_mov_b32 v121, 1
    s_mov_b64 exec, 1
    buffer_atomic_add v121, v120, s[36:39], 0 offen
    s_mov_b64 exec, -1
Lda_316:
Lcx_315:
    v_and_b32 v20, 15, v1
    v_lshrrev_b32 v21, 4, v1
    v_and_b32 v22, 1, v1
    v_cmp_eq_u32 vcc, 1, v22
    v_mov_b32 v22, 0x44444444
    v_mov_b32 v23, 0xeeeeeeee
    v_cndmask_b32 v2, v22, v23, vcc
    v_lshlrev_b32 v24, 4, v1
    v_add_u32 v4, 0x20000, v24
    v_lshrrev_b32 v22, 3, v20
    s_lshl_b32 s61, s56, 1
    v_add_u32 v22, s61, v22
    v_and_b32 v22, 3, v22
    v_lshlrev_b32 v22, 8, v22
    v_lshlrev_b32 v23, 6, v21
    v_add_u32 v22, v22, v23
    v_and_b32 v23, 1, v20
    v_lshlrev_b32 v23, 4, v23
    v_add_u32 v22, v22, v23
    v_bfe_u32 v23, v20, 1, 2
    v_lshlrev_b32 v23, 2, v23
    v_add_u32 v22, v22, v23
    s_lshr_b32 s61, s56, 1
    s_lshl_b32 s61, s61, 10
    s_add_u32 s61, s61, 0x24000
    v_add_u32 v5, s61, v22
    v_mul_u32_u24 v22, 544, v21
    v_lshlrev_b32 v23, 2, v20
    v_add_u32 v22, v22, v23
    s_lshl_b32 s61, s56, 6
    s_add_u32 s61, s61, 0x25000
    v_add_u32 v6, s61, v22
    v_and_b32 v22, 7, v20
    v_mul_u32_u24 v22, 272, v22
    v_lshlrev_b32 v23, 4, v21
    v_add_u32 v22, v22, v23
    v_add_u32 v7, 0x25000, v22
    s_mul_i32 s62, s56, 1536
    s_add_u32 s62, s62, 0x25880
    v_add_u32 v10, s62, v24
    v_lshlrev_b32 v22, 6, v21
    v_bfe_u32 v23, v20, 1, 1
    v_lshlrev_b32 v23, 4, v23
    v_add_u32 v22, v22, v23
    v_bfe_u32 v23, v20, 2, 1
    v_lshlrev_b32 v23, 3, v23
    v_add_u32 v22, v22, v23
    v_lshrrev_b32 v23, 3, v20
    v_lshlrev_b32 v23, 8, v23
    v_add_u32 v22, v22, v23
    v_and_b32 v23, 1, v20
    v_lshlrev_b32 v23, 1, v23
    v_add_u32 v22, v22, v23
    s_add_u32 s61, s62, 512
    v_add_u32 v8, s61, v22
    v_bfe_u32 v22, v20, 2, 1
    v_lshlrev_b32 v22, 8, v22
    v_lshlrev_b32 v23, 6, v21
    v_add_u32 v22, v22, v23
    v_bfe_u32 v23, v20, 1, 1
    v_lshlrev_b32 v23, 3, v23
    v_add_u32 v22, v22, v23
    v_and_b32 v23, 1, v20
    v_lshlrev_b32 v23, 1, v23
    v_add_u32 v22, v22, v23
    v_add_u32 v22, s62, v22
    v_mov_b32 v23, 163000
    v_cmp_gt_u32 vcc, 8, v20
    s_nop 1
    v_cndmask_b32 v9, v23, v22, vcc
    s_lshl_b32 s61, s56, 11
    v_add_u32 v11, s61, v24
    v_lshrrev_b32 v22, 2, v20
    s_lshl_b32 s61, s56, 2
    v_add_u32 v22, s61, v22
    v_lshlrev_b32 v23, 1, v22
    v_add_u32 v23, s58, v23
    v_add_u32 v23, v23, v21
    v_and_b32 v23, 31, v23
    v_lshlrev_b32 v23, 6, v23
    v_lshlrev_b32 v22, 11, v22
    v_add_u32 v22, v22, v23
    v_lshlrev_b32 v23, 16, v21
    v_add_u32 v22, v22, v23
    v_and_b32 v23, 3, v20
    v_lshlrev_b32 v23, 4, v23
    v_add_u32 v12, v22, v23
    s_lshl_b32 s61, s58, 2
    s_add_u32 s61, s61, s56
    s_lshl_b32 s63, s61, 11
    s_sub_u32 s95, s63, 0x20000
    v_bfe_u32 v22, v20, 1, 1
    v_lshlrev_b32 v22, 8, v22
    v_and_b32 v23, 1, v20
    v_lshlrev_b32 v23, 4, v23
    v_add_u32 v22, v22, v23
    v_lshlrev_b32 v23, 3, v21
    v_add_u32 v22, v22, v23
    s_and_b32 s63, s61, 15
    s_lshl_b32 s63, s63, 9
    s_lshr_b32 s61, s61, 4
    s_lshl_b32 s61, s61, 5
    s_add_u32 s61, s61, s63
    v_add_u32 v14, s61, v22
    v_and_b32 v22, 7, v1
    v_mul_u32_u24 v22, 272, v22
    v_bfe_u32 v23, v1, 3, 2
    v_lshlrev_b32 v23, 4, v23
    v_add_u32 v22, v22, v23
    s_lshl_b32 s61, s56, 6
    s_add_u32 s61, s61, 0x25000
    v_add_u32 v15, s61, v22
    s_lshl_b32 s61, s58, 11
    s_lshl_b32 s63, s56, 9
    s_add_u32 s61, s61, s63
    v_add_u32 v16, s61, v24
    v_lshrrev_b32 v22, 1, v21
    v_lshlrev_b32 v22, 8, v22
    v_lshlrev_b32 v23, 4, v20
    v_add_u32 v22, v22, v23
    v_and_b32 v23, 1, v21
    v_lshlrev_b32 v23, 2, v23
    v_add_u32 v22, v22, v23
    s_add_u32 s61, s62, 1024
    v_add_u32 v17, s61, v22
    s_lshl_b32 s61, s56, 11
    s_lshl_b32 s63, s58, 13
    s_add_u32 s63, s61, s63
    v_add_u32 v18, s63, v24
    s_add_u32 s94, s61, 0x22000
    v_add_u32 v19, 0x20000, v11
    s_add_u32 s3, s56, 1
    s_and_b32 s3, s3, 3
    s_lshl_b32 s3, s3, 11
    s_add_u32 s3, s3, 0x20000
    v_add_u32 v0, s3, v24
    s_add_u32 s3, s56, 2
    s_and_b32 s3, s3, 3
    s_lshl_b32 s3, s3, 11
    s_add_u32 s3, s3, 0x20000
    v_add_u32 v11, s3, v24
    s_add_u32 s3, s56, 3
    s_and_b32 s3, s3, 3
    s_lshl_b32 s3, s3, 11
    s_add_u32 s3, s3, 0x20000
    v_add_u32 v13, s3, v24
    s_mov_b32 s60, s57
    s_lshl_b32 s61, s60, 20
    s_add_u32 s66, s61, 0x8c00000
    s_lshl_b32 s61, s60, 14
    s_add_u32 s67, s61, 0x8e00000
    s_lshl_b32 s68, s60, 24
    s_lshl_b32 s69, s60, 22
    s_lshl_b32 s61, s60, 16
    s_lshl_b32 s63, s58, 5
    s_add_u32 s61, s61, s63
    s_add_u32 s70, s61, 0x9000000
    s_lshl_b32 s61, s60, 5
    s_add_u32 s61, s61, s58
    s_lshl_b32 s61, s61, 7
    s_lshl_b32 s63, s56, 2
    s_add_u32 s61, s61, s63
    s_add_u32 s74, s61, 0x9020000
    s_mov_b32 s73, 0x3e0293ee
    v_mov_b64 v[24:25], 0
    v_mov_b64 v[26:27], 0
    ds_write_b128 v10, v[24:27]
    v_mov_b64 v[64:65], 0
    v_mov_b64 v[66:67], 0
    v_mov_b64 v[68:69], 0
    v_mov_b64 v[70:71], 0
    v_mov_b64 v[72:73], 0
    v_mov_b64 v[74:75], 0
    v_mov_b64 v[76:77], 0
    v_mov_b64 v[78:79], 0
    s_mov_b32 s40, s6
    s_and_b32 s41, s7, 0xffff
    s_mov_b32 s42, 0x2000
    s_mov_b32 s43, 0x20000
    v_bfe_u32 v22, v1, 1, 3
    v_lshlrev_b32 v22, 10, v22
    v_lshlrev_b32 v23, 5, v21
    v_add_u32 v22, v22, v23
    v_and_b32 v23, 1, v1
    v_lshlrev_b32 v23, 4, v23
    v_add_u32 v22, v22, v23
    s_lshl_b32 s61, s56, 8
    buffer_load_dwordx4 v[96:99], v22, s[40:43], s61 offen offset:0
    buffer_load_dwordx4 v[100:103], v22, s[40:43], s61 offen offset:128
    v_and_b32 v44, 15, v1
    v_mov_b32 v40, 0
    v_cmp_eq_u32 vcc, 0, v44
    v_mov_b32 v45, 0x3f80
    s_nop 0
    v_cndmask_b32 v40, v40, v45, vcc
    v_cmp_eq_u32 vcc, 1, v44
    v_mov_b32 v45, 0x3f800000
    s_nop 0
    v_cndmask_b32 v40, v40, v45, vcc
    v_mov_b32 v41, 0
    v_cmp_eq_u32 vcc, 2, v44
    v_mov_b32 v45, 0x3f80
    s_nop 0
    v_cndmask_b32 v41, v41, v45, vcc
    v_cmp_eq_u32 vcc, 3, v44
    v_mov_b32 v45, 0x3f800000
    s_nop 0
    v_cndmask_b32 v41, v41, v45, vcc
    v_mov_b32 v42, 0
    v_cmp_eq_u32 vcc, 4, v44
    v_mov_b32 v45, 0x3f80
    s_nop 0
    v_cndmask_b32 v42, v42, v45, vcc
    v_cmp_eq_u32 vcc, 5, v44
    v_mov_b32 v45, 0x3f800000
    s_nop 0
    v_cndmask_b32 v42, v42, v45, vcc
    v_mov_b32 v43, 0
    v_cmp_eq_u32 vcc, 6, v44
    v_mov_b32 v45, 0x3f80
    s_nop 0
    v_cndmask_b32 v43, v43, v45, vcc
    v_cmp_eq_u32 vcc, 7, v44
    v_mov_b32 v45, 0x3f800000
    s_nop 0
    v_cndmask_b32 v43, v43, v45, vcc
    ds_write_b128 v4, v[40:43] offset:28800
    s_waitcnt vmcnt(0)
    v_lshlrev_b32 v120, 2, v1
    s_cmp_lg_u32 s56, 0
    s_cbranch_scc1 Lcw_318
Lcw_317:
    buffer_load_dword v121, v120, s[36:39], 0 offen sc1
    s_add_u32 s99, s99, 1
    s_cmp_gt_u32 s99, 0x2dc6c0
    s_cbranch_scc0 Lto_319
    s_mov_b32 s3, 2
    s_branch L_abort
Lto_319:
    s_waitcnt vmcnt(0)
    v_readlane_b32 s3, v121, 8
    s_cmp_ge_u32 s3, 256
    s_cbranch_scc1 Lcw_320
    s_sleep 8
    s_branch Lcw_317
Lcw_320:
    v_readlane_b32 s3, v121, s57
    v_mov_b32 v120, 163836
    s_nop 0
    v_mov_b32 v121, s3
    ds_write_b32 v120, v121
    s_waitcnt lgkmcnt(0)
Lcw_318:
    s_barrier
    v_mov_b32 v120, 163836
    ds_read_b32 v121, v120
    s_waitcnt lgkmcnt(0)
    v_readfirstlane_b32 s3, v121
    s_cmp_lt_u32 s3, 32
    s_cselect_b32 s59, 1, 0
    s_barrier
    s_cmp_eq_u32 s59, 1
    s_cbranch_scc1 Lchs_321
    v_mov_b32 v32, -1
    v_mov_b32 v33, -1
    v_mov_b32 v34, -1
    v_mov_b32 v35, -1
    s_add_u32 s61, s66, 0x0
    buffer_store_dwordx4 v[32:35], v12, s[32:35], s61 offen
    s_add_u32 s61, s66, 0x8000
    buffer_store_dwordx4 v[32:35], v12, s[32:35], s61 offen
    s_add_u32 s61, s67, 0x0
    s_mov_b32 exec_lo, 0x000f000f
    s_mov_b32 exec_hi, 0
    buffer_store_dwordx2 v[32:33], v14, s[32:35], s61 offen
    s_mov_b64 exec, -1
    s_add_u32 s61, s66, 0x40000
    buffer_store_dwordx4 v[32:35], v12, s[32:35], s61 offen
    s_add_u32 s61, s66, 0x48000
    buffer_store_dwordx4 v[32:35], v12, s[32:35], s61 offen
    s_add_u32 s61, s67, 0x2000
    s_mov_b32 exec_lo, 0x000f000f
    s_mov_b32 exec_hi, 0
    buffer_store_dwordx2 v[32:33], v14, s[32:35], s61 offen
    s_mov_b64 exec, -1
Lchs_321:
    s_mov_b32 s64, 0
    s_mov_b32 s78, 0
    s_and_b32 s3, s64, 1
    s_lshl_b32 s61, s3, 18
    s_add_u32 s80, s61, s66
    s_add_u32 s81, s80, 0x8000
    s_lshl_b32 s3, s3, 13
    s_add_u32 s84, s3, s67
    s_xor_b32 s3, s3, 0x2000
    s_add_u32 s75, s3, s67
    s_add_u32 s98, s80, s95
    s_lshr_b32 s65, s64, 1
    s_and_b32 s65, s65, 1
    s_lshl_b32 s61, s64, 16
    s_add_u32 s61, s61, s69
    s_add_u32 s83, s61, 0x1800000
    s_add_u32 s82, s61, 0x1000000
    s_add_u32 s79, s64, 1
    s_min_u32 s79, s79, 63
    s_mov_b32 s91, 0x9200000
    s_mov_b32 s92, 0x9300000
    s_mov_b32 s86, 0x00ff00ff
    s_mov_b32 s87, 0x00ff00ff
    s_mov_b32 s88, 0x000f000f
    s_mov_b32 s89, 0
    v_and_b32 v22, 15, v1
    s_lshl_b32 s61, s56, 4
    v_add_u32 v22, s61, v22
    v_lshlrev_b32 v22, 7, v22
    s_lshl_b32 s61, s58, 13
    s_add_u32 s62, s61, 0x6000000
    s_add_u32 s61, s61, 0x4000000
    v_mov_b32 v23, s61
    v_mov_b32 v24, s62
    v_and_b32 v25, 16, v1
    v_cmp_eq_u32 vcc, 0, v25
    s_nop 1
    v_cndmask_b32 v23, v24, v23, vcc
    v_add_u32 v124, v22, v23
    v_mov_b32 v125, 0
    s_lshl_b32 s61, s60, 2
    s_add_u32 s61, s61, 48
    s_cmp_lg_u32 s56, 0
    s_cbranch_scc1 Ldw_323
    v_mov_b32 v22, s61
    s_mov_b64 exec, 1
Ldw_322:
    buffer_load_dword v23, v22, s[36:39], 0 offen sc1
    s_add_u32 s99, s99, 1
    s_cmp_gt_u32 s99, 0x2dc6c0
    s_cbranch_scc0 Lto_324
    s_mov_b32 s3, 13
    s_branch L_abort
Lto_324:
    s_waitcnt vmcnt(0)
    v_cmp_gt_u32 vcc, 32, v23
    s_cbranch_vccz Ldw_325
    s_sleep 2
    s_branch Ldw_322
Ldw_325:
    s_mov_b64 exec, -1
Ldw_323:
    s_barrier
    s_lshl_b32 s61, s64, 10
    s_add_u32 s61, s61, s70
    v_and_b32 v112, 7, v1
    v_lshlrev_b32 v112, 2, v112
Lkv_326:
    buffer_load_dword v113, v112, s[32:35], s61 offen sc1
    s_sleep 2
    s_add_u32 s99, s99, 1
    s_cmp_gt_u32 s99, 0x2dc6c0
    s_cbranch_scc0 Lto_327
    s_mov_b32 s3, 10
    s_branch L_abort
Lto_327:
    s_waitcnt vmcnt(0)
    v_cmp_eq_u32 vcc, 0, v113
    s_cbranch_vccnz Lkv_326
    s_lshl_b32 s76, s64, 18
    s_add_u32 s76, s76, s68
    s_add_u32 s77, s76, 0x6000000
    s_add_u32 s76, s76, 0x4000000
    s_mov_b32 m0, s94
    s_nop 0
    buffer_load_dwordx4 v18, s[32:35], s76 offen lds
    buffer_load_dwordx4 v18, s[32:35], s76 offen offset:1024 lds
    buffer_load_dwordx4 v[68:71], v18, s[32:35], s77 offen
    buffer_load_dwordx4 v[76:79], v18, s[32:35], s77 offen offset:1024
    v_mov_b64 v[32:33], 0
    v_mov_b64 v[34:35], 0
    v_mov_b64 v[36:37], 0
    v_mov_b64 v[38:39], 0
    v_mov_b64 v[40:41], 0
    v_mov_b64 v[42:43], 0
    v_mov_b64 v[44:45], 0
    v_mov_b64 v[46:47], 0
    v_mov_b64 v[112:113], 0
    v_mov_b64 v[114:115], 0
    v_mov_b64 v[116:117], 0
    v_mov_b64 v[118:119], 0
    v_mov_b64 v[120:121], 0
    v_mov_b64 v[122:123], 0
    s_waitcnt vmcnt(0)
    ds_read_b128 v[80:83], v3 offset:0
    ds_read_b128 v[84:87], v3 offset:1024
    ds_read_b128 v[88:91], v3 offset:2048
    ds_read_b128 v[92:95], v3 offset:3072
    v_mov_b64 v[48:49], 0
    v_mov_b64 v[50:51], 0
    v_mov_b64 v[52:53], 0
    v_mov_b64 v[54:55], 0
    s_cmp_eq_u32 s59, 1
    s_cbranch_scc1 Lchslow_328
Lch_329:
    ds_write_b128 v19, v[96:99] offset:0
    ds_write_b128 v19, v[100:103] offset:1024
    v_smfmac_f32_16x16x64_bf16 v[32:35], v[96:99], a[0:7], v2
    v_smfmac_f32_16x16x64_bf16 v[40:43], v[96:99], a[16:23], v2
    v_smfmac_f32_16x16x64_bf16 v[36:39], v[96:99], a[8:15], v2
    s_waitcnt lgkmcnt(0)
    v_smfmac_f32_16x16x64_bf16 v[44:47], v[96:99], v[80:87], v2
    s_barrier
    ds_read_b128 v[28:31], v0 offset:0
    ds_read_b128 v[20:23], v0 offset:1024
    ds_read_b128 v[24:27], v11 offset:0
    ds_read_b128 v[80:83], v3 offset:4096
    ds_read_b128 v[84:87], v3 offset:5120
    v_smfmac_f32_16x16x64_bf16 v[32:35], v[100:103], a[24:31], v2
    v_smfmac_f32_16x16x64_bf16 v[40:43], v[100:103], a[40:47], v2
    v_smfmac_f32_16x16x64_bf16 v[36:39], v[100:103], a[32:39], v2
    v_smfmac_f32_16x16x64_bf16 v[44:47], v[100:103], v[88:95], v2
    ds_read_b128 v[88:91], v3 offset:6144
    ds_read_b128 v[92:95], v3 offset:7168
    s_waitcnt lgkmcnt(6)
    v_smfmac_f32_16x16x64_bf16 v[32:35], v[28:31], a[48:55], v2
    v_smfmac_f32_16x16x64_bf16 v[40:43], v[28:31], a[64:71], v2
    v_smfmac_f32_16x16x64_bf16 v[36:39], v[28:31], a[56:63], v2
    s_waitcnt lgkmcnt(2)
    v_smfmac_f32_16x16x64_bf16 v[44:47], v[28:31], v[80:87], v2
    ds_read_b128 v[28:31], v11 offset:1024
    ds_read_b128 v[80:83], v3 offset:8192
    ds_read_b128 v[84:87], v3 offset:9216
    ds_read_b128 v[96:99], v4 offset:8192
    ds_read_b128 v[100:103], v4 offset:9216
    v_smfmac_f32_16x16x64_bf16 v[32:35], v[20:23], a[72:79], v2
    s_cmp_eq_u32 s78, 0
    s_cbranch_scc1 Lct_330
    s_lshl_b32 s3, s79, 18
    s_add_u32 s3, s3, s68
    buffer_load_dword v125, v124, s[32:35], s3 offen
Lct_330:
    v_smfmac_f32_16x16x64_bf16 v[40:43], v[20:23], a[88:95], v2
    v_smfmac_f32_16x16x64_bf16 v[36:39], v[20:23], a[80:87], v2
    s_waitcnt lgkmcnt(5)
    v_smfmac_f32_16x16x64_bf16 v[44:47], v[20:23], v[88:95], v2
    ds_read_b128 v[20:23], v13 offset:0
    ds_read_b128 v[88:91], v3 offset:10240
    ds_read_b128 v[92:95], v3 offset:11264
    v_smfmac_f32_16x16x64_bf16 v[32:35], v[24:27], a[96:103], v2
    v_smfmac_f32_16x16x64_bf16 v[40:43], v[24:27], a[112:119], v2
    s_add_u32 s3, s64, 2
    s_min_u32 s3, s3, 63
    s_lshl_b32 s3, s3, 10
    s_add_u32 s3, s3, s70
    v_and_b32 v56, 7, v1
    v_lshlrev_b32 v56, 2, v56
    buffer_load_dword v125, v56, s[32:35], s3 offen sc1
    v_smfmac_f32_16x16x64_bf16 v[36:39], v[24:27], a[104:111], v2
    s_waitcnt lgkmcnt(5)
    v_smfmac_f32_16x16x64_bf16 v[44:47], v[24:27], v[80:87], v2
    ds_read_b128 v[24:27], v13 offset:1024
    ds_read_b128 v[80:83], v3 offset:12288
    ds_read_b128 v[84:87], v3 offset:13312
    ds_read_b128 v[104:107], v4 offset:10240
    ds_read_b128 v[108:111], v4 offset:11264
    v_smfmac_f32_16x16x64_bf16 v[32:35], v[28:31], a[120:127], v2
    v_smfmac_f32_16x16x64_bf16 v[40:43], v[28:31], a[136:143], v2
    v_smfmac_f32_16x16x64_bf16 v[36:39], v[28:31], a[128:135], v2
    s_waitcnt lgkmcnt(5)
    v_smfmac_f32_16x16x64_bf16 v[44:47], v[28:31], v[88:95], v2
    ds_read_b128 v[88:91], v3 offset:14336
    ds_read_b128 v[92:95], v3 offset:15360
    ds_read_b128 v[28:31], v19 offset:0
    v_smfmac_f32_16x16x64_bf16 v[32:35], v[20:23], a[144:151], v2
    v_smfmac_f32_16x16x64_bf16 v[40:43], v[20:23], a[160:167], v2
    v_smfmac_f32_16x16x64_bf16 v[36:39], v[20:23], a[152:159], v2
    s_waitcnt lgkmcnt(5)
    v_smfmac_f32_16x16x64_bf16 v[44:47], v[20:23], v[80:87], v2
    ds_read_b128 v[20:23], v19 offset:1024
    v_smfmac_f32_16x16x64_bf16 v[32:35], v[24:27], a[168:175], v2
    v_smfmac_f32_16x16x64_bf16 v[40:43], v[24:27], a[184:191], v2
    v_smfmac_f32_16x16x64_bf16 v[36:39], v[24:27], a[176:183], v2
    s_waitcnt lgkmcnt(2)
    v_smfmac_f32_16x16x64_bf16 v[44:47], v[24:27], v[88:95], v2
    ds_read_b128 v[24:27], v0 offset:0
    ds_read_b128 v[80:83], v4 offset:12288
    ds_read_b128 v[84:87], v4 offset:13312
    ds_read_b128 v[88:91], v4 offset:14336
    ds_read_b128 v[92:95], v4 offset:15360
    s_waitcnt lgkmcnt(6)
    v_smfmac_f32_16x16x64_bf16 v[48:51], v[28:31], a[192:199], v2
    v_smfmac_f32_16x16x64_bf16 v[52:55], v[28:31], a[200:207], v2
    ds_read_b128 v[28:31], v0 offset:1024
    v_add_f32 v32, v32, v33
    v_add_f32 v34, v34, v35
    v_add_f32 v36, v36, v37
    v_add_f32 v38, v38, v39
    v_add_f32 v40, v40, v41
    v_add_f32 v42, v42, v43
    v_add_f32 v44, v44, v45
    v_add_f32 v46, v46, v47
    v_cvt_pk_bf16_f32 v56, v32, v36
    v_cvt_pk_bf16_f32 v58, v40, v44
    v_cvt_pk_bf16_f32 v57, v34, v38
    v_cvt_pk_bf16_f32 v59, v42, v46
    ds_write_b32 v5, v56 offset:0
    ds_write_b32 v6, v58 offset:0
    ds_write_b32 v5, v57 offset:32
    ds_write_b32 v6, v59 offset:272
    s_waitcnt lgkmcnt(10)
    v_smfmac_f32_16x16x64_bf16 v[48:51], v[20:23], a[208:215], v2
    v_smfmac_f32_16x16x64_bf16 v[52:55], v[20:23], a[216:223], v2
    ds_read_b128 v[20:23], v11 offset:0
    s_waitcnt lgkmcnt(1)
    s_barrier
    ds_read_b128 v[56:59], v4 offset:16384
    ds_read_b128 v[60:63], v4 offset:17408
    ds_read_b128 v[32:35], v7 offset:0
    ds_read_b128 v[36:39], v7 offset:64
    ds_read_b128 v[40:43], v7 offset:128
    ds_read_b128 v[44:47], v7 offset:192
    v_smfmac_f32_16x16x64_bf16 v[48:51], v[24:27], a[224:231], v2
    v_smfmac_f32_16x16x64_bf16 v[52:55], v[24:27], a[232:239], v2
    ds_read_b128 v[24:27], v11 offset:1024
    v_smfmac_f32_16x16x64_bf16 v[48:51], v[28:31], a[240:247], v2
    v_smfmac_f32_16x16x64_bf16 v[52:55], v[28:31], a[248:255], v2
    ds_read_b128 v[28:31], v13 offset:0
    s_waitcnt lgkmcnt(7)
    v_smfmac_f32_16x16x64_bf16 v[112:115], v[56:59], v[96:103], v2
    v_smfmac_f32_16x16x64_bf16 v[116:119], v[56:59], v[80:87], v2
    s_waitcnt lgkmcnt(6)
    v_smfmac_f32_16x16x64_bf16 v[112:115], v[60:63], v[104:111], v2
    v_smfmac_f32_16x16x64_bf16 v[116:119], v[60:63], v[88:95], v2
    s_waitcnt lgkmcnt(2)
    v_smfmac_f32_16x16x64_bf16 v[120:123], v[56:59], v[32:39], v2
    v_smfmac_f32_16x16x64_bf16 v[120:123], v[60:63], v[40:47], v2
    ds_read_b128 v[80:83], v3 offset:16384
    ds_read_b128 v[84:87], v3 offset:17408
    ds_read_b128 v[88:91], v3 offset:18432
    ds_read_b128 v[92:95], v3 offset:19456
    ds_read_b128 v[96:99], v3 offset:20480
    ds_read_b128 v[100:103], v3 offset:21504
    ds_read_b128 v[104:107], v3 offset:22528
    ds_read_b128 v[108:111], v3 offset:23552
    v_add_f32 v112, v112, v113
    v_add_f32 v114, v114, v115
    v_add_f32 v116, v116, v117
    v_add_f32 v118, v118, v119
    v_add_f32 v120, v120, v121
    v_add_f32 v122, v122, v123
    v_mov_b32 v33, 0xff800000
    v_cndmask_b32 v120, v33, v120, s[86:87]
    v_cndmask_b32 v122, v33, v122, s[86:87]
    v_max3_f32 v34, v112, v116, v120
    v_max3_f32 v35, v114, v118, v122
    s_waitcnt lgkmcnt(4)
    v_smfmac_f32_16x16x64_bf16 v[48:51], v[20:23], v[80:87], v2
    v_smfmac_f32_16x16x64_bf16 v[52:55], v[20:23], v[88:95], v2
    ds_read_b128 v[20:23], v13 offset:1024
    v_max_f32 v34, v34, v34 row_ror:8 row_mask:0xf bank_mask:0xf
    v_max_f32 v35, v35, v35 row_ror:8 row_mask:0xf bank_mask:0xf
    ds_read_b128 v[80:83], v3 offset:24576
    ds_read_b128 v[84:87], v3 offset:25600
    v_max_f32 v34, v34, v34 row_ror:4 row_mask:0xf bank_mask:0xf
    v_max_f32 v35, v35, v35 row_ror:4 row_mask:0xf bank_mask:0xf
    ds_read_b128 v[88:91], v3 offset:26624
    ds_read_b128 v[92:95], v3 offset:27648
    v_max_f32 v34, v34, v34 row_ror:2 row_mask:0xf bank_mask:0xf
    v_max_f32 v35, v35, v35 row_ror:2 row_mask:0xf bank_mask:0xf
    s_waitcnt lgkmcnt(5)
    v_smfmac_f32_16x16x64_bf16 v[48:51], v[24:27], v[96:103], v2
    v_smfmac_f32_16x16x64_bf16 v[52:55], v[24:27], v[104:111], v2
    v_max_f32 v34, v34, v34 row_ror:1 row_mask:0xf bank_mask:0xf
    v_max_f32 v35, v35, v35 row_ror:1 row_mask:0xf bank_mask:0xf
    v_mul_f32 v34, s73, v34
    v_mul_f32 v35, s73, v35
    ds_read_b128 v[96:99], v3 offset:28672
    ds_read_b128 v[100:103], v3 offset:29696
    v_fma_f32 v112, v112, s73, -v34
    v_fma_f32 v114, v114, s73, -v35
    v_fma_f32 v116, v116, s73, -v34
    v_fma_f32 v118, v118, s73, -v35
    v_fma_f32 v120, v120, s73, -v34
    v_fma_f32 v122, v122, s73, -v35
    ds_read_b128 v[104:107], v3 offset:30720
    ds_read_b128 v[108:111], v3 offset:31744
    v_exp_f32 v112, v112
    v_exp_f32 v114, v114
    v_exp_f32 v116, v116
    v_exp_f32 v118, v118
    v_exp_f32 v120, v120
    v_exp_f32 v122, v122
    s_waitcnt lgkmcnt(4)
    v_smfmac_f32_16x16x64_bf16 v[48:51], v[28:31], v[80:87], v2
    v_smfmac_f32_16x16x64_bf16 v[52:55], v[28:31], v[88:95], v2
    v_cvt_pk_bf16_f32 v36, v112, v114
    v_cvt_pk_bf16_f32 v37, v116, v118
    v_cvt_pk_bf16_f32 v38, v120, v122
    s_waitcnt lgkmcnt(0)
    v_smfmac_f32_16x16x64_bf16 v[48:51], v[20:23], v[96:103], v2
    v_smfmac_f32_16x16x64_bf16 v[52:55], v[20:23], v[104:111], v2
    ds_write_b16 v8, v36 offset:0
    ds_write_b16_d16_hi v8, v36 offset:32
    ds_write_b16 v8, v37 offset:4
    ds_write_b16_d16_hi v8, v37 offset:36
    ds_write_b16 v9, v38
    ds_write_b16_d16_hi v9, v38 offset:32
    ds_read_b128 v[56:59], v10
    ds_read_b128 v[60:63], v15
    v_add_f32 v40, v112, v116
    v_add_f32 v41, v114, v118
    v_add_f32 v40, v40, v120
    v_add_f32 v41, v41, v122
    v_mov_b64 v[112:113], 0
    v_mov_b64 v[114:115], 0
    v_mov_b64 v[116:117], 0
    v_mov_b64 v[118:119], 0
    v_add_f32 v48, v48, v49
    v_add_f32 v50, v50, v51
    v_add_f32 v52, v52, v53
    v_add_f32 v54, v54, v55
    v_cvt_pk_bf16_f32 v64, v48, v50
    v_cvt_pk_bf16_f32 v72, v52, v54
    v_add_f32 v40, v40, v40 row_ror:8 row_mask:0xf bank_mask:0xf
    v_add_f32 v41, v41, v41 row_ror:8 row_mask:0xf bank_mask:0xf
    s_waitcnt lgkmcnt(1)
    v_smfmac_f32_16x16x64_bf16 v[112:115], v[56:59], v[64:71], v2
    v_smfmac_f32_16x16x64_bf16 v[116:119], v[56:59], v[72:79], v2
    s_waitcnt lgkmcnt(0)
    s_mov_b32 exec_hi, 0
    buffer_store_dwordx4 v[60:63], v16, s[32:35], s82 offen sc1
    s_mov_b64 exec, -1
    v_add_f32 v40, v40, v40 row_ror:4 row_mask:0xf bank_mask:0xf
    v_add_f32 v41, v41, v41 row_ror:4 row_mask:0xf bank_mask:0xf
    ds_write_b32 v17, v64 offset:0
    v_add_f32 v40, v40, v40 row_ror:2 row_mask:0xf bank_mask:0xf
    v_add_f32 v41, v41, v41 row_ror:2 row_mask:0xf bank_mask:0xf
    ds_write_b32 v17, v72 offset:8
    v_add_f32 v40, v40, v40 row_ror:1 row_mask:0xf bank_mask:0xf
    v_add_f32 v41, v41, v41 row_ror:1 row_mask:0xf bank_mask:0xf
    v_rcp_f32 v40, v40
    v_rcp_f32 v41, v41
    v_add_f32 v112, v112, v113
    v_add_f32 v114, v114, v115
    v_add_f32 v116, v116, v117
    v_add_f32 v118, v118, v119
    v_mul_f32 v112, v112, v40
    v_mul_f32 v114, v114, v41
    v_mul_f32 v116, v116, v40
    v_mul_f32 v118, v118, v41
    v_cvt_pk_bf16_f32 v32, v112, v116
    ds_write_b32 v5, v32 offset:2048
    v_cvt_pk_bf16_f32 v33, v114, v118
    ds_write_b32 v5, v33 offset:2080
    ds_read_b128 v[56:59], v10 offset:1024
    v_mov_b64 v[80:81], 0
    v_mov_b64 v[82:83], 0
    v_mov_b64 v[84:85], 0
    v_mov_b64 v[86:87], 0
    v_mov_b64 v[88:89], 0
    v_mov_b64 v[90:91], 0
    v_mov_b64 v[92:93], 0
    v_mov_b64 v[94:95], 0
    s_waitcnt lgkmcnt(1)
    s_barrier
    ds_read_b128 v[20:23], v4 offset:18432
    ds_read_b128 v[24:27], v4 offset:19456
    ds_read_b128 v[28:31], v4 offset:28800
    s_waitcnt lgkmcnt(3)
    s_mov_b32 exec_hi, 0
    buffer_store_dwordx4 v[56:59], v16, s[32:35], s83 offen sc1
    s_mov_b64 exec, -1
    v_mov_b64 v[96:97], 0
    v_mov_b64 v[98:99], 0
    v_mov_b64 v[100:101], 0
    v_mov_b64 v[102:103], 0
    v_mov_b64 v[104:105], 0
    v_mov_b64 v[106:107], 0
    v_mov_b64 v[108:109], 0
    v_mov_b64 v[110:111], 0
    s_waitcnt lgkmcnt(2)
    v_smfmac_f32_16x16x64_bf16 v[80:83], v[20:23], v[128:135], v2
    v_smfmac_f32_16x16x64_bf16 v[84:87], v[20:23], v[144:151], v2
    v_smfmac_f32_16x16x64_bf16 v[88:91], v[20:23], v[160:167], v2
    v_smfmac_f32_16x16x64_bf16 v[92:95], v[20:23], v[176:183], v2
    v_smfmac_f32_16x16x64_bf16 v[96:99], v[20:23], v[192:199], v2
    v_smfmac_f32_16x16x64_bf16 v[100:103], v[20:23], v[208:215], v2
    v_smfmac_f32_16x16x64_bf16 v[104:107], v[20:23], v[224:231], v2
    v_smfmac_f32_16x16x64_bf16 v[108:111], v[20:23], v[240:247], v2
    s_cmp_eq_u32 s78, 0
    s_cbranch_scc1 Lck_331
    s_lshl_b32 s76, s79, 18
    s_add_u32 s76, s76, s68
    s_add_u32 s77, s76, 0x6000000
    s_add_u32 s76, s76, 0x4000000
    s_mov_b32 m0, s94
    s_nop 0
    buffer_load_dwordx4 v18, s[32:35], s76 offen lds
    buffer_load_dwordx4 v18, s[32:35], s76 offen offset:1024 lds
    buffer_load_dwordx4 v[68:71], v18, s[32:35], s77 offen
    buffer_load_dwordx4 v[76:79], v18, s[32:35], s77 offen offset:1024
Lck_331:
    s_waitcnt lgkmcnt(1)
    v_smfmac_f32_16x16x64_bf16 v[80:83], v[24:27], v[136:143], v2
    v_smfmac_f32_16x16x64_bf16 v[84:87], v[24:27], v[152:159], v2
    v_smfmac_f32_16x16x64_bf16 v[88:91], v[24:27], v[168:175], v2
    v_smfmac_f32_16x16x64_bf16 v[92:95], v[24:27], v[184:191], v2
    v_smfmac_f32_16x16x64_bf16 v[96:99], v[24:27], v[200:207], v2
    v_smfmac_f32_16x16x64_bf16 v[100:103], v[24:27], v[216:223], v2
    v_smfmac_f32_16x16x64_bf16 v[104:107], v[24:27], v[232:239], v2
    v_smfmac_f32_16x16x64_bf16 v[108:111], v[24:27], v[248:255], v2
    s_nop 0
    v_add_f32 v80, v80, v81
    v_add_f32 v82, v82, v83
    v_add_f32 v84, v84, v85
    v_add_f32 v86, v86, v87
    v_cvt_pk_bf16_f32 v32, v80, v84
    v_cvt_pk_bf16_f32 v36, v82, v86
    v_bfi_b32 v32, 1, s65, v32
    v_bfi_b32 v36, 1, s65, v36
    v_add_f32 v88, v88, v89
    v_add_f32 v90, v90, v91
    v_add_f32 v92, v92, v93
    v_add_f32 v94, v94, v95
    v_cvt_pk_bf16_f32 v33, v88, v92
    v_cvt_pk_bf16_f32 v37, v90, v94
    v_add_f32 v96, v96, v97
    v_add_f32 v98, v98, v99
    v_add_f32 v100, v100, v101
    v_add_f32 v102, v102, v103
    v_cvt_pk_bf16_f32 v34, v96, v100
    v_cvt_pk_bf16_f32 v38, v98, v102
    v_add_f32 v104, v104, v105
    v_add_f32 v106, v106, v107
    v_add_f32 v108, v108, v109
    v_add_f32 v110, v110, v111
    v_cvt_pk_bf16_f32 v35, v104, v108
    v_cvt_pk_bf16_f32 v39, v106, v110
    buffer_store_dwordx4 v[32:35], v12, s[32:35], s80 offen
    buffer_store_dwordx4 v[36:39], v12, s[32:35], s81 offen
    s_waitcnt lgkmcnt(0)
    s_cmp_eq_u32 s64, 63
    s_cbranch_scc1 Lchend_332
    v_mov_b64 v[40:41], 0
    v_mov_b64 v[42:43], 0
    v_mov_b64 v[44:45], 0
    v_mov_b64 v[46:47], 0
    v_mov_b64 v[116:117], 0
    v_mov_b64 v[118:119], 0
    v_mov_b64 v[120:121], 0
    v_mov_b64 v[122:123], 0
    v_mov_b64 v[48:49], 0
    v_mov_b64 v[50:51], 0
    v_mov_b64 v[52:53], 0
    v_mov_b64 v[54:55], 0
    s_sub_u32 s90, s75, 0x20000
    s_mov_b32 s91, s82
    s_mov_b32 s92, s83
    v_mov_b64 v[32:33], 0
    v_mov_b64 v[34:35], 0
    v_mov_b64 v[36:37], 0
    v_mov_b64 v[38:39], 0
Lchp_333:
    buffer_load_dwordx4 v[80:83], v4, s[32:35], s98 offen offset:0 sc1
    buffer_load_dwordx4 v[84:87], v4, s[32:35], s98 offen offset:1024 sc1
    s_add_u32 s99, s99, 1
    s_cmp_gt_u32 s99, 0x2dc6c0
    s_cbranch_scc0 Lto_334
    s_mov_b32 s3, 11
    s_branch L_abort
Lto_334:
    s_waitcnt vmcnt(0)
    v_mfma_f32_16x16x32_bf16 v[88:91], v[28:31], v[80:83], 0
    v_xor_b32 v112, s65, v80
    v_xor_b32 v113, s65, v84
    v_mfma_f32_16x16x32_bf16 v[88:91], v[28:31], v[84:87], v[88:91]
    v_or_b32 v112, v112, v113
    v_and_b32 v112, 1, v112
    v_cmp_ne_u32 vcc, 0, v112
    s_cbranch_vccnz Lchp_333
    s_nop 3
    v_add_f32 v88, v88, v88 row_ror:4 row_mask:0xf bank_mask:0xf
    v_add_f32 v89, v89, v89 row_ror:4 row_mask:0xf bank_mask:0xf
    v_add_f32 v90, v90, v90 row_ror:4 row_mask:0xf bank_mask:0xf
    v_add_f32 v91, v91, v91 row_ror:4 row_mask:0xf bank_mask:0xf
    v_add_f32 v88, v88, v88 row_ror:8 row_mask:0xf bank_mask:0xf
    v_add_f32 v89, v89, v89 row_ror:8 row_mask:0xf bank_mask:0xf
    v_add_f32 v90, v90, v90 row_ror:8 row_mask:0xf bank_mask:0xf
    v_add_f32 v91, v91, v91 row_ror:8 row_mask:0xf bank_mask:0xf
    v_cvt_pk_bf16_f32 v80, v88, v89
    v_cvt_pk_bf16_f32 v81, v90, v91
    v_min_u32 v80, -2, v80
    v_min_u32 v81, -2, v81
    s_mov_b64 exec, s[88:89]
    buffer_store_dwordx2 v[80:81], v14, s[32:35], s75 offen
    v_mov_b64 v[82:83], -1
    buffer_store_dwordx2 v[82:83], v14, s[32:35], s84 offen
    s_mov_b64 exec, -1
    s_cmp_lg_u32 s78, 0
    s_cbranch_scc1 Lcr_335
    s_lshl_b32 s61, s79, 10
    s_add_u32 s61, s61, s70
    v_and_b32 v112, 7, v1
    v_lshlrev_b32 v112, 2, v112
Lkv_336:
    buffer_load_dword v113, v112, s[32:35], s61 offen sc1
    s_sleep 2
    s_add_u32 s99, s99, 1
    s_cmp_gt_u32 s99, 0x2dc6c0
    s_cbranch_scc0 Lto_337
    s_mov_b32 s3, 10
    s_branch L_abort
Lto_337:
    s_waitcnt vmcnt(0)
    v_cmp_eq_u32 vcc, 0, v113
    s_cbranch_vccnz Lkv_336
    s_lshl_b32 s76, s79, 18
    s_add_u32 s76, s76, s68
    s_add_u32 s77, s76, 0x6000000
    s_add_u32 s76, s76, 0x4000000
    s_mov_b32 m0, s94
    s_nop 0
    buffer_load_dwordx4 v18, s[32:35], s76 offen lds
    buffer_load_dwordx4 v18, s[32:35], s76 offen offset:1024 lds
    buffer_load_dwordx4 v[68:71], v18, s[32:35], s77 offen
    buffer_load_dwordx4 v[76:79], v18, s[32:35], s77 offen offset:1024
Lcr_335:
    v_cmp_eq_u32 vcc, 0, v125
    s_and_b32 s3, vcc_lo, 0xff
    s_cselect_b32 s78, 0, 1
    s_add_u32 s64, s64, 1
    s_cmp_lg_u32 s64, 11
    s_cbranch_scc1 Lcq_338
    s_lshl_b32 s61, s60, 2
    s_add_u32 s61, s61, 80
    s_cmp_lg_u32 s56, 0
    s_cbranch_scc1 Ldw_340
    v_mov_b32 v112, s61
    s_mov_b64 exec, 1
Ldw_339:
    buffer_load_dword v113, v112, s[36:39], 0 offen sc1
    s_add_u32 s99, s99, 1
    s_cmp_gt_u32 s99, 0x2dc6c0
    s_cbranch_scc0 Lto_341
    s_mov_b32 s3, 14
    s_branch L_abort
Lto_341:
    s_waitcnt vmcnt(0)
    v_cmp_gt_u32 vcc, 32, v113
    s_cbranch_vccz Ldw_342
    s_sleep 1
    s_branch Ldw_339
Ldw_342:
    s_mov_b64 exec, -1
Ldw_340:
    s_barrier
Lcq_338:
    s_and_b32 s3, s64, 1
    s_lshl_b32 s61, s3, 18
    s_add_u32 s80, s61, s66
    s_add_u32 s81, s80, 0x8000
    s_lshl_b32 s3, s3, 13
    s_add_u32 s84, s3, s67
    s_xor_b32 s3, s3, 0x2000
    s_add_u32 s75, s3, s67
    s_add_u32 s98, s80, s95
    s_lshr_b32 s65, s64, 1
    s_and_b32 s65, s65, 1
    s_lshl_b32 s61, s64, 16
    s_add_u32 s61, s61, s69
    s_add_u32 s83, s61, 0x1800000
    s_add_u32 s82, s61, 0x1000000
    s_add_u32 s79, s64, 1
    s_min_u32 s79, s79, 63
    v_mov_b64 v[112:113], 0
    v_mov_b64 v[114:115], 0
    ds_read_b128 v[80:83], v3 offset:0
    ds_read_b128 v[84:87], v3 offset:1024
    ds_read_b128 v[88:91], v3 offset:2048
    ds_read_b128 v[92:95], v3 offset:3072
Lchg_343:
    buffer_load_dwordx4 v[96:99], v19, s[32:35], s90 offen offset:0 sc1
    buffer_load_dwordx4 v[100:103], v19, s[32:35], s90 offen offset:1024 sc1
    s_add_u32 s99, s99, 1
    s_cmp_gt_u32 s99, 0x2dc6c0
    s_cbranch_scc0 Lto_344
    s_mov_b32 s3, 12
    s_branch L_abort
Lto_344:
    s_waitcnt vmcnt(0)
    v_max3_u32 v104, v96, v98, v100
    v_max_u32 v104, v104, v102
    v_cmp_eq_u32 vcc, -1, v104
    s_cbranch_vccnz Lchg_343
    s_branch Lch_329
Lchend_332:
    s_waitcnt lgkmcnt(0)
    s_mov_b32 exec_hi, 0
    buffer_store_dwordx4 v[60:63], v16, s[32:35], s82 offen sc1
    buffer_store_dwordx4 v[56:59], v16, s[32:35], s83 offen sc1
    s_mov_b64 exec, -1
    s_branch L_exit
Lchslow_328:
Lch_345:
    ds_write_b128 v19, v[96:99] offset:0
    ds_write_b128 v19, v[100:103] offset:1024
    v_smfmac_f32_16x16x64_bf16 v[32:35], v[96:99], a[0:7], v2
    v_smfmac_f32_16x16x64_bf16 v[40:43], v[96:99], a[16:23], v2
    v_smfmac_f32_16x16x64_bf16 v[36:39], v[96:99], a[8:15], v2
    s_waitcnt lgkmcnt(0)
    v_smfmac_f32_16x16x64_bf16 v[44:47], v[96:99], v[80:87], v2
    s_barrier
    ds_read_b128 v[28:31], v0 offset:0
    ds_read_b128 v[20:23], v0 offset:1024
    ds_read_b128 v[24:27], v11 offset:0
    ds_read_b128 v[80:83], v3 offset:4096
    ds_read_b128 v[84:87], v3 offset:5120
    v_smfmac_f32_16x16x64_bf16 v[32:35], v[100:103], a[24:31], v2
    v_smfmac_f32_16x16x64_bf16 v[40:43], v[100:103], a[40:47], v2
    v_smfmac_f32_16x16x64_bf16 v[36:39], v[100:103], a[32:39], v2
    v_smfmac_f32_16x16x64_bf16 v[44:47], v[100:103], v[88:95], v2
    ds_read_b128 v[88:91], v3 offset:6144
    ds_read_b128 v[92:95], v3 offset:7168
    s_waitcnt lgkmcnt(6)
    v_smfmac_f32_16x16x64_bf16 v[32:35], v[28:31], a[48:55], v2
    v_smfmac_f32_16x16x64_bf16 v[40:43], v[28:31], a[64:71], v2
    v_smfmac_f32_16x16x64_bf16 v[36:39], v[28:31], a[56:63], v2
    s_waitcnt lgkmcnt(2)
    v_smfmac_f32_16x16x64_bf16 v[44:47], v[28:31], v[80:87], v2
    ds_read_b128 v[28:31], v11 offset:1024
    ds_read_b128 v[80:83], v3 offset:8192
    ds_read_b128 v[84:87], v3 offset:9216
    ds_read_b128 v[96:99], v4 offset:8192
    ds_read_b128 v[100:103], v4 offset:9216
    v_smfmac_f32_16x16x64_bf16 v[32:35], v[20:23], a[72:79], v2
    s_cmp_eq_u32 s78, 0
    s_cbranch_scc1 Lct_346
    s_lshl_b32 s3, s79, 18
    s_add_u32 s3, s3, s68
    buffer_load_dword v125, v124, s[32:35], s3 offen
Lct_346:
    v_smfmac_f32_16x16x64_bf16 v[40:43], v[20:23], a[88:95], v2
    v_smfmac_f32_16x16x64_bf16 v[36:39], v[20:23], a[80:87], v2
    s_waitcnt lgkmcnt(5)
    v_smfmac_f32_16x16x64_bf16 v[44:47], v[20:23], v[88:95], v2
    ds_read_b128 v[20:23], v13 offset:0
    ds_read_b128 v[88:91], v3 offset:10240
    ds_read_b128 v[92:95], v3 offset:11264
    v_smfmac_f32_16x16x64_bf16 v[32:35], v[24:27], a[96:103], v2
    v_smfmac_f32_16x16x64_bf16 v[40:43], v[24:27], a[112:119], v2
    s_add_u32 s3, s64, 2
    s_min_u32 s3, s3, 63
    s_lshl_b32 s3, s3, 10
    s_add_u32 s3, s3, s70
    v_and_b32 v56, 7, v1
    v_lshlrev_b32 v56, 2, v56
    buffer_load_dword v125, v56, s[32:35], s3 offen sc1
    v_smfmac_f32_16x16x64_bf16 v[36:39], v[24:27], a[104:111], v2
    s_waitcnt lgkmcnt(5)
    v_smfmac_f32_16x16x64_bf16 v[44:47], v[24:27], v[80:87], v2
    ds_read_b128 v[24:27], v13 offset:1024
    ds_read_b128 v[80:83], v3 offset:12288
    ds_read_b128 v[84:87], v3 offset:13312
    ds_read_b128 v[104:107], v4 offset:10240
    ds_read_b128 v[108:111], v4 offset:11264
    v_smfmac_f32_16x16x64_bf16 v[32:35], v[28:31], a[120:127], v2
    v_smfmac_f32_16x16x64_bf16 v[40:43], v[28:31], a[136:143], v2
    v_smfmac_f32_16x16x64_bf16 v[36:39], v[28:31], a[128:135], v2
    s_waitcnt lgkmcnt(5)
    v_smfmac_f32_16x16x64_bf16 v[44:47], v[28:31], v[88:95], v2
    ds_read_b128 v[88:91], v3 offset:14336
    ds_read_b128 v[92:95], v3 offset:15360
    ds_read_b128 v[28:31], v19 offset:0
    v_smfmac_f32_16x16x64_bf16 v[32:35], v[20:23], a[144:151], v2
    v_smfmac_f32_16x16x64_bf16 v[40:43], v[20:23], a[160:167], v2
    v_smfmac_f32_16x16x64_bf16 v[36:39], v[20:23], a[152:159], v2
    s_waitcnt lgkmcnt(5)
    v_smfmac_f32_16x16x64_bf16 v[44:47], v[20:23], v[80:87], v2
    ds_read_b128 v[20:23], v19 offset:1024
    v_smfmac_f32_16x16x64_bf16 v[32:35], v[24:27], a[168:175], v2
    v_smfmac_f32_16x16x64_bf16 v[40:43], v[24:27], a[184:191], v2
    v_smfmac_f32_16x16x64_bf16 v[36:39], v[24:27], a[176:183], v2
    s_waitcnt lgkmcnt(2)
    v_smfmac_f32_16x16x64_bf16 v[44:47], v[24:27], v[88:95], v2
    ds_read_b128 v[24:27], v0 offset:0
    ds_read_b128 v[80:83], v4 offset:12288
    ds_read_b128 v[84:87], v4 offset:13312
    ds_read_b128 v[88:91], v4 offset:14336
    ds_read_b128 v[92:95], v4 offset:15360
    s_waitcnt lgkmcnt(6)
    v_smfmac_f32_16x16x64_bf16 v[48:51], v[28:31], a[192:199], v2
    v_smfmac_f32_16x16x64_bf16 v[52:55], v[28:31], a[200:207], v2
    ds_read_b128 v[28:31], v0 offset:1024
    v_add_f32 v32, v32, v33
    v_add_f32 v34, v34, v35
    v_add_f32 v36, v36, v37
    v_add_f32 v38, v38, v39
    v_add_f32 v40, v40, v41
    v_add_f32 v42, v42, v43
    v_add_f32 v44, v44, v45
    v_add_f32 v46, v46, v47
    v_cvt_pk_bf16_f32 v56, v32, v36
    v_cvt_pk_bf16_f32 v58, v40, v44
    v_cvt_pk_bf16_f32 v57, v34, v38
    v_cvt_pk_bf16_f32 v59, v42, v46
    ds_write_b32 v5, v56 offset:0
    ds_write_b32 v6, v58 offset:0
    ds_write_b32 v5, v57 offset:32
    ds_write_b32 v6, v59 offset:272
    s_waitcnt lgkmcnt(10)
    v_smfmac_f32_16x16x64_bf16 v[48:51], v[20:23], a[208:215], v2
    v_smfmac_f32_16x16x64_bf16 v[52:55], v[20:23], a[216:223], v2
    ds_read_b128 v[20:23], v11 offset:0
    s_waitcnt lgkmcnt(1)
    s_barrier
    ds_read_b128 v[56:59], v4 offset:16384
    ds_read_b128 v[60:63], v4 offset:17408
    ds_read_b128 v[32:35], v7 offset:0
    ds_read_b128 v[36:39], v7 offset:64
    ds_read_b128 v[40:43], v7 offset:128
    ds_read_b128 v[44:47], v7 offset:192
    v_smfmac_f32_16x16x64_bf16 v[48:51], v[24:27], a[224:231], v2
    v_smfmac_f32_16x16x64_bf16 v[52:55], v[24:27], a[232:239], v2
    ds_read_b128 v[24:27], v11 offset:1024
    v_smfmac_f32_16x16x64_bf16 v[48:51], v[28:31], a[240:247], v2
    v_smfmac_f32_16x16x64_bf16 v[52:55], v[28:31], a[248:255], v2
    ds_read_b128 v[28:31], v13 offset:0
    s_waitcnt lgkmcnt(7)
    v_smfmac_f32_16x16x64_bf16 v[112:115], v[56:59], v[96:103], v2
    v_smfmac_f32_16x16x64_bf16 v[116:119], v[56:59], v[80:87], v2
    s_waitcnt lgkmcnt(6)
    v_smfmac_f32_16x16x64_bf16 v[112:115], v[60:63], v[104:111], v2
    v_smfmac_f32_16x16x64_bf16 v[116:119], v[60:63], v[88:95], v2
    s_waitcnt lgkmcnt(2)
    v_smfmac_f32_16x16x64_bf16 v[120:123], v[56:59], v[32:39], v2
    v_smfmac_f32_16x16x64_bf16 v[120:123], v[60:63], v[40:47], v2
    ds_read_b128 v[80:83], v3 offset:16384
    ds_read_b128 v[84:87], v3 offset:17408
    ds_read_b128 v[88:91], v3 offset:18432
    ds_read_b128 v[92:95], v3 offset:19456
    ds_read_b128 v[96:99], v3 offset:20480
    ds_read_b128 v[100:103], v3 offset:21504
    ds_read_b128 v[104:107], v3 offset:22528
    ds_read_b128 v[108:111], v3 offset:23552
    v_add_f32 v112, v112, v113
    v_add_f32 v114, v114, v115
    v_add_f32 v116, v116, v117
    v_add_f32 v118, v118, v119
    v_add_f32 v120, v120, v121
    v_add_f32 v122, v122, v123
    v_mov_b32 v33, 0xff800000
    v_cndmask_b32 v120, v33, v120, s[86:87]
    v_cndmask_b32 v122, v33, v122, s[86:87]
    v_max3_f32 v34, v112, v116, v120
    v_max3_f32 v35, v114, v118, v122
    s_waitcnt lgkmcnt(4)
    v_smfmac_f32_16x16x64_bf16 v[48:51], v[20:23], v[80:87], v2
    v_smfmac_f32_16x16x64_bf16 v[52:55], v[20:23], v[88:95], v2
    ds_read_b128 v[20:23], v13 offset:1024
    v_max_f32 v34, v34, v34 row_ror:8 row_mask:0xf bank_mask:0xf
    v_max_f32 v35, v35, v35 row_ror:8 row_mask:0xf bank_mask:0xf
    ds_read_b128 v[80:83], v3 offset:24576
    ds_read_b128 v[84:87], v3 offset:25600
    v_max_f32 v34, v34, v34 row_ror:4 row_mask:0xf bank_mask:0xf
    v_max_f32 v35, v35, v35 row_ror:4 row_mask:0xf bank_mask:0xf
    ds_read_b128 v[88:91], v3 offset:26624
    ds_read_b128 v[92:95], v3 offset:27648
    v_max_f32 v34, v34, v34 row_ror:2 row_mask:0xf bank_mask:0xf
    v_max_f32 v35, v35, v35 row_ror:2 row_mask:0xf bank_mask:0xf
    s_waitcnt lgkmcnt(5)
    v_smfmac_f32_16x16x64_bf16 v[48:51], v[24:27], v[96:103], v2
    v_smfmac_f32_16x16x64_bf16 v[52:55], v[24:27], v[104:111], v2
    v_max_f32 v34, v34, v34 row_ror:1 row_mask:0xf bank_mask:0xf
    v_max_f32 v35, v35, v35 row_ror:1 row_mask:0xf bank_mask:0xf
    v_mul_f32 v34, s73, v34
    v_mul_f32 v35, s73, v35
    ds_read_b128 v[96:99], v3 offset:28672
    ds_read_b128 v[100:103], v3 offset:29696
    v_fma_f32 v112, v112, s73, -v34
    v_fma_f32 v114, v114, s73, -v35
    v_fma_f32 v116, v116, s73, -v34
    v_fma_f32 v118, v118, s73, -v35
    v_fma_f32 v120, v120, s73, -v34
    v_fma_f32 v122, v122, s73, -v35
    ds_read_b128 v[104:107], v3 offset:30720
    ds_read_b128 v[108:111], v3 offset:31744
    v_exp_f32 v112, v112
    v_exp_f32 v114, v114
    v_exp_f32 v116, v116
    v_exp_f32 v118, v118
    v_exp_f32 v120, v120
    v_exp_f32 v122, v122
    s_waitcnt lgkmcnt(4)
    v_smfmac_f32_16x16x64_bf16 v[48:51], v[28:31], v[80:87], v2
    v_smfmac_f32_16x16x64_bf16 v[52:55], v[28:31], v[88:95], v2
    v_cvt_pk_bf16_f32 v36, v112, v114
    v_cvt_pk_bf16_f32 v37, v116, v118
    v_cvt_pk_bf16_f32 v38, v120, v122
    s_waitcnt lgkmcnt(0)
    v_smfmac_f32_16x16x64_bf16 v[48:51], v[20:23], v[96:103], v2
    v_smfmac_f32_16x16x64_bf16 v[52:55], v[20:23], v[104:111], v2
    ds_write_b16 v8, v36 offset:0
    ds_write_b16_d16_hi v8, v36 offset:32
    ds_write_b16 v8, v37 offset:4
    ds_write_b16_d16_hi v8, v37 offset:36
    ds_write_b16 v9, v38
    ds_write_b16_d16_hi v9, v38 offset:32
    ds_read_b128 v[56:59], v10
    ds_read_b128 v[60:63], v15
    v_add_f32 v40, v112, v116
    v_add_f32 v41, v114, v118
    v_add_f32 v40, v40, v120
    v_add_f32 v41, v41, v122
    v_mov_b64 v[112:113], 0
    v_mov_b64 v[114:115], 0
    v_mov_b64 v[116:117], 0
    v_mov_b64 v[118:119], 0
    v_add_f32 v48, v48, v49
    v_add_f32 v50, v50, v51
    v_add_f32 v52, v52, v53
    v_add_f32 v54, v54, v55
    v_cvt_pk_bf16_f32 v64, v48, v50
    v_cvt_pk_bf16_f32 v72, v52, v54
    v_add_f32 v40, v40, v40 row_ror:8 row_mask:0xf bank_mask:0xf
    v_add_f32 v41, v41, v41 row_ror:8 row_mask:0xf bank_mask:0xf
    s_waitcnt lgkmcnt(1)
    v_smfmac_f32_16x16x64_bf16 v[112:115], v[56:59], v[64:71], v2
    v_smfmac_f32_16x16x64_bf16 v[116:119], v[56:59], v[72:79], v2
    s_waitcnt lgkmcnt(0)
    s_mov_b32 exec_hi, 0
    buffer_store_dwordx4 v[60:63], v16, s[32:35], s82 offen sc1
    s_mov_b64 exec, -1
    v_add_f32 v40, v40, v40 row_ror:4 row_mask:0xf bank_mask:0xf
    v_add_f32 v41, v41, v41 row_ror:4 row_mask:0xf bank_mask:0xf
    ds_write_b32 v17, v64 offset:0
    v_add_f32 v40, v40, v40 row_ror:2 row_mask:0xf bank_mask:0xf
    v_add_f32 v41, v41, v41 row_ror:2 row_mask:0xf bank_mask:0xf
    ds_write_b32 v17, v72 offset:8
    v_add_f32 v40, v40, v40 row_ror:1 row_mask:0xf bank_mask:0xf
    v_add_f32 v41, v41, v41 row_ror:1 row_mask:0xf bank_mask:0xf
    v_rcp_f32 v40, v40
    v_rcp_f32 v41, v41
    v_add_f32 v112, v112, v113
    v_add_f32 v114, v114, v115
    v_add_f32 v116, v116, v117
    v_add_f32 v118, v118, v119
    v_mul_f32 v112, v112, v40
    v_mul_f32 v114, v114, v41
    v_mul_f32 v116, v116, v40
    v_mul_f32 v118, v118, v41
    v_cvt_pk_bf16_f32 v32, v112, v116
    ds_write_b32 v5, v32 offset:2048
    v_cvt_pk_bf16_f32 v33, v114, v118
    ds_write_b32 v5, v33 offset:2080
    ds_read_b128 v[56:59], v10 offset:1024
    v_mov_b64 v[80:81], 0
    v_mov_b64 v[82:83], 0
    v_mov_b64 v[84:85], 0
    v_mov_b64 v[86:87], 0
    v_mov_b64 v[88:89], 0
    v_mov_b64 v[90:91], 0
    v_mov_b64 v[92:93], 0
    v_mov_b64 v[94:95], 0
    s_waitcnt lgkmcnt(1)
    s_barrier
    ds_read_b128 v[20:23], v4 offset:18432
    ds_read_b128 v[24:27], v4 offset:19456
    ds_read_b128 v[28:31], v4 offset:28800
    s_waitcnt lgkmcnt(3)
    s_mov_b32 exec_hi, 0
    buffer_store_dwordx4 v[56:59], v16, s[32:35], s83 offen sc1
    s_mov_b64 exec, -1
    v_mov_b64 v[96:97], 0
    v_mov_b64 v[98:99], 0
    v_mov_b64 v[100:101], 0
    v_mov_b64 v[102:103], 0
    v_mov_b64 v[104:105], 0
    v_mov_b64 v[106:107], 0
    v_mov_b64 v[108:109], 0
    v_mov_b64 v[110:111], 0
    s_waitcnt lgkmcnt(2)
    v_smfmac_f32_16x16x64_bf16 v[80:83], v[20:23], v[128:135], v2
    v_smfmac_f32_16x16x64_bf16 v[84:87], v[20:23], v[144:151], v2
    v_smfmac_f32_16x16x64_bf16 v[88:91], v[20:23], v[160:167], v2
    v_smfmac_f32_16x16x64_bf16 v[92:95], v[20:23], v[176:183], v2
    v_smfmac_f32_16x16x64_bf16 v[96:99], v[20:23], v[192:199], v2
    v_smfmac_f32_16x16x64_bf16 v[100:103], v[20:23], v[208:215], v2
    v_smfmac_f32_16x16x64_bf16 v[104:107], v[20:23], v[224:231], v2
    v_smfmac_f32_16x16x64_bf16 v[108:111], v[20:23], v[240:247], v2
    s_cmp_eq_u32 s78, 0
    s_cbranch_scc1 Lck_347
    s_lshl_b32 s76, s79, 18
    s_add_u32 s76, s76, s68
    s_add_u32 s77, s76, 0x6000000
    s_add_u32 s76, s76, 0x4000000
    s_mov_b32 m0, s94
    s_nop 0
    buffer_load_dwordx4 v18, s[32:35], s76 offen lds
    buffer_load_dwordx4 v18, s[32:35], s76 offen offset:1024 lds
    buffer_load_dwordx4 v[68:71], v18, s[32:35], s77 offen
    buffer_load_dwordx4 v[76:79], v18, s[32:35], s77 offen offset:1024
Lck_347:
    s_waitcnt lgkmcnt(1)
    v_smfmac_f32_16x16x64_bf16 v[80:83], v[24:27], v[136:143], v2
    v_smfmac_f32_16x16x64_bf16 v[84:87], v[24:27], v[152:159], v2
    v_smfmac_f32_16x16x64_bf16 v[88:91], v[24:27], v[168:175], v2
    v_smfmac_f32_16x16x64_bf16 v[92:95], v[24:27], v[184:191], v2
    v_smfmac_f32_16x16x64_bf16 v[96:99], v[24:27], v[200:207], v2
    v_smfmac_f32_16x16x64_bf16 v[100:103], v[24:27], v[216:223], v2
    v_smfmac_f32_16x16x64_bf16 v[104:107], v[24:27], v[232:239], v2
    v_smfmac_f32_16x16x64_bf16 v[108:111], v[24:27], v[248:255], v2
    s_nop 0
    v_add_f32 v80, v80, v81
    v_add_f32 v82, v82, v83
    v_add_f32 v84, v84, v85
    v_add_f32 v86, v86, v87
    v_cvt_pk_bf16_f32 v32, v80, v84
    v_cvt_pk_bf16_f32 v36, v82, v86
    v_bfi_b32 v32, 1, s65, v32
    v_bfi_b32 v36, 1, s65, v36
    v_add_f32 v88, v88, v89
    v_add_f32 v90, v90, v91
    v_add_f32 v92, v92, v93
    v_add_f32 v94, v94, v95
    v_cvt_pk_bf16_f32 v33, v88, v92
    v_cvt_pk_bf16_f32 v37, v90, v94
    v_add_f32 v96, v96, v97
    v_add_f32 v98, v98, v99
    v_add_f32 v100, v100, v101
    v_add_f32 v102, v102, v103
    v_cvt_pk_bf16_f32 v34, v96, v100
    v_cvt_pk_bf16_f32 v38, v98, v102
    v_add_f32 v104, v104, v105
    v_add_f32 v106, v106, v107
    v_add_f32 v108, v108, v109
    v_add_f32 v110, v110, v111
    v_cvt_pk_bf16_f32 v35, v104, v108
    v_cvt_pk_bf16_f32 v39, v106, v110
    buffer_store_dwordx4 v[32:35], v12, s[32:35], s80 offen sc1
    buffer_store_dwordx4 v[36:39], v12, s[32:35], s81 offen sc1
    s_waitcnt lgkmcnt(0)
    s_cmp_eq_u32 s64, 63
    s_cbranch_scc1 Lchend_348
    v_mov_b64 v[40:41], 0
    v_mov_b64 v[42:43], 0
    v_mov_b64 v[44:45], 0
    v_mov_b64 v[46:47], 0
    v_mov_b64 v[116:117], 0
    v_mov_b64 v[118:119], 0
    v_mov_b64 v[120:121], 0
    v_mov_b64 v[122:123], 0
    v_mov_b64 v[48:49], 0
    v_mov_b64 v[50:51], 0
    v_mov_b64 v[52:53], 0
    v_mov_b64 v[54:55], 0
    s_sub_u32 s90, s75, 0x20000
    s_mov_b32 s91, s82
    s_mov_b32 s92, s83
    v_mov_b64 v[32:33], 0
    v_mov_b64 v[34:35], 0
    v_mov_b64 v[36:37], 0
    v_mov_b64 v[38:39], 0
Lchp_349:
    buffer_load_dwordx4 v[80:83], v4, s[32:35], s98 offen offset:0 sc1
    buffer_load_dwordx4 v[84:87], v4, s[32:35], s98 offen offset:1024 sc1
    s_add_u32 s99, s99, 1
    s_cmp_gt_u32 s99, 0x2dc6c0
    s_cbranch_scc0 Lto_350
    s_mov_b32 s3, 11
    s_branch L_abort
Lto_350:
    s_waitcnt vmcnt(0)
    v_mfma_f32_16x16x32_bf16 v[88:91], v[28:31], v[80:83], 0
    v_xor_b32 v112, s65, v80
    v_xor_b32 v113, s65, v84
    v_mfma_f32_16x16x32_bf16 v[88:91], v[28:31], v[84:87], v[88:91]
    v_or_b32 v112, v112, v113
    v_and_b32 v112, 1, v112
    v_cmp_ne_u32 vcc, 0, v112
    s_cbranch_vccnz Lchp_349
    s_nop 3
    v_add_f32 v88, v88, v88 row_ror:4 row_mask:0xf bank_mask:0xf
    v_add_f32 v89, v89, v89 row_ror:4 row_mask:0xf bank_mask:0xf
    v_add_f32 v90, v90, v90 row_ror:4 row_mask:0xf bank_mask:0xf
    v_add_f32 v91, v91, v91 row_ror:4 row_mask:0xf bank_mask:0xf
    v_add_f32 v88, v88, v88 row_ror:8 row_mask:0xf bank_mask:0xf
    v_add_f32 v89, v89, v89 row_ror:8 row_mask:0xf bank_mask:0xf
    v_add_f32 v90, v90, v90 row_ror:8 row_mask:0xf bank_mask:0xf
    v_add_f32 v91, v91, v91 row_ror:8 row_mask:0xf bank_mask:0xf
    v_cvt_pk_bf16_f32 v80, v88, v89
    v_cvt_pk_bf16_f32 v81, v90, v91
    v_min_u32 v80, -2, v80
    v_min_u32 v81, -2, v81
    s_mov_b64 exec, s[88:89]
    buffer_store_dwordx2 v[80:81], v14, s[32:35], s75 offen sc1
    v_mov_b64 v[82:83], -1
    buffer_store_dwordx2 v[82:83], v14, s[32:35], s84 offen sc1
    s_mov_b64 exec, -1
    s_cmp_lg_u32 s78, 0
    s_cbranch_scc1 Lcr_351
    s_lshl_b32 s61, s79, 10
    s_add_u32 s61, s61, s70
    v_and_b32 v112, 7, v1
    v_lshlrev_b32 v112, 2, v112
Lkv_352:
    buffer_load_dword v113, v112, s[32:35], s61 offen sc1
    s_sleep 2
    s_add_u32 s99, s99, 1
    s_cmp_gt_u32 s99, 0x2dc6c0
    s_cbranch_scc0 Lto_353
    s_mov_b32 s3, 10
    s_branch L_abort
Lto_353:
    s_waitcnt vmcnt(0)
    v_cmp_eq_u32 vcc, 0, v113
    s_cbranch_vccnz Lkv_352
    s_lshl_b32 s76, s79, 18
    s_add_u32 s76, s76, s68
    s_add_u32 s77, s76, 0x6000000
    s_add_u32 s76, s76, 0x4000000
    s_mov_b32 m0, s94
    s_nop 0
    buffer_load_dwordx4 v18, s[32:35], s76 offen lds
    buffer_load_dwordx4 v18, s[32:35], s76 offen offset:1024 lds
    buffer_load_dwordx4 v[68:71], v18, s[32:35], s77 offen
    buffer_load_dwordx4 v[76:79], v18, s[32:35], s77 offen offset:1024
Lcr_351:
    v_cmp_eq_u32 vcc, 0, v125
    s_and_b32 s3, vcc_lo, 0xff
    s_cselect_b32 s78, 0, 1
    s_add_u32 s64, s64, 1
    s_cmp_lg_u32 s64, 11
    s_cbranch_scc1 Lcq_354
    s_lshl_b32 s61, s60, 2
    s_add_u32 s61, s61, 80
    s_cmp_lg_u32 s56, 0
    s_cbranch_scc1 Ldw_356
    v_mov_b32 v112, s61
    s_mov_b64 exec, 1
Ldw_355:
    buffer_load_dword v113, v112, s[36:39], 0 offen sc1
    s_add_u32 s99, s99, 1
    s_cmp_gt_u32 s99, 0x2dc6c0
    s_cbranch_scc0 Lto_357
    s_mov_b32 s3, 14
    s_branch L_abort
Lto_357:
    s_waitcnt vmcnt(0)
    v_cmp_gt_u32 vcc, 32, v113
    s_cbranch_vccz Ldw_358
    s_sleep 1
    s_branch Ldw_355
Ldw_358:
    s_mov_b64 exec, -1
Ldw_356:
    s_barrier
Lcq_354:
    s_and_b32 s3, s64, 1
    s_lshl_b32 s61, s3, 18
    s_add_u32 s80, s61, s66
    s_add_u32 s81, s80, 0x8000
    s_lshl_b32 s3, s3, 13
    s_add_u32 s84, s3, s67
    s_xor_b32 s3, s3, 0x2000
    s_add_u32 s75, s3, s67
    s_add_u32 s98, s80, s95
    s_lshr_b32 s65, s64, 1
    s_and_b32 s65, s65, 1
    s_lshl_b32 s61, s64, 16
    s_add_u32 s61, s61, s69
    s_add_u32 s83, s61, 0x1800000
    s_add_u32 s82, s61, 0x1000000
    s_add_u32 s79, s64, 1
    s_min_u32 s79, s79, 63
    v_mov_b64 v[112:113], 0
    v_mov_b64 v[114:115], 0
    ds_read_b128 v[80:83], v3 offset:0
    ds_read_b128 v[84:87], v3 offset:1024
    ds_read_b128 v[88:91], v3 offset:2048
    ds_read_b128 v[92:95], v3 offset:3072
Lchg_359:
    buffer_load_dwordx4 v[96:99], v19, s[32:35], s90 offen offset:0 sc1
    buffer_load_dwordx4 v[100:103], v19, s[32:35], s90 offen offset:1024 sc1
    s_add_u32 s99, s99, 1
    s_cmp_gt_u32 s99, 0x2dc6c0
    s_cbranch_scc0 Lto_360
    s_mov_b32 s3, 12
    s_branch L_abort
Lto_360:
    s_waitcnt vmcnt(0)
    v_max3_u32 v104, v96, v98, v100
    v_max_u32 v104, v104, v102
    v_cmp_eq_u32 vcc, -1, v104
    s_cbranch_vccnz Lchg_359
    s_branch Lch_345
Lchend_348:
    s_waitcnt lgkmcnt(0)
    s_mov_b32 exec_hi, 0
    buffer_store_dwordx4 v[60:63], v16, s[32:35], s82 offen sc1
    buffer_store_dwordx4 v[56:59], v16, s[32:35], s83 offen sc1
    s_mov_b64 exec, -1
    s_branch L_exit
    s_branch L_exit
L_abort:
    s_mov_b64 exec, 1
    v_mov_b32 v1, 40
    v_mov_b32 v2, 1
    buffer_atomic_add v2, v1, s[36:39], 0 offen sc0
    s_lshl_b32 s3, s3, 8
    s_or_b32 s3, s3, s57
    s_lshl_b32 s3, s3, 8
    s_or_b32 s3, s3, s58
    s_lshl_b32 s3, s3, 2
    s_or_b32 s3, s3, s56
    s_lshl_b32 s3, s3, 6
    s_and_b32 s64, s64, 63
    s_or_b32 s3, s3, s64
    s_waitcnt vmcnt(0)
    v_lshlrev_b32 v2, 2, v2
    v_add_u32 v1, 128, v2
    v_mov_b32 v2, s3
    buffer_store_dword v2, v1, s[36:39], 0 offen sc1
L_exit:
    s_endpgm
.section .rodata,"a"
.p2align 6
.amdhsa_kernel interleave_layers__memory_aug_recurrent_mem_tr__swiglu_ffn__prompt_kernel
  .amdhsa_next_free_vgpr 512
  .amdhsa_next_free_sgpr 102
  .amdhsa_accum_offset 256
  .amdhsa_group_segment_fixed_size 0
  .amdhsa_kernarg_size 112
  .amdhsa_user_sgpr_count 2
  .amdhsa_user_sgpr_kernarg_segment_ptr 1
  .amdhsa_system_sgpr_workgroup_id_x 1
.end_amdhsa_kernel
```
